```python
import torch

def _softmax(x, axis=-1):
    return torch.softmax(x, dim=axis)

def _gelu(x):
    return torch.nn.functional.gelu(x, approximate='tanh')

def _silu(x):
    return torch.nn.functional.silu(x)

def _sigmoid(x):
    return torch.sigmoid(x)

def _layernorm(x, axis=-1, eps=1e-05):
    m = x.mean(dim=axis, keepdim=True)
    v = x.var(dim=axis, keepdim=True, unbiased=False)
    return (x - m) / torch.sqrt(v + eps)

def _scatter_add(tgt, idx, src, axis=0):
    return tgt.clone().index_add_(axis, idx, src)

def _segment_sum(src, seg, n):
    out = torch.zeros((n,) + src.shape[1:], dtype=src.dtype)
    return out.index_add_(0, seg, src)

def _pad(x, pw):
    flat = tuple((v for pair in reversed(pw) for v in pair))
    return torch.nn.functional.pad(x, flat)
kernel_name = 'concat_heads__linear_attn_block__memory_aug_recurrent_mem_tr__prompt'

def setup_inputs():

    _w = lambda a: (lambda t: t.to(torch.bfloat16) if t.is_floating_point() else t)(torch.as_tensor(a))

    def _A_setup():
        B, S, D = (1, 2048, 640)
        return {'x': _w((lambda *s: torch.randn(*s, dtype=torch.bfloat16) * 0.05)(B, S, D)), 'wqkv': _w((lambda *s: torch.randn(*s, dtype=torch.bfloat16) * 1.6)(D, 3 * D)), 'wo': _w((lambda *s: torch.randn(*s, dtype=torch.bfloat16) * 0.1)(D, D))}
    _A_in = _A_setup()

    def _B_setup():
        B, S, Dm = (1, 2048, 640)
        H, Dh = (32, 192)
        M, seg = (8, 32)
        seg = min(seg, S)
        S = S // seg * seg
        return {'x': _w((lambda *s: torch.randn(*s, dtype=torch.bfloat16) * 0.05)(B, S, Dm)), 'mem0': _w((lambda *s: torch.randn(*s, dtype=torch.bfloat16) * 0.8)(B, M, Dm)), 'Wq': _w((lambda *s: torch.randn(*s, dtype=torch.bfloat16) * 1.6)(Dm, H, Dh) * Dm ** (-0.5)), 'Wk': _w((lambda *s: torch.randn(*s, dtype=torch.bfloat16) * 1.6)(Dm, H, Dh) * Dm ** (-0.5)), 'Wv': _w((lambda *s: torch.randn(*s, dtype=torch.bfloat16) * 0.8)(Dm, H, Dh) * Dm ** (-0.5)), 'Wo': _w((lambda *s: torch.randn(*s, dtype=torch.bfloat16) * 0.8)(H, Dh, Dm) * (H * Dh) ** (-0.5)), 'seg_len': seg}
    _B_in = _B_setup()
    return {'A_x': _A_in['x'], 'A_wqkv': _A_in['wqkv'], 'A_wo': _A_in['wo'], 'B_x': _B_in['x'], 'B_mem0': _B_in['mem0'], 'B_Wq': _B_in['Wq'], 'B_Wk': _B_in['Wk'], 'B_Wv': _B_in['Wv'], 'B_Wo': _B_in['Wo'], 'B_seg_len': _B_in['seg_len']}

def reference(A_x, A_wqkv, A_wo, B_x, B_mem0, B_Wq, B_Wk, B_Wv, B_Wo, B_seg_len):

    def _A_ref(x, wqkv, wo):
        B, S, D = x.shape
        H = 32
        Dh = D // H
        qkv = (lambda x, *d: x.permute(*d))((x @ wqkv).reshape(B, S, 3, H, Dh), 2, 0, 3, 1, 4)
        q, k, v = (qkv[0], qkv[1], qkv[2])
        phi = lambda t: torch.where(t > 0, t + 1, torch.exp(t)) + 1e-06
        pq, pk = (phi(q), phi(k))
        kv = torch.einsum('bhsd,bhse->bhde', pk, v)
        z = torch.einsum('bhsd->bhd', pk)
        num = torch.einsum('bhqd,bhde->bhqe', pq, kv)
        den = torch.einsum('bhqd,bhd->bhq', pq, z)[..., None] + 1e-06
        o = num / den
        return (lambda x, *d: x.permute(*d))(o, 0, 2, 1, 3).reshape(B, S, D) @ wo

    def _B_ref(x, mem0, Wq, Wk, Wv, Wo, seg_len):
        B, S, Dm = x.shape
        H, Dh = (Wq.shape[1], Wq.shape[2])
        M = mem0.shape[1]
        scale = Dh ** (-0.5)
        n_seg = S // seg_len
        L = M + seg_len
        idx = torch.arange(L)
        mask = (idx[:, None] < M) | (idx[:, None] >= idx[None, :])
        mem = mem0
        outs = []
        for s in range(n_seg):
            xs = x[:, s * seg_len:(s + 1) * seg_len, :].clone()
            h = torch.concatenate([mem, xs], axis=1)
            q = torch.einsum('btd,dhe->bhte', h, Wq)
            k = torch.einsum('btd,dhe->bhte', h, Wk)
            v = torch.einsum('btd,dhe->bhte', h, Wv)
            scores = torch.einsum('bhqe,bhke->bhqk', q, k) * scale
            scores = torch.where(mask[None, None], scores, -1000000000.0)
            p = _softmax(scores, axis=-1)
            o = torch.einsum('bhqk,bhke->bhqe', p, v)
            o = torch.einsum('bhte,hed->btd', o, Wo)
            mem = o[:, :M, :].clone()
            outs.append(o[:, M:, :])
        return torch.concatenate(outs, axis=1)
    a = _A_ref(A_x, A_wqkv, A_wo)
    b = _B_ref(B_x, B_mem0, B_Wq, B_Wk, B_Wv, B_Wo, B_seg_len)
    return torch.concatenate([a, b], axis=-1)
```

```asm
; @launch grid=(256,1,1) block=(256,1,1) lds=147520
.amdgcn_target "amdgcn-amd-amdhsa--gfx950"
.text
.globl concat_heads__linear_attn_block__memory_aug_recurrent_mem_tr__prompt_kernel
.p2align 8
.type concat_heads__linear_attn_block__memory_aug_recurrent_mem_tr__prompt_kernel,@function
concat_heads__linear_attn_block__memory_aug_recurrent_mem_tr__prompt_kernel:
  s_cmp_ge_u32 s2, 256
  s_cbranch_scc1 K_END
  s_load_dwordx16 s[4:19], s[0:1], 0
  s_load_dwordx8 s[20:27], s[0:1], 64
  s_load_dwordx2 s[28:29], s[0:1], 96
  s_waitcnt lgkmcnt(0)
  s_mov_b32 s40, s28
  s_mov_b32 s41, s29
  s_mov_b32 s42, 268435456
  s_mov_b32 s43, 0x20000
  s_mov_b32 s44, s26
  s_mov_b32 s45, s27
  s_mov_b32 s46, 256
  s_mov_b32 s47, 0x20000
  v_lshrrev_b32 v1, 6, v0
  s_nop 0
  v_readfirstlane_b32 s48, v1
  s_nop 3
  s_cmp_eq_u32 s48, 0
  s_cbranch_scc1 K_NOPF
  s_getpc_b64 s[62:63]
K_PFPC:
  s_sub_u32 s62, s62, K_PFPC-concat_heads__linear_attn_block__memory_aug_recurrent_mem_tr__prompt_kernel
  s_subb_u32 s63, s63, 0
  s_sub_u32 s61, s48, 1
  s_mul_i32 s61, s61, 30720
  v_and_b32 v2, 63, v0
  v_lshlrev_b32 v2, 4, v2
  v_add_u32 v2, s61, v2
  s_mov_b32 s61, 0
K_PFL:
  global_load_dwordx4 v[8:11], v2, s[62:63]
  v_add_u32 v2, 1024, v2
  s_add_u32 s61, s61, 1
  s_cmp_lt_u32 s61, 30
  s_cbranch_scc1 K_PFL
  s_waitcnt vmcnt(0)
K_NOPF:
  s_getreg_b32 s70, hwreg(HW_REG_XCC_ID)
  s_and_b32 s70, s70, 7
  v_cmp_eq_u32 vcc, 0, v0
  s_and_saveexec_b64 s[72:73], vcc
  s_cbranch_execz K_NOAT
  s_lshl_b32 s71, s70, 2
  v_mov_b32 v1, 1
  v_mov_b32 v3, 1
  s_mov_b32 s74, 176
  buffer_atomic_add v1, off, s[44:47], s71 sc0
  buffer_atomic_add v3, off, s[44:47], s74 sc0
  s_waitcnt vmcnt(0)
  v_readfirstlane_b32 s71, v1
  v_readfirstlane_b32 s75, v3
  s_nop 3
  s_mov_b32 s76, 0
  s_cmp_lt_u32 s75, 128
  s_cbranch_scc1 K_DECIDE
  s_cmp_ge_u32 s70, 4
  s_cbranch_scc1 K_DECIDED
  s_cmp_ge_u32 s71, 32
  s_cbranch_scc1 K_DECIDED
K_DECIDE:
  s_mov_b32 s77, 20000
  s_mov_b32 s82, 0
K_DLOOP:
  s_mov_b32 s74, 0
  buffer_load_dwordx4 v[4:7], off, s[44:47], s74 sc1
  buffer_load_dwordx4 v[8:11], off, s[44:47], s74 offset:16 sc1
  s_mov_b32 s74, 176
  buffer_load_dwordx2 v[12:13], off, s[44:47], s74 sc1
  s_waitcnt vmcnt(0)
  v_readfirstlane_b32 s76, v13
  s_nop 3
  s_cmp_lg_u32 s76, 0
  s_cbranch_scc1 K_DECIDED
  v_min_u32 v4, v4, v5
  v_min_u32 v6, v6, v7
  v_min_u32 v4, v4, v6
  v_min_u32 v8, v8, v9
  v_min_u32 v10, v10, v11
  v_min_u32 v8, v8, v10
  s_nop 0
  v_readfirstlane_b32 s78, v4
  v_readfirstlane_b32 s79, v8
  v_readfirstlane_b32 s80, v12
  s_nop 3
  s_mov_b32 s81, 0
  s_cmp_ge_u32 s78, 32
  s_cbranch_scc0 K_NOTFAST
  s_cmp_ge_u32 s79, 1
  s_cbranch_scc0 K_NOTFAST
  s_mov_b32 s81, 1
  s_branch K_TRY
K_NOTFAST:
  s_cmp_ge_u32 s82, 256
  s_cselect_b32 s81, 2, 0
  s_mov_b32 s82, s80
  s_sub_u32 s77, s77, 1
  s_cselect_b32 s81, 2, s81
  s_cmp_eq_u32 s81, 0
  s_cbranch_scc0 K_TRY
  s_sleep 2
  s_branch K_DLOOP
K_TRY:
  v_mov_b32 v4, s81
  v_mov_b32 v5, 0
  s_mov_b32 s74, 180
  buffer_atomic_cmpswap v[4:5], off, s[44:47], s74 sc0
  s_waitcnt vmcnt(0)
  v_readfirstlane_b32 s76, v4
  s_nop 3
  s_cmp_eq_u32 s76, 0
  s_cselect_b32 s76, s81, s76
K_DECIDED:
  v_mov_b32 v4, s71
  v_mov_b32 v5, s75
  v_mov_b32 v6, s76
  v_mov_b32 v2, 147456
  ds_write_b96 v2, v[4:6]
  s_waitcnt lgkmcnt(0)
K_NOAT:
  s_mov_b64 exec, s[72:73]
  s_barrier
  v_mov_b32 v2, 147456
  ds_read_b96 v[4:6], v2
  s_waitcnt lgkmcnt(0)
  v_readfirstlane_b32 s71, v4
  v_readfirstlane_b32 s75, v5
  v_readfirstlane_b32 s76, v6
  s_barrier
  s_cmp_eq_u32 s76, 2
  s_cbranch_scc1 K_SLOWMODE
  s_cmp_ge_u32 s70, 4
  s_cbranch_scc1 K_OTHER
  s_cmp_ge_u32 s71, 32
  s_cbranch_scc1 WORKER_FAR
  s_lshl_b32 s49, s70, 1
  s_lshr_b32 s72, s71, 4
  s_add_u32 s49, s49, s72
  s_and_b32 s50, s71, 15
  s_mov_b32 s26, 0
  s_branch K_REC
K_SLOWMODE:
  s_cmp_ge_u32 s75, 128
  s_cbranch_scc1 WORKER_FAR
  s_lshr_b32 s49, s75, 4
  s_and_b32 s50, s75, 15
  s_mov_b32 s26, 1
  s_branch K_REC
WORKER_FAR:
  s_branch WORKER_T
K_REC:
  v_and_b32 v1, 63, v0
  v_lshrrev_b32 v15, 6, v0
  s_nop 0
  v_readfirstlane_b32 s48, v15
  s_lshr_b32 s61, s50, 2
  s_lshl_b32 s51, s49, 2
  s_add_u32 s51, s51, s61
  s_and_b32 s52, s50, 3
  s_mov_b32 s89, s50
  s_add_u32 s90, s50, 16
  s_add_u32 s91, s50, 32
  s_cmp_lt_u32 s50, 8
  s_cselect_b32 s54, 3, 2
  s_cselect_b32 s91, s91, s90
  s_lshl_b32 s65, s48, 4
  s_add_u32 s65, s65, s50
  s_mov_b32 s64, 300000
  v_lshrrev_b32 v16, 4, v1
  v_and_b32 v17, 15, v1
  v_and_b32 v18, 7, v1
  v_bfe_u32 v15, v1, 3, 1
  v_lshlrev_b32 v3, 4, v1
  s_lshl_b32 s61, s48, 10
  v_add_u32 v14, s61, v3
  v_and_b32 v4, 0x37, v1
  v_lshlrev_b32 v4, 4, v4
  v_lshl_add_u32 v4, v15, 11, v4
  v_lshl_add_u32 v5, v16, 3, v18
  v_lshlrev_b32 v82, 3, v5
  v_lshlrev_b32 v5, 4, v5
  s_mul_i32 s61, s48, 5120
  s_add_u32 s61, s61, 10240
  v_lshlrev_b32 v6, 9, v15
  v_add_u32 v6, v6, v5
  v_add_u32 v6, 256, v6
  v_add_u32 v6, s61, v6
  v_lshl_add_u32 v7, v15, 2, v82
  v_add_u32 v7, s61, v7
  v_lshrrev_b32 v8, 1, v16
  v_lshl_add_u32 v8, v18, 1, v8
  v_lshlrev_b32 v8, 4, v8
  v_and_b32 v9, 1, v16
  v_lshl_add_u32 v8, v9, 3, v8
  v_lshlrev_b32 v9, 11, v15
  v_add_u32 v9, v9, v5
  v_lshrrev_b32 v10, 2, v17
  v_lshlrev_b32 v10, 3, v10
  v_and_b32 v11, 3, v17
  v_add_u32 v10, v10, v11
  s_lshl_b32 s61, s48, 2
  s_sub_u32 s61, s61, 4
  s_max_i32 s61, s61, 0
  v_add_u32 v10, s61, v10
  v_lshlrev_b32 v10, 5, v10
  v_lshl_add_u32 v10, v16, 3, v10
  v_lshrrev_b32 v11, 1, v16
  v_lshlrev_b32 v11, 9, v11
  v_lshl_add_u32 v11, v17, 5, v11
  v_and_b32 v12, 1, v16
  v_lshl_add_u32 v11, v12, 4, v11
  v_lshlrev_b32 v12, 4, v17
  v_lshl_add_u32 v12, v16, 2, v12
  v_lshrrev_b32 v13, 2, v17
  v_lshlrev_b32 v13, 1, v13
  v_and_b32 v76, 1, v17
  v_add_u32 v13, v13, v76
  v_lshlrev_b32 v13, 5, v13
  v_lshl_add_u32 v13, v16, 3, v13
  v_lshlrev_b32 v76, 4, v17
  v_lshl_add_u32 v76, v16, 2, v76
  v_add_u32 v76, 10240, v76
  v_lshlrev_b32 v78, 5, v17
  v_lshl_add_u32 v78, v16, 3, v78
  v_add_u32 v78, 11776, v78
  v_lshrrev_b32 v77, 2, v17
  v_lshl_add_u32 v77, v16, 2, v77
  v_and_b32 v19, 3, v17
  v_lshlrev_b32 v19, 3, v19
  v_lshl_add_u32 v79, v77, 5, v19
  v_add_u32 v79, 11776, v79
  v_lshl_add_u32 v77, v77, 4, v19
  v_add_u32 v77, 10240, v77
  v_and_b32 v19, 1, v1
  v_cmp_eq_u32 vcc, 1, v19
  v_mov_b32 v19, 0x4444
  v_mov_b32 v20, 0xeeee
  s_nop 0
  v_cndmask_b32 v19, v19, v20, vcc
  v_cmp_gt_u32 vcc, 8, v17
  s_mov_b64 s[76:77], vcc
  v_and_b32 v15, 2, v17
  v_cmp_eq_u32 vcc, 0, v15
  s_mov_b64 s[78:79], vcc
  v_mov_b32 v20, -1
  v_mov_b32 v21, -1
  v_mov_b32 v22, -1
  v_mov_b32 v23, -1
  v_mov_b32 v133, 0
  v_mov_b32 v165, 0
  v_mov_b32 v167, 0
  v_mov_b32 v169, 0
  v_mov_b32 v180, -1
  v_mov_b32 v181, -1
  v_mov_b32 v182, -1
  v_mov_b32 v183, -1
  v_mov_b32 v170, -1
  v_mov_b32 v171, -1
  v_bfe_u32 v103, v1, 3, 1
  v_bfe_u32 v104, v1, 2, 2
  s_cmp_eq_u32 s48, 0
  s_cselect_b32 s61, 3, 2
  v_min_u32 v104, s61, v104
  v_mul_u32_u24 v104, 3072, v104
  v_and_b32 v105, 3, v1
  v_lshl_add_u32 v104, v105, 8, v104
  s_lshl_b32 s61, s48, 10
  s_add_u32 s61, s61, 4
  v_add_u32 v104, s61, v104
  v_mov_b32 v172, 0x3f803f80
  v_mov_b32 v173, 0x3f803f80
  v_mov_b32 v174, 0x3f803f80
  v_mov_b32 v175, 0x3f803f80
  s_mul_i32 s82, s50, 1280
  s_add_u32 s82, s82, 10240
  s_cmp_eq_u32 s48, 1
  s_cselect_b32 s61, 256, 0
  s_cmp_eq_u32 s48, 2
  s_cselect_b32 s61, 768, s61
  s_add_u32 s82, s82, s61
  s_lshr_b32 s61, s50, 2
  s_mul_i32 s30, s61, 3072
  s_mul_i32 s61, s52, 768
  s_add_u32 s30, s30, s61
  s_add_u32 s30, s30, 30720
  s_lshl_b32 s85, s65, 8
  s_cmp_eq_u32 s48, 2
  s_cselect_b32 s24, s91, s65
  s_mov_b32 s88, 0x3dd53b95
  s_min_u32 s61, s48, 2
  s_lshl_b32 s62, s61, 10
  v_add_u32 v106, s62, v3
  s_lshl_b32 s62, s61, 9
  v_add_u32 v107, s62, v79
  s_mul_i32 s80, s50, 1280
  s_add_u32 s80, s80, 10240
  v_lshrrev_b32 v2, 4, v1
  v_mul_u32_u24 v2, 655360, v2
  v_and_b32 v15, 15, v1
  v_lshl_add_u32 v2, v15, 4, v2
  v_mov_b32 v100, v10
  s_mul_i32 s92, s49, 43008
  s_add_u32 s92, s92, 178257920
  s_cmp_eq_u32 s48, 3
  s_cbranch_scc0 NI_1
  s_cmp_eq_u32 s26, 1
  s_cbranch_scc1 IS_2
  s_mov_b32 s61, 68
PW_4:
  buffer_load_dword v15, off, s[44:47], s61 sc1
  s_waitcnt vmcnt(0)
  v_cmp_eq_u32 vcc, 0, v15
  s_cbranch_vccz PD_5
  s_sleep 4
  s_sub_u32 s64, s64, 1
  s_cbranch_scc0 PW_4
  s_mov_b32 s64, 0
PD_5:
  v_readfirstlane_b32 s87, v15
  s_nop 3
  s_max_u32 s87, s87, 1
  s_sub_u32 s87, s87, 1
  s_xor_b32 s87, s87, 0
  s_branch IG_3
IS_2:
  s_mov_b32 s87, 0
IG_3:
  s_lshr_b32 s61, s65, 1
  s_lshl_b32 s61, s61, 14
  s_and_b32 s62, s65, 1
  s_lshl_b32 s62, s62, 12
  s_add_u32 s86, s61, s62
  s_lshl_b32 s62, s87, 13
  s_add_u32 s86, s86, s62
  s_lshl_b32 s62, s49, 9
  s_add_u32 s84, s86, s62
  s_lshr_b32 s61, s89, 1
  s_lshl_b32 s61, s61, 14
  s_and_b32 s62, s89, 1
  s_lshl_b32 s62, s62, 12
  s_add_u32 s31, s61, s62
  s_lshl_b32 s62, s87, 13
  s_add_u32 s31, s31, s62
  s_lshl_b32 s62, s49, 9
  s_add_u32 s31, s31, s62
  s_lshr_b32 s61, s90, 1
  s_lshl_b32 s61, s61, 14
  s_and_b32 s62, s90, 1
  s_lshl_b32 s62, s62, 12
  s_add_u32 s74, s61, s62
  s_lshl_b32 s62, s87, 13
  s_add_u32 s74, s74, s62
  s_lshl_b32 s62, s49, 9
  s_add_u32 s74, s74, s62
  s_lshr_b32 s61, s91, 1
  s_lshl_b32 s61, s61, 14
  s_and_b32 s62, s91, 1
  s_lshl_b32 s62, s62, 12
  s_add_u32 s75, s61, s62
  s_lshl_b32 s62, s87, 13
  s_add_u32 s75, s75, s62
  s_lshl_b32 s62, s49, 9
  s_add_u32 s75, s75, s62
  s_mov_b32 s93, s92
  s_add_u32 s93, s93, 0
  s_mov_b32 s94, 180355072
  s_mov_b64 exec, s[76:77]
  s_add_u32 s61, s93, s80
  buffer_store_dwordx2 v[20:21], v82, s[40:43], s61 offen sc1
  buffer_store_dwordx4 v[20:23], v5, s[40:43], s61 offen offset:256 sc1
  buffer_store_dwordx4 v[20:23], v5, s[40:43], s61 offen offset:768 sc1
  s_add_u32 s61, s30, s93
  buffer_store_dwordx2 v[20:21], v8, s[40:43], s61 offen offset:0 sc1
  buffer_store_dwordx2 v[20:21], v8, s[40:43], s61 offen offset:256 sc1
  buffer_store_dwordx2 v[20:21], v8, s[40:43], s61 offen offset:512 sc1
  s_add_u32 s61, s94, s31
  buffer_store_dwordx4 v[20:23], v5, s[40:43], s61 offen sc1
  s_lshl_b32 s61, s89, 8
  s_add_u32 s61, s61, s93
  buffer_store_dwordx2 v[20:21], v8, s[40:43], s61 offen sc1
  s_add_u32 s61, s94, s74
  buffer_store_dwordx4 v[20:23], v5, s[40:43], s61 offen sc1
  s_lshl_b32 s61, s90, 8
  s_add_u32 s61, s61, s93
  buffer_store_dwordx2 v[20:21], v8, s[40:43], s61 offen sc1
  s_add_u32 s61, s94, s75
  buffer_store_dwordx4 v[20:23], v5, s[40:43], s61 offen sc1
  s_lshl_b32 s61, s91, 8
  s_add_u32 s61, s61, s93
  buffer_store_dwordx2 v[20:21], v8, s[40:43], s61 offen sc1
  s_mov_b64 exec, -1
  s_mov_b32 s93, s92
  s_add_u32 s93, s93, 344064
  s_mov_b32 s94, 180682752
  s_mov_b64 exec, s[76:77]
  s_add_u32 s61, s93, s80
  buffer_store_dwordx2 v[20:21], v82, s[40:43], s61 offen sc1
  buffer_store_dwordx4 v[20:23], v5, s[40:43], s61 offen offset:256 sc1
  buffer_store_dwordx4 v[20:23], v5, s[40:43], s61 offen offset:768 sc1
  s_add_u32 s61, s30, s93
  buffer_store_dwordx2 v[20:21], v8, s[40:43], s61 offen offset:0 sc1
  buffer_store_dwordx2 v[20:21], v8, s[40:43], s61 offen offset:256 sc1
  buffer_store_dwordx2 v[20:21], v8, s[40:43], s61 offen offset:512 sc1
  s_add_u32 s61, s94, s31
  buffer_store_dwordx4 v[20:23], v5, s[40:43], s61 offen sc1
  s_lshl_b32 s61, s89, 8
  s_add_u32 s61, s61, s93
  buffer_store_dwordx2 v[20:21], v8, s[40:43], s61 offen sc1
  s_add_u32 s61, s94, s74
  buffer_store_dwordx4 v[20:23], v5, s[40:43], s61 offen sc1
  s_lshl_b32 s61, s90, 8
  s_add_u32 s61, s61, s93
  buffer_store_dwordx2 v[20:21], v8, s[40:43], s61 offen sc1
  s_add_u32 s61, s94, s75
  buffer_store_dwordx4 v[20:23], v5, s[40:43], s61 offen sc1
  s_lshl_b32 s61, s91, 8
  s_add_u32 s61, s61, s93
  buffer_store_dwordx2 v[20:21], v8, s[40:43], s61 offen sc1
  s_mov_b64 exec, -1
  s_mov_b32 s93, s92
  s_add_u32 s93, s93, 688128
  s_mov_b32 s94, 181010432
  s_mov_b64 exec, s[76:77]
  s_add_u32 s61, s93, s80
  buffer_store_dwordx2 v[20:21], v82, s[40:43], s61 offen sc1
  buffer_store_dwordx4 v[20:23], v5, s[40:43], s61 offen offset:256 sc1
  buffer_store_dwordx4 v[20:23], v5, s[40:43], s61 offen offset:768 sc1
  s_add_u32 s61, s30, s93
  buffer_store_dwordx2 v[20:21], v8, s[40:43], s61 offen offset:0 sc1
  buffer_store_dwordx2 v[20:21], v8, s[40:43], s61 offen offset:256 sc1
  buffer_store_dwordx2 v[20:21], v8, s[40:43], s61 offen offset:512 sc1
  s_add_u32 s61, s94, s31
  buffer_store_dwordx4 v[20:23], v5, s[40:43], s61 offen sc1
  s_lshl_b32 s61, s89, 8
  s_add_u32 s61, s61, s93
  buffer_store_dwordx2 v[20:21], v8, s[40:43], s61 offen sc1
  s_add_u32 s61, s94, s74
  buffer_store_dwordx4 v[20:23], v5, s[40:43], s61 offen sc1
  s_lshl_b32 s61, s90, 8
  s_add_u32 s61, s61, s93
  buffer_store_dwordx2 v[20:21], v8, s[40:43], s61 offen sc1
  s_add_u32 s61, s94, s75
  buffer_store_dwordx4 v[20:23], v5, s[40:43], s61 offen sc1
  s_lshl_b32 s61, s91, 8
  s_add_u32 s61, s61, s93
  buffer_store_dwordx2 v[20:21], v8, s[40:43], s61 offen sc1
  s_mov_b64 exec, -1
  s_mov_b32 s93, s92
  s_add_u32 s93, s93, 1032192
  s_mov_b32 s94, 181338112
  s_mov_b64 exec, s[76:77]
  s_add_u32 s61, s93, s80
  buffer_store_dwordx2 v[20:21], v82, s[40:43], s61 offen sc1
  buffer_store_dwordx4 v[20:23], v5, s[40:43], s61 offen offset:256 sc1
  buffer_store_dwordx4 v[20:23], v5, s[40:43], s61 offen offset:768 sc1
  s_add_u32 s61, s30, s93
  buffer_store_dwordx2 v[20:21], v8, s[40:43], s61 offen offset:0 sc1
  buffer_store_dwordx2 v[20:21], v8, s[40:43], s61 offen offset:256 sc1
  buffer_store_dwordx2 v[20:21], v8, s[40:43], s61 offen offset:512 sc1
  s_add_u32 s61, s94, s31
  buffer_store_dwordx4 v[20:23], v5, s[40:43], s61 offen sc1
  s_lshl_b32 s61, s89, 8
  s_add_u32 s61, s61, s93
  buffer_store_dwordx2 v[20:21], v8, s[40:43], s61 offen sc1
  s_add_u32 s61, s94, s74
  buffer_store_dwordx4 v[20:23], v5, s[40:43], s61 offen sc1
  s_lshl_b32 s61, s90, 8
  s_add_u32 s61, s61, s93
  buffer_store_dwordx2 v[20:21], v8, s[40:43], s61 offen sc1
  s_add_u32 s61, s94, s75
  buffer_store_dwordx4 v[20:23], v5, s[40:43], s61 offen sc1
  s_lshl_b32 s61, s91, 8
  s_add_u32 s61, s61, s93
  buffer_store_dwordx2 v[20:21], v8, s[40:43], s61 offen sc1
  s_mov_b64 exec, -1
  s_lshl_b32 s61, s49, 4
  s_add_u32 s61, s61, s50
  s_lshl_b32 s61, s61, 8
  s_add_u32 s61, s61, 182452224
  v_mov_b32 v15, 0
  s_mov_b64 exec, 1
  buffer_store_dword v15, off, s[40:43], s61 sc1
  s_mov_b64 exec, -1
  s_lshl_b32 s61, s49, 4
  s_add_u32 s61, s61, s50
  s_cmp_lt_u32 s61, 64
  s_cbranch_scc0 ZF_6
  s_lshl_b32 s61, s61, 8
  s_add_u32 s61, s61, 182517760
  v_mov_b32 v15, 0
  s_mov_b64 exec, 1
  buffer_store_dword v15, off, s[40:43], s61 sc1
  s_mov_b64 exec, -1
ZF_6:
  s_waitcnt vmcnt(0)
  s_mov_b64 exec, 1
  v_mov_b32 v15, 1
  s_mov_b32 s61, 64
  buffer_atomic_add v15, off, s[44:47], s61
  s_mov_b64 exec, -1
NI_1:
  v_and_b32 v15, 15, v1
  v_lshrrev_b32 v16, 4, v1
  v_lshrrev_b32 v17, 2, v15
  v_and_b32 v15, 3, v15
  v_lshlrev_b32 v15, 3, v15
  v_lshrrev_b32 v18, 1, v16
  v_lshlrev_b32 v18, 4, v18
  v_and_b32 v84, 1, v16
  v_lshl_add_u32 v18, v84, 2, v18
  v_add_u32 v18, v18, v17
  v_mul_u32_u24 v84, 96, v18
  v_add_u32 v84, v84, v15
  v_lshl_add_u32 v85, v18, 5, v15
  s_mul_i32 s63, s48, 18432
  s_add_u32 s63, s63, 73728
  v_add_u32 v85, s63, v85
  v_lshrrev_b32 v15, 1, v1
  v_and_b32 v16, 1, v1
  v_lshlrev_b32 v16, 4, v16
  v_mul_u32_u24 v87, 1280, v15
  v_add_u32 v87, v87, v16
  v_add_u32 v15, 0, v1
  v_mul_u32_u24 v16, 10923, v15
  v_lshrrev_b32 v16, 16, v16
  v_mul_u32_u24 v17, 6, v16
  v_sub_u32 v17, v15, v17
  v_mul_u32_u24 v16, 12288, v16
  v_lshl_add_u32 v24, v17, 4, v16
  v_add_u32 v15, 64, v1
  v_mul_u32_u24 v16, 10923, v15
  v_lshrrev_b32 v16, 16, v16
  v_mul_u32_u24 v17, 6, v16
  v_sub_u32 v17, v15, v17
  v_mul_u32_u24 v16, 12288, v16
  v_lshl_add_u32 v25, v17, 4, v16
  v_add_u32 v15, 128, v1
  v_mul_u32_u24 v16, 10923, v15
  v_lshrrev_b32 v16, 16, v16
  v_mul_u32_u24 v17, 6, v16
  v_sub_u32 v17, v15, v17
  v_mul_u32_u24 v16, 12288, v16
  v_lshl_add_u32 v26, v17, 4, v16
  v_add_u32 v15, 192, v1
  v_mul_u32_u24 v16, 10923, v15
  v_lshrrev_b32 v16, 16, v16
  v_mul_u32_u24 v17, 6, v16
  v_sub_u32 v17, v15, v17
  v_mul_u32_u24 v16, 12288, v16
  v_lshl_add_u32 v27, v17, 4, v16
  v_add_u32 v15, 256, v1
  v_mul_u32_u24 v16, 10923, v15
  v_lshrrev_b32 v16, 16, v16
  v_mul_u32_u24 v17, 6, v16
  v_sub_u32 v17, v15, v17
  v_mul_u32_u24 v16, 12288, v16
  v_lshl_add_u32 v28, v17, 4, v16
  v_add_u32 v15, 320, v1
  v_mul_u32_u24 v16, 10923, v15
  v_lshrrev_b32 v16, 16, v16
  v_mul_u32_u24 v17, 6, v16
  v_sub_u32 v17, v15, v17
  v_mul_u32_u24 v16, 12288, v16
  v_lshl_add_u32 v29, v17, 4, v16
  s_mov_b32 s32, s14
  s_mov_b32 s33, s15
  s_cmp_eq_u32 s48, 1
  s_cselect_b32 s32, s16, s32
  s_cselect_b32 s33, s17, s33
  s_cmp_eq_u32 s48, 2
  s_cselect_b32 s32, s18, s32
  s_cselect_b32 s33, s19, s33
  s_cmp_eq_u32 s48, 3
  s_cselect_b32 s32, s20, s32
  s_cselect_b32 s33, s21, s33
  s_mov_b32 s34, 7864320
  s_mov_b32 s35, 0x20000
  s_mul_i32 s61, s51, 384
  s_mul_i32 s62, s52, 96
  s_add_u32 s74, s61, s62
  s_mul_i32 s75, s48, 6144
  s_cmp_eq_u32 s48, 3
  s_cbranch_scc1 W3_7
  s_add_u32 m0, s75, 0
  s_nop 0
  buffer_load_dwordx4 v24, s[32:35], s74 offen lds
  s_add_u32 m0, s75, 1024
  s_nop 0
  buffer_load_dwordx4 v25, s[32:35], s74 offen lds
  s_add_u32 m0, s75, 2048
  s_nop 0
  buffer_load_dwordx4 v26, s[32:35], s74 offen lds
  s_add_u32 m0, s75, 3072
  s_nop 0
  buffer_load_dwordx4 v27, s[32:35], s74 offen lds
  s_add_u32 m0, s75, 4096
  s_nop 0
  buffer_load_dwordx4 v28, s[32:35], s74 offen lds
  s_add_u32 m0, s75, 5120
  s_nop 0
  buffer_load_dwordx4 v29, s[32:35], s74 offen lds
  s_add_u32 s74, s74, 786432
  s_add_u32 m0, s75, 18432
  s_nop 0
  buffer_load_dwordx4 v24, s[32:35], s74 offen lds
  s_add_u32 m0, s75, 19456
  s_nop 0
  buffer_load_dwordx4 v25, s[32:35], s74 offen lds
  s_add_u32 m0, s75, 20480
  s_nop 0
  buffer_load_dwordx4 v26, s[32:35], s74 offen lds
  s_add_u32 m0, s75, 21504
  s_nop 0
  buffer_load_dwordx4 v27, s[32:35], s74 offen lds
  s_add_u32 m0, s75, 22528
  s_nop 0
  buffer_load_dwordx4 v28, s[32:35], s74 offen lds
  s_add_u32 m0, s75, 23552
  s_nop 0
  buffer_load_dwordx4 v29, s[32:35], s74 offen lds
  s_add_u32 s74, s74, 786432
  s_add_u32 m0, s75, 36864
  s_nop 0
  buffer_load_dwordx4 v24, s[32:35], s74 offen lds
  s_add_u32 m0, s75, 37888
  s_nop 0
  buffer_load_dwordx4 v25, s[32:35], s74 offen lds
  s_add_u32 m0, s75, 38912
  s_nop 0
  buffer_load_dwordx4 v26, s[32:35], s74 offen lds
  s_add_u32 m0, s75, 39936
  s_nop 0
  buffer_load_dwordx4 v27, s[32:35], s74 offen lds
  s_add_u32 m0, s75, 40960
  s_nop 0
  buffer_load_dwordx4 v28, s[32:35], s74 offen lds
  s_add_u32 m0, s75, 41984
  s_nop 0
  buffer_load_dwordx4 v29, s[32:35], s74 offen lds
  s_add_u32 s74, s74, 786432
  s_add_u32 m0, s75, 55296
  s_nop 0
  buffer_load_dwordx4 v24, s[32:35], s74 offen lds
  s_add_u32 m0, s75, 56320
  s_nop 0
  buffer_load_dwordx4 v25, s[32:35], s74 offen lds
  s_add_u32 m0, s75, 57344
  s_nop 0
  buffer_load_dwordx4 v26, s[32:35], s74 offen lds
  s_add_u32 m0, s75, 58368
  s_nop 0
  buffer_load_dwordx4 v27, s[32:35], s74 offen lds
  s_add_u32 m0, s75, 59392
  s_nop 0
  buffer_load_dwordx4 v28, s[32:35], s74 offen lds
  s_add_u32 m0, s75, 60416
  s_nop 0
  buffer_load_dwordx4 v29, s[32:35], s74 offen lds
  s_add_u32 s74, s74, 786432
  s_branch WJ_8
W3_7:
  s_lshl_b32 s61, s49, 2
  s_add_u32 s61, s61, 0
  s_mul_i32 s61, s61, 245760
  s_lshl_b32 s62, s89, 5
  s_add_u32 s62, s62, s61
  s_mov_b32 m0, 73728
  s_add_u32 s70, s62, 0
  buffer_load_dwordx4 v87, s[32:35], s70 offen lds
  s_mov_b32 m0, 74752
  s_add_u32 s70, s62, 40960
  buffer_load_dwordx4 v87, s[32:35], s70 offen lds
  s_mov_b32 m0, 75776
  s_add_u32 s70, s62, 81920
  buffer_load_dwordx4 v87, s[32:35], s70 offen lds
  s_mov_b32 m0, 76800
  s_add_u32 s70, s62, 122880
  buffer_load_dwordx4 v87, s[32:35], s70 offen lds
  s_mov_b32 m0, 77824
  s_add_u32 s70, s62, 163840
  buffer_load_dwordx4 v87, s[32:35], s70 offen lds
  s_mov_b32 m0, 78848
  s_add_u32 s70, s62, 204800
  buffer_load_dwordx4 v87, s[32:35], s70 offen lds
  s_lshl_b32 s62, s90, 5
  s_add_u32 s62, s62, s61
  s_mov_b32 m0, 79872
  s_add_u32 s70, s62, 0
  buffer_load_dwordx4 v87, s[32:35], s70 offen lds
  s_mov_b32 m0, 80896
  s_add_u32 s70, s62, 40960
  buffer_load_dwordx4 v87, s[32:35], s70 offen lds
  s_mov_b32 m0, 81920
  s_add_u32 s70, s62, 81920
  buffer_load_dwordx4 v87, s[32:35], s70 offen lds
  s_mov_b32 m0, 82944
  s_add_u32 s70, s62, 122880
  buffer_load_dwordx4 v87, s[32:35], s70 offen lds
  s_mov_b32 m0, 83968
  s_add_u32 s70, s62, 163840
  buffer_load_dwordx4 v87, s[32:35], s70 offen lds
  s_mov_b32 m0, 84992
  s_add_u32 s70, s62, 204800
  buffer_load_dwordx4 v87, s[32:35], s70 offen lds
  s_lshl_b32 s62, s91, 5
  s_add_u32 s62, s62, s61
  s_mov_b32 m0, 86016
  s_add_u32 s70, s62, 0
  buffer_load_dwordx4 v87, s[32:35], s70 offen lds
  s_mov_b32 m0, 87040
  s_add_u32 s70, s62, 40960
  buffer_load_dwordx4 v87, s[32:35], s70 offen lds
  s_mov_b32 m0, 88064
  s_add_u32 s70, s62, 81920
  buffer_load_dwordx4 v87, s[32:35], s70 offen lds
  s_mov_b32 m0, 89088
  s_add_u32 s70, s62, 122880
  buffer_load_dwordx4 v87, s[32:35], s70 offen lds
  s_mov_b32 m0, 90112
  s_add_u32 s70, s62, 163840
  buffer_load_dwordx4 v87, s[32:35], s70 offen lds
  s_mov_b32 m0, 91136
  s_add_u32 s70, s62, 204800
  buffer_load_dwordx4 v87, s[32:35], s70 offen lds
  s_lshl_b32 s61, s49, 2
  s_add_u32 s61, s61, 1
  s_mul_i32 s61, s61, 245760
  s_lshl_b32 s62, s89, 5
  s_add_u32 s62, s62, s61
  s_mov_b32 m0, 92160
  s_add_u32 s70, s62, 0
  buffer_load_dwordx4 v87, s[32:35], s70 offen lds
  s_mov_b32 m0, 93184
  s_add_u32 s70, s62, 40960
  buffer_load_dwordx4 v87, s[32:35], s70 offen lds
  s_mov_b32 m0, 94208
  s_add_u32 s70, s62, 81920
  buffer_load_dwordx4 v87, s[32:35], s70 offen lds
  s_mov_b32 m0, 95232
  s_add_u32 s70, s62, 122880
  buffer_load_dwordx4 v87, s[32:35], s70 offen lds
  s_mov_b32 m0, 96256
  s_add_u32 s70, s62, 163840
  buffer_load_dwordx4 v87, s[32:35], s70 offen lds
  s_mov_b32 m0, 97280
  s_add_u32 s70, s62, 204800
  buffer_load_dwordx4 v87, s[32:35], s70 offen lds
  s_lshl_b32 s62, s90, 5
  s_add_u32 s62, s62, s61
  s_mov_b32 m0, 98304
  s_add_u32 s70, s62, 0
  buffer_load_dwordx4 v87, s[32:35], s70 offen lds
  s_mov_b32 m0, 99328
  s_add_u32 s70, s62, 40960
  buffer_load_dwordx4 v87, s[32:35], s70 offen lds
  s_mov_b32 m0, 100352
  s_add_u32 s70, s62, 81920
  buffer_load_dwordx4 v87, s[32:35], s70 offen lds
  s_mov_b32 m0, 101376
  s_add_u32 s70, s62, 122880
  buffer_load_dwordx4 v87, s[32:35], s70 offen lds
  s_mov_b32 m0, 102400
  s_add_u32 s70, s62, 163840
  buffer_load_dwordx4 v87, s[32:35], s70 offen lds
  s_mov_b32 m0, 103424
  s_add_u32 s70, s62, 204800
  buffer_load_dwordx4 v87, s[32:35], s70 offen lds
  s_lshl_b32 s62, s91, 5
  s_add_u32 s62, s62, s61
  s_mov_b32 m0, 104448
  s_add_u32 s70, s62, 0
  buffer_load_dwordx4 v87, s[32:35], s70 offen lds
  s_mov_b32 m0, 105472
  s_add_u32 s70, s62, 40960
  buffer_load_dwordx4 v87, s[32:35], s70 offen lds
  s_mov_b32 m0, 106496
  s_add_u32 s70, s62, 81920
  buffer_load_dwordx4 v87, s[32:35], s70 offen lds
  s_mov_b32 m0, 107520
  s_add_u32 s70, s62, 122880
  buffer_load_dwordx4 v87, s[32:35], s70 offen lds
  s_mov_b32 m0, 108544
  s_add_u32 s70, s62, 163840
  buffer_load_dwordx4 v87, s[32:35], s70 offen lds
  s_mov_b32 m0, 109568
  s_add_u32 s70, s62, 204800
  buffer_load_dwordx4 v87, s[32:35], s70 offen lds
  s_lshl_b32 s61, s49, 2
  s_add_u32 s61, s61, 2
  s_mul_i32 s61, s61, 245760
  s_lshl_b32 s62, s89, 5
  s_add_u32 s62, s62, s61
  s_mov_b32 m0, 110592
  s_add_u32 s70, s62, 0
  buffer_load_dwordx4 v87, s[32:35], s70 offen lds
  s_mov_b32 m0, 111616
  s_add_u32 s70, s62, 40960
  buffer_load_dwordx4 v87, s[32:35], s70 offen lds
  s_mov_b32 m0, 112640
  s_add_u32 s70, s62, 81920
  buffer_load_dwordx4 v87, s[32:35], s70 offen lds
  s_mov_b32 m0, 113664
  s_add_u32 s70, s62, 122880
  buffer_load_dwordx4 v87, s[32:35], s70 offen lds
  s_mov_b32 m0, 114688
  s_add_u32 s70, s62, 163840
  buffer_load_dwordx4 v87, s[32:35], s70 offen lds
  s_mov_b32 m0, 115712
  s_add_u32 s70, s62, 204800
  buffer_load_dwordx4 v87, s[32:35], s70 offen lds
  s_lshl_b32 s62, s90, 5
  s_add_u32 s62, s62, s61
  s_mov_b32 m0, 116736
  s_add_u32 s70, s62, 0
  buffer_load_dwordx4 v87, s[32:35], s70 offen lds
  s_mov_b32 m0, 117760
  s_add_u32 s70, s62, 40960
  buffer_load_dwordx4 v87, s[32:35], s70 offen lds
  s_mov_b32 m0, 118784
  s_add_u32 s70, s62, 81920
  buffer_load_dwordx4 v87, s[32:35], s70 offen lds
  s_mov_b32 m0, 119808
  s_add_u32 s70, s62, 122880
  buffer_load_dwordx4 v87, s[32:35], s70 offen lds
  s_mov_b32 m0, 120832
  s_add_u32 s70, s62, 163840
  buffer_load_dwordx4 v87, s[32:35], s70 offen lds
  s_mov_b32 m0, 121856
  s_add_u32 s70, s62, 204800
  buffer_load_dwordx4 v87, s[32:35], s70 offen lds
  s_lshl_b32 s62, s91, 5
  s_add_u32 s62, s62, s61
  s_mov_b32 m0, 122880
  s_add_u32 s70, s62, 0
  buffer_load_dwordx4 v87, s[32:35], s70 offen lds
  s_mov_b32 m0, 123904
  s_add_u32 s70, s62, 40960
  buffer_load_dwordx4 v87, s[32:35], s70 offen lds
  s_mov_b32 m0, 124928
  s_add_u32 s70, s62, 81920
  buffer_load_dwordx4 v87, s[32:35], s70 offen lds
  s_mov_b32 m0, 125952
  s_add_u32 s70, s62, 122880
  buffer_load_dwordx4 v87, s[32:35], s70 offen lds
  s_mov_b32 m0, 126976
  s_add_u32 s70, s62, 163840
  buffer_load_dwordx4 v87, s[32:35], s70 offen lds
  s_mov_b32 m0, 128000
  s_add_u32 s70, s62, 204800
  buffer_load_dwordx4 v87, s[32:35], s70 offen lds
  s_lshl_b32 s61, s49, 2
  s_add_u32 s61, s61, 3
  s_mul_i32 s61, s61, 245760
  s_lshl_b32 s62, s89, 5
  s_add_u32 s62, s62, s61
  s_mov_b32 m0, 129024
  s_add_u32 s70, s62, 0
  buffer_load_dwordx4 v87, s[32:35], s70 offen lds
  s_mov_b32 m0, 130048
  s_add_u32 s70, s62, 40960
  buffer_load_dwordx4 v87, s[32:35], s70 offen lds
  s_mov_b32 m0, 131072
  s_add_u32 s70, s62, 81920
  buffer_load_dwordx4 v87, s[32:35], s70 offen lds
  s_mov_b32 m0, 132096
  s_add_u32 s70, s62, 122880
  buffer_load_dwordx4 v87, s[32:35], s70 offen lds
  s_mov_b32 m0, 133120
  s_add_u32 s70, s62, 163840
  buffer_load_dwordx4 v87, s[32:35], s70 offen lds
  s_mov_b32 m0, 134144
  s_add_u32 s70, s62, 204800
  buffer_load_dwordx4 v87, s[32:35], s70 offen lds
  s_lshl_b32 s62, s90, 5
  s_add_u32 s62, s62, s61
  s_mov_b32 m0, 135168
  s_add_u32 s70, s62, 0
  buffer_load_dwordx4 v87, s[32:35], s70 offen lds
  s_mov_b32 m0, 136192
  s_add_u32 s70, s62, 40960
  buffer_load_dwordx4 v87, s[32:35], s70 offen lds
  s_mov_b32 m0, 137216
  s_add_u32 s70, s62, 81920
  buffer_load_dwordx4 v87, s[32:35], s70 offen lds
  s_mov_b32 m0, 138240
  s_add_u32 s70, s62, 122880
  buffer_load_dwordx4 v87, s[32:35], s70 offen lds
  s_mov_b32 m0, 139264
  s_add_u32 s70, s62, 163840
  buffer_load_dwordx4 v87, s[32:35], s70 offen lds
  s_mov_b32 m0, 140288
  s_add_u32 s70, s62, 204800
  buffer_load_dwordx4 v87, s[32:35], s70 offen lds
  s_lshl_b32 s62, s91, 5
  s_add_u32 s62, s62, s61
  s_mov_b32 m0, 141312
  s_add_u32 s70, s62, 0
  buffer_load_dwordx4 v87, s[32:35], s70 offen lds
  s_mov_b32 m0, 142336
  s_add_u32 s70, s62, 40960
  buffer_load_dwordx4 v87, s[32:35], s70 offen lds
  s_mov_b32 m0, 143360
  s_add_u32 s70, s62, 81920
  buffer_load_dwordx4 v87, s[32:35], s70 offen lds
  s_mov_b32 m0, 144384
  s_add_u32 s70, s62, 122880
  buffer_load_dwordx4 v87, s[32:35], s70 offen lds
  s_mov_b32 m0, 145408
  s_add_u32 s70, s62, 163840
  buffer_load_dwordx4 v87, s[32:35], s70 offen lds
  s_mov_b32 m0, 146432
  s_add_u32 s70, s62, 204800
  buffer_load_dwordx4 v87, s[32:35], s70 offen lds
WJ_8:
  s_lshl_b32 s62, s48, 5
  v_add_u32 v86, s62, v84
  v_add_u32 v88, 36864, v86
  v_add_u32 v89, 36864, v84
  s_cmp_eq_u32 s48, 3
  s_cbranch_scc1 UA_9
  s_waitcnt vmcnt(18)
UA_9:
  s_barrier
  s_cmp_eq_u32 s48, 3
  s_cbranch_scc1 UB_10
  ds_read_b64_tr_b16 v[40:41], v86 offset:0
  ds_read_b64_tr_b16 v[42:43], v86 offset:768
  ds_read_b64_tr_b16 v[44:45], v86 offset:3072
  ds_read_b64_tr_b16 v[46:47], v86 offset:3840
  ds_read_b64_tr_b16 v[48:49], v86 offset:6144
  ds_read_b64_tr_b16 v[50:51], v86 offset:6912
  ds_read_b64_tr_b16 v[52:53], v86 offset:9216
  ds_read_b64_tr_b16 v[54:55], v86 offset:9984
  s_waitcnt lgkmcnt(0)
  v_accvgpr_write_b32 a0, v40
  v_accvgpr_write_b32 a1, v42
  v_accvgpr_write_b32 a2, v41
  v_accvgpr_write_b32 a3, v43
  v_accvgpr_write_b32 a4, v44
  v_accvgpr_write_b32 a5, v46
  v_accvgpr_write_b32 a6, v45
  v_accvgpr_write_b32 a7, v47
  v_accvgpr_write_b32 a80, v48
  v_accvgpr_write_b32 a81, v50
  v_accvgpr_write_b32 a82, v49
  v_accvgpr_write_b32 a83, v51
  v_accvgpr_write_b32 a84, v52
  v_accvgpr_write_b32 a85, v54
  v_accvgpr_write_b32 a86, v53
  v_accvgpr_write_b32 a87, v55
  s_branch UE_11
UB_10:
  ds_read_b64_tr_b16 v[40:41], v84 offset:12288
  ds_read_b64_tr_b16 v[42:43], v84 offset:13056
  ds_read_b64_tr_b16 v[44:45], v84 offset:15360
  ds_read_b64_tr_b16 v[46:47], v84 offset:16128
  s_waitcnt lgkmcnt(0)
  v_accvgpr_write_b32 a0, v40
  v_accvgpr_write_b32 a1, v42
  v_accvgpr_write_b32 a2, v41
  v_accvgpr_write_b32 a3, v43
  v_accvgpr_write_b32 a4, v44
  v_accvgpr_write_b32 a5, v46
  v_accvgpr_write_b32 a6, v45
  v_accvgpr_write_b32 a7, v47
  ds_read_b64_tr_b16 v[48:49], v84 offset:12320
  ds_read_b64_tr_b16 v[50:51], v84 offset:13088
  ds_read_b64_tr_b16 v[52:53], v84 offset:15392
  ds_read_b64_tr_b16 v[54:55], v84 offset:16160
  s_waitcnt lgkmcnt(0)
  v_accvgpr_write_b32 a80, v48
  v_accvgpr_write_b32 a81, v50
  v_accvgpr_write_b32 a82, v49
  v_accvgpr_write_b32 a83, v51
  v_accvgpr_write_b32 a84, v52
  v_accvgpr_write_b32 a85, v54
  v_accvgpr_write_b32 a86, v53
  v_accvgpr_write_b32 a87, v55
  ds_read_b64_tr_b16 v[40:41], v84 offset:12352
  ds_read_b64_tr_b16 v[42:43], v84 offset:13120
  ds_read_b64_tr_b16 v[44:45], v84 offset:15424
  ds_read_b64_tr_b16 v[46:47], v84 offset:16192
  s_waitcnt lgkmcnt(0)
  v_accvgpr_write_b32 a160, v40
  v_accvgpr_write_b32 a161, v42
  v_accvgpr_write_b32 a162, v41
  v_accvgpr_write_b32 a163, v43
  v_accvgpr_write_b32 a164, v44
  v_accvgpr_write_b32 a165, v46
  v_accvgpr_write_b32 a166, v45
  v_accvgpr_write_b32 a167, v47
UE_11:
  s_barrier
  s_cmp_eq_u32 s48, 3
  s_cbranch_scc1 UN_12
  s_add_u32 m0, s75, 0
  s_nop 0
  buffer_load_dwordx4 v24, s[32:35], s74 offen lds
  s_add_u32 m0, s75, 1024
  s_nop 0
  buffer_load_dwordx4 v25, s[32:35], s74 offen lds
  s_add_u32 m0, s75, 2048
  s_nop 0
  buffer_load_dwordx4 v26, s[32:35], s74 offen lds
  s_add_u32 m0, s75, 3072
  s_nop 0
  buffer_load_dwordx4 v27, s[32:35], s74 offen lds
  s_add_u32 m0, s75, 4096
  s_nop 0
  buffer_load_dwordx4 v28, s[32:35], s74 offen lds
  s_add_u32 m0, s75, 5120
  s_nop 0
  buffer_load_dwordx4 v29, s[32:35], s74 offen lds
  s_add_u32 s74, s74, 786432
UN_12:
  s_cmp_eq_u32 s48, 3
  s_cbranch_scc1 UA_13
  s_waitcnt vmcnt(18)
UA_13:
  s_barrier
  s_cmp_eq_u32 s48, 3
  s_cbranch_scc1 UB_14
  ds_read_b64_tr_b16 v[40:41], v86 offset:18432
  ds_read_b64_tr_b16 v[42:43], v86 offset:19200
  ds_read_b64_tr_b16 v[44:45], v86 offset:21504
  ds_read_b64_tr_b16 v[46:47], v86 offset:22272
  ds_read_b64_tr_b16 v[48:49], v86 offset:24576
  ds_read_b64_tr_b16 v[50:51], v86 offset:25344
  ds_read_b64_tr_b16 v[52:53], v86 offset:27648
  ds_read_b64_tr_b16 v[54:55], v86 offset:28416
  s_waitcnt lgkmcnt(0)
  v_accvgpr_write_b32 a8, v40
  v_accvgpr_write_b32 a9, v42
  v_accvgpr_write_b32 a10, v41
  v_accvgpr_write_b32 a11, v43
  v_accvgpr_write_b32 a12, v44
  v_accvgpr_write_b32 a13, v46
  v_accvgpr_write_b32 a14, v45
  v_accvgpr_write_b32 a15, v47
  v_accvgpr_write_b32 a88, v48
  v_accvgpr_write_b32 a89, v50
  v_accvgpr_write_b32 a90, v49
  v_accvgpr_write_b32 a91, v51
  v_accvgpr_write_b32 a92, v52
  v_accvgpr_write_b32 a93, v54
  v_accvgpr_write_b32 a94, v53
  v_accvgpr_write_b32 a95, v55
  s_branch UE_15
UB_14:
  ds_read_b64_tr_b16 v[40:41], v84 offset:30720
  ds_read_b64_tr_b16 v[42:43], v84 offset:31488
  ds_read_b64_tr_b16 v[44:45], v84 offset:33792
  ds_read_b64_tr_b16 v[46:47], v84 offset:34560
  s_waitcnt lgkmcnt(0)
  v_accvgpr_write_b32 a8, v40
  v_accvgpr_write_b32 a9, v42
  v_accvgpr_write_b32 a10, v41
  v_accvgpr_write_b32 a11, v43
  v_accvgpr_write_b32 a12, v44
  v_accvgpr_write_b32 a13, v46
  v_accvgpr_write_b32 a14, v45
  v_accvgpr_write_b32 a15, v47
  ds_read_b64_tr_b16 v[48:49], v84 offset:30752
  ds_read_b64_tr_b16 v[50:51], v84 offset:31520
  ds_read_b64_tr_b16 v[52:53], v84 offset:33824
  ds_read_b64_tr_b16 v[54:55], v84 offset:34592
  s_waitcnt lgkmcnt(0)
  v_accvgpr_write_b32 a88, v48
  v_accvgpr_write_b32 a89, v50
  v_accvgpr_write_b32 a90, v49
  v_accvgpr_write_b32 a91, v51
  v_accvgpr_write_b32 a92, v52
  v_accvgpr_write_b32 a93, v54
  v_accvgpr_write_b32 a94, v53
  v_accvgpr_write_b32 a95, v55
  ds_read_b64_tr_b16 v[40:41], v84 offset:30784
  ds_read_b64_tr_b16 v[42:43], v84 offset:31552
  ds_read_b64_tr_b16 v[44:45], v84 offset:33856
  ds_read_b64_tr_b16 v[46:47], v84 offset:34624
  s_waitcnt lgkmcnt(0)
  v_accvgpr_write_b32 a168, v40
  v_accvgpr_write_b32 a169, v42
  v_accvgpr_write_b32 a170, v41
  v_accvgpr_write_b32 a171, v43
  v_accvgpr_write_b32 a172, v44
  v_accvgpr_write_b32 a173, v46
  v_accvgpr_write_b32 a174, v45
  v_accvgpr_write_b32 a175, v47
UE_15:
  s_barrier
  s_cmp_eq_u32 s48, 3
  s_cbranch_scc1 UN_16
  s_add_u32 m0, s75, 18432
  s_nop 0
  buffer_load_dwordx4 v24, s[32:35], s74 offen lds
  s_add_u32 m0, s75, 19456
  s_nop 0
  buffer_load_dwordx4 v25, s[32:35], s74 offen lds
  s_add_u32 m0, s75, 20480
  s_nop 0
  buffer_load_dwordx4 v26, s[32:35], s74 offen lds
  s_add_u32 m0, s75, 21504
  s_nop 0
  buffer_load_dwordx4 v27, s[32:35], s74 offen lds
  s_add_u32 m0, s75, 22528
  s_nop 0
  buffer_load_dwordx4 v28, s[32:35], s74 offen lds
  s_add_u32 m0, s75, 23552
  s_nop 0
  buffer_load_dwordx4 v29, s[32:35], s74 offen lds
  s_add_u32 s74, s74, 786432
UN_16:
  s_cmp_eq_u32 s48, 3
  s_cbranch_scc1 UA_17
  s_waitcnt vmcnt(18)
UA_17:
  s_barrier
  s_cmp_eq_u32 s48, 3
  s_cbranch_scc1 UB_18
  ds_read_b64_tr_b16 v[40:41], v88 offset:0
  ds_read_b64_tr_b16 v[42:43], v88 offset:768
  ds_read_b64_tr_b16 v[44:45], v88 offset:3072
  ds_read_b64_tr_b16 v[46:47], v88 offset:3840
  ds_read_b64_tr_b16 v[48:49], v88 offset:6144
  ds_read_b64_tr_b16 v[50:51], v88 offset:6912
  ds_read_b64_tr_b16 v[52:53], v88 offset:9216
  ds_read_b64_tr_b16 v[54:55], v88 offset:9984
  s_waitcnt lgkmcnt(0)
  v_accvgpr_write_b32 a16, v40
  v_accvgpr_write_b32 a17, v42
  v_accvgpr_write_b32 a18, v41
  v_accvgpr_write_b32 a19, v43
  v_accvgpr_write_b32 a20, v44
  v_accvgpr_write_b32 a21, v46
  v_accvgpr_write_b32 a22, v45
  v_accvgpr_write_b32 a23, v47
  v_accvgpr_write_b32 a96, v48
  v_accvgpr_write_b32 a97, v50
  v_accvgpr_write_b32 a98, v49
  v_accvgpr_write_b32 a99, v51
  v_accvgpr_write_b32 a100, v52
  v_accvgpr_write_b32 a101, v54
  v_accvgpr_write_b32 a102, v53
  v_accvgpr_write_b32 a103, v55
  s_branch UE_19
UB_18:
  ds_read_b64_tr_b16 v[40:41], v89 offset:12288
  ds_read_b64_tr_b16 v[42:43], v89 offset:13056
  ds_read_b64_tr_b16 v[44:45], v89 offset:15360
  ds_read_b64_tr_b16 v[46:47], v89 offset:16128
  s_waitcnt lgkmcnt(0)
  v_accvgpr_write_b32 a16, v40
  v_accvgpr_write_b32 a17, v42
  v_accvgpr_write_b32 a18, v41
  v_accvgpr_write_b32 a19, v43
  v_accvgpr_write_b32 a20, v44
  v_accvgpr_write_b32 a21, v46
  v_accvgpr_write_b32 a22, v45
  v_accvgpr_write_b32 a23, v47
  ds_read_b64_tr_b16 v[48:49], v89 offset:12320
  ds_read_b64_tr_b16 v[50:51], v89 offset:13088
  ds_read_b64_tr_b16 v[52:53], v89 offset:15392
  ds_read_b64_tr_b16 v[54:55], v89 offset:16160
  s_waitcnt lgkmcnt(0)
  v_accvgpr_write_b32 a96, v48
  v_accvgpr_write_b32 a97, v50
  v_accvgpr_write_b32 a98, v49
  v_accvgpr_write_b32 a99, v51
  v_accvgpr_write_b32 a100, v52
  v_accvgpr_write_b32 a101, v54
  v_accvgpr_write_b32 a102, v53
  v_accvgpr_write_b32 a103, v55
  ds_read_b64_tr_b16 v[40:41], v89 offset:12352
  ds_read_b64_tr_b16 v[42:43], v89 offset:13120
  ds_read_b64_tr_b16 v[44:45], v89 offset:15424
  ds_read_b64_tr_b16 v[46:47], v89 offset:16192
  s_waitcnt lgkmcnt(0)
  v_accvgpr_write_b32 a176, v40
  v_accvgpr_write_b32 a177, v42
  v_accvgpr_write_b32 a178, v41
  v_accvgpr_write_b32 a179, v43
  v_accvgpr_write_b32 a180, v44
  v_accvgpr_write_b32 a181, v46
  v_accvgpr_write_b32 a182, v45
  v_accvgpr_write_b32 a183, v47
UE_19:
  s_barrier
  s_cmp_eq_u32 s48, 3
  s_cbranch_scc1 UN_20
  s_add_u32 m0, s75, 36864
  s_nop 0
  buffer_load_dwordx4 v24, s[32:35], s74 offen lds
  s_add_u32 m0, s75, 37888
  s_nop 0
  buffer_load_dwordx4 v25, s[32:35], s74 offen lds
  s_add_u32 m0, s75, 38912
  s_nop 0
  buffer_load_dwordx4 v26, s[32:35], s74 offen lds
  s_add_u32 m0, s75, 39936
  s_nop 0
  buffer_load_dwordx4 v27, s[32:35], s74 offen lds
  s_add_u32 m0, s75, 40960
  s_nop 0
  buffer_load_dwordx4 v28, s[32:35], s74 offen lds
  s_add_u32 m0, s75, 41984
  s_nop 0
  buffer_load_dwordx4 v29, s[32:35], s74 offen lds
  s_add_u32 s74, s74, 786432
UN_20:
  s_cmp_eq_u32 s48, 3
  s_cbranch_scc1 UA_21
  s_waitcnt vmcnt(18)
UA_21:
  s_barrier
  s_cmp_eq_u32 s48, 3
  s_cbranch_scc1 UB_22
  ds_read_b64_tr_b16 v[40:41], v88 offset:18432
  ds_read_b64_tr_b16 v[42:43], v88 offset:19200
  ds_read_b64_tr_b16 v[44:45], v88 offset:21504
  ds_read_b64_tr_b16 v[46:47], v88 offset:22272
  ds_read_b64_tr_b16 v[48:49], v88 offset:24576
  ds_read_b64_tr_b16 v[50:51], v88 offset:25344
  ds_read_b64_tr_b16 v[52:53], v88 offset:27648
  ds_read_b64_tr_b16 v[54:55], v88 offset:28416
  s_waitcnt lgkmcnt(0)
  v_accvgpr_write_b32 a24, v40
  v_accvgpr_write_b32 a25, v42
  v_accvgpr_write_b32 a26, v41
  v_accvgpr_write_b32 a27, v43
  v_accvgpr_write_b32 a28, v44
  v_accvgpr_write_b32 a29, v46
  v_accvgpr_write_b32 a30, v45
  v_accvgpr_write_b32 a31, v47
  v_accvgpr_write_b32 a104, v48
  v_accvgpr_write_b32 a105, v50
  v_accvgpr_write_b32 a106, v49
  v_accvgpr_write_b32 a107, v51
  v_accvgpr_write_b32 a108, v52
  v_accvgpr_write_b32 a109, v54
  v_accvgpr_write_b32 a110, v53
  v_accvgpr_write_b32 a111, v55
  s_branch UE_23
UB_22:
  ds_read_b64_tr_b16 v[40:41], v89 offset:30720
  ds_read_b64_tr_b16 v[42:43], v89 offset:31488
  ds_read_b64_tr_b16 v[44:45], v89 offset:33792
  ds_read_b64_tr_b16 v[46:47], v89 offset:34560
  s_waitcnt lgkmcnt(0)
  v_accvgpr_write_b32 a24, v40
  v_accvgpr_write_b32 a25, v42
  v_accvgpr_write_b32 a26, v41
  v_accvgpr_write_b32 a27, v43
  v_accvgpr_write_b32 a28, v44
  v_accvgpr_write_b32 a29, v46
  v_accvgpr_write_b32 a30, v45
  v_accvgpr_write_b32 a31, v47
  ds_read_b64_tr_b16 v[48:49], v89 offset:30752
  ds_read_b64_tr_b16 v[50:51], v89 offset:31520
  ds_read_b64_tr_b16 v[52:53], v89 offset:33824
  ds_read_b64_tr_b16 v[54:55], v89 offset:34592
  s_waitcnt lgkmcnt(0)
  v_accvgpr_write_b32 a104, v48
  v_accvgpr_write_b32 a105, v50
  v_accvgpr_write_b32 a106, v49
  v_accvgpr_write_b32 a107, v51
  v_accvgpr_write_b32 a108, v52
  v_accvgpr_write_b32 a109, v54
  v_accvgpr_write_b32 a110, v53
  v_accvgpr_write_b32 a111, v55
  ds_read_b64_tr_b16 v[40:41], v89 offset:30784
  ds_read_b64_tr_b16 v[42:43], v89 offset:31552
  ds_read_b64_tr_b16 v[44:45], v89 offset:33856
  ds_read_b64_tr_b16 v[46:47], v89 offset:34624
  s_waitcnt lgkmcnt(0)
  v_accvgpr_write_b32 a184, v40
  v_accvgpr_write_b32 a185, v42
  v_accvgpr_write_b32 a186, v41
  v_accvgpr_write_b32 a187, v43
  v_accvgpr_write_b32 a188, v44
  v_accvgpr_write_b32 a189, v46
  v_accvgpr_write_b32 a190, v45
  v_accvgpr_write_b32 a191, v47
UE_23:
  s_barrier
  s_cmp_eq_u32 s48, 3
  s_cbranch_scc1 UN_24
  s_add_u32 m0, s75, 55296
  s_nop 0
  buffer_load_dwordx4 v24, s[32:35], s74 offen lds
  s_add_u32 m0, s75, 56320
  s_nop 0
  buffer_load_dwordx4 v25, s[32:35], s74 offen lds
  s_add_u32 m0, s75, 57344
  s_nop 0
  buffer_load_dwordx4 v26, s[32:35], s74 offen lds
  s_add_u32 m0, s75, 58368
  s_nop 0
  buffer_load_dwordx4 v27, s[32:35], s74 offen lds
  s_add_u32 m0, s75, 59392
  s_nop 0
  buffer_load_dwordx4 v28, s[32:35], s74 offen lds
  s_add_u32 m0, s75, 60416
  s_nop 0
  buffer_load_dwordx4 v29, s[32:35], s74 offen lds
  s_add_u32 s74, s74, 786432
UN_24:
  s_cmp_eq_u32 s48, 3
  s_cbranch_scc1 UA_25
  s_waitcnt vmcnt(18)
UA_25:
  s_barrier
  s_cmp_eq_u32 s48, 3
  s_cbranch_scc1 UB_26
  ds_read_b64_tr_b16 v[40:41], v86 offset:0
  ds_read_b64_tr_b16 v[42:43], v86 offset:768
  ds_read_b64_tr_b16 v[44:45], v86 offset:3072
  ds_read_b64_tr_b16 v[46:47], v86 offset:3840
  ds_read_b64_tr_b16 v[48:49], v86 offset:6144
  ds_read_b64_tr_b16 v[50:51], v86 offset:6912
  ds_read_b64_tr_b16 v[52:53], v86 offset:9216
  ds_read_b64_tr_b16 v[54:55], v86 offset:9984
  s_waitcnt lgkmcnt(0)
  v_accvgpr_write_b32 a32, v40
  v_accvgpr_write_b32 a33, v42
  v_accvgpr_write_b32 a34, v41
  v_accvgpr_write_b32 a35, v43
  v_accvgpr_write_b32 a36, v44
  v_accvgpr_write_b32 a37, v46
  v_accvgpr_write_b32 a38, v45
  v_accvgpr_write_b32 a39, v47
  v_accvgpr_write_b32 a112, v48
  v_accvgpr_write_b32 a113, v50
  v_accvgpr_write_b32 a114, v49
  v_accvgpr_write_b32 a115, v51
  v_accvgpr_write_b32 a116, v52
  v_accvgpr_write_b32 a117, v54
  v_accvgpr_write_b32 a118, v53
  v_accvgpr_write_b32 a119, v55
  s_branch UE_27
UB_26:
  ds_read_b64_tr_b16 v[40:41], v84 offset:12288
  ds_read_b64_tr_b16 v[42:43], v84 offset:13056
  ds_read_b64_tr_b16 v[44:45], v84 offset:15360
  ds_read_b64_tr_b16 v[46:47], v84 offset:16128
  s_waitcnt lgkmcnt(0)
  v_accvgpr_write_b32 a32, v40
  v_accvgpr_write_b32 a33, v42
  v_accvgpr_write_b32 a34, v41
  v_accvgpr_write_b32 a35, v43
  v_accvgpr_write_b32 a36, v44
  v_accvgpr_write_b32 a37, v46
  v_accvgpr_write_b32 a38, v45
  v_accvgpr_write_b32 a39, v47
  ds_read_b64_tr_b16 v[48:49], v84 offset:12320
  ds_read_b64_tr_b16 v[50:51], v84 offset:13088
  ds_read_b64_tr_b16 v[52:53], v84 offset:15392
  ds_read_b64_tr_b16 v[54:55], v84 offset:16160
  s_waitcnt lgkmcnt(0)
  v_accvgpr_write_b32 a112, v48
  v_accvgpr_write_b32 a113, v50
  v_accvgpr_write_b32 a114, v49
  v_accvgpr_write_b32 a115, v51
  v_accvgpr_write_b32 a116, v52
  v_accvgpr_write_b32 a117, v54
  v_accvgpr_write_b32 a118, v53
  v_accvgpr_write_b32 a119, v55
  ds_read_b64_tr_b16 v[40:41], v84 offset:12352
  ds_read_b64_tr_b16 v[42:43], v84 offset:13120
  ds_read_b64_tr_b16 v[44:45], v84 offset:15424
  ds_read_b64_tr_b16 v[46:47], v84 offset:16192
  s_waitcnt lgkmcnt(0)
  v_accvgpr_write_b32 a192, v40
  v_accvgpr_write_b32 a193, v42
  v_accvgpr_write_b32 a194, v41
  v_accvgpr_write_b32 a195, v43
  v_accvgpr_write_b32 a196, v44
  v_accvgpr_write_b32 a197, v46
  v_accvgpr_write_b32 a198, v45
  v_accvgpr_write_b32 a199, v47
UE_27:
  s_barrier
  s_cmp_eq_u32 s48, 3
  s_cbranch_scc1 UN_28
  s_add_u32 m0, s75, 0
  s_nop 0
  buffer_load_dwordx4 v24, s[32:35], s74 offen lds
  s_add_u32 m0, s75, 1024
  s_nop 0
  buffer_load_dwordx4 v25, s[32:35], s74 offen lds
  s_add_u32 m0, s75, 2048
  s_nop 0
  buffer_load_dwordx4 v26, s[32:35], s74 offen lds
  s_add_u32 m0, s75, 3072
  s_nop 0
  buffer_load_dwordx4 v27, s[32:35], s74 offen lds
  s_add_u32 m0, s75, 4096
  s_nop 0
  buffer_load_dwordx4 v28, s[32:35], s74 offen lds
  s_add_u32 m0, s75, 5120
  s_nop 0
  buffer_load_dwordx4 v29, s[32:35], s74 offen lds
  s_add_u32 s74, s74, 786432
UN_28:
  s_cmp_eq_u32 s48, 3
  s_cbranch_scc1 UA_29
  s_waitcnt vmcnt(18)
UA_29:
  s_barrier
  s_cmp_eq_u32 s48, 3
  s_cbranch_scc1 UB_30
  ds_read_b64_tr_b16 v[40:41], v86 offset:18432
  ds_read_b64_tr_b16 v[42:43], v86 offset:19200
  ds_read_b64_tr_b16 v[44:45], v86 offset:21504
  ds_read_b64_tr_b16 v[46:47], v86 offset:22272
  ds_read_b64_tr_b16 v[48:49], v86 offset:24576
  ds_read_b64_tr_b16 v[50:51], v86 offset:25344
  ds_read_b64_tr_b16 v[52:53], v86 offset:27648
  ds_read_b64_tr_b16 v[54:55], v86 offset:28416
  s_waitcnt lgkmcnt(0)
  v_accvgpr_write_b32 a40, v40
  v_accvgpr_write_b32 a41, v42
  v_accvgpr_write_b32 a42, v41
  v_accvgpr_write_b32 a43, v43
  v_accvgpr_write_b32 a44, v44
  v_accvgpr_write_b32 a45, v46
  v_accvgpr_write_b32 a46, v45
  v_accvgpr_write_b32 a47, v47
  v_accvgpr_write_b32 a120, v48
  v_accvgpr_write_b32 a121, v50
  v_accvgpr_write_b32 a122, v49
  v_accvgpr_write_b32 a123, v51
  v_accvgpr_write_b32 a124, v52
  v_accvgpr_write_b32 a125, v54
  v_accvgpr_write_b32 a126, v53
  v_accvgpr_write_b32 a127, v55
  s_branch UE_31
UB_30:
  ds_read_b64_tr_b16 v[40:41], v84 offset:30720
  ds_read_b64_tr_b16 v[42:43], v84 offset:31488
  ds_read_b64_tr_b16 v[44:45], v84 offset:33792
  ds_read_b64_tr_b16 v[46:47], v84 offset:34560
  s_waitcnt lgkmcnt(0)
  v_accvgpr_write_b32 a40, v40
  v_accvgpr_write_b32 a41, v42
  v_accvgpr_write_b32 a42, v41
  v_accvgpr_write_b32 a43, v43
  v_accvgpr_write_b32 a44, v44
  v_accvgpr_write_b32 a45, v46
  v_accvgpr_write_b32 a46, v45
  v_accvgpr_write_b32 a47, v47
  ds_read_b64_tr_b16 v[48:49], v84 offset:30752
  ds_read_b64_tr_b16 v[50:51], v84 offset:31520
  ds_read_b64_tr_b16 v[52:53], v84 offset:33824
  ds_read_b64_tr_b16 v[54:55], v84 offset:34592
  s_waitcnt lgkmcnt(0)
  v_accvgpr_write_b32 a120, v48
  v_accvgpr_write_b32 a121, v50
  v_accvgpr_write_b32 a122, v49
  v_accvgpr_write_b32 a123, v51
  v_accvgpr_write_b32 a124, v52
  v_accvgpr_write_b32 a125, v54
  v_accvgpr_write_b32 a126, v53
  v_accvgpr_write_b32 a127, v55
  ds_read_b64_tr_b16 v[40:41], v84 offset:30784
  ds_read_b64_tr_b16 v[42:43], v84 offset:31552
  ds_read_b64_tr_b16 v[44:45], v84 offset:33856
  ds_read_b64_tr_b16 v[46:47], v84 offset:34624
  s_waitcnt lgkmcnt(0)
  v_accvgpr_write_b32 a200, v40
  v_accvgpr_write_b32 a201, v42
  v_accvgpr_write_b32 a202, v41
  v_accvgpr_write_b32 a203, v43
  v_accvgpr_write_b32 a204, v44
  v_accvgpr_write_b32 a205, v46
  v_accvgpr_write_b32 a206, v45
  v_accvgpr_write_b32 a207, v47
UE_31:
  s_barrier
  s_cmp_eq_u32 s48, 3
  s_cbranch_scc1 UN_32
  s_add_u32 m0, s75, 18432
  s_nop 0
  buffer_load_dwordx4 v24, s[32:35], s74 offen lds
  s_add_u32 m0, s75, 19456
  s_nop 0
  buffer_load_dwordx4 v25, s[32:35], s74 offen lds
  s_add_u32 m0, s75, 20480
  s_nop 0
  buffer_load_dwordx4 v26, s[32:35], s74 offen lds
  s_add_u32 m0, s75, 21504
  s_nop 0
  buffer_load_dwordx4 v27, s[32:35], s74 offen lds
  s_add_u32 m0, s75, 22528
  s_nop 0
  buffer_load_dwordx4 v28, s[32:35], s74 offen lds
  s_add_u32 m0, s75, 23552
  s_nop 0
  buffer_load_dwordx4 v29, s[32:35], s74 offen lds
  s_add_u32 s74, s74, 786432
UN_32:
  s_cmp_eq_u32 s48, 3
  s_cbranch_scc1 UA_33
  s_waitcnt vmcnt(18)
UA_33:
  s_barrier
  s_cmp_eq_u32 s48, 3
  s_cbranch_scc1 UB_34
  ds_read_b64_tr_b16 v[40:41], v88 offset:0
  ds_read_b64_tr_b16 v[42:43], v88 offset:768
  ds_read_b64_tr_b16 v[44:45], v88 offset:3072
  ds_read_b64_tr_b16 v[46:47], v88 offset:3840
  ds_read_b64_tr_b16 v[48:49], v88 offset:6144
  ds_read_b64_tr_b16 v[50:51], v88 offset:6912
  ds_read_b64_tr_b16 v[52:53], v88 offset:9216
  ds_read_b64_tr_b16 v[54:55], v88 offset:9984
  s_waitcnt lgkmcnt(0)
  v_accvgpr_write_b32 a48, v40
  v_accvgpr_write_b32 a49, v42
  v_accvgpr_write_b32 a50, v41
  v_accvgpr_write_b32 a51, v43
  v_accvgpr_write_b32 a52, v44
  v_accvgpr_write_b32 a53, v46
  v_accvgpr_write_b32 a54, v45
  v_accvgpr_write_b32 a55, v47
  v_accvgpr_write_b32 a128, v48
  v_accvgpr_write_b32 a129, v50
  v_accvgpr_write_b32 a130, v49
  v_accvgpr_write_b32 a131, v51
  v_accvgpr_write_b32 a132, v52
  v_accvgpr_write_b32 a133, v54
  v_accvgpr_write_b32 a134, v53
  v_accvgpr_write_b32 a135, v55
  s_branch UE_35
UB_34:
  ds_read_b64_tr_b16 v[40:41], v89 offset:12288
  ds_read_b64_tr_b16 v[42:43], v89 offset:13056
  ds_read_b64_tr_b16 v[44:45], v89 offset:15360
  ds_read_b64_tr_b16 v[46:47], v89 offset:16128
  s_waitcnt lgkmcnt(0)
  v_accvgpr_write_b32 a48, v40
  v_accvgpr_write_b32 a49, v42
  v_accvgpr_write_b32 a50, v41
  v_accvgpr_write_b32 a51, v43
  v_accvgpr_write_b32 a52, v44
  v_accvgpr_write_b32 a53, v46
  v_accvgpr_write_b32 a54, v45
  v_accvgpr_write_b32 a55, v47
  ds_read_b64_tr_b16 v[48:49], v89 offset:12320
  ds_read_b64_tr_b16 v[50:51], v89 offset:13088
  ds_read_b64_tr_b16 v[52:53], v89 offset:15392
  ds_read_b64_tr_b16 v[54:55], v89 offset:16160
  s_waitcnt lgkmcnt(0)
  v_accvgpr_write_b32 a128, v48
  v_accvgpr_write_b32 a129, v50
  v_accvgpr_write_b32 a130, v49
  v_accvgpr_write_b32 a131, v51
  v_accvgpr_write_b32 a132, v52
  v_accvgpr_write_b32 a133, v54
  v_accvgpr_write_b32 a134, v53
  v_accvgpr_write_b32 a135, v55
  ds_read_b64_tr_b16 v[40:41], v89 offset:12352
  ds_read_b64_tr_b16 v[42:43], v89 offset:13120
  ds_read_b64_tr_b16 v[44:45], v89 offset:15424
  ds_read_b64_tr_b16 v[46:47], v89 offset:16192
  s_waitcnt lgkmcnt(0)
  v_accvgpr_write_b32 a208, v40
  v_accvgpr_write_b32 a209, v42
  v_accvgpr_write_b32 a210, v41
  v_accvgpr_write_b32 a211, v43
  v_accvgpr_write_b32 a212, v44
  v_accvgpr_write_b32 a213, v46
  v_accvgpr_write_b32 a214, v45
  v_accvgpr_write_b32 a215, v47
UE_35:
  s_barrier
  s_cmp_eq_u32 s48, 3
  s_cbranch_scc1 UA_36
  s_waitcnt vmcnt(12)
UA_36:
  s_barrier
  s_cmp_eq_u32 s48, 3
  s_cbranch_scc1 UB_37
  ds_read_b64_tr_b16 v[40:41], v88 offset:18432
  ds_read_b64_tr_b16 v[42:43], v88 offset:19200
  ds_read_b64_tr_b16 v[44:45], v88 offset:21504
  ds_read_b64_tr_b16 v[46:47], v88 offset:22272
  ds_read_b64_tr_b16 v[48:49], v88 offset:24576
  ds_read_b64_tr_b16 v[50:51], v88 offset:25344
  ds_read_b64_tr_b16 v[52:53], v88 offset:27648
  ds_read_b64_tr_b16 v[54:55], v88 offset:28416
  s_waitcnt lgkmcnt(0)
  v_accvgpr_write_b32 a56, v40
  v_accvgpr_write_b32 a57, v42
  v_accvgpr_write_b32 a58, v41
  v_accvgpr_write_b32 a59, v43
  v_accvgpr_write_b32 a60, v44
  v_accvgpr_write_b32 a61, v46
  v_accvgpr_write_b32 a62, v45
  v_accvgpr_write_b32 a63, v47
  v_accvgpr_write_b32 a136, v48
  v_accvgpr_write_b32 a137, v50
  v_accvgpr_write_b32 a138, v49
  v_accvgpr_write_b32 a139, v51
  v_accvgpr_write_b32 a140, v52
  v_accvgpr_write_b32 a141, v54
  v_accvgpr_write_b32 a142, v53
  v_accvgpr_write_b32 a143, v55
  s_branch UE_38
UB_37:
  ds_read_b64_tr_b16 v[40:41], v89 offset:30720
  ds_read_b64_tr_b16 v[42:43], v89 offset:31488
  ds_read_b64_tr_b16 v[44:45], v89 offset:33792
  ds_read_b64_tr_b16 v[46:47], v89 offset:34560
  s_waitcnt lgkmcnt(0)
  v_accvgpr_write_b32 a56, v40
  v_accvgpr_write_b32 a57, v42
  v_accvgpr_write_b32 a58, v41
  v_accvgpr_write_b32 a59, v43
  v_accvgpr_write_b32 a60, v44
  v_accvgpr_write_b32 a61, v46
  v_accvgpr_write_b32 a62, v45
  v_accvgpr_write_b32 a63, v47
  ds_read_b64_tr_b16 v[48:49], v89 offset:30752
  ds_read_b64_tr_b16 v[50:51], v89 offset:31520
  ds_read_b64_tr_b16 v[52:53], v89 offset:33824
  ds_read_b64_tr_b16 v[54:55], v89 offset:34592
  s_waitcnt lgkmcnt(0)
  v_accvgpr_write_b32 a136, v48
  v_accvgpr_write_b32 a137, v50
  v_accvgpr_write_b32 a138, v49
  v_accvgpr_write_b32 a139, v51
  v_accvgpr_write_b32 a140, v52
  v_accvgpr_write_b32 a141, v54
  v_accvgpr_write_b32 a142, v53
  v_accvgpr_write_b32 a143, v55
  ds_read_b64_tr_b16 v[40:41], v89 offset:30784
  ds_read_b64_tr_b16 v[42:43], v89 offset:31552
  ds_read_b64_tr_b16 v[44:45], v89 offset:33856
  ds_read_b64_tr_b16 v[46:47], v89 offset:34624
  s_waitcnt lgkmcnt(0)
  v_accvgpr_write_b32 a216, v40
  v_accvgpr_write_b32 a217, v42
  v_accvgpr_write_b32 a218, v41
  v_accvgpr_write_b32 a219, v43
  v_accvgpr_write_b32 a220, v44
  v_accvgpr_write_b32 a221, v46
  v_accvgpr_write_b32 a222, v45
  v_accvgpr_write_b32 a223, v47
UE_38:
  s_barrier
  s_cmp_eq_u32 s48, 3
  s_cbranch_scc1 UA_39
  s_waitcnt vmcnt(6)
UA_39:
  s_barrier
  s_cmp_eq_u32 s48, 3
  s_cbranch_scc1 UB_40
  ds_read_b64_tr_b16 v[40:41], v86 offset:0
  ds_read_b64_tr_b16 v[42:43], v86 offset:768
  ds_read_b64_tr_b16 v[44:45], v86 offset:3072
  ds_read_b64_tr_b16 v[46:47], v86 offset:3840
  ds_read_b64_tr_b16 v[48:49], v86 offset:6144
  ds_read_b64_tr_b16 v[50:51], v86 offset:6912
  ds_read_b64_tr_b16 v[52:53], v86 offset:9216
  ds_read_b64_tr_b16 v[54:55], v86 offset:9984
  s_waitcnt lgkmcnt(0)
  v_accvgpr_write_b32 a64, v40
  v_accvgpr_write_b32 a65, v42
  v_accvgpr_write_b32 a66, v41
  v_accvgpr_write_b32 a67, v43
  v_accvgpr_write_b32 a68, v44
  v_accvgpr_write_b32 a69, v46
  v_accvgpr_write_b32 a70, v45
  v_accvgpr_write_b32 a71, v47
  v_accvgpr_write_b32 a144, v48
  v_accvgpr_write_b32 a145, v50
  v_accvgpr_write_b32 a146, v49
  v_accvgpr_write_b32 a147, v51
  v_accvgpr_write_b32 a148, v52
  v_accvgpr_write_b32 a149, v54
  v_accvgpr_write_b32 a150, v53
  v_accvgpr_write_b32 a151, v55
  s_branch UE_41
UB_40:
  ds_read_b64_tr_b16 v[40:41], v84 offset:12288
  ds_read_b64_tr_b16 v[42:43], v84 offset:13056
  ds_read_b64_tr_b16 v[44:45], v84 offset:15360
  ds_read_b64_tr_b16 v[46:47], v84 offset:16128
  s_waitcnt lgkmcnt(0)
  v_accvgpr_write_b32 a64, v40
  v_accvgpr_write_b32 a65, v42
  v_accvgpr_write_b32 a66, v41
  v_accvgpr_write_b32 a67, v43
  v_accvgpr_write_b32 a68, v44
  v_accvgpr_write_b32 a69, v46
  v_accvgpr_write_b32 a70, v45
  v_accvgpr_write_b32 a71, v47
  ds_read_b64_tr_b16 v[48:49], v84 offset:12320
  ds_read_b64_tr_b16 v[50:51], v84 offset:13088
  ds_read_b64_tr_b16 v[52:53], v84 offset:15392
  ds_read_b64_tr_b16 v[54:55], v84 offset:16160
  s_waitcnt lgkmcnt(0)
  v_accvgpr_write_b32 a144, v48
  v_accvgpr_write_b32 a145, v50
  v_accvgpr_write_b32 a146, v49
  v_accvgpr_write_b32 a147, v51
  v_accvgpr_write_b32 a148, v52
  v_accvgpr_write_b32 a149, v54
  v_accvgpr_write_b32 a150, v53
  v_accvgpr_write_b32 a151, v55
  ds_read_b64_tr_b16 v[40:41], v84 offset:12352
  ds_read_b64_tr_b16 v[42:43], v84 offset:13120
  ds_read_b64_tr_b16 v[44:45], v84 offset:15424
  ds_read_b64_tr_b16 v[46:47], v84 offset:16192
  s_waitcnt lgkmcnt(0)
  v_accvgpr_write_b32 a224, v40
  v_accvgpr_write_b32 a225, v42
  v_accvgpr_write_b32 a226, v41
  v_accvgpr_write_b32 a227, v43
  v_accvgpr_write_b32 a228, v44
  v_accvgpr_write_b32 a229, v46
  v_accvgpr_write_b32 a230, v45
  v_accvgpr_write_b32 a231, v47
UE_41:
  s_barrier
  s_cmp_eq_u32 s48, 3
  s_cbranch_scc1 UA_42
  s_waitcnt vmcnt(0)
UA_42:
  s_barrier
  s_cmp_eq_u32 s48, 3
  s_cbranch_scc1 UB_43
  ds_read_b64_tr_b16 v[40:41], v86 offset:18432
  ds_read_b64_tr_b16 v[42:43], v86 offset:19200
  ds_read_b64_tr_b16 v[44:45], v86 offset:21504
  ds_read_b64_tr_b16 v[46:47], v86 offset:22272
  ds_read_b64_tr_b16 v[48:49], v86 offset:24576
  ds_read_b64_tr_b16 v[50:51], v86 offset:25344
  ds_read_b64_tr_b16 v[52:53], v86 offset:27648
  ds_read_b64_tr_b16 v[54:55], v86 offset:28416
  s_waitcnt lgkmcnt(0)
  v_accvgpr_write_b32 a72, v40
  v_accvgpr_write_b32 a73, v42
  v_accvgpr_write_b32 a74, v41
  v_accvgpr_write_b32 a75, v43
  v_accvgpr_write_b32 a76, v44
  v_accvgpr_write_b32 a77, v46
  v_accvgpr_write_b32 a78, v45
  v_accvgpr_write_b32 a79, v47
  v_accvgpr_write_b32 a152, v48
  v_accvgpr_write_b32 a153, v50
  v_accvgpr_write_b32 a154, v49
  v_accvgpr_write_b32 a155, v51
  v_accvgpr_write_b32 a156, v52
  v_accvgpr_write_b32 a157, v54
  v_accvgpr_write_b32 a158, v53
  v_accvgpr_write_b32 a159, v55
  s_branch UE_44
UB_43:
  ds_read_b64_tr_b16 v[40:41], v84 offset:30720
  ds_read_b64_tr_b16 v[42:43], v84 offset:31488
  ds_read_b64_tr_b16 v[44:45], v84 offset:33792
  ds_read_b64_tr_b16 v[46:47], v84 offset:34560
  s_waitcnt lgkmcnt(0)
  v_accvgpr_write_b32 a72, v40
  v_accvgpr_write_b32 a73, v42
  v_accvgpr_write_b32 a74, v41
  v_accvgpr_write_b32 a75, v43
  v_accvgpr_write_b32 a76, v44
  v_accvgpr_write_b32 a77, v46
  v_accvgpr_write_b32 a78, v45
  v_accvgpr_write_b32 a79, v47
  ds_read_b64_tr_b16 v[48:49], v84 offset:30752
  ds_read_b64_tr_b16 v[50:51], v84 offset:31520
  ds_read_b64_tr_b16 v[52:53], v84 offset:33824
  ds_read_b64_tr_b16 v[54:55], v84 offset:34592
  s_waitcnt lgkmcnt(0)
  v_accvgpr_write_b32 a152, v48
  v_accvgpr_write_b32 a153, v50
  v_accvgpr_write_b32 a154, v49
  v_accvgpr_write_b32 a155, v51
  v_accvgpr_write_b32 a156, v52
  v_accvgpr_write_b32 a157, v54
  v_accvgpr_write_b32 a158, v53
  v_accvgpr_write_b32 a159, v55
  ds_read_b64_tr_b16 v[40:41], v84 offset:30784
  ds_read_b64_tr_b16 v[42:43], v84 offset:31552
  ds_read_b64_tr_b16 v[44:45], v84 offset:33856
  ds_read_b64_tr_b16 v[46:47], v84 offset:34624
  s_waitcnt lgkmcnt(0)
  v_accvgpr_write_b32 a232, v40
  v_accvgpr_write_b32 a233, v42
  v_accvgpr_write_b32 a234, v41
  v_accvgpr_write_b32 a235, v43
  v_accvgpr_write_b32 a236, v44
  v_accvgpr_write_b32 a237, v46
  v_accvgpr_write_b32 a238, v45
  v_accvgpr_write_b32 a239, v47
UE_44:
  s_barrier
  s_waitcnt vmcnt(0)
  s_barrier
  ds_read_b64_tr_b16 v[40:41], v85 offset:0
  ds_read_b64_tr_b16 v[42:43], v85 offset:256
  ds_read_b64_tr_b16 v[44:45], v85 offset:1024
  ds_read_b64_tr_b16 v[46:47], v85 offset:1280
  s_waitcnt lgkmcnt(0)
  v_mov_b32 v184, v40
  v_mov_b32 v185, v42
  v_mov_b32 v186, v41
  v_mov_b32 v187, v43
  v_mov_b32 v188, v44
  v_mov_b32 v189, v46
  v_mov_b32 v190, v45
  v_mov_b32 v191, v47
  ds_read_b64_tr_b16 v[40:41], v85 offset:2048
  ds_read_b64_tr_b16 v[42:43], v85 offset:2304
  ds_read_b64_tr_b16 v[44:45], v85 offset:3072
  ds_read_b64_tr_b16 v[46:47], v85 offset:3328
  s_waitcnt lgkmcnt(0)
  v_mov_b32 v192, v40
  v_mov_b32 v193, v42
  v_mov_b32 v194, v41
  v_mov_b32 v195, v43
  v_mov_b32 v196, v44
  v_mov_b32 v197, v46
  v_mov_b32 v198, v45
  v_mov_b32 v199, v47
  ds_read_b64_tr_b16 v[40:41], v85 offset:4096
  ds_read_b64_tr_b16 v[42:43], v85 offset:4352
  ds_read_b64_tr_b16 v[44:45], v85 offset:5120
  ds_read_b64_tr_b16 v[46:47], v85 offset:5376
  s_waitcnt lgkmcnt(0)
  v_mov_b32 v200, v40
  v_mov_b32 v201, v42
  v_mov_b32 v202, v41
  v_mov_b32 v203, v43
  v_mov_b32 v204, v44
  v_mov_b32 v205, v46
  v_mov_b32 v206, v45
  v_mov_b32 v207, v47
  ds_read_b64_tr_b16 v[40:41], v85 offset:6144
  ds_read_b64_tr_b16 v[42:43], v85 offset:6400
  ds_read_b64_tr_b16 v[44:45], v85 offset:7168
  ds_read_b64_tr_b16 v[46:47], v85 offset:7424
  s_waitcnt lgkmcnt(0)
  v_mov_b32 v208, v40
  v_mov_b32 v209, v42
  v_mov_b32 v210, v41
  v_mov_b32 v211, v43
  v_mov_b32 v212, v44
  v_mov_b32 v213, v46
  v_mov_b32 v214, v45
  v_mov_b32 v215, v47
  ds_read_b64_tr_b16 v[40:41], v85 offset:8192
  ds_read_b64_tr_b16 v[42:43], v85 offset:8448
  ds_read_b64_tr_b16 v[44:45], v85 offset:9216
  ds_read_b64_tr_b16 v[46:47], v85 offset:9472
  s_waitcnt lgkmcnt(0)
  v_mov_b32 v216, v40
  v_mov_b32 v217, v42
  v_mov_b32 v218, v41
  v_mov_b32 v219, v43
  v_mov_b32 v220, v44
  v_mov_b32 v221, v46
  v_mov_b32 v222, v45
  v_mov_b32 v223, v47
  ds_read_b64_tr_b16 v[40:41], v85 offset:10240
  ds_read_b64_tr_b16 v[42:43], v85 offset:10496
  ds_read_b64_tr_b16 v[44:45], v85 offset:11264
  ds_read_b64_tr_b16 v[46:47], v85 offset:11520
  s_waitcnt lgkmcnt(0)
  v_mov_b32 v224, v40
  v_mov_b32 v225, v42
  v_mov_b32 v226, v41
  v_mov_b32 v227, v43
  v_mov_b32 v228, v44
  v_mov_b32 v229, v46
  v_mov_b32 v230, v45
  v_mov_b32 v231, v47
  ds_read_b64_tr_b16 v[40:41], v85 offset:12288
  ds_read_b64_tr_b16 v[42:43], v85 offset:12544
  ds_read_b64_tr_b16 v[44:45], v85 offset:13312
  ds_read_b64_tr_b16 v[46:47], v85 offset:13568
  s_waitcnt lgkmcnt(0)
  v_mov_b32 v232, v40
  v_mov_b32 v233, v42
  v_mov_b32 v234, v41
  v_mov_b32 v235, v43
  v_mov_b32 v236, v44
  v_mov_b32 v237, v46
  v_mov_b32 v238, v45
  v_mov_b32 v239, v47
  ds_read_b64_tr_b16 v[40:41], v85 offset:14336
  ds_read_b64_tr_b16 v[42:43], v85 offset:14592
  ds_read_b64_tr_b16 v[44:45], v85 offset:15360
  ds_read_b64_tr_b16 v[46:47], v85 offset:15616
  s_waitcnt lgkmcnt(0)
  v_mov_b32 v240, v40
  v_mov_b32 v241, v42
  v_mov_b32 v242, v41
  v_mov_b32 v243, v43
  v_mov_b32 v244, v44
  v_mov_b32 v245, v46
  v_mov_b32 v246, v45
  v_mov_b32 v247, v47
  ds_read_b64_tr_b16 v[40:41], v85 offset:16384
  ds_read_b64_tr_b16 v[42:43], v85 offset:16640
  ds_read_b64_tr_b16 v[44:45], v85 offset:17408
  ds_read_b64_tr_b16 v[46:47], v85 offset:17664
  s_waitcnt lgkmcnt(0)
  v_mov_b32 v248, v40
  v_mov_b32 v249, v42
  v_mov_b32 v250, v41
  v_mov_b32 v251, v43
  v_mov_b32 v252, v44
  v_mov_b32 v253, v46
  v_mov_b32 v254, v45
  v_mov_b32 v255, v47
  s_barrier
  s_cmp_eq_u32 s26, 1
  s_cbranch_scc1 K_RECS_FAR
  s_mov_b32 s61, 68
PW_45:
  buffer_load_dword v15, off, s[44:47], s61 sc1
  s_waitcnt vmcnt(0)
  v_cmp_eq_u32 vcc, 0, v15
  s_cbranch_vccz PD_46
  s_sleep 4
  s_sub_u32 s64, s64, 1
  s_cbranch_scc0 PW_45
  s_mov_b32 s64, 0
PD_46:
  v_readfirstlane_b32 s87, v15
  s_nop 3
  s_max_u32 s87, s87, 1
  s_sub_u32 s87, s87, 1
  s_xor_b32 s87, s87, 0
  s_lshr_b32 s61, s65, 1
  s_lshl_b32 s61, s61, 14
  s_and_b32 s62, s65, 1
  s_lshl_b32 s62, s62, 12
  s_add_u32 s86, s61, s62
  s_lshl_b32 s62, s87, 13
  s_add_u32 s86, s86, s62
  s_lshl_b32 s62, s49, 9
  s_add_u32 s84, s86, s62
  s_lshr_b32 s61, s89, 1
  s_lshl_b32 s61, s61, 14
  s_and_b32 s62, s89, 1
  s_lshl_b32 s62, s62, 12
  s_add_u32 s31, s61, s62
  s_lshl_b32 s62, s87, 13
  s_add_u32 s31, s31, s62
  s_lshl_b32 s62, s49, 9
  s_add_u32 s31, s31, s62
  s_lshr_b32 s61, s90, 1
  s_lshl_b32 s61, s61, 14
  s_and_b32 s62, s90, 1
  s_lshl_b32 s62, s62, 12
  s_add_u32 s74, s61, s62
  s_lshl_b32 s62, s87, 13
  s_add_u32 s74, s74, s62
  s_lshl_b32 s62, s49, 9
  s_add_u32 s74, s74, s62
  s_lshr_b32 s61, s91, 1
  s_lshl_b32 s61, s61, 14
  s_and_b32 s62, s91, 1
  s_lshl_b32 s62, s62, 12
  s_add_u32 s75, s61, s62
  s_lshl_b32 s62, s87, 13
  s_add_u32 s75, s75, s62
  s_lshl_b32 s62, s49, 9
  s_add_u32 s75, s75, s62
  s_cmp_eq_u32 s48, 0
  s_cbranch_scc0 SBX_48
  s_mov_b64 exec, 1
  s_mov_b32 s61, 64
SB_47:
  buffer_load_dword v15, off, s[44:47], s61 sc1
  s_waitcnt vmcnt(0)
  v_cmp_gt_u32 vcc, 128, v15
  s_cbranch_vccz PD_49
  s_sleep 3
  s_sub_u32 s64, s64, 1
  s_cbranch_scc0 SB_47
  s_mov_b32 s64, 0
PD_49:
  s_mov_b64 exec, -1
SBX_48:
  s_barrier
  s_mul_i32 s61, s51, 12
  s_mul_i32 s62, s52, 3
  s_add_u32 s61, s61, s62
  s_lshl_b32 s66, s61, 16
  s_add_u32 s66, s66, 0
  s_lshl_b32 s69, s61, 14
  s_add_u32 s69, s69, 155189248
  s_lshl_b32 s61, s49, 2
  s_mul_i32 s67, s61, 2621440
  s_add_u32 s67, s67, 50331648
  s_mul_i32 s68, s61, 655360
  s_add_u32 s68, s68, 134217728
  s_mov_b32 s53, 0
  s_cmp_eq_u32 s48, 3
  s_cbranch_scc0 NI_50
  s_mov_b32 s62, 172
  s_mov_b32 s61, 2000000
KW_51:
  buffer_load_dword v15, off, s[44:47], s62 sc1
  s_waitcnt vmcnt(0)
  v_cmp_gt_u32 vcc, 64, v15
  s_cbranch_vccz KD_52
  s_sleep 8
  s_sub_u32 s61, s61, 1
  s_cbranch_scc0 KW_51
KD_52:
  s_mov_b32 s93, 32768
  s_lshl_b32 s61, s89, 16
  s_add_u32 s61, s61, s67
  s_add_u32 s61, s61, 0
  s_add_u32 m0, s93, 0
  s_nop 0
  buffer_load_dwordx4 v11, s[40:43], s61 offen sc1 lds
  s_lshl_b32 s61, s90, 16
  s_add_u32 s61, s61, s67
  s_add_u32 s61, s61, 0
  s_add_u32 m0, s93, 1024
  s_nop 0
  buffer_load_dwordx4 v11, s[40:43], s61 offen sc1 lds
  s_lshl_b32 s61, s91, 16
  s_add_u32 s61, s61, s67
  s_add_u32 s61, s61, 0
  s_add_u32 m0, s93, 2048
  s_nop 0
  buffer_load_dwordx4 v11, s[40:43], s61 offen sc1 lds
  s_lshl_b32 s61, s89, 16
  s_add_u32 s61, s61, s67
  s_add_u32 s61, s61, 2621440
  s_add_u32 m0, s93, 3072
  s_nop 0
  buffer_load_dwordx4 v11, s[40:43], s61 offen sc1 lds
  s_lshl_b32 s61, s90, 16
  s_add_u32 s61, s61, s67
  s_add_u32 s61, s61, 2621440
  s_add_u32 m0, s93, 4096
  s_nop 0
  buffer_load_dwordx4 v11, s[40:43], s61 offen sc1 lds
  s_lshl_b32 s61, s91, 16
  s_add_u32 s61, s61, s67
  s_add_u32 s61, s61, 2621440
  s_add_u32 m0, s93, 5120
  s_nop 0
  buffer_load_dwordx4 v11, s[40:43], s61 offen sc1 lds
  s_lshl_b32 s61, s89, 16
  s_add_u32 s61, s61, s67
  s_add_u32 s61, s61, 5242880
  s_add_u32 m0, s93, 6144
  s_nop 0
  buffer_load_dwordx4 v11, s[40:43], s61 offen sc1 lds
  s_lshl_b32 s61, s90, 16
  s_add_u32 s61, s61, s67
  s_add_u32 s61, s61, 5242880
  s_add_u32 m0, s93, 7168
  s_nop 0
  buffer_load_dwordx4 v11, s[40:43], s61 offen sc1 lds
  s_lshl_b32 s61, s91, 16
  s_add_u32 s61, s61, s67
  s_add_u32 s61, s61, 5242880
  s_add_u32 m0, s93, 8192
  s_nop 0
  buffer_load_dwordx4 v11, s[40:43], s61 offen sc1 lds
  s_lshl_b32 s61, s89, 16
  s_add_u32 s61, s61, s67
  s_add_u32 s61, s61, 7864320
  s_add_u32 m0, s93, 9216
  s_nop 0
  buffer_load_dwordx4 v11, s[40:43], s61 offen sc1 lds
  s_lshl_b32 s61, s90, 16
  s_add_u32 s61, s61, s67
  s_add_u32 s61, s61, 7864320
  s_add_u32 m0, s93, 10240
  s_nop 0
  buffer_load_dwordx4 v11, s[40:43], s61 offen sc1 lds
  s_lshl_b32 s61, s91, 16
  s_add_u32 s61, s61, s67
  s_add_u32 s61, s61, 7864320
  s_add_u32 m0, s93, 11264
  s_nop 0
  buffer_load_dwordx4 v11, s[40:43], s61 offen sc1 lds
  s_add_u32 m0, s93, 12288
  s_add_u32 s61, s66, 0
  buffer_load_dwordx4 v3, s[40:43], s61 offen sc1 lds
  s_add_u32 m0, s93, 13312
  s_add_u32 s61, s66, 65536
  buffer_load_dwordx4 v3, s[40:43], s61 offen sc1 lds
  s_add_u32 m0, s93, 14336
  s_add_u32 s61, s66, 131072
  buffer_load_dwordx4 v3, s[40:43], s61 offen sc1 lds
NI_50:
  s_add_u32 s66, s66, 1024
  s_add_u32 s67, s67, 1024
  s_mov_b32 s32, s12
  s_mov_b32 s33, s13
  s_mov_b32 s34, 10240
  s_mov_b32 s35, 0x20000
  v_bfe_u32 v15, v1, 1, 3
  v_mul_u32_u24 v15, 1280, v15
  v_lshrrev_b32 v16, 4, v1
  v_lshl_add_u32 v15, v16, 5, v15
  v_and_b32 v16, 1, v1
  v_lshl_add_u32 v15, v16, 4, v15
  s_lshl_b32 s61, s48, 7
  buffer_load_dwordx4 v[84:87], v15, s[32:35], s61 offen offset:0
  buffer_load_dwordx4 v[88:91], v15, s[32:35], s61 offen offset:512
  buffer_load_dwordx4 v[92:95], v15, s[32:35], s61 offen offset:1024
  v_mov_b32 v17, 0
  v_mov_b32 v18, 31744
  ds_write_b32 v18, v17
  s_waitcnt vmcnt(0) lgkmcnt(0)
  s_barrier
  s_add_u32 s61, s53, 0
  s_and_b32 s61, s61, 3
  s_mul_i32 s61, s61, 344064
  s_add_u32 s55, s61, s92
  s_add_u32 s61, s53, 1
  s_and_b32 s61, s61, 3
  s_mul_i32 s61, s61, 344064
  s_add_u32 s56, s61, s92
  s_add_u32 s61, s53, 2
  s_and_b32 s61, s61, 3
  s_mul_i32 s61, s61, 344064
  s_add_u32 s57, s61, s92
  s_add_u32 s61, s53, 3
  s_and_b32 s61, s61, 3
  s_mul_i32 s61, s61, 344064
  s_add_u32 s58, s61, s92
  s_and_b32 s61, s53, 3
  s_mul_i32 s59, s61, 327680
  s_add_u32 s59, s59, 180355072
  s_xor_b32 s61, s61, 2
  s_mul_i32 s60, s61, 327680
  s_add_u32 s60, s60, 180355072
  ds_write_b128 v14, v[84:87] offset:0
  ds_write_b128 v14, v[88:91] offset:4096
  s_cmp_lt_u32 s48, 2
  s_cbranch_scc0 NW_53
  ds_write_b128 v14, v[92:95] offset:8192
NW_53:
  v_mov_b32 v64, 0
  v_mov_b32 v65, 0
  v_mov_b32 v66, 0
  v_mov_b32 v67, 0
  v_mov_b32 v68, 0
  v_mov_b32 v69, 0
  v_mov_b32 v70, 0
  v_mov_b32 v71, 0
  v_mov_b32 v72, 0
  v_mov_b32 v73, 0
  v_mov_b32 v74, 0
  v_mov_b32 v75, 0
  s_and_b32 s81, s53, 1
  s_mul_i32 s81, s81, 15360
  s_add_u32 s81, s81, 32768
  s_xor_b32 s83, s53, 1
  s_and_b32 s83, s83, 1
  s_mul_i32 s83, s83, 15360
  s_add_u32 s83, s83, 32768
  s_mul_i32 s61, s48, 3072
  s_add_u32 s61, s61, s81
  v_add_u32 v17, s61, v3
  v_add_u32 v18, s81, v100
  s_lshl_b32 s61, s24, 14
  s_add_u32 s20, s61, s68
  s_sub_u32 s20, s20, 256
  s_lshl_b32 s61, s48, 14
  s_add_u32 s21, s61, s69
  s_sub_u32 s21, s21, 256
  s_waitcnt lgkmcnt(0)
  s_branch REC_BC
REC_LOOP:
  v_mov_b32 v64, 0
  v_mov_b32 v65, 0
  v_mov_b32 v66, 0
  v_mov_b32 v67, 0
  v_mov_b32 v68, 0
  v_mov_b32 v69, 0
  v_mov_b32 v70, 0
  v_mov_b32 v71, 0
  v_mov_b32 v72, 0
  v_mov_b32 v73, 0
  v_mov_b32 v74, 0
  v_mov_b32 v75, 0
  s_and_b32 s81, s53, 1
  s_mul_i32 s81, s81, 15360
  s_add_u32 s81, s81, 32768
  s_xor_b32 s83, s53, 1
  s_and_b32 s83, s83, 1
  s_mul_i32 s83, s83, 15360
  s_add_u32 s83, s83, 32768
  s_mul_i32 s61, s48, 3072
  s_add_u32 s61, s61, s81
  v_add_u32 v17, s61, v3
  v_add_u32 v18, s81, v100
  s_lshl_b32 s61, s24, 14
  s_add_u32 s20, s61, s68
  s_sub_u32 s20, s20, 256
  s_lshl_b32 s61, s48, 14
  s_add_u32 s21, s61, s69
  s_sub_u32 s21, s21, 256
  s_add_u32 s62, s55, 4096
  s_add_u32 s63, s55, 8192
  s_cmp_lt_u32 s48, 2
  s_cbranch_scc1 PM0_55
PM_54:
  buffer_load_dwordx4 v[84:87], v14, s[40:43], s55 offen sc1
  buffer_load_dwordx4 v[88:91], v14, s[40:43], s62 offen sc1
  s_waitcnt vmcnt(0)
  v_max3_u32 v15, v85, v87, v89
  v_mov_b32 v16, v91
  v_max_u32 v15, v15, v16
  v_cmp_eq_u32 vcc, -1, v15
  s_cbranch_vccz PD_56
  s_sub_u32 s64, s64, 1
  s_cbranch_scc0 PM_54
  s_mov_b32 s64, 0
PD_56:
  ds_write_b128 v14, v[84:87] offset:0
  ds_write_b128 v14, v[88:91] offset:4096
  s_waitcnt lgkmcnt(0)
  s_branch REC_BC2
PM0_55:
  buffer_load_dwordx4 v[84:87], v14, s[40:43], s55 offen sc1
  buffer_load_dwordx4 v[88:91], v14, s[40:43], s62 offen sc1
  buffer_load_dwordx4 v[92:95], v14, s[40:43], s63 offen sc1
  s_waitcnt vmcnt(0)
  v_max3_u32 v15, v85, v87, v89
  v_max3_u32 v16, v91, v93, v95
  v_max_u32 v15, v15, v16
  v_cmp_eq_u32 vcc, -1, v15
  s_cbranch_vccz PD_57
  s_sub_u32 s64, s64, 1
  s_cbranch_scc0 PM0_55
  s_mov_b32 s64, 0
PD_57:
  ds_write_b128 v14, v[84:87] offset:0
  ds_write_b128 v14, v[88:91] offset:4096
  ds_write_b128 v14, v[92:95] offset:8192
  s_waitcnt lgkmcnt(0)
  s_branch REC_BC2
REC_BC:
REC_BC2:
  s_barrier
  ds_read_b128 v[92:95], v106 offset:26112
  ds_read_b64_tr_b16 v[96:97], v107
  ds_read_b128 v[24:27], v3 offset:0
  ds_read_b128 v[28:31], v3 offset:1024
  ds_read_b128 v[32:35], v3 offset:2048
  ds_read_b128 v[36:39], v3 offset:3072
  ds_read_b128 v[40:43], v3 offset:4096
  ds_read_b128 v[44:47], v3 offset:5120
  ds_read_b128 v[48:51], v3 offset:6144
  ds_read_b128 v[52:55], v3 offset:7168
  ds_read_b128 v[56:59], v3 offset:8192
  ds_read_b128 v[60:63], v3 offset:9216
  s_cmp_eq_u32 s48, 3
  s_cbranch_scc1 A3_58
  s_waitcnt lgkmcnt(9)
  s_cmp_eq_u32 s53, 0
  s_cbranch_scc1 S0_68
  s_cmp_ge_u32 s48, s54
  s_cbranch_scc1 S1_69
  buffer_store_dwordx4 v[92:95], v2, s[40:43], s20 offen sc1
S1_69:
  s_mov_b64 exec, s[78:79]
  buffer_store_dwordx2 v[96:97], v13, s[40:43], s21 offen sc1
  s_mov_b64 exec, -1
S0_68:
  v_smfmac_f32_16x16x64_bf16 v[64:67], v[24:27], a[0:7], v19
  v_smfmac_f32_16x16x64_bf16 v[68:71], v[24:27], a[80:87], v19
  s_waitcnt lgkmcnt(8)
  v_smfmac_f32_16x16x64_bf16 v[64:67], v[28:31], a[8:15], v19
  v_smfmac_f32_16x16x64_bf16 v[68:71], v[28:31], a[88:95], v19
  s_waitcnt lgkmcnt(7)
  v_smfmac_f32_16x16x64_bf16 v[64:67], v[32:35], a[16:23], v19
  v_smfmac_f32_16x16x64_bf16 v[68:71], v[32:35], a[96:103], v19
  s_waitcnt lgkmcnt(6)
  v_smfmac_f32_16x16x64_bf16 v[64:67], v[36:39], a[24:31], v19
  v_smfmac_f32_16x16x64_bf16 v[68:71], v[36:39], a[104:111], v19
  ds_read_b128 v[140:143], v17 offset:0
  ds_read_b128 v[144:147], v17 offset:1024
  ds_read_b128 v[148:151], v17 offset:2048
  ds_read_b64 v[120:121], v18 offset:12288
  ds_read_b64 v[122:123], v18 offset:13312
  ds_read_b64 v[124:125], v18 offset:14336
  s_waitcnt lgkmcnt(11)
  v_smfmac_f32_16x16x64_bf16 v[64:67], v[40:43], a[32:39], v19
  v_smfmac_f32_16x16x64_bf16 v[68:71], v[40:43], a[112:119], v19
  s_waitcnt lgkmcnt(10)
  v_smfmac_f32_16x16x64_bf16 v[64:67], v[44:47], a[40:47], v19
  v_smfmac_f32_16x16x64_bf16 v[68:71], v[44:47], a[120:127], v19
  s_waitcnt lgkmcnt(9)
  v_smfmac_f32_16x16x64_bf16 v[64:67], v[48:51], a[48:55], v19
  v_smfmac_f32_16x16x64_bf16 v[68:71], v[48:51], a[128:135], v19
  s_waitcnt lgkmcnt(8)
  v_smfmac_f32_16x16x64_bf16 v[64:67], v[52:55], a[56:63], v19
  v_smfmac_f32_16x16x64_bf16 v[68:71], v[52:55], a[136:143], v19
  s_waitcnt lgkmcnt(7)
  v_smfmac_f32_16x16x64_bf16 v[64:67], v[56:59], a[64:71], v19
  v_smfmac_f32_16x16x64_bf16 v[68:71], v[56:59], a[144:151], v19
  s_waitcnt lgkmcnt(6)
  v_smfmac_f32_16x16x64_bf16 v[64:67], v[60:63], a[72:79], v19
  v_smfmac_f32_16x16x64_bf16 v[68:71], v[60:63], a[152:159], v19
  s_lshl_b32 s61, s48, 8
  v_add_u32 v15, s61, v76
  s_lshl_b32 s61, s48, 9
  v_add_u32 v16, s61, v78
  s_nop 2
  v_add_f32 v64, v64, v65
  v_add_f32 v66, v66, v67
  v_add_f32 v68, v68, v69
  v_add_f32 v70, v70, v71
  v_cvt_pk_bf16_f32 v64, v64, v66
  v_cvt_pk_bf16_f32 v68, v68, v70
  ds_write_b32 v15, v64
  ds_write_b32 v16, v68
  s_branch AJ_59
A3_58:
  s_waitcnt lgkmcnt(9)
  v_smfmac_f32_16x16x64_bf16 v[64:67], v[24:27], a[0:7], v19
  v_smfmac_f32_16x16x64_bf16 v[68:71], v[24:27], a[80:87], v19
  v_smfmac_f32_16x16x64_bf16 v[72:75], v[24:27], a[160:167], v19
  s_waitcnt lgkmcnt(8)
  v_smfmac_f32_16x16x64_bf16 v[64:67], v[28:31], a[8:15], v19
  v_smfmac_f32_16x16x64_bf16 v[68:71], v[28:31], a[88:95], v19
  v_smfmac_f32_16x16x64_bf16 v[72:75], v[28:31], a[168:175], v19
  s_waitcnt lgkmcnt(7)
  v_smfmac_f32_16x16x64_bf16 v[64:67], v[32:35], a[16:23], v19
  v_smfmac_f32_16x16x64_bf16 v[68:71], v[32:35], a[96:103], v19
  v_smfmac_f32_16x16x64_bf16 v[72:75], v[32:35], a[176:183], v19
  s_waitcnt lgkmcnt(6)
  v_smfmac_f32_16x16x64_bf16 v[64:67], v[36:39], a[24:31], v19
  v_smfmac_f32_16x16x64_bf16 v[68:71], v[36:39], a[104:111], v19
  v_smfmac_f32_16x16x64_bf16 v[72:75], v[36:39], a[184:191], v19
  ds_read_b128 v[140:143], v17 offset:0
  ds_read_b128 v[144:147], v17 offset:1024
  ds_read_b128 v[148:151], v17 offset:2048
  ds_read_b64 v[120:121], v18 offset:12288
  ds_read_b64 v[122:123], v18 offset:13312
  ds_read_b64 v[124:125], v18 offset:14336
  s_waitcnt lgkmcnt(11)
  v_smfmac_f32_16x16x64_bf16 v[64:67], v[40:43], a[32:39], v19
  v_smfmac_f32_16x16x64_bf16 v[68:71], v[40:43], a[112:119], v19
  v_smfmac_f32_16x16x64_bf16 v[72:75], v[40:43], a[192:199], v19
  s_waitcnt lgkmcnt(10)
  v_smfmac_f32_16x16x64_bf16 v[64:67], v[44:47], a[40:47], v19
  v_smfmac_f32_16x16x64_bf16 v[68:71], v[44:47], a[120:127], v19
  v_smfmac_f32_16x16x64_bf16 v[72:75], v[44:47], a[200:207], v19
  s_waitcnt lgkmcnt(9)
  v_smfmac_f32_16x16x64_bf16 v[64:67], v[48:51], a[48:55], v19
  v_smfmac_f32_16x16x64_bf16 v[68:71], v[48:51], a[128:135], v19
  v_smfmac_f32_16x16x64_bf16 v[72:75], v[48:51], a[208:215], v19
  s_waitcnt lgkmcnt(8)
  v_smfmac_f32_16x16x64_bf16 v[64:67], v[52:55], a[56:63], v19
  v_smfmac_f32_16x16x64_bf16 v[68:71], v[52:55], a[136:143], v19
  v_smfmac_f32_16x16x64_bf16 v[72:75], v[52:55], a[216:223], v19
  s_waitcnt lgkmcnt(7)
  v_smfmac_f32_16x16x64_bf16 v[64:67], v[56:59], a[64:71], v19
  v_smfmac_f32_16x16x64_bf16 v[68:71], v[56:59], a[144:151], v19
  v_smfmac_f32_16x16x64_bf16 v[72:75], v[56:59], a[224:231], v19
  s_waitcnt lgkmcnt(6)
  v_smfmac_f32_16x16x64_bf16 v[64:67], v[60:63], a[72:79], v19
  v_smfmac_f32_16x16x64_bf16 v[68:71], v[60:63], a[152:159], v19
  v_smfmac_f32_16x16x64_bf16 v[72:75], v[60:63], a[232:239], v19
  s_barrier
  s_nop 6
  v_add_f32 v64, v64, v65
  v_add_f32 v66, v66, v67
  v_add_f32 v68, v68, v69
  v_add_f32 v70, v70, v71
  v_add_f32 v72, v72, v73
  v_add_f32 v74, v74, v75
  v_cvt_pk_bf16_f32 v64, v64, v66
  v_cvt_pk_bf16_f32 v68, v68, v70
  v_cvt_pk_bf16_f32 v72, v72, v74
  ds_write_b32 v76, v64 offset:768
  ds_write_b32 v76, v68 offset:1024
  ds_write_b32 v76, v72 offset:1280
  s_waitcnt lgkmcnt(0)
  s_branch AV_60
AJ_59:
  s_waitcnt lgkmcnt(0)
  s_barrier
  ds_read_b64_tr_b16 v[108:109], v77 offset:0
  ds_read_b64_tr_b16 v[110:111], v77 offset:256
  ds_read_b64_tr_b16 v[112:113], v77 offset:512
  s_cmp_eq_u32 s48, 0
  s_cbranch_scc0 AX_61
  ds_read_b64_tr_b16 v[114:115], v79 offset:0
  ds_read_b64_tr_b16 v[116:117], v79 offset:512
  ds_read_b64_tr_b16 v[118:119], v79 offset:1024
  s_waitcnt lgkmcnt(0)
  v_mfma_f32_16x16x16_bf16 v[136:139], v[114:115], v[108:109], 0
  v_mfma_f32_16x16x16_bf16 v[136:139], v[116:117], v[110:111], v[136:139]
  v_mfma_f32_16x16x16_bf16 v[136:139], v[118:119], v[112:113], v[136:139]
  v_mov_b32 v24, 0
  v_mov_b32 v25, 0
  v_mov_b32 v26, 0
  v_mov_b32 v27, 0
  v_mov_b32 v28, 0
  v_mov_b32 v29, 0
  v_mov_b32 v30, 0
  s_add_u32 s61, s55, s82
  s_mov_b64 exec, s[76:77]
  buffer_store_dwordx2 v[136:137], v82, s[40:43], s61 offen
  s_mov_b64 exec, -1
  v_mov_b32 v31, 0
  v_mov_b32 v32, 0
  v_mov_b32 v33, 0
  v_mov_b32 v34, 0
  v_mov_b32 v35, 0
  s_add_u32 s61, s57, s80
  s_mov_b64 exec, s[76:77]
  buffer_store_dwordx2 v[20:21], v82, s[40:43], s61 offen
  s_mov_b64 exec, -1
  s_branch AB_63
AX_61:
  s_waitcnt lgkmcnt(0)
  v_mfma_f32_16x16x16_bf16 v[136:139], v[120:121], v[108:109], 0
  v_mfma_f32_16x16x16_bf16 v[136:139], v[122:123], v[110:111], v[136:139]
  v_mfma_f32_16x16x16_bf16 v[136:139], v[124:125], v[112:113], v[136:139]
  v_mov_b32 v24, 0
  v_mov_b32 v25, 0
  v_mov_b32 v26, 0
  v_mov_b32 v27, 0
  v_mov_b32 v28, 0
  v_mov_b32 v29, 0
  v_mov_b32 v30, 0
  s_add_u32 s61, s55, s82
  s_mov_b64 exec, s[76:77]
  buffer_store_dwordx4 v[136:139], v5, s[40:43], s61 offen
  s_mov_b64 exec, -1
  v_mov_b32 v31, 0
  v_mov_b32 v32, 0
  v_mov_b32 v33, 0
  v_mov_b32 v34, 0
  v_mov_b32 v35, 0
  s_cmp_eq_u32 s48, 2
  s_cbranch_scc1 W2_70
  s_add_u32 s61, s57, s82
  s_mov_b64 exec, s[76:77]
  buffer_store_dwordx4 v[20:23], v5, s[40:43], s61 offen
  s_mov_b64 exec, -1
  s_branch W1_71
W2_70:
  s_add_u32 s61, s57, s82
  s_mov_b64 exec, s[76:77]
  buffer_store_dwordx4 v[20:23], v5, s[40:43], s61 offen
  s_mov_b64 exec, -1
W1_71:
  s_branch AB_63
AV_60:
  ds_read_b64_tr_b16 v[108:109], v77 offset:768
  ds_read_b64_tr_b16 v[110:111], v77 offset:1024
  ds_read_b64_tr_b16 v[112:113], v77 offset:1280
  s_waitcnt lgkmcnt(0)
  s_add_u32 s61, s30, s55
  s_mov_b64 exec, s[76:77]
  buffer_store_dwordx2 v[108:109], v8, s[40:43], s61 offen offset:0
  buffer_store_dwordx2 v[110:111], v8, s[40:43], s61 offen offset:256
  buffer_store_dwordx2 v[112:113], v8, s[40:43], s61 offen offset:512
  s_mov_b64 exec, -1
  v_mov_b32 v24, 0
  v_mov_b32 v25, 0
  v_mov_b32 v26, 0
  v_mov_b32 v27, 0
  v_mov_b32 v28, 0
  v_mov_b32 v29, 0
  v_mov_b32 v30, 0
  v_mov_b32 v31, 0
  v_mov_b32 v32, 0
  v_mov_b32 v33, 0
  v_mov_b32 v34, 0
  v_mov_b32 v35, 0
  s_add_u32 s61, s30, s57
  s_mov_b32 exec_hi, 0xffff
  buffer_store_dwordx4 v[20:23], v3, s[40:43], s61 offen
  s_mov_b64 exec, -1
AB_63:
  s_mul_i32 s62, s48, 3072
  s_add_u32 s62, s62, 30720
  s_add_u32 s62, s62, s55
  s_mul_i32 s61, s48, 2621440
  s_add_u32 s23, s61, s67
  s_mul_i32 s61, s48, 3072
  s_add_u32 s3, s61, s83
  s_min_u32 s61, s48, 2
  s_lshl_b32 s22, s61, 16
  s_add_u32 s22, s22, s66
  s_lshl_b32 s61, s61, 10
  s_add_u32 s70, s61, s83
  s_add_u32 s70, s70, 12288
  s_cmp_eq_u32 s53, 63
  s_cbranch_scc1 REC_LAST
  s_sub_u32 s61, s60, s59
  v_mad_i32_i24 v101, v103, s61, v5
  v_add_u32 v101, s59, v101
  s_sub_u32 s61, s58, s56
  v_mad_i32_i24 v102, v103, s61, v8
  v_add_u32 v102, s56, v102
PS_72:
  buffer_load_dwordx4 v[84:87], v3, s[40:43], s62 offen offset:0 sc1
  buffer_load_dwordx4 v[88:91], v3, s[40:43], s62 offen offset:1024 sc1
  buffer_load_dwordx4 v[92:95], v3, s[40:43], s62 offen offset:2048 sc1
  buffer_load_dwordx4 v[36:39], v6, s[40:43], s55 offen offset:0 sc1
  buffer_load_dword v64, v7, s[40:43], s55 offen offset:0 sc1
  buffer_load_dwordx4 v[40:43], v6, s[40:43], s55 offen offset:1280 sc1
  buffer_load_dword v65, v7, s[40:43], s55 offen offset:1280 sc1
  buffer_load_dwordx4 v[44:47], v6, s[40:43], s55 offen offset:2560 sc1
  buffer_load_dword v66, v7, s[40:43], s55 offen offset:2560 sc1
  buffer_load_dwordx4 v[48:51], v6, s[40:43], s55 offen offset:3840 sc1
  buffer_load_dword v67, v7, s[40:43], s55 offen offset:3840 sc1
  s_waitcnt vmcnt(0)
  v_max3_u32 v15, v85, v87, v89
  v_max3_u32 v16, v91, v93, v95
  v_max3_u32 v15, v36, v40, v15
  v_max3_u32 v16, v44, v48, v16
  v_max3_u32 v15, v64, v65, v15
  v_max3_u32 v16, v66, v67, v16
  v_max_u32 v15, v15, v16
  v_cmp_eq_u32 vcc, -1, v15
  s_cbranch_vccz PD_73
  s_sub_u32 s64, s64, 1
  s_cbranch_scc0 PS_72
  s_mov_b32 s64, 0
PD_73:
  v_smfmac_f32_16x16x64_bf16 v[24:27], v[84:87], v[184:191], v19
  v_pk_add_f32 v[36:37], v[36:37], v[40:41]
  v_pk_add_f32 v[38:39], v[38:39], v[42:43]
  v_smfmac_f32_16x16x64_bf16 v[28:31], v[84:87], v[208:215], v19
  v_pk_add_f32 v[44:45], v[44:45], v[48:49]
  v_pk_add_f32 v[46:47], v[46:47], v[50:51]
  v_smfmac_f32_16x16x64_bf16 v[32:35], v[84:87], v[232:239], v19
  v_pk_add_f32 v[64:65], v[64:65], v[66:67]
  v_pk_add_f32 v[48:49], v[36:37], v[44:45]
  v_smfmac_f32_16x16x64_bf16 v[24:27], v[88:91], v[192:199], v19
  v_pk_add_f32 v[50:51], v[38:39], v[46:47]
  v_add_f32 v52, v64, v65
  v_smfmac_f32_16x16x64_bf16 v[28:31], v[88:91], v[216:223], v19
  v_max3_f32 v68, v48, v49, v50
  v_max3_f32 v68, v51, v52, v68
  v_smfmac_f32_16x16x64_bf16 v[32:35], v[88:91], v[240:247], v19
  s_lshl_b32 s61, s89, 16
  s_add_u32 m0, s3, 0
  s_add_u32 s61, s61, s23
  buffer_load_dwordx4 v11, s[40:43], s61 offen sc1 lds
  v_max_f32_dpp v68, v68, v68 row_ror:8 row_mask:0xf bank_mask:0xf
  v_smfmac_f32_16x16x64_bf16 v[24:27], v[92:95], v[200:207], v19
  v_mov_b32 v69, v68
  s_lshl_b32 s61, s90, 16
  s_add_u32 m0, s3, 1024
  s_add_u32 s61, s61, s23
  buffer_load_dwordx4 v11, s[40:43], s61 offen sc1 lds
  v_smfmac_f32_16x16x64_bf16 v[28:31], v[92:95], v[224:231], v19
  v_permlane16_swap_b32 v68, v69
  s_cmp_eq_u32 s54, 2
  s_cbranch_scc1 PD2_74
  s_lshl_b32 s61, s91, 16
  s_add_u32 m0, s3, 2048
  s_add_u32 s61, s61, s23
  buffer_load_dwordx4 v11, s[40:43], s61 offen sc1 lds
PD2_74:
  s_nop 0
  v_smfmac_f32_16x16x64_bf16 v[32:35], v[92:95], v[248:255], v19
  v_max_f32 v68, v68, v69
  v_mov_b32 v69, v68
  s_mov_b32 m0, s70
  s_nop 0
  buffer_load_dwordx4 v3, s[40:43], s22 offen sc1 lds
  v_permlane32_swap_b32 v68, v69
  s_nop 0
  v_max_f32 v68, v68, v69
  v_mul_f32 v68, s88, v68
  v_fma_f32 v48, v48, s88, -v68
  v_fma_f32 v49, v49, s88, -v68
  v_fma_f32 v50, v50, s88, -v68
  v_fma_f32 v51, v51, s88, -v68
  v_fma_f32 v52, v52, s88, -v68
  v_exp_f32 v52, v52
  v_exp_f32 v48, v48
  v_exp_f32 v49, v49
  v_exp_f32 v50, v50
  v_exp_f32 v51, v51
  v_add_f32 v24, v24, v25
  v_add_f32 v26, v26, v27
  v_add_f32 v28, v28, v29
  v_add_f32 v30, v30, v31
  v_add_f32 v32, v32, v33
  v_add_f32 v34, v34, v35
  v_cvt_pk_bf16_f32 v164, v24, v26
  v_cvt_pk_bf16_f32 v166, v28, v30
  v_cvt_pk_bf16_f32 v168, v32, v34
  v_mov_b32_dpp v53, v52 row_ror:8 row_mask:0xf bank_mask:0xf
  v_cvt_pk_bf16_f32 v128, v48, v49
  v_cvt_pk_bf16_f32 v129, v50, v51
  v_cvt_pk_bf16_f32 v132, v52, v53
  v_mov_b32_dpp v130, v128 row_ror:8 row_mask:0xf bank_mask:0xf
  v_mov_b32_dpp v131, v129 row_ror:8 row_mask:0xf bank_mask:0xf
  s_nop 1
  v_mfma_f32_16x16x32_bf16 v[36:39], v[140:143], v[128:131], 0
  v_mfma_f32_16x16x32_bf16 v[40:43], v[144:147], v[128:131], 0
  v_mfma_f32_16x16x32_bf16 v[44:47], v[148:151], v[128:131], 0
  v_mfma_f32_16x16x32_bf16 v[176:179], v[172:175], v[128:131], 0
  s_nop 2
  v_mfma_f32_16x16x16_bf16 v[36:39], v[164:165], v[132:133], v[36:39]
  v_mfma_f32_16x16x16_bf16 v[40:43], v[166:167], v[132:133], v[40:43]
  v_mfma_f32_16x16x16_bf16 v[44:47], v[168:169], v[132:133], v[44:47]
  v_mfma_f32_16x16x16_bf16 v[176:179], v[172:173], v[132:133], v[176:179]
  s_lshl_b32 s61, s48, 8
  v_add_u32 v15, s61, v12
  ds_write_b32 v15, v164 offset:26112
  ds_write_b32 v15, v166 offset:27136
  ds_write_b32 v15, v168 offset:28160
  s_nop 2
  v_rcp_f32 v80, v176
  s_nop 0
  v_mov_b32 v81, v80
  v_pk_mul_f32 v[36:37], v[36:37], v[80:81]
  v_pk_mul_f32 v[38:39], v[38:39], v[80:81]
  v_pk_mul_f32 v[40:41], v[40:41], v[80:81]
  v_pk_mul_f32 v[42:43], v[42:43], v[80:81]
  v_pk_mul_f32 v[44:45], v[44:45], v[80:81]
  v_pk_mul_f32 v[46:47], v[46:47], v[80:81]
  ds_write_b128 v14, v[36:39] offset:13824
  ds_write_b128 v14, v[40:43] offset:17920
  ds_write_b128 v14, v[44:47] offset:22016
  s_waitcnt lgkmcnt(0)
  s_barrier
  s_cmp_eq_u32 s48, 3
  s_cbranch_scc1 W3_76
  s_cmp_lt_u32 s48, s54
  s_cbranch_scc0 BN_75
  s_lshl_b32 s61, s48, 12
  v_add_u32 v15, s61, v4
  ds_read_b128 v[84:87], v15 offset:13824
  ds_read_b128 v[88:91], v15 offset:14848
  s_waitcnt lgkmcnt(0)
  v_pk_add_f32 v[84:85], v[84:85], v[88:89]
  v_pk_add_f32 v[86:87], v[86:87], v[90:91]
  s_nop 1
  v_add_f32_dpp v180, v84, v84 row_ror:8 row_mask:0xf bank_mask:0x3
  v_add_f32_dpp v181, v85, v85 row_ror:8 row_mask:0xf bank_mask:0x3
  v_add_f32_dpp v182, v86, v86 row_ror:8 row_mask:0xf bank_mask:0x3
  v_add_f32_dpp v183, v87, v87 row_ror:8 row_mask:0xf bank_mask:0x3
  buffer_store_dwordx4 v[180:183], v101, s[40:43], s84 offen sc1
BN_75:
  s_add_u32 s53, s53, 1
  s_add_u32 s62, s59, s86
  s_add_u32 s61, s53, 0
  s_and_b32 s61, s61, 3
  s_mul_i32 s61, s61, 344064
  s_add_u32 s55, s61, s92
  s_add_u32 s61, s53, 1
  s_and_b32 s61, s61, 3
  s_mul_i32 s61, s61, 344064
  s_add_u32 s56, s61, s92
  s_add_u32 s61, s53, 2
  s_and_b32 s61, s61, 3
  s_mul_i32 s61, s61, 344064
  s_add_u32 s57, s61, s92
  s_add_u32 s61, s53, 3
  s_and_b32 s61, s61, 3
  s_mul_i32 s61, s61, 344064
  s_add_u32 s58, s61, s92
  s_and_b32 s61, s53, 3
  s_mul_i32 s59, s61, 327680
  s_add_u32 s59, s59, 180355072
  s_xor_b32 s61, s61, 2
  s_mul_i32 s60, s61, 327680
  s_add_u32 s60, s60, 180355072
  s_cmp_lt_u32 s48, s54
  s_cbranch_scc0 CE_77
  s_sleep 8
PG_78:
  buffer_load_dwordx4 v[84:87], v9, s[40:43], s62 offen offset:0 sc1
  buffer_load_dwordx4 v[88:91], v9, s[40:43], s62 offen offset:512 sc1
  buffer_load_dwordx4 v[92:95], v9, s[40:43], s62 offen offset:1024 sc1
  buffer_load_dwordx4 v[96:99], v9, s[40:43], s62 offen offset:1536 sc1
  s_waitcnt vmcnt(0)
  v_max3_u32 v15, v84, v88, v92
  v_mov_b32 v16, v96
  v_max_u32 v15, v15, v16
  v_cmp_eq_u32 vcc, -1, v15
  s_cbranch_vccz PD_79
  s_sub_u32 s64, s64, 1
  s_cbranch_scc0 PG_78
  s_mov_b32 s64, 0
PD_79:
  v_pk_add_f32 v[84:85], v[84:85], v[88:89]
  v_pk_add_f32 v[86:87], v[86:87], v[90:91]
  v_pk_add_f32 v[92:93], v[92:93], v[96:97]
  v_pk_add_f32 v[94:95], v[94:95], v[98:99]
  v_pk_add_f32 v[84:85], v[84:85], v[92:93]
  v_pk_add_f32 v[86:87], v[86:87], v[94:95]
  s_nop 1
  v_add_f32_dpp v84, v84, v84 row_ror:8 row_mask:0xf bank_mask:0xf
  v_add_f32_dpp v85, v85, v85 row_ror:8 row_mask:0xf bank_mask:0xf
  v_add_f32_dpp v86, v86, v86 row_ror:8 row_mask:0xf bank_mask:0xf
  v_add_f32_dpp v87, v87, v87 row_ror:8 row_mask:0xf bank_mask:0xf
  s_mov_b64 exec, s[76:77]
  v_cvt_pk_bf16_f32 v170, v84, v85
  v_cvt_pk_bf16_f32 v171, v86, v87
  s_mov_b64 exec, -1
  buffer_store_dwordx2 v[170:171], v102, s[40:43], s85 offen
  s_branch CE_77
W3_76:
  s_lshl_b32 s61, s49, 4
  s_add_u32 s61, s61, s50
  s_lshl_b32 s61, s61, 8
  s_add_u32 s61, s61, 182452224
  v_mov_b32 v15, s53
  s_mov_b64 exec, 1
  buffer_store_dword v15, off, s[40:43], s61 sc1
  s_mov_b64 exec, -1
  s_cmp_eq_u32 s53, 2
  s_cbranch_scc0 K4_81
  v_mov_b32 v16, 128
  s_mov_b32 s62, 96
  s_mov_b32 s61, 2000000
KW_82:
  buffer_load_dword v15, off, s[44:47], s62 sc1
  s_waitcnt vmcnt(0)
  v_cmp_gt_u32 vcc, v16, v15
  s_cbranch_vccz KD_83
  s_sleep 8
  s_sub_u32 s61, s61, 1
  s_cbranch_scc0 KW_82
KD_83:
K4_81:
  s_add_u32 s62, s53, 2
  s_and_b32 s61, s62, 7
  s_cmp_eq_u32 s61, 0
  s_cbranch_scc0 KV_80
  s_cmp_lt_u32 s62, 64
  s_cbranch_scc0 KV_80
  s_lshr_b32 s62, s62, 3
  s_lshl_b32 s62, s62, 2
  s_add_u32 s62, s62, 96
  s_mov_b32 s61, 2000000
KW_84:
  buffer_load_dword v15, off, s[44:47], s62 sc1
  s_waitcnt vmcnt(0)
  v_cmp_gt_u32 vcc, 64, v15
  s_cbranch_vccz KD_85
  s_sleep 8
  s_sub_u32 s61, s61, 1
  s_cbranch_scc0 KW_84
KD_85:
KV_80:
  s_waitcnt vmcnt(0)
  s_add_u32 s53, s53, 1
  s_add_u32 s61, s53, 0
  s_and_b32 s61, s61, 3
  s_mul_i32 s61, s61, 344064
  s_add_u32 s55, s61, s92
  s_add_u32 s61, s53, 1
  s_and_b32 s61, s61, 3
  s_mul_i32 s61, s61, 344064
  s_add_u32 s56, s61, s92
  s_add_u32 s61, s53, 2
  s_and_b32 s61, s61, 3
  s_mul_i32 s61, s61, 344064
  s_add_u32 s57, s61, s92
  s_add_u32 s61, s53, 3
  s_and_b32 s61, s61, 3
  s_mul_i32 s61, s61, 344064
  s_add_u32 s58, s61, s92
  s_and_b32 s61, s53, 3
  s_mul_i32 s59, s61, 327680
  s_add_u32 s59, s59, 180355072
  s_xor_b32 s61, s61, 2
  s_mul_i32 s60, s61, 327680
  s_add_u32 s60, s60, 180355072
CE_77:
  s_add_u32 s66, s66, 1024
  s_add_u32 s67, s67, 1024
  s_add_u32 s69, s69, 256
  s_add_u32 s68, s68, 256
  s_branch REC_LOOP
REC_LAST:
PV_86:
  buffer_load_dwordx4 v[84:87], v3, s[40:43], s62 offen offset:0 sc1
  buffer_load_dwordx4 v[88:91], v3, s[40:43], s62 offen offset:1024 sc1
  buffer_load_dwordx4 v[92:95], v3, s[40:43], s62 offen offset:2048 sc1
  s_waitcnt vmcnt(0)
  v_max3_u32 v15, v85, v87, v89
  v_max3_u32 v16, v91, v93, v95
  v_max_u32 v15, v15, v16
  v_cmp_eq_u32 vcc, -1, v15
  s_cbranch_vccz PD_87
  s_sub_u32 s64, s64, 1
  s_cbranch_scc0 PV_86
  s_mov_b32 s64, 0
PD_87:
  v_smfmac_f32_16x16x64_bf16 v[24:27], v[84:87], v[184:191], v19
  v_smfmac_f32_16x16x64_bf16 v[28:31], v[84:87], v[208:215], v19
  v_smfmac_f32_16x16x64_bf16 v[32:35], v[84:87], v[232:239], v19
  v_smfmac_f32_16x16x64_bf16 v[24:27], v[88:91], v[192:199], v19
  v_smfmac_f32_16x16x64_bf16 v[28:31], v[88:91], v[216:223], v19
  v_smfmac_f32_16x16x64_bf16 v[32:35], v[88:91], v[240:247], v19
  v_smfmac_f32_16x16x64_bf16 v[24:27], v[92:95], v[200:207], v19
  v_smfmac_f32_16x16x64_bf16 v[28:31], v[92:95], v[224:231], v19
  v_smfmac_f32_16x16x64_bf16 v[32:35], v[92:95], v[248:255], v19
  s_nop 7
  v_add_f32 v24, v24, v25
  v_add_f32 v26, v26, v27
  v_add_f32 v28, v28, v29
  v_add_f32 v30, v30, v31
  v_add_f32 v32, v32, v33
  v_add_f32 v34, v34, v35
  v_cvt_pk_bf16_f32 v164, v24, v26
  v_cvt_pk_bf16_f32 v166, v28, v30
  v_cvt_pk_bf16_f32 v168, v32, v34
  s_lshl_b32 s61, s48, 8
  v_add_u32 v15, s61, v12
  ds_write_b32 v15, v164 offset:26112
  ds_write_b32 v15, v166 offset:27136
  ds_write_b32 v15, v168 offset:28160
  s_waitcnt lgkmcnt(0)
  s_barrier
  s_cmp_eq_u32 s48, 3
  s_cbranch_scc0 RL_88
  ds_read_b128 v[84:87], v3 offset:26112
  ds_read_b128 v[88:91], v3 offset:27136
  ds_read_b128 v[92:95], v3 offset:28160
  ds_read_b64_tr_b16 v[114:115], v79 offset:0
  ds_read_b64_tr_b16 v[116:117], v79 offset:512
  ds_read_b64_tr_b16 v[118:119], v79 offset:1024
  s_waitcnt lgkmcnt(0)
  s_lshl_b32 s61, s89, 14
  s_add_u32 s61, s61, s68
  buffer_store_dwordx4 v[84:87], v2, s[40:43], s61 offen sc1
  s_lshl_b32 s61, s90, 14
  s_add_u32 s61, s61, s68
  buffer_store_dwordx4 v[88:91], v2, s[40:43], s61 offen sc1
  s_lshl_b32 s61, s91, 14
  s_add_u32 s61, s61, s68
  buffer_store_dwordx4 v[92:95], v2, s[40:43], s61 offen sc1
  s_mov_b64 exec, s[78:79]
  s_add_u32 s61, s69, 0
  buffer_store_dwordx2 v[114:115], v13, s[40:43], s61 offen sc1
  s_add_u32 s61, s69, 16384
  buffer_store_dwordx2 v[116:117], v13, s[40:43], s61 offen sc1
  s_add_u32 s61, s69, 32768
  buffer_store_dwordx2 v[118:119], v13, s[40:43], s61 offen sc1
  s_mov_b64 exec, -1
  s_waitcnt vmcnt(0)
  s_lshl_b32 s61, s49, 4
  s_add_u32 s61, s61, s50
  s_lshl_b32 s61, s61, 8
  s_add_u32 s61, s61, 182452224
  v_mov_b32 v15, 64
  s_mov_b64 exec, 1
  buffer_store_dword v15, off, s[40:43], s61 sc1
  s_mov_b64 exec, -1
RL_88:
  s_branch K_RECDONE
K_RECS_FAR:
  s_mov_b32 s87, 0
  s_lshr_b32 s61, s65, 1
  s_lshl_b32 s61, s61, 14
  s_and_b32 s62, s65, 1
  s_lshl_b32 s62, s62, 12
  s_add_u32 s86, s61, s62
  s_lshl_b32 s62, s87, 13
  s_add_u32 s86, s86, s62
  s_lshl_b32 s62, s49, 9
  s_add_u32 s84, s86, s62
  s_lshr_b32 s61, s89, 1
  s_lshl_b32 s61, s61, 14
  s_and_b32 s62, s89, 1
  s_lshl_b32 s62, s62, 12
  s_add_u32 s31, s61, s62
  s_lshl_b32 s62, s87, 13
  s_add_u32 s31, s31, s62
  s_lshl_b32 s62, s49, 9
  s_add_u32 s31, s31, s62
  s_lshr_b32 s61, s90, 1
  s_lshl_b32 s61, s61, 14
  s_and_b32 s62, s90, 1
  s_lshl_b32 s62, s62, 12
  s_add_u32 s74, s61, s62
  s_lshl_b32 s62, s87, 13
  s_add_u32 s74, s74, s62
  s_lshl_b32 s62, s49, 9
  s_add_u32 s74, s74, s62
  s_lshr_b32 s61, s91, 1
  s_lshl_b32 s61, s61, 14
  s_and_b32 s62, s91, 1
  s_lshl_b32 s62, s62, 12
  s_add_u32 s75, s61, s62
  s_lshl_b32 s62, s87, 13
  s_add_u32 s75, s75, s62
  s_lshl_b32 s62, s49, 9
  s_add_u32 s75, s75, s62
  s_cmp_eq_u32 s48, 0
  s_cbranch_scc0 SBX_90
  s_mov_b64 exec, 1
  s_mov_b32 s61, 64
SB_89:
  buffer_load_dword v15, off, s[44:47], s61 sc1
  s_waitcnt vmcnt(0)
  v_cmp_gt_u32 vcc, 128, v15
  s_cbranch_vccz PD_91
  s_sleep 3
  s_sub_u32 s64, s64, 1
  s_cbranch_scc0 SB_89
  s_mov_b32 s64, 0
PD_91:
  s_mov_b64 exec, -1
SBX_90:
  s_barrier
  s_mul_i32 s61, s51, 12
  s_mul_i32 s62, s52, 3
  s_add_u32 s61, s61, s62
  s_lshl_b32 s66, s61, 16
  s_add_u32 s66, s66, 0
  s_lshl_b32 s69, s61, 14
  s_add_u32 s69, s69, 155189248
  s_lshl_b32 s61, s49, 2
  s_mul_i32 s67, s61, 2621440
  s_add_u32 s67, s67, 50331648
  s_mul_i32 s68, s61, 655360
  s_add_u32 s68, s68, 134217728
  s_mov_b32 s53, 0
  s_cmp_eq_u32 s48, 3
  s_cbranch_scc0 NI_92
  s_mov_b32 s62, 172
  s_mov_b32 s61, 2000000
KW_93:
  buffer_load_dword v15, off, s[44:47], s62 sc1
  s_waitcnt vmcnt(0)
  v_cmp_gt_u32 vcc, 64, v15
  s_cbranch_vccz KD_94
  s_sleep 8
  s_sub_u32 s61, s61, 1
  s_cbranch_scc0 KW_93
KD_94:
  s_mov_b32 s93, 32768
  s_lshl_b32 s61, s89, 16
  s_add_u32 s61, s61, s67
  s_add_u32 s61, s61, 0
  s_add_u32 m0, s93, 0
  s_nop 0
  buffer_load_dwordx4 v11, s[40:43], s61 offen sc1 lds
  s_lshl_b32 s61, s90, 16
  s_add_u32 s61, s61, s67
  s_add_u32 s61, s61, 0
  s_add_u32 m0, s93, 1024
  s_nop 0
  buffer_load_dwordx4 v11, s[40:43], s61 offen sc1 lds
  s_lshl_b32 s61, s91, 16
  s_add_u32 s61, s61, s67
  s_add_u32 s61, s61, 0
  s_add_u32 m0, s93, 2048
  s_nop 0
  buffer_load_dwordx4 v11, s[40:43], s61 offen sc1 lds
  s_lshl_b32 s61, s89, 16
  s_add_u32 s61, s61, s67
  s_add_u32 s61, s61, 2621440
  s_add_u32 m0, s93, 3072
  s_nop 0
  buffer_load_dwordx4 v11, s[40:43], s61 offen sc1 lds
  s_lshl_b32 s61, s90, 16
  s_add_u32 s61, s61, s67
  s_add_u32 s61, s61, 2621440
  s_add_u32 m0, s93, 4096
  s_nop 0
  buffer_load_dwordx4 v11, s[40:43], s61 offen sc1 lds
  s_lshl_b32 s61, s91, 16
  s_add_u32 s61, s61, s67
  s_add_u32 s61, s61, 2621440
  s_add_u32 m0, s93, 5120
  s_nop 0
  buffer_load_dwordx4 v11, s[40:43], s61 offen sc1 lds
  s_lshl_b32 s61, s89, 16
  s_add_u32 s61, s61, s67
  s_add_u32 s61, s61, 5242880
  s_add_u32 m0, s93, 6144
  s_nop 0
  buffer_load_dwordx4 v11, s[40:43], s61 offen sc1 lds
  s_lshl_b32 s61, s90, 16
  s_add_u32 s61, s61, s67
  s_add_u32 s61, s61, 5242880
  s_add_u32 m0, s93, 7168
  s_nop 0
  buffer_load_dwordx4 v11, s[40:43], s61 offen sc1 lds
  s_lshl_b32 s61, s91, 16
  s_add_u32 s61, s61, s67
  s_add_u32 s61, s61, 5242880
  s_add_u32 m0, s93, 8192
  s_nop 0
  buffer_load_dwordx4 v11, s[40:43], s61 offen sc1 lds
  s_lshl_b32 s61, s89, 16
  s_add_u32 s61, s61, s67
  s_add_u32 s61, s61, 7864320
  s_add_u32 m0, s93, 9216
  s_nop 0
  buffer_load_dwordx4 v11, s[40:43], s61 offen sc1 lds
  s_lshl_b32 s61, s90, 16
  s_add_u32 s61, s61, s67
  s_add_u32 s61, s61, 7864320
  s_add_u32 m0, s93, 10240
  s_nop 0
  buffer_load_dwordx4 v11, s[40:43], s61 offen sc1 lds
  s_lshl_b32 s61, s91, 16
  s_add_u32 s61, s61, s67
  s_add_u32 s61, s61, 7864320
  s_add_u32 m0, s93, 11264
  s_nop 0
  buffer_load_dwordx4 v11, s[40:43], s61 offen sc1 lds
  s_add_u32 m0, s93, 12288
  s_add_u32 s61, s66, 0
  buffer_load_dwordx4 v3, s[40:43], s61 offen sc1 lds
  s_add_u32 m0, s93, 13312
  s_add_u32 s61, s66, 65536
  buffer_load_dwordx4 v3, s[40:43], s61 offen sc1 lds
  s_add_u32 m0, s93, 14336
  s_add_u32 s61, s66, 131072
  buffer_load_dwordx4 v3, s[40:43], s61 offen sc1 lds
NI_92:
  s_add_u32 s66, s66, 1024
  s_add_u32 s67, s67, 1024
  s_mov_b32 s32, s12
  s_mov_b32 s33, s13
  s_mov_b32 s34, 10240
  s_mov_b32 s35, 0x20000
  v_bfe_u32 v15, v1, 1, 3
  v_mul_u32_u24 v15, 1280, v15
  v_lshrrev_b32 v16, 4, v1
  v_lshl_add_u32 v15, v16, 5, v15
  v_and_b32 v16, 1, v1
  v_lshl_add_u32 v15, v16, 4, v15
  s_lshl_b32 s61, s48, 7
  buffer_load_dwordx4 v[84:87], v15, s[32:35], s61 offen offset:0
  buffer_load_dwordx4 v[88:91], v15, s[32:35], s61 offen offset:512
  buffer_load_dwordx4 v[92:95], v15, s[32:35], s61 offen offset:1024
  v_mov_b32 v17, 0
  v_mov_b32 v18, 31744
  ds_write_b32 v18, v17
  s_waitcnt vmcnt(0) lgkmcnt(0)
  s_barrier
  s_add_u32 s61, s53, 0
  s_and_b32 s61, s61, 3
  s_mul_i32 s61, s61, 344064
  s_add_u32 s55, s61, s92
  s_add_u32 s61, s53, 1
  s_and_b32 s61, s61, 3
  s_mul_i32 s61, s61, 344064
  s_add_u32 s56, s61, s92
  s_add_u32 s61, s53, 2
  s_and_b32 s61, s61, 3
  s_mul_i32 s61, s61, 344064
  s_add_u32 s57, s61, s92
  s_add_u32 s61, s53, 3
  s_and_b32 s61, s61, 3
  s_mul_i32 s61, s61, 344064
  s_add_u32 s58, s61, s92
  s_and_b32 s61, s53, 3
  s_mul_i32 s59, s61, 327680
  s_add_u32 s59, s59, 180355072
  s_xor_b32 s61, s61, 2
  s_mul_i32 s60, s61, 327680
  s_add_u32 s60, s60, 180355072
  ds_write_b128 v14, v[84:87] offset:0
  ds_write_b128 v14, v[88:91] offset:4096
  s_cmp_lt_u32 s48, 2
  s_cbranch_scc0 NW_95
  ds_write_b128 v14, v[92:95] offset:8192
NW_95:
  v_mov_b32 v64, 0
  v_mov_b32 v65, 0
  v_mov_b32 v66, 0
  v_mov_b32 v67, 0
  v_mov_b32 v68, 0
  v_mov_b32 v69, 0
  v_mov_b32 v70, 0
  v_mov_b32 v71, 0
  v_mov_b32 v72, 0
  v_mov_b32 v73, 0
  v_mov_b32 v74, 0
  v_mov_b32 v75, 0
  s_and_b32 s81, s53, 1
  s_mul_i32 s81, s81, 15360
  s_add_u32 s81, s81, 32768
  s_xor_b32 s83, s53, 1
  s_and_b32 s83, s83, 1
  s_mul_i32 s83, s83, 15360
  s_add_u32 s83, s83, 32768
  s_mul_i32 s61, s48, 3072
  s_add_u32 s61, s61, s81
  v_add_u32 v17, s61, v3
  v_add_u32 v18, s81, v100
  s_lshl_b32 s61, s24, 14
  s_add_u32 s20, s61, s68
  s_sub_u32 s20, s20, 256
  s_lshl_b32 s61, s48, 14
  s_add_u32 s21, s61, s69
  s_sub_u32 s21, s21, 256
  s_waitcnt lgkmcnt(0)
  s_branch SREC_BC
SREC_LOOP:
  v_mov_b32 v64, 0
  v_mov_b32 v65, 0
  v_mov_b32 v66, 0
  v_mov_b32 v67, 0
  v_mov_b32 v68, 0
  v_mov_b32 v69, 0
  v_mov_b32 v70, 0
  v_mov_b32 v71, 0
  v_mov_b32 v72, 0
  v_mov_b32 v73, 0
  v_mov_b32 v74, 0
  v_mov_b32 v75, 0
  s_and_b32 s81, s53, 1
  s_mul_i32 s81, s81, 15360
  s_add_u32 s81, s81, 32768
  s_xor_b32 s83, s53, 1
  s_and_b32 s83, s83, 1
  s_mul_i32 s83, s83, 15360
  s_add_u32 s83, s83, 32768
  s_mul_i32 s61, s48, 3072
  s_add_u32 s61, s61, s81
  v_add_u32 v17, s61, v3
  v_add_u32 v18, s81, v100
  s_lshl_b32 s61, s24, 14
  s_add_u32 s20, s61, s68
  s_sub_u32 s20, s20, 256
  s_lshl_b32 s61, s48, 14
  s_add_u32 s21, s61, s69
  s_sub_u32 s21, s21, 256
  s_add_u32 s62, s55, 4096
  s_add_u32 s63, s55, 8192
  s_cmp_lt_u32 s48, 2
  s_cbranch_scc1 PM0_97
PM_96:
  buffer_load_dwordx4 v[84:87], v14, s[40:43], s55 offen sc1
  buffer_load_dwordx4 v[88:91], v14, s[40:43], s62 offen sc1
  s_waitcnt vmcnt(0)
  v_max3_u32 v15, v85, v87, v89
  v_mov_b32 v16, v91
  v_max_u32 v15, v15, v16
  v_cmp_eq_u32 vcc, -1, v15
  s_cbranch_vccz PD_98
  s_sub_u32 s64, s64, 1
  s_cbranch_scc0 PM_96
  s_mov_b32 s64, 0
PD_98:
  ds_write_b128 v14, v[84:87] offset:0
  ds_write_b128 v14, v[88:91] offset:4096
  s_waitcnt lgkmcnt(0)
  s_branch SSREC_BC2
PM0_97:
  buffer_load_dwordx4 v[84:87], v14, s[40:43], s55 offen sc1
  buffer_load_dwordx4 v[88:91], v14, s[40:43], s62 offen sc1
  buffer_load_dwordx4 v[92:95], v14, s[40:43], s63 offen sc1
  s_waitcnt vmcnt(0)
  v_max3_u32 v15, v85, v87, v89
  v_max3_u32 v16, v91, v93, v95
  v_max_u32 v15, v15, v16
  v_cmp_eq_u32 vcc, -1, v15
  s_cbranch_vccz PD_99
  s_sub_u32 s64, s64, 1
  s_cbranch_scc0 PM0_97
  s_mov_b32 s64, 0
PD_99:
  ds_write_b128 v14, v[84:87] offset:0
  ds_write_b128 v14, v[88:91] offset:4096
  ds_write_b128 v14, v[92:95] offset:8192
  s_waitcnt lgkmcnt(0)
  s_branch SSREC_BC2
SREC_BC:
SSREC_BC2:
  s_barrier
  ds_read_b128 v[92:95], v106 offset:26112
  ds_read_b64_tr_b16 v[96:97], v107
  ds_read_b128 v[24:27], v3 offset:0
  ds_read_b128 v[28:31], v3 offset:1024
  ds_read_b128 v[32:35], v3 offset:2048
  ds_read_b128 v[36:39], v3 offset:3072
  ds_read_b128 v[40:43], v3 offset:4096
  ds_read_b128 v[44:47], v3 offset:5120
  ds_read_b128 v[48:51], v3 offset:6144
  ds_read_b128 v[52:55], v3 offset:7168
  ds_read_b128 v[56:59], v3 offset:8192
  ds_read_b128 v[60:63], v3 offset:9216
  s_cmp_eq_u32 s48, 3
  s_cbranch_scc1 A3_100
  s_waitcnt lgkmcnt(9)
  s_cmp_eq_u32 s53, 0
  s_cbranch_scc1 S0_110
  s_cmp_ge_u32 s48, s54
  s_cbranch_scc1 S1_111
  buffer_store_dwordx4 v[92:95], v2, s[40:43], s20 offen sc1
S1_111:
  s_mov_b64 exec, s[78:79]
  buffer_store_dwordx2 v[96:97], v13, s[40:43], s21 offen sc1
  s_mov_b64 exec, -1
S0_110:
  v_smfmac_f32_16x16x64_bf16 v[64:67], v[24:27], a[0:7], v19
  v_smfmac_f32_16x16x64_bf16 v[68:71], v[24:27], a[80:87], v19
  s_waitcnt lgkmcnt(8)
  v_smfmac_f32_16x16x64_bf16 v[64:67], v[28:31], a[8:15], v19
  v_smfmac_f32_16x16x64_bf16 v[68:71], v[28:31], a[88:95], v19
  s_waitcnt lgkmcnt(7)
  v_smfmac_f32_16x16x64_bf16 v[64:67], v[32:35], a[16:23], v19
  v_smfmac_f32_16x16x64_bf16 v[68:71], v[32:35], a[96:103], v19
  s_waitcnt lgkmcnt(6)
  v_smfmac_f32_16x16x64_bf16 v[64:67], v[36:39], a[24:31], v19
  v_smfmac_f32_16x16x64_bf16 v[68:71], v[36:39], a[104:111], v19
  ds_read_b128 v[140:143], v17 offset:0
  ds_read_b128 v[144:147], v17 offset:1024
  ds_read_b128 v[148:151], v17 offset:2048
  ds_read_b64 v[120:121], v18 offset:12288
  ds_read_b64 v[122:123], v18 offset:13312
  ds_read_b64 v[124:125], v18 offset:14336
  s_waitcnt lgkmcnt(11)
  v_smfmac_f32_16x16x64_bf16 v[64:67], v[40:43], a[32:39], v19
  v_smfmac_f32_16x16x64_bf16 v[68:71], v[40:43], a[112:119], v19
  s_waitcnt lgkmcnt(10)
  v_smfmac_f32_16x16x64_bf16 v[64:67], v[44:47], a[40:47], v19
  v_smfmac_f32_16x16x64_bf16 v[68:71], v[44:47], a[120:127], v19
  s_waitcnt lgkmcnt(9)
  v_smfmac_f32_16x16x64_bf16 v[64:67], v[48:51], a[48:55], v19
  v_smfmac_f32_16x16x64_bf16 v[68:71], v[48:51], a[128:135], v19
  s_waitcnt lgkmcnt(8)
  v_smfmac_f32_16x16x64_bf16 v[64:67], v[52:55], a[56:63], v19
  v_smfmac_f32_16x16x64_bf16 v[68:71], v[52:55], a[136:143], v19
  s_waitcnt lgkmcnt(7)
  v_smfmac_f32_16x16x64_bf16 v[64:67], v[56:59], a[64:71], v19
  v_smfmac_f32_16x16x64_bf16 v[68:71], v[56:59], a[144:151], v19
  s_waitcnt lgkmcnt(6)
  v_smfmac_f32_16x16x64_bf16 v[64:67], v[60:63], a[72:79], v19
  v_smfmac_f32_16x16x64_bf16 v[68:71], v[60:63], a[152:159], v19
  s_lshl_b32 s61, s48, 8
  v_add_u32 v15, s61, v76
  s_lshl_b32 s61, s48, 9
  v_add_u32 v16, s61, v78
  s_nop 2
  v_add_f32 v64, v64, v65
  v_add_f32 v66, v66, v67
  v_add_f32 v68, v68, v69
  v_add_f32 v70, v70, v71
  v_cvt_pk_bf16_f32 v64, v64, v66
  v_cvt_pk_bf16_f32 v68, v68, v70
  ds_write_b32 v15, v64
  ds_write_b32 v16, v68
  s_branch AJ_101
A3_100:
  s_waitcnt lgkmcnt(9)
  v_smfmac_f32_16x16x64_bf16 v[64:67], v[24:27], a[0:7], v19
  v_smfmac_f32_16x16x64_bf16 v[68:71], v[24:27], a[80:87], v19
  v_smfmac_f32_16x16x64_bf16 v[72:75], v[24:27], a[160:167], v19
  s_waitcnt lgkmcnt(8)
  v_smfmac_f32_16x16x64_bf16 v[64:67], v[28:31], a[8:15], v19
  v_smfmac_f32_16x16x64_bf16 v[68:71], v[28:31], a[88:95], v19
  v_smfmac_f32_16x16x64_bf16 v[72:75], v[28:31], a[168:175], v19
  s_waitcnt lgkmcnt(7)
  v_smfmac_f32_16x16x64_bf16 v[64:67], v[32:35], a[16:23], v19
  v_smfmac_f32_16x16x64_bf16 v[68:71], v[32:35], a[96:103], v19
  v_smfmac_f32_16x16x64_bf16 v[72:75], v[32:35], a[176:183], v19
  s_waitcnt lgkmcnt(6)
  v_smfmac_f32_16x16x64_bf16 v[64:67], v[36:39], a[24:31], v19
  v_smfmac_f32_16x16x64_bf16 v[68:71], v[36:39], a[104:111], v19
  v_smfmac_f32_16x16x64_bf16 v[72:75], v[36:39], a[184:191], v19
  ds_read_b128 v[140:143], v17 offset:0
  ds_read_b128 v[144:147], v17 offset:1024
  ds_read_b128 v[148:151], v17 offset:2048
  ds_read_b64 v[120:121], v18 offset:12288
  ds_read_b64 v[122:123], v18 offset:13312
  ds_read_b64 v[124:125], v18 offset:14336
  s_waitcnt lgkmcnt(11)
  v_smfmac_f32_16x16x64_bf16 v[64:67], v[40:43], a[32:39], v19
  v_smfmac_f32_16x16x64_bf16 v[68:71], v[40:43], a[112:119], v19
  v_smfmac_f32_16x16x64_bf16 v[72:75], v[40:43], a[192:199], v19
  s_waitcnt lgkmcnt(10)
  v_smfmac_f32_16x16x64_bf16 v[64:67], v[44:47], a[40:47], v19
  v_smfmac_f32_16x16x64_bf16 v[68:71], v[44:47], a[120:127], v19
  v_smfmac_f32_16x16x64_bf16 v[72:75], v[44:47], a[200:207], v19
  s_waitcnt lgkmcnt(9)
  v_smfmac_f32_16x16x64_bf16 v[64:67], v[48:51], a[48:55], v19
  v_smfmac_f32_16x16x64_bf16 v[68:71], v[48:51], a[128:135], v19
  v_smfmac_f32_16x16x64_bf16 v[72:75], v[48:51], a[208:215], v19
  s_waitcnt lgkmcnt(8)
  v_smfmac_f32_16x16x64_bf16 v[64:67], v[52:55], a[56:63], v19
  v_smfmac_f32_16x16x64_bf16 v[68:71], v[52:55], a[136:143], v19
  v_smfmac_f32_16x16x64_bf16 v[72:75], v[52:55], a[216:223], v19
  s_waitcnt lgkmcnt(7)
  v_smfmac_f32_16x16x64_bf16 v[64:67], v[56:59], a[64:71], v19
  v_smfmac_f32_16x16x64_bf16 v[68:71], v[56:59], a[144:151], v19
  v_smfmac_f32_16x16x64_bf16 v[72:75], v[56:59], a[224:231], v19
  s_waitcnt lgkmcnt(6)
  v_smfmac_f32_16x16x64_bf16 v[64:67], v[60:63], a[72:79], v19
  v_smfmac_f32_16x16x64_bf16 v[68:71], v[60:63], a[152:159], v19
  v_smfmac_f32_16x16x64_bf16 v[72:75], v[60:63], a[232:239], v19
  s_barrier
  s_nop 6
  v_add_f32 v64, v64, v65
  v_add_f32 v66, v66, v67
  v_add_f32 v68, v68, v69
  v_add_f32 v70, v70, v71
  v_add_f32 v72, v72, v73
  v_add_f32 v74, v74, v75
  v_cvt_pk_bf16_f32 v64, v64, v66
  v_cvt_pk_bf16_f32 v68, v68, v70
  v_cvt_pk_bf16_f32 v72, v72, v74
  ds_write_b32 v76, v64 offset:768
  ds_write_b32 v76, v68 offset:1024
  ds_write_b32 v76, v72 offset:1280
  s_waitcnt lgkmcnt(0)
  s_branch AV_102
AJ_101:
  s_waitcnt lgkmcnt(0)
  s_barrier
  ds_read_b64_tr_b16 v[108:109], v77 offset:0
  ds_read_b64_tr_b16 v[110:111], v77 offset:256
  ds_read_b64_tr_b16 v[112:113], v77 offset:512
  s_cmp_eq_u32 s48, 0
  s_cbranch_scc0 AX_103
  ds_read_b64_tr_b16 v[114:115], v79 offset:0
  ds_read_b64_tr_b16 v[116:117], v79 offset:512
  ds_read_b64_tr_b16 v[118:119], v79 offset:1024
  s_waitcnt lgkmcnt(0)
  v_mfma_f32_16x16x16_bf16 v[136:139], v[114:115], v[108:109], 0
  v_mfma_f32_16x16x16_bf16 v[136:139], v[116:117], v[110:111], v[136:139]
  v_mfma_f32_16x16x16_bf16 v[136:139], v[118:119], v[112:113], v[136:139]
  v_mov_b32 v24, 0
  v_mov_b32 v25, 0
  v_mov_b32 v26, 0
  v_mov_b32 v27, 0
  v_mov_b32 v28, 0
  v_mov_b32 v29, 0
  v_mov_b32 v30, 0
  s_add_u32 s61, s55, s82
  s_mov_b64 exec, s[76:77]
  buffer_store_dwordx2 v[136:137], v82, s[40:43], s61 offen sc1
  s_mov_b64 exec, -1
  v_mov_b32 v31, 0
  v_mov_b32 v32, 0
  v_mov_b32 v33, 0
  v_mov_b32 v34, 0
  v_mov_b32 v35, 0
  s_add_u32 s61, s57, s80
  s_mov_b64 exec, s[76:77]
  buffer_store_dwordx2 v[20:21], v82, s[40:43], s61 offen sc1
  s_mov_b64 exec, -1
  s_branch AB_105
AX_103:
  s_waitcnt lgkmcnt(0)
  v_mfma_f32_16x16x16_bf16 v[136:139], v[120:121], v[108:109], 0
  v_mfma_f32_16x16x16_bf16 v[136:139], v[122:123], v[110:111], v[136:139]
  v_mfma_f32_16x16x16_bf16 v[136:139], v[124:125], v[112:113], v[136:139]
  v_mov_b32 v24, 0
  v_mov_b32 v25, 0
  v_mov_b32 v26, 0
  v_mov_b32 v27, 0
  v_mov_b32 v28, 0
  v_mov_b32 v29, 0
  v_mov_b32 v30, 0
  s_add_u32 s61, s55, s82
  s_mov_b64 exec, s[76:77]
  buffer_store_dwordx4 v[136:139], v5, s[40:43], s61 offen sc1
  s_mov_b64 exec, -1
  v_mov_b32 v31, 0
  v_mov_b32 v32, 0
  v_mov_b32 v33, 0
  v_mov_b32 v34, 0
  v_mov_b32 v35, 0
  s_cmp_eq_u32 s48, 2
  s_cbranch_scc1 W2_112
  s_add_u32 s61, s57, s82
  s_mov_b64 exec, s[76:77]
  buffer_store_dwordx4 v[20:23], v5, s[40:43], s61 offen sc1
  s_mov_b64 exec, -1
  s_branch W1_113
W2_112:
  s_add_u32 s61, s57, s82
  s_mov_b64 exec, s[76:77]
  buffer_store_dwordx4 v[20:23], v5, s[40:43], s61 offen sc1
  s_mov_b64 exec, -1
W1_113:
  s_branch AB_105
AV_102:
  ds_read_b64_tr_b16 v[108:109], v77 offset:768
  ds_read_b64_tr_b16 v[110:111], v77 offset:1024
  ds_read_b64_tr_b16 v[112:113], v77 offset:1280
  s_waitcnt lgkmcnt(0)
  s_add_u32 s61, s30, s55
  s_mov_b64 exec, s[76:77]
  buffer_store_dwordx2 v[108:109], v8, s[40:43], s61 offen offset:0 sc1
  buffer_store_dwordx2 v[110:111], v8, s[40:43], s61 offen offset:256 sc1
  buffer_store_dwordx2 v[112:113], v8, s[40:43], s61 offen offset:512 sc1
  s_mov_b64 exec, -1
  v_mov_b32 v24, 0
  v_mov_b32 v25, 0
  v_mov_b32 v26, 0
  v_mov_b32 v27, 0
  v_mov_b32 v28, 0
  v_mov_b32 v29, 0
  v_mov_b32 v30, 0
  v_mov_b32 v31, 0
  v_mov_b32 v32, 0
  v_mov_b32 v33, 0
  v_mov_b32 v34, 0
  v_mov_b32 v35, 0
  s_add_u32 s61, s30, s57
  s_mov_b32 exec_hi, 0xffff
  buffer_store_dwordx4 v[20:23], v3, s[40:43], s61 offen sc1
  s_mov_b64 exec, -1
AB_105:
  s_mul_i32 s62, s48, 3072
  s_add_u32 s62, s62, 30720
  s_add_u32 s62, s62, s55
  s_mul_i32 s61, s48, 2621440
  s_add_u32 s23, s61, s67
  s_mul_i32 s61, s48, 3072
  s_add_u32 s3, s61, s83
  s_min_u32 s61, s48, 2
  s_lshl_b32 s22, s61, 16
  s_add_u32 s22, s22, s66
  s_lshl_b32 s61, s61, 10
  s_add_u32 s70, s61, s83
  s_add_u32 s70, s70, 12288
  s_cmp_eq_u32 s53, 63
  s_cbranch_scc1 SREC_LAST
  s_sub_u32 s61, s60, s59
  v_mad_i32_i24 v101, v103, s61, v5
  v_add_u32 v101, s59, v101
  s_sub_u32 s61, s58, s56
  v_mad_i32_i24 v102, v103, s61, v8
  v_add_u32 v102, s56, v102
PS_114:
  buffer_load_dwordx4 v[84:87], v3, s[40:43], s62 offen offset:0 sc1
  buffer_load_dwordx4 v[88:91], v3, s[40:43], s62 offen offset:1024 sc1
  buffer_load_dwordx4 v[92:95], v3, s[40:43], s62 offen offset:2048 sc1
  buffer_load_dwordx4 v[36:39], v6, s[40:43], s55 offen offset:0 sc1
  buffer_load_dword v64, v7, s[40:43], s55 offen offset:0 sc1
  buffer_load_dwordx4 v[40:43], v6, s[40:43], s55 offen offset:1280 sc1
  buffer_load_dword v65, v7, s[40:43], s55 offen offset:1280 sc1
  buffer_load_dwordx4 v[44:47], v6, s[40:43], s55 offen offset:2560 sc1
  buffer_load_dword v66, v7, s[40:43], s55 offen offset:2560 sc1
  buffer_load_dwordx4 v[48:51], v6, s[40:43], s55 offen offset:3840 sc1
  buffer_load_dword v67, v7, s[40:43], s55 offen offset:3840 sc1
  s_waitcnt vmcnt(0)
  v_max3_u32 v15, v85, v87, v89
  v_max3_u32 v16, v91, v93, v95
  v_max3_u32 v15, v36, v40, v15
  v_max3_u32 v16, v44, v48, v16
  v_max3_u32 v15, v64, v65, v15
  v_max3_u32 v16, v66, v67, v16
  v_max_u32 v15, v15, v16
  v_cmp_eq_u32 vcc, -1, v15
  s_cbranch_vccz PD_115
  s_sub_u32 s64, s64, 1
  s_cbranch_scc0 PS_114
  s_mov_b32 s64, 0
PD_115:
  v_smfmac_f32_16x16x64_bf16 v[24:27], v[84:87], v[184:191], v19
  v_pk_add_f32 v[36:37], v[36:37], v[40:41]
  v_pk_add_f32 v[38:39], v[38:39], v[42:43]
  v_smfmac_f32_16x16x64_bf16 v[28:31], v[84:87], v[208:215], v19
  v_pk_add_f32 v[44:45], v[44:45], v[48:49]
  v_pk_add_f32 v[46:47], v[46:47], v[50:51]
  v_smfmac_f32_16x16x64_bf16 v[32:35], v[84:87], v[232:239], v19
  v_pk_add_f32 v[64:65], v[64:65], v[66:67]
  v_pk_add_f32 v[48:49], v[36:37], v[44:45]
  v_smfmac_f32_16x16x64_bf16 v[24:27], v[88:91], v[192:199], v19
  v_pk_add_f32 v[50:51], v[38:39], v[46:47]
  v_add_f32 v52, v64, v65
  v_smfmac_f32_16x16x64_bf16 v[28:31], v[88:91], v[216:223], v19
  v_max3_f32 v68, v48, v49, v50
  v_max3_f32 v68, v51, v52, v68
  v_smfmac_f32_16x16x64_bf16 v[32:35], v[88:91], v[240:247], v19
  s_lshl_b32 s61, s89, 16
  s_add_u32 m0, s3, 0
  s_add_u32 s61, s61, s23
  buffer_load_dwordx4 v11, s[40:43], s61 offen sc1 lds
  v_max_f32_dpp v68, v68, v68 row_ror:8 row_mask:0xf bank_mask:0xf
  v_smfmac_f32_16x16x64_bf16 v[24:27], v[92:95], v[200:207], v19
  v_mov_b32 v69, v68
  s_lshl_b32 s61, s90, 16
  s_add_u32 m0, s3, 1024
  s_add_u32 s61, s61, s23
  buffer_load_dwordx4 v11, s[40:43], s61 offen sc1 lds
  v_smfmac_f32_16x16x64_bf16 v[28:31], v[92:95], v[224:231], v19
  v_permlane16_swap_b32 v68, v69
  s_cmp_eq_u32 s54, 2
  s_cbranch_scc1 PD2_116
  s_lshl_b32 s61, s91, 16
  s_add_u32 m0, s3, 2048
  s_add_u32 s61, s61, s23
  buffer_load_dwordx4 v11, s[40:43], s61 offen sc1 lds
PD2_116:
  s_nop 0
  v_smfmac_f32_16x16x64_bf16 v[32:35], v[92:95], v[248:255], v19
  v_max_f32 v68, v68, v69
  v_mov_b32 v69, v68
  s_mov_b32 m0, s70
  s_nop 0
  buffer_load_dwordx4 v3, s[40:43], s22 offen sc1 lds
  v_permlane32_swap_b32 v68, v69
  s_nop 0
  v_max_f32 v68, v68, v69
  v_mul_f32 v68, s88, v68
  v_fma_f32 v48, v48, s88, -v68
  v_fma_f32 v49, v49, s88, -v68
  v_fma_f32 v50, v50, s88, -v68
  v_fma_f32 v51, v51, s88, -v68
  v_fma_f32 v52, v52, s88, -v68
  v_exp_f32 v52, v52
  v_exp_f32 v48, v48
  v_exp_f32 v49, v49
  v_exp_f32 v50, v50
  v_exp_f32 v51, v51
  v_add_f32 v24, v24, v25
  v_add_f32 v26, v26, v27
  v_add_f32 v28, v28, v29
  v_add_f32 v30, v30, v31
  v_add_f32 v32, v32, v33
  v_add_f32 v34, v34, v35
  v_cvt_pk_bf16_f32 v164, v24, v26
  v_cvt_pk_bf16_f32 v166, v28, v30
  v_cvt_pk_bf16_f32 v168, v32, v34
  v_mov_b32_dpp v53, v52 row_ror:8 row_mask:0xf bank_mask:0xf
  v_cvt_pk_bf16_f32 v128, v48, v49
  v_cvt_pk_bf16_f32 v129, v50, v51
  v_cvt_pk_bf16_f32 v132, v52, v53
  v_mov_b32_dpp v130, v128 row_ror:8 row_mask:0xf bank_mask:0xf
  v_mov_b32_dpp v131, v129 row_ror:8 row_mask:0xf bank_mask:0xf
  s_nop 1
  v_mfma_f32_16x16x32_bf16 v[36:39], v[140:143], v[128:131], 0
  v_mfma_f32_16x16x32_bf16 v[40:43], v[144:147], v[128:131], 0
  v_mfma_f32_16x16x32_bf16 v[44:47], v[148:151], v[128:131], 0
  v_mfma_f32_16x16x32_bf16 v[176:179], v[172:175], v[128:131], 0
  s_nop 2
  v_mfma_f32_16x16x16_bf16 v[36:39], v[164:165], v[132:133], v[36:39]
  v_mfma_f32_16x16x16_bf16 v[40:43], v[166:167], v[132:133], v[40:43]
  v_mfma_f32_16x16x16_bf16 v[44:47], v[168:169], v[132:133], v[44:47]
  v_mfma_f32_16x16x16_bf16 v[176:179], v[172:173], v[132:133], v[176:179]
  s_lshl_b32 s61, s48, 8
  v_add_u32 v15, s61, v12
  ds_write_b32 v15, v164 offset:26112
  ds_write_b32 v15, v166 offset:27136
  ds_write_b32 v15, v168 offset:28160
  s_nop 2
  v_rcp_f32 v80, v176
  s_nop 0
  v_mov_b32 v81, v80
  v_pk_mul_f32 v[36:37], v[36:37], v[80:81]
  v_pk_mul_f32 v[38:39], v[38:39], v[80:81]
  v_pk_mul_f32 v[40:41], v[40:41], v[80:81]
  v_pk_mul_f32 v[42:43], v[42:43], v[80:81]
  v_pk_mul_f32 v[44:45], v[44:45], v[80:81]
  v_pk_mul_f32 v[46:47], v[46:47], v[80:81]
  ds_write_b128 v14, v[36:39] offset:13824
  ds_write_b128 v14, v[40:43] offset:17920
  ds_write_b128 v14, v[44:47] offset:22016
  s_waitcnt lgkmcnt(0)
  s_barrier
  s_cmp_eq_u32 s48, 3
  s_cbranch_scc1 W3_118
  s_cmp_lt_u32 s48, s54
  s_cbranch_scc0 BN_117
  s_lshl_b32 s61, s48, 12
  v_add_u32 v15, s61, v4
  ds_read_b128 v[84:87], v15 offset:13824
  ds_read_b128 v[88:91], v15 offset:14848
  s_waitcnt lgkmcnt(0)
  v_pk_add_f32 v[84:85], v[84:85], v[88:89]
  v_pk_add_f32 v[86:87], v[86:87], v[90:91]
  s_nop 1
  v_add_f32_dpp v180, v84, v84 row_ror:8 row_mask:0xf bank_mask:0x3
  v_add_f32_dpp v181, v85, v85 row_ror:8 row_mask:0xf bank_mask:0x3
  v_add_f32_dpp v182, v86, v86 row_ror:8 row_mask:0xf bank_mask:0x3
  v_add_f32_dpp v183, v87, v87 row_ror:8 row_mask:0xf bank_mask:0x3
  buffer_store_dwordx4 v[180:183], v101, s[40:43], s84 offen sc1
BN_117:
  s_add_u32 s53, s53, 1
  s_add_u32 s62, s59, s86
  s_add_u32 s61, s53, 0
  s_and_b32 s61, s61, 3
  s_mul_i32 s61, s61, 344064
  s_add_u32 s55, s61, s92
  s_add_u32 s61, s53, 1
  s_and_b32 s61, s61, 3
  s_mul_i32 s61, s61, 344064
  s_add_u32 s56, s61, s92
  s_add_u32 s61, s53, 2
  s_and_b32 s61, s61, 3
  s_mul_i32 s61, s61, 344064
  s_add_u32 s57, s61, s92
  s_add_u32 s61, s53, 3
  s_and_b32 s61, s61, 3
  s_mul_i32 s61, s61, 344064
  s_add_u32 s58, s61, s92
  s_and_b32 s61, s53, 3
  s_mul_i32 s59, s61, 327680
  s_add_u32 s59, s59, 180355072
  s_xor_b32 s61, s61, 2
  s_mul_i32 s60, s61, 327680
  s_add_u32 s60, s60, 180355072
  s_cmp_lt_u32 s48, s54
  s_cbranch_scc0 CE_119
  s_sleep 8
PG_120:
  buffer_load_dwordx4 v[84:87], v9, s[40:43], s62 offen offset:0 sc1
  buffer_load_dwordx4 v[88:91], v9, s[40:43], s62 offen offset:512 sc1
  buffer_load_dwordx4 v[92:95], v9, s[40:43], s62 offen offset:1024 sc1
  buffer_load_dwordx4 v[96:99], v9, s[40:43], s62 offen offset:1536 sc1
  s_waitcnt vmcnt(0)
  v_max3_u32 v15, v84, v88, v92
  v_mov_b32 v16, v96
  v_max_u32 v15, v15, v16
  v_cmp_eq_u32 vcc, -1, v15
  s_cbranch_vccz PD_121
  s_sub_u32 s64, s64, 1
  s_cbranch_scc0 PG_120
  s_mov_b32 s64, 0
PD_121:
  v_pk_add_f32 v[84:85], v[84:85], v[88:89]
  v_pk_add_f32 v[86:87], v[86:87], v[90:91]
  v_pk_add_f32 v[92:93], v[92:93], v[96:97]
  v_pk_add_f32 v[94:95], v[94:95], v[98:99]
  v_pk_add_f32 v[84:85], v[84:85], v[92:93]
  v_pk_add_f32 v[86:87], v[86:87], v[94:95]
  s_nop 1
  v_add_f32_dpp v84, v84, v84 row_ror:8 row_mask:0xf bank_mask:0xf
  v_add_f32_dpp v85, v85, v85 row_ror:8 row_mask:0xf bank_mask:0xf
  v_add_f32_dpp v86, v86, v86 row_ror:8 row_mask:0xf bank_mask:0xf
  v_add_f32_dpp v87, v87, v87 row_ror:8 row_mask:0xf bank_mask:0xf
  s_mov_b64 exec, s[76:77]
  v_cvt_pk_bf16_f32 v170, v84, v85
  v_cvt_pk_bf16_f32 v171, v86, v87
  s_mov_b64 exec, -1
  buffer_store_dwordx2 v[170:171], v102, s[40:43], s85 offen sc1
  s_branch CE_119
W3_118:
  s_lshl_b32 s61, s49, 4
  s_add_u32 s61, s61, s50
  s_lshl_b32 s61, s61, 8
  s_add_u32 s61, s61, 182452224
  v_mov_b32 v15, s53
  s_mov_b64 exec, 1
  buffer_store_dword v15, off, s[40:43], s61 sc1
  s_mov_b64 exec, -1
  s_cmp_eq_u32 s53, 2
  s_cbranch_scc0 K4_123
  v_mov_b32 v16, 128
  s_mov_b32 s62, 96
  s_mov_b32 s61, 2000000
KW_124:
  buffer_load_dword v15, off, s[44:47], s62 sc1
  s_waitcnt vmcnt(0)
  v_cmp_gt_u32 vcc, v16, v15
  s_cbranch_vccz KD_125
  s_sleep 8
  s_sub_u32 s61, s61, 1
  s_cbranch_scc0 KW_124
KD_125:
K4_123:
  s_add_u32 s62, s53, 2
  s_and_b32 s61, s62, 7
  s_cmp_eq_u32 s61, 0
  s_cbranch_scc0 KV_122
  s_cmp_lt_u32 s62, 64
  s_cbranch_scc0 KV_122
  s_lshr_b32 s62, s62, 3
  s_lshl_b32 s62, s62, 2
  s_add_u32 s62, s62, 96
  s_mov_b32 s61, 2000000
KW_126:
  buffer_load_dword v15, off, s[44:47], s62 sc1
  s_waitcnt vmcnt(0)
  v_cmp_gt_u32 vcc, 64, v15
  s_cbranch_vccz KD_127
  s_sleep 8
  s_sub_u32 s61, s61, 1
  s_cbranch_scc0 KW_126
KD_127:
KV_122:
  s_waitcnt vmcnt(0)
  s_add_u32 s53, s53, 1
  s_add_u32 s61, s53, 0
  s_and_b32 s61, s61, 3
  s_mul_i32 s61, s61, 344064
  s_add_u32 s55, s61, s92
  s_add_u32 s61, s53, 1
  s_and_b32 s61, s61, 3
  s_mul_i32 s61, s61, 344064
  s_add_u32 s56, s61, s92
  s_add_u32 s61, s53, 2
  s_and_b32 s61, s61, 3
  s_mul_i32 s61, s61, 344064
  s_add_u32 s57, s61, s92
  s_add_u32 s61, s53, 3
  s_and_b32 s61, s61, 3
  s_mul_i32 s61, s61, 344064
  s_add_u32 s58, s61, s92
  s_and_b32 s61, s53, 3
  s_mul_i32 s59, s61, 327680
  s_add_u32 s59, s59, 180355072
  s_xor_b32 s61, s61, 2
  s_mul_i32 s60, s61, 327680
  s_add_u32 s60, s60, 180355072
CE_119:
  s_add_u32 s66, s66, 1024
  s_add_u32 s67, s67, 1024
  s_add_u32 s69, s69, 256
  s_add_u32 s68, s68, 256
  s_branch SREC_LOOP
SREC_LAST:
PV_128:
  buffer_load_dwordx4 v[84:87], v3, s[40:43], s62 offen offset:0 sc1
  buffer_load_dwordx4 v[88:91], v3, s[40:43], s62 offen offset:1024 sc1
  buffer_load_dwordx4 v[92:95], v3, s[40:43], s62 offen offset:2048 sc1
  s_waitcnt vmcnt(0)
  v_max3_u32 v15, v85, v87, v89
  v_max3_u32 v16, v91, v93, v95
  v_max_u32 v15, v15, v16
  v_cmp_eq_u32 vcc, -1, v15
  s_cbranch_vccz PD_129
  s_sub_u32 s64, s64, 1
  s_cbranch_scc0 PV_128
  s_mov_b32 s64, 0
PD_129:
  v_smfmac_f32_16x16x64_bf16 v[24:27], v[84:87], v[184:191], v19
  v_smfmac_f32_16x16x64_bf16 v[28:31], v[84:87], v[208:215], v19
  v_smfmac_f32_16x16x64_bf16 v[32:35], v[84:87], v[232:239], v19
  v_smfmac_f32_16x16x64_bf16 v[24:27], v[88:91], v[192:199], v19
  v_smfmac_f32_16x16x64_bf16 v[28:31], v[88:91], v[216:223], v19
  v_smfmac_f32_16x16x64_bf16 v[32:35], v[88:91], v[240:247], v19
  v_smfmac_f32_16x16x64_bf16 v[24:27], v[92:95], v[200:207], v19
  v_smfmac_f32_16x16x64_bf16 v[28:31], v[92:95], v[224:231], v19
  v_smfmac_f32_16x16x64_bf16 v[32:35], v[92:95], v[248:255], v19
  s_nop 7
  v_add_f32 v24, v24, v25
  v_add_f32 v26, v26, v27
  v_add_f32 v28, v28, v29
  v_add_f32 v30, v30, v31
  v_add_f32 v32, v32, v33
  v_add_f32 v34, v34, v35
  v_cvt_pk_bf16_f32 v164, v24, v26
  v_cvt_pk_bf16_f32 v166, v28, v30
  v_cvt_pk_bf16_f32 v168, v32, v34
  s_lshl_b32 s61, s48, 8
  v_add_u32 v15, s61, v12
  ds_write_b32 v15, v164 offset:26112
  ds_write_b32 v15, v166 offset:27136
  ds_write_b32 v15, v168 offset:28160
  s_waitcnt lgkmcnt(0)
  s_barrier
  s_cmp_eq_u32 s48, 3
  s_cbranch_scc0 RL_130
  ds_read_b128 v[84:87], v3 offset:26112
  ds_read_b128 v[88:91], v3 offset:27136
  ds_read_b128 v[92:95], v3 offset:28160
  ds_read_b64_tr_b16 v[114:115], v79 offset:0
  ds_read_b64_tr_b16 v[116:117], v79 offset:512
  ds_read_b64_tr_b16 v[118:119], v79 offset:1024
  s_waitcnt lgkmcnt(0)
  s_lshl_b32 s61, s89, 14
  s_add_u32 s61, s61, s68
  buffer_store_dwordx4 v[84:87], v2, s[40:43], s61 offen sc1
  s_lshl_b32 s61, s90, 14
  s_add_u32 s61, s61, s68
  buffer_store_dwordx4 v[88:91], v2, s[40:43], s61 offen sc1
  s_lshl_b32 s61, s91, 14
  s_add_u32 s61, s61, s68
  buffer_store_dwordx4 v[92:95], v2, s[40:43], s61 offen sc1
  s_mov_b64 exec, s[78:79]
  s_add_u32 s61, s69, 0
  buffer_store_dwordx2 v[114:115], v13, s[40:43], s61 offen sc1
  s_add_u32 s61, s69, 16384
  buffer_store_dwordx2 v[116:117], v13, s[40:43], s61 offen sc1
  s_add_u32 s61, s69, 32768
  buffer_store_dwordx2 v[118:119], v13, s[40:43], s61 offen sc1
  s_mov_b64 exec, -1
  s_waitcnt vmcnt(0)
  s_lshl_b32 s61, s49, 4
  s_add_u32 s61, s61, s50
  s_lshl_b32 s61, s61, 8
  s_add_u32 s61, s61, 182452224
  v_mov_b32 v15, 64
  s_mov_b64 exec, 1
  buffer_store_dword v15, off, s[40:43], s61 sc1
  s_mov_b64 exec, -1
RL_130:
K_RECDONE:
  s_waitcnt vmcnt(0)
WORKER_T:
  s_branch WORKER
K_OTHER:
  s_cmp_eq_u32 s70, 4
  s_cbranch_scc0 WORKER
  s_cmp_eq_u32 s71, 0
  s_cbranch_scc0 WORKER
  v_cmp_eq_u32 vcc, 0, v0
  s_and_saveexec_b64 s[72:73], vcc
  s_cbranch_execz MP_131
  v_mov_b32 v1, 0
  s_mov_b32 s74, 181665792
  s_add_u32 s75, s74, 8192
  buffer_store_dword v1, off, s[40:43], s74 sc1
  buffer_store_dword v1, off, s[40:43], s75 sc1
  s_waitcnt vmcnt(0)
  s_memtime s[76:77]
  s_waitcnt lgkmcnt(0)
  buffer_store_dword v1, off, s[40:43], s74 sc1
  s_waitcnt vmcnt(0)
  buffer_store_dword v1, off, s[40:43], s74 sc1
  s_waitcnt vmcnt(0)
  buffer_store_dword v1, off, s[40:43], s74 sc1
  s_waitcnt vmcnt(0)
  buffer_store_dword v1, off, s[40:43], s74 sc1
  s_waitcnt vmcnt(0)
  buffer_store_dword v1, off, s[40:43], s74 sc1
  s_waitcnt vmcnt(0)
  buffer_store_dword v1, off, s[40:43], s74 sc1
  s_waitcnt vmcnt(0)
  s_memtime s[78:79]
  s_waitcnt lgkmcnt(0)
  s_sub_u32 s80, s78, s76
  s_memtime s[76:77]
  s_waitcnt lgkmcnt(0)
  buffer_store_dword v1, off, s[40:43], s75 sc1
  s_waitcnt vmcnt(0)
  buffer_store_dword v1, off, s[40:43], s75 sc1
  s_waitcnt vmcnt(0)
  buffer_store_dword v1, off, s[40:43], s75 sc1
  s_waitcnt vmcnt(0)
  buffer_store_dword v1, off, s[40:43], s75 sc1
  s_waitcnt vmcnt(0)
  buffer_store_dword v1, off, s[40:43], s75 sc1
  s_waitcnt vmcnt(0)
  buffer_store_dword v1, off, s[40:43], s75 sc1
  s_waitcnt vmcnt(0)
  s_memtime s[78:79]
  s_waitcnt lgkmcnt(0)
  s_sub_u32 s81, s78, s76
  s_cmp_gt_u32 s81, s80
  s_cselect_b32 s82, 2, 1
  v_mov_b32 v1, s82
  s_mov_b32 s74, 68
  buffer_store_dword v1, off, s[44:47], s74 sc1
  v_mov_b32 v2, s80
  s_mov_b32 s74, 72
  buffer_store_dword v2, off, s[44:47], s74 sc1
  v_mov_b32 v2, s81
  s_mov_b32 s74, 76
  buffer_store_dword v2, off, s[44:47], s74 sc1
  s_waitcnt vmcnt(0)
MP_131:
  s_mov_b64 exec, s[72:73]
WORKER:
  s_waitcnt lgkmcnt(0)
  s_load_dwordx16 s[4:19], s[0:1], 0
  s_load_dwordx8 s[20:27], s[0:1], 64
  s_load_dwordx2 s[28:29], s[0:1], 96
  s_waitcnt lgkmcnt(0)
  s_mov_b32 s96, s26
  s_mov_b32 s97, s27
  s_mov_b32 s98, 256
  s_mov_b32 s99, 0x20000
  s_mov_b32 s40, s28
  s_mov_b32 s41, s29
  s_mov_b32 s42, 268435456
  s_mov_b32 s43, 0x20000
  s_mov_b32 s101, 3000000
  v_lshrrev_b32 v1, 6, v0
  s_nop 0
  v_readfirstlane_b32 s48, v1
  s_nop 3
  s_getreg_b32 s31, hwreg(HW_REG_XCC_ID)
  s_and_b32 s31, s31, 3
  s_mov_b32 s30, s31
  s_cmp_eq_u32 s48, 0
  s_cbranch_scc0 W_JN
  s_mov_b64 exec, 1
  s_mov_b32 s94, 0
W_JL:
  s_add_u32 s95, s31, s94
  s_and_b32 s95, s95, 3
  s_mov_b32 s30, s95
  s_lshl_b32 s95, s95, 2
  s_add_u32 s95, s95, 184
  v_mov_b32 v1, 1
  buffer_atomic_add v1, off, s[96:99], s95 sc0
  s_waitcnt vmcnt(0)
  v_readfirstlane_b32 s95, v1
  s_nop 3
  s_cmp_lt_u32 s95, 32
  s_cbranch_scc1 W_JD
  s_add_u32 s94, s94, 1
  s_cmp_lt_u32 s94, 4
  s_cbranch_scc1 W_JL
  s_mov_b32 s30, s31
W_JD:
  v_mov_b32 v1, s30
  v_mov_b32 v2, 147456
  ds_write_b32 v2, v1
  s_waitcnt lgkmcnt(0)
  s_mov_b64 exec, -1
W_JN:
  s_barrier
  v_mov_b32 v2, 147456
  ds_read_b32 v1, v2
  s_waitcnt lgkmcnt(0)
  v_readfirstlane_b32 s30, v1
  s_mov_b32 s31, 0
  s_mov_b32 s3, 2047
W_LOOP:
  v_lshrrev_b32 v1, 6, v0
  s_nop 0
  v_readfirstlane_b32 s48, v1
  s_nop 3
  s_add_u32 s94, s30, s31
  s_and_b32 s94, s94, 3
  s_lshl_b32 s95, s94, 2
  s_add_u32 s95, s95, 32
  s_barrier
  s_cmp_eq_u32 s48, 0
  s_cbranch_scc0 W_NOTK
  s_mov_b64 exec, 1
  v_mov_b32 v1, 1
  buffer_atomic_add v1, off, s[96:99], s95 sc0
  s_waitcnt vmcnt(0)
  v_mov_b32 v2, 147456
  ds_write_b32 v2, v1
  s_waitcnt lgkmcnt(0)
  s_mov_b64 exec, -1
W_NOTK:
  s_barrier
  v_mov_b32 v2, 147456
  ds_read_b32 v1, v2
  s_waitcnt lgkmcnt(0)
  v_readfirstlane_b32 s100, v1
  s_nop 3
  s_min_u32 s100, s100, 350
  s_mul_i32 s94, s94, 351
  s_add_u32 s94, s94, s100
  s_mov_b32 s3, s94
  s_lshl_b32 s94, s94, 2
  s_getpc_b64 s[62:63]
W_PC:
  s_add_u32 s62, s62, QTAB-W_PC
  s_addc_u32 s63, s63, 0
  s_load_dword s95, s[62:63], s94
  s_waitcnt lgkmcnt(0)
  s_cmp_eq_u32 s95, -1
  s_cbranch_scc0 W_GOT
  s_add_u32 s31, s31, 1
  s_cmp_lt_u32 s31, 4
  s_cbranch_scc1 W_LOOP
  s_branch K_END_FAR
W_GOT:
  s_lshr_b32 s94, s95, 16
  s_and_b32 s93, s95, 0xffff
  s_cmp_eq_u32 s94, 8
  s_cbranch_scc1 W_FO_FAR
  s_cmp_eq_u32 s94, 7
  s_cbranch_scc1 W_P1_FAR
  s_cmp_eq_u32 s94, 6
  s_cbranch_scc1 W_FIN_FAR
  s_cmp_eq_u32 s94, 5
  s_cbranch_scc1 W_A3_FAR
  s_cmp_eq_u32 s94, 4
  s_cbranch_scc1 W_AS_FAR
  s_cmp_eq_u32 s94, 3
  s_cbranch_scc1 W_A2_FAR
  s_branch W_PROJ
W_FO_FAR:
  s_branch W_FO_T
W_P1_FAR:
  s_branch W_P1_T
K_END_FAR:
  s_branch K_END_T
W_FIN_FAR:
  s_branch W_FIN_T
W_A3_FAR:
  s_branch W_A3_T
W_AS_FAR:
  s_branch W_AS_T
W_A2_FAR:
  s_branch W_A2_T
W_PROJ:
  v_and_b32 v1, 63, v0
  v_lshrrev_b32 v14, 6, v0
  s_nop 0
  v_readfirstlane_b32 s48, v14
  v_and_b32 v14, 31, v1
  v_and_b32 v16, 0x13, v14
  v_and_b32 v17, 4, v14
  v_lshl_add_u32 v16, v17, 1, v16
  v_and_b32 v17, 8, v14
  v_lshrrev_b32 v17, 1, v17
  v_add_u32 v14, v16, v17
  v_lshrrev_b32 v15, 5, v1
  v_lshrrev_b32 v16, 1, v14
  v_and_b32 v16, 7, v16
  s_mul_i32 s55, s48, 8192
  v_lshlrev_b32 v17, 7, v14
  v_add_u32 v17, s55, v17
  v_add_u32 v18, 0, v15
  v_xor_b32 v18, v18, v16
  v_lshlrev_b32 v18, 4, v18
  v_add_u32 v2, v17, v18
  v_add_u32 v18, 2, v15
  v_xor_b32 v18, v18, v16
  v_lshlrev_b32 v18, 4, v18
  v_add_u32 v3, v17, v18
  v_add_u32 v18, 4, v15
  v_xor_b32 v18, v18, v16
  v_lshlrev_b32 v18, 4, v18
  v_add_u32 v4, v17, v18
  v_add_u32 v18, 6, v15
  v_xor_b32 v18, v18, v16
  v_lshlrev_b32 v18, 4, v18
  v_add_u32 v5, v17, v18
  v_lshlrev_b32 v13, 5, v14
  v_lshlrev_b32 v18, 4, v15
  v_add_u32 v13, v13, v18
  v_and_b32 v16, 15, v1
  v_lshrrev_b32 v17, 2, v16
  v_and_b32 v18, 3, v16
  v_lshrrev_b32 v22, 1, v18
  v_and_b32 v18, 1, v18
  v_lshl_add_u32 v18, v18, 1, v22
  v_lshrrev_b32 v19, 4, v1
  v_and_b32 v20, 1, v19
  v_lshlrev_b32 v20, 5, v20
  v_lshlrev_b32 v18, 3, v18
  v_add_u32 v20, v20, v18
  v_lshlrev_b32 v21, 3, v15
  v_add_u32 v21, v21, v17
  v_lshlrev_b32 v21, 6, v21
  v_add_u32 v21, v21, v20
  v_add_u32 v6, 65536, v21
  v_add_u32 v7, 90112, v21
  v_and_b32 v18, 3, v16
  v_lshlrev_b32 v18, 3, v18
  v_and_b32 v20, 1, v19
  v_lshlrev_b32 v20, 5, v20
  v_add_u32 v20, v20, v18
  v_lshlrev_b32 v21, 3, v15
  v_add_u32 v21, v21, v17
  v_lshlrev_b32 v21, 6, v21
  v_add_u32 v21, v21, v20
  v_add_u32 v8, 65536, v21
  v_add_u32 v9, 90112, v21
  v_lshrrev_b32 v16, 4, v1
  v_add_u32 v16, 0, v16
  v_and_b32 v17, 7, v1
  v_xor_b32 v16, v16, v17
  v_lshlrev_b32 v16, 4, v16
  v_lshrrev_b32 v17, 3, v1
  v_mul_u32_u24 v17, 1280, v17
  v_add_u32 v10, v16, v17
  v_lshrrev_b32 v16, 4, v1
  v_add_u32 v16, 4, v16
  v_and_b32 v17, 7, v1
  v_xor_b32 v16, v16, v17
  v_lshlrev_b32 v16, 4, v16
  v_lshrrev_b32 v17, 3, v1
  v_mul_u32_u24 v17, 1280, v17
  v_add_u32 v11, v16, v17
  s_mul_i32 s50, s48, 8192
  s_lshl_b32 s52, s48, 10
  s_mov_b32 s32, s10
  s_mov_b32 s33, s11
  s_mov_b32 s34, 2621440
  s_mov_b32 s35, 0x20000
  s_mov_b32 s44, s20
  s_mov_b32 s45, s21
  s_mov_b32 s46, 7864320
  s_mov_b32 s47, 0x20000
  s_mul_i32 s78, s48, 3072
  s_cmp_eq_u32 s94, 1
  s_cbranch_scc1 WP_Q
  s_cmp_eq_u32 s94, 2
  s_cbranch_scc1 WP_A1
  s_lshr_b32 s66, s93, 6
  s_and_b32 s65, s93, 31
  s_bitcmp1_b32 s93, 5
  s_cselect_b32 s67, 0, 2
  s_branch WP_GO
WP_Q:
  s_lshr_b32 s66, s93, 5
  s_and_b32 s65, s93, 31
  s_mov_b32 s67, 1
  s_branch WP_GO
WP_A1:
  s_mul_i32 s66, s93, 6554
  s_lshr_b32 s66, s66, 16
  s_mul_i32 s69, s66, 10
  s_sub_u32 s65, s93, s69
  s_mov_b32 s67, 3
WP_GO:
  s_lshl_b32 s58, s66, 8
  s_mul_i32 s59, s65, 384
  s_mov_b32 s53, 12288
  s_mov_b32 s36, s18
  s_mov_b32 s37, s19
  s_mov_b32 s60, 0
  s_cmp_eq_u32 s67, 0
  s_cselect_b32 s36, s16, s36
  s_cselect_b32 s37, s17, s37
  s_cselect_b32 s60, 0, s60
  s_cmp_eq_u32 s67, 1
  s_cselect_b32 s36, s14, s36
  s_cselect_b32 s37, s15, s37
  s_cselect_b32 s60, 25165824, s60
  s_mov_b32 s38, 7864320
  s_mov_b32 s39, 0x20000
  s_cmp_eq_u32 s67, 3
  s_cbranch_scc0 WP_NOTA
  s_mov_b32 s53, 3840
  s_mov_b32 s36, s6
  s_mov_b32 s37, s7
  s_mov_b32 s38, 2457600
  s_mov_b32 s32, s4
  s_mov_b32 s33, s5
  s_mov_b32 s60, 161480704
WP_NOTA:
  s_mul_i32 s55, s48, 64
  s_add_u32 s55, s55, s58
  s_mul_i32 s49, s55, 1280
  s_lshl_b32 s55, s48, 4
  s_mul_i32 s51, s55, s53
  s_add_u32 s51, s51, s59
  s_lshl_b32 s54, s53, 6
  v_lshrrev_b32 v14, 2, v1
  v_mul_lo_u32 v14, v14, s53
  v_and_b32 v15, 3, v1
  v_lshlrev_b32 v15, 4, v15
  v_add_u32 v12, v14, v15
  s_lshr_b32 s63, s58, 5
  s_mul_i32 s64, s48, 2
  s_add_u32 s63, s63, s64
  s_mul_i32 s68, s65, 768
  s_add_u32 s68, s68, s63
  s_lshl_b32 s68, s68, 10
  s_add_u32 s56, s68, s60
  s_add_u32 s57, s56, 1024
  s_mul_i32 s68, s65, 2560
  s_add_u32 s68, s68, s63
  s_lshl_b32 s68, s68, 10
  s_add_u32 s76, s68, 50331648
  s_add_u32 s77, s76, 1024
  s_mul_i32 s68, s65, 192
  s_mul_i32 s69, s48, 48
  s_add_u32 s68, s68, s69
  s_mul_i32 s75, s68, 1280
  v_lshrrev_b32 v14, 2, v1
  v_mul_u32_u24 v14, 1280, v14
  v_and_b32 v15, 3, v1
  v_lshlrev_b32 v15, 4, v15
  v_add_u32 v15, v15, v14
  v_mov_b32 v31, v6
  s_add_u32 m0, s50, 0
  s_add_u32 s55, s49, 0
  buffer_load_dwordx4 v10, s[32:35], s55 offen  lds
  s_add_u32 m0, s50, 1024
  s_add_u32 s55, s49, 10240
  buffer_load_dwordx4 v11, s[32:35], s55 offen  lds
  s_add_u32 m0, s50, 2048
  s_add_u32 s55, s49, 20480
  buffer_load_dwordx4 v10, s[32:35], s55 offen  lds
  s_add_u32 m0, s50, 3072
  s_add_u32 s55, s49, 30720
  buffer_load_dwordx4 v11, s[32:35], s55 offen  lds
  s_add_u32 m0, s50, 4096
  s_add_u32 s55, s49, 40960
  buffer_load_dwordx4 v10, s[32:35], s55 offen  lds
  s_add_u32 m0, s50, 5120
  s_add_u32 s55, s49, 51200
  buffer_load_dwordx4 v11, s[32:35], s55 offen  lds
  s_add_u32 m0, s50, 6144
  s_add_u32 s55, s49, 61440
  buffer_load_dwordx4 v10, s[32:35], s55 offen  lds
  s_add_u32 m0, s50, 7168
  s_add_u32 s55, s49, 71680
  buffer_load_dwordx4 v11, s[32:35], s55 offen  lds
  s_add_u32 s49, s49, 128
  s_add_u32 m0, s52, 65536
  s_add_u32 s55, s51, 0
  buffer_load_dwordx4 v12, s[36:39], s55 offen  lds
  s_add_u32 m0, s52, 69632
  s_add_u32 s55, s51, 64
  buffer_load_dwordx4 v12, s[36:39], s55 offen  lds
  s_add_u32 m0, s52, 73728
  s_add_u32 s55, s51, 128
  buffer_load_dwordx4 v12, s[36:39], s55 offen  lds
  s_add_u32 m0, s52, 77824
  s_add_u32 s55, s51, 192
  buffer_load_dwordx4 v12, s[36:39], s55 offen  lds
  s_add_u32 m0, s52, 81920
  s_add_u32 s55, s51, 256
  buffer_load_dwordx4 v12, s[36:39], s55 offen  lds
  s_add_u32 m0, s52, 86016
  s_add_u32 s55, s51, 320
  buffer_load_dwordx4 v12, s[36:39], s55 offen  lds
  s_add_u32 s51, s51, s54
  s_add_u32 m0, s50, 32768
  s_add_u32 s55, s49, 0
  buffer_load_dwordx4 v10, s[32:35], s55 offen  lds
  s_add_u32 m0, s50, 33792
  s_add_u32 s55, s49, 10240
  buffer_load_dwordx4 v11, s[32:35], s55 offen  lds
  s_add_u32 m0, s50, 34816
  s_add_u32 s55, s49, 20480
  buffer_load_dwordx4 v10, s[32:35], s55 offen  lds
  s_add_u32 m0, s50, 35840
  s_add_u32 s55, s49, 30720
  buffer_load_dwordx4 v11, s[32:35], s55 offen  lds
  s_add_u32 m0, s50, 36864
  s_add_u32 s55, s49, 40960
  buffer_load_dwordx4 v10, s[32:35], s55 offen  lds
  s_add_u32 m0, s50, 37888
  s_add_u32 s55, s49, 51200
  buffer_load_dwordx4 v11, s[32:35], s55 offen  lds
  s_add_u32 m0, s50, 38912
  s_add_u32 s55, s49, 61440
  buffer_load_dwordx4 v10, s[32:35], s55 offen  lds
  s_add_u32 m0, s50, 39936
  s_add_u32 s55, s49, 71680
  buffer_load_dwordx4 v11, s[32:35], s55 offen  lds
  s_add_u32 s49, s49, 128
  s_add_u32 m0, s52, 90112
  s_add_u32 s55, s51, 0
  buffer_load_dwordx4 v12, s[36:39], s55 offen  lds
  s_add_u32 m0, s52, 94208
  s_add_u32 s55, s51, 64
  buffer_load_dwordx4 v12, s[36:39], s55 offen  lds
  s_add_u32 m0, s52, 98304
  s_add_u32 s55, s51, 128
  buffer_load_dwordx4 v12, s[36:39], s55 offen  lds
  s_add_u32 m0, s52, 102400
  s_add_u32 s55, s51, 192
  buffer_load_dwordx4 v12, s[36:39], s55 offen  lds
  s_add_u32 m0, s52, 106496
  s_add_u32 s55, s51, 256
  buffer_load_dwordx4 v12, s[36:39], s55 offen  lds
  s_add_u32 m0, s52, 110592
  s_add_u32 s55, s51, 320
  buffer_load_dwordx4 v12, s[36:39], s55 offen  lds
  s_add_u32 s51, s51, s54
  s_add_u32 m0, s52, 114688
  s_add_u32 s55, s51, 0
  buffer_load_dwordx4 v12, s[36:39], s55 offen  lds
  s_add_u32 m0, s52, 118784
  s_add_u32 s55, s51, 64
  buffer_load_dwordx4 v12, s[36:39], s55 offen  lds
  s_add_u32 m0, s52, 122880
  s_add_u32 s55, s51, 128
  buffer_load_dwordx4 v12, s[36:39], s55 offen  lds
  s_add_u32 m0, s52, 126976
  s_add_u32 s55, s51, 192
  buffer_load_dwordx4 v12, s[36:39], s55 offen  lds
  s_add_u32 m0, s52, 131072
  s_add_u32 s55, s51, 256
  buffer_load_dwordx4 v12, s[36:39], s55 offen  lds
  s_add_u32 m0, s52, 135168
  s_add_u32 s55, s51, 320
  buffer_load_dwordx4 v12, s[36:39], s55 offen  lds
  s_add_u32 s51, s51, s54
  s_mov_b32 s81, 0
  s_waitcnt vmcnt(20)
  s_barrier
  ds_read_b128 a[24:27], v2 offset:0
  ds_read_b128 a[28:31], v2 offset:4096
  ds_read_b64_tr_b16 a[0:1], v6 offset:0
  ds_read_b64_tr_b16 a[2:3], v6 offset:256
  ds_read_b64_tr_b16 a[4:5], v6 offset:4096
  ds_read_b64_tr_b16 a[6:7], v6 offset:4352
  ds_read_b64_tr_b16 a[8:9], v6 offset:8192
  ds_read_b64_tr_b16 a[10:11], v6 offset:8448
  ds_read_b64_tr_b16 a[12:13], v6 offset:12288
  ds_read_b64_tr_b16 a[14:15], v6 offset:12544
  ds_read_b64_tr_b16 a[16:17], v6 offset:16384
  ds_read_b64_tr_b16 a[18:19], v6 offset:16640
  ds_read_b64_tr_b16 a[20:21], v6 offset:20480
  ds_read_b64_tr_b16 a[22:23], v6 offset:20736
  s_waitcnt lgkmcnt(0)
  v_mfma_f32_32x32x16_bf16 v[64:79], a[0:3], a[24:27], 0
  ds_read_b128 a[56:59], v3 offset:0
  ds_read_b128 a[60:63], v3 offset:4096
  ds_read_b64_tr_b16 a[32:33], v6 offset:1024
  v_mfma_f32_32x32x16_bf16 v[80:95], a[0:3], a[28:31], 0
  ds_read_b64_tr_b16 a[34:35], v6 offset:1280
  ds_read_b64_tr_b16 a[36:37], v6 offset:5120
  ds_read_b64_tr_b16 a[38:39], v6 offset:5376
  v_mfma_f32_32x32x16_bf16 v[96:111], a[4:7], a[24:27], 0
  ds_read_b64_tr_b16 a[40:41], v6 offset:9216
  ds_read_b64_tr_b16 a[42:43], v6 offset:9472
  ds_read_b64_tr_b16 a[44:45], v6 offset:13312
  v_mfma_f32_32x32x16_bf16 v[112:127], a[4:7], a[28:31], 0
  ds_read_b64_tr_b16 a[46:47], v6 offset:13568
  ds_read_b64_tr_b16 a[48:49], v6 offset:17408
  ds_read_b64_tr_b16 a[50:51], v6 offset:17664
  v_mfma_f32_32x32x16_bf16 v[128:143], a[8:11], a[24:27], 0
  ds_read_b64_tr_b16 a[52:53], v6 offset:21504
  ds_read_b64_tr_b16 a[54:55], v6 offset:21760
  v_mfma_f32_32x32x16_bf16 v[144:159], a[8:11], a[28:31], 0
  v_mfma_f32_32x32x16_bf16 v[160:175], a[12:15], a[24:27], 0
  v_mfma_f32_32x32x16_bf16 v[176:191], a[12:15], a[28:31], 0
  v_mfma_f32_32x32x16_bf16 v[192:207], a[16:19], a[24:27], 0
  v_mfma_f32_32x32x16_bf16 v[208:223], a[16:19], a[28:31], 0
  v_mfma_f32_32x32x16_bf16 v[224:239], a[20:23], a[24:27], 0
  v_mfma_f32_32x32x16_bf16 v[240:255], a[20:23], a[28:31], 0
  s_waitcnt lgkmcnt(0)
  v_mfma_f32_32x32x16_bf16 v[64:79], a[32:35], a[56:59], v[64:79]
  ds_read_b128 a[24:27], v4 offset:0
  ds_read_b128 a[28:31], v4 offset:4096
  ds_read_b64_tr_b16 a[0:1], v6 offset:2048
  v_mfma_f32_32x32x16_bf16 v[80:95], a[32:35], a[60:63], v[80:95]
  ds_read_b64_tr_b16 a[2:3], v6 offset:2304
  ds_read_b64_tr_b16 a[4:5], v6 offset:6144
  ds_read_b64_tr_b16 a[6:7], v6 offset:6400
  v_mfma_f32_32x32x16_bf16 v[96:111], a[36:39], a[56:59], v[96:111]
  ds_read_b64_tr_b16 a[8:9], v6 offset:10240
  ds_read_b64_tr_b16 a[10:11], v6 offset:10496
  ds_read_b64_tr_b16 a[12:13], v6 offset:14336
  v_mfma_f32_32x32x16_bf16 v[112:127], a[36:39], a[60:63], v[112:127]
  ds_read_b64_tr_b16 a[14:15], v6 offset:14592
  ds_read_b64_tr_b16 a[16:17], v6 offset:18432
  ds_read_b64_tr_b16 a[18:19], v6 offset:18688
  v_mfma_f32_32x32x16_bf16 v[128:143], a[40:43], a[56:59], v[128:143]
  ds_read_b64_tr_b16 a[20:21], v6 offset:22528
  ds_read_b64_tr_b16 a[22:23], v6 offset:22784
  v_mfma_f32_32x32x16_bf16 v[144:159], a[40:43], a[60:63], v[144:159]
  v_mfma_f32_32x32x16_bf16 v[160:175], a[44:47], a[56:59], v[160:175]
  v_mfma_f32_32x32x16_bf16 v[176:191], a[44:47], a[60:63], v[176:191]
  v_mfma_f32_32x32x16_bf16 v[192:207], a[48:51], a[56:59], v[192:207]
  v_mfma_f32_32x32x16_bf16 v[208:223], a[48:51], a[60:63], v[208:223]
  v_mfma_f32_32x32x16_bf16 v[224:239], a[52:55], a[56:59], v[224:239]
  v_mfma_f32_32x32x16_bf16 v[240:255], a[52:55], a[60:63], v[240:255]
  s_waitcnt lgkmcnt(0)
  v_mfma_f32_32x32x16_bf16 v[64:79], a[0:3], a[24:27], v[64:79]
  ds_read_b128 a[56:59], v5 offset:0
  ds_read_b128 a[60:63], v5 offset:4096
  ds_read_b64_tr_b16 a[32:33], v6 offset:3072
  v_mfma_f32_32x32x16_bf16 v[80:95], a[0:3], a[28:31], v[80:95]
  ds_read_b64_tr_b16 a[34:35], v6 offset:3328
  ds_read_b64_tr_b16 a[36:37], v6 offset:7168
  ds_read_b64_tr_b16 a[38:39], v6 offset:7424
  v_mfma_f32_32x32x16_bf16 v[96:111], a[4:7], a[24:27], v[96:111]
  ds_read_b64_tr_b16 a[40:41], v6 offset:11264
  ds_read_b64_tr_b16 a[42:43], v6 offset:11520
  ds_read_b64_tr_b16 a[44:45], v6 offset:15360
  v_mfma_f32_32x32x16_bf16 v[112:127], a[4:7], a[28:31], v[112:127]
  ds_read_b64_tr_b16 a[46:47], v6 offset:15616
  ds_read_b64_tr_b16 a[48:49], v6 offset:19456
  ds_read_b64_tr_b16 a[50:51], v6 offset:19712
  v_mfma_f32_32x32x16_bf16 v[128:143], a[8:11], a[24:27], v[128:143]
  ds_read_b64_tr_b16 a[52:53], v6 offset:23552
  ds_read_b64_tr_b16 a[54:55], v6 offset:23808
  v_mfma_f32_32x32x16_bf16 v[144:159], a[8:11], a[28:31], v[144:159]
  v_mfma_f32_32x32x16_bf16 v[160:175], a[12:15], a[24:27], v[160:175]
  v_mfma_f32_32x32x16_bf16 v[176:191], a[12:15], a[28:31], v[176:191]
  v_mfma_f32_32x32x16_bf16 v[192:207], a[16:19], a[24:27], v[192:207]
  v_mfma_f32_32x32x16_bf16 v[208:223], a[16:19], a[28:31], v[208:223]
  s_add_u32 s83, s81, s52
  s_add_u32 s83, s83, 65536
  v_mfma_f32_32x32x16_bf16 v[224:239], a[20:23], a[24:27], v[224:239]
  s_add_u32 s81, s81, 24576
  s_cmp_eq_u32 s81, 73728
  s_cselect_b32 s81, 0, s81
  v_mfma_f32_32x32x16_bf16 v[240:255], a[20:23], a[28:31], v[240:255]
  v_add_u32 v30, s81, v31
  s_waitcnt lgkmcnt(0)
  v_mfma_f32_32x32x16_bf16 v[64:79], a[32:35], a[56:59], v[64:79]
  v_mfma_f32_32x32x16_bf16 v[80:95], a[32:35], a[60:63], v[80:95]
  s_waitcnt vmcnt(6)
  s_barrier
  v_mov_b32 v7, v30
  s_mov_b32 s82, s83
  ds_read_b128 a[24:27], v2 offset:32768
  ds_read_b128 a[28:31], v2 offset:36864
  ds_read_b64_tr_b16 a[0:1], v7 offset:0
  v_mfma_f32_32x32x16_bf16 v[96:111], a[36:39], a[56:59], v[96:111]
  ds_read_b64_tr_b16 a[2:3], v7 offset:256
  ds_read_b64_tr_b16 a[4:5], v7 offset:4096
  ds_read_b64_tr_b16 a[6:7], v7 offset:4352
  v_mfma_f32_32x32x16_bf16 v[112:127], a[36:39], a[60:63], v[112:127]
  ds_read_b64_tr_b16 a[8:9], v7 offset:8192
  ds_read_b64_tr_b16 a[10:11], v7 offset:8448
  ds_read_b64_tr_b16 a[12:13], v7 offset:12288
  v_mfma_f32_32x32x16_bf16 v[128:143], a[40:43], a[56:59], v[128:143]
  ds_read_b64_tr_b16 a[14:15], v7 offset:12544
  ds_read_b64_tr_b16 a[16:17], v7 offset:16384
  ds_read_b64_tr_b16 a[18:19], v7 offset:16640
  v_mfma_f32_32x32x16_bf16 v[144:159], a[40:43], a[60:63], v[144:159]
  ds_read_b64_tr_b16 a[20:21], v7 offset:20480
  ds_read_b64_tr_b16 a[22:23], v7 offset:20736
  s_add_u32 m0, s50, 0
  s_add_u32 s55, s49, 0
  buffer_load_dwordx4 v10, s[32:35], s55 offen  lds
  v_mfma_f32_32x32x16_bf16 v[160:175], a[44:47], a[56:59], v[160:175]
  s_add_u32 m0, s50, 1024
  s_add_u32 s55, s49, 10240
  buffer_load_dwordx4 v11, s[32:35], s55 offen  lds
  v_mfma_f32_32x32x16_bf16 v[176:191], a[44:47], a[60:63], v[176:191]
  s_add_u32 m0, s50, 2048
  s_add_u32 s55, s49, 20480
  buffer_load_dwordx4 v10, s[32:35], s55 offen  lds
  v_mfma_f32_32x32x16_bf16 v[192:207], a[48:51], a[56:59], v[192:207]
  s_add_u32 m0, s50, 3072
  s_add_u32 s55, s49, 30720
  buffer_load_dwordx4 v11, s[32:35], s55 offen  lds
  v_mfma_f32_32x32x16_bf16 v[208:223], a[48:51], a[60:63], v[208:223]
  s_add_u32 m0, s50, 4096
  s_add_u32 s55, s49, 40960
  buffer_load_dwordx4 v10, s[32:35], s55 offen  lds
  v_mfma_f32_32x32x16_bf16 v[224:239], a[52:55], a[56:59], v[224:239]
  s_add_u32 m0, s50, 5120
  s_add_u32 s55, s49, 51200
  buffer_load_dwordx4 v11, s[32:35], s55 offen  lds
  v_mfma_f32_32x32x16_bf16 v[240:255], a[52:55], a[60:63], v[240:255]
  s_waitcnt lgkmcnt(0)
  v_mfma_f32_32x32x16_bf16 v[64:79], a[0:3], a[24:27], v[64:79]
  ds_read_b128 a[56:59], v3 offset:32768
  ds_read_b128 a[60:63], v3 offset:36864
  ds_read_b64_tr_b16 a[32:33], v7 offset:1024
  v_mfma_f32_32x32x16_bf16 v[80:95], a[0:3], a[28:31], v[80:95]
  ds_read_b64_tr_b16 a[34:35], v7 offset:1280
  ds_read_b64_tr_b16 a[36:37], v7 offset:5120
  ds_read_b64_tr_b16 a[38:39], v7 offset:5376
  v_mfma_f32_32x32x16_bf16 v[96:111], a[4:7], a[24:27], v[96:111]
  ds_read_b64_tr_b16 a[40:41], v7 offset:9216
  ds_read_b64_tr_b16 a[42:43], v7 offset:9472
  ds_read_b64_tr_b16 a[44:45], v7 offset:13312
  v_mfma_f32_32x32x16_bf16 v[112:127], a[4:7], a[28:31], v[112:127]
  ds_read_b64_tr_b16 a[46:47], v7 offset:13568
  ds_read_b64_tr_b16 a[48:49], v7 offset:17408
  ds_read_b64_tr_b16 a[50:51], v7 offset:17664
  v_mfma_f32_32x32x16_bf16 v[128:143], a[8:11], a[24:27], v[128:143]
  ds_read_b64_tr_b16 a[52:53], v7 offset:21504
  ds_read_b64_tr_b16 a[54:55], v7 offset:21760
  v_mfma_f32_32x32x16_bf16 v[144:159], a[8:11], a[28:31], v[144:159]
  v_mfma_f32_32x32x16_bf16 v[160:175], a[12:15], a[24:27], v[160:175]
  s_add_u32 m0, s50, 6144
  s_add_u32 s55, s49, 61440
  buffer_load_dwordx4 v10, s[32:35], s55 offen  lds
  v_mfma_f32_32x32x16_bf16 v[176:191], a[12:15], a[28:31], v[176:191]
  s_add_u32 m0, s50, 7168
  s_add_u32 s55, s49, 71680
  buffer_load_dwordx4 v11, s[32:35], s55 offen  lds
  s_add_u32 s49, s49, 128
  v_mfma_f32_32x32x16_bf16 v[192:207], a[16:19], a[24:27], v[192:207]
  s_add_u32 m0, s82, 0
  s_add_u32 s55, s51, 0
  buffer_load_dwordx4 v12, s[36:39], s55 offen  lds
  v_mfma_f32_32x32x16_bf16 v[208:223], a[16:19], a[28:31], v[208:223]
  s_add_u32 m0, s82, 4096
  s_add_u32 s55, s51, 64
  buffer_load_dwordx4 v12, s[36:39], s55 offen  lds
  v_mfma_f32_32x32x16_bf16 v[224:239], a[20:23], a[24:27], v[224:239]
  s_add_u32 m0, s82, 8192
  s_add_u32 s55, s51, 128
  buffer_load_dwordx4 v12, s[36:39], s55 offen  lds
  v_mfma_f32_32x32x16_bf16 v[240:255], a[20:23], a[28:31], v[240:255]
  s_waitcnt lgkmcnt(0)
  v_mfma_f32_32x32x16_bf16 v[64:79], a[32:35], a[56:59], v[64:79]
  ds_read_b128 a[24:27], v4 offset:32768
  ds_read_b128 a[28:31], v4 offset:36864
  ds_read_b64_tr_b16 a[0:1], v7 offset:2048
  v_mfma_f32_32x32x16_bf16 v[80:95], a[32:35], a[60:63], v[80:95]
  ds_read_b64_tr_b16 a[2:3], v7 offset:2304
  ds_read_b64_tr_b16 a[4:5], v7 offset:6144
  ds_read_b64_tr_b16 a[6:7], v7 offset:6400
  v_mfma_f32_32x32x16_bf16 v[96:111], a[36:39], a[56:59], v[96:111]
  ds_read_b64_tr_b16 a[8:9], v7 offset:10240
  ds_read_b64_tr_b16 a[10:11], v7 offset:10496
  ds_read_b64_tr_b16 a[12:13], v7 offset:14336
  v_mfma_f32_32x32x16_bf16 v[112:127], a[36:39], a[60:63], v[112:127]
  ds_read_b64_tr_b16 a[14:15], v7 offset:14592
  ds_read_b64_tr_b16 a[16:17], v7 offset:18432
  ds_read_b64_tr_b16 a[18:19], v7 offset:18688
  v_mfma_f32_32x32x16_bf16 v[128:143], a[40:43], a[56:59], v[128:143]
  ds_read_b64_tr_b16 a[20:21], v7 offset:22528
  ds_read_b64_tr_b16 a[22:23], v7 offset:22784
  v_mfma_f32_32x32x16_bf16 v[144:159], a[40:43], a[60:63], v[144:159]
  v_mfma_f32_32x32x16_bf16 v[160:175], a[44:47], a[56:59], v[160:175]
  v_mfma_f32_32x32x16_bf16 v[176:191], a[44:47], a[60:63], v[176:191]
  v_mfma_f32_32x32x16_bf16 v[192:207], a[48:51], a[56:59], v[192:207]
  s_add_u32 m0, s82, 12288
  s_add_u32 s55, s51, 192
  buffer_load_dwordx4 v12, s[36:39], s55 offen  lds
  v_mfma_f32_32x32x16_bf16 v[208:223], a[48:51], a[60:63], v[208:223]
  s_add_u32 m0, s82, 16384
  s_add_u32 s55, s51, 256
  buffer_load_dwordx4 v12, s[36:39], s55 offen  lds
  v_mfma_f32_32x32x16_bf16 v[224:239], a[52:55], a[56:59], v[224:239]
  s_add_u32 m0, s82, 20480
  s_add_u32 s55, s51, 320
  buffer_load_dwordx4 v12, s[36:39], s55 offen  lds
  s_add_u32 s51, s51, s54
  v_mfma_f32_32x32x16_bf16 v[240:255], a[52:55], a[60:63], v[240:255]
  s_waitcnt lgkmcnt(0)
  v_mfma_f32_32x32x16_bf16 v[64:79], a[0:3], a[24:27], v[64:79]
  ds_read_b128 a[56:59], v5 offset:32768
  ds_read_b128 a[60:63], v5 offset:36864
  ds_read_b64_tr_b16 a[32:33], v7 offset:3072
  v_mfma_f32_32x32x16_bf16 v[80:95], a[0:3], a[28:31], v[80:95]
  ds_read_b64_tr_b16 a[34:35], v7 offset:3328
  ds_read_b64_tr_b16 a[36:37], v7 offset:7168
  ds_read_b64_tr_b16 a[38:39], v7 offset:7424
  v_mfma_f32_32x32x16_bf16 v[96:111], a[4:7], a[24:27], v[96:111]
  ds_read_b64_tr_b16 a[40:41], v7 offset:11264
  ds_read_b64_tr_b16 a[42:43], v7 offset:11520
  ds_read_b64_tr_b16 a[44:45], v7 offset:15360
  v_mfma_f32_32x32x16_bf16 v[112:127], a[4:7], a[28:31], v[112:127]
  ds_read_b64_tr_b16 a[46:47], v7 offset:15616
  ds_read_b64_tr_b16 a[48:49], v7 offset:19456
  ds_read_b64_tr_b16 a[50:51], v7 offset:19712
  v_mfma_f32_32x32x16_bf16 v[128:143], a[8:11], a[24:27], v[128:143]
  ds_read_b64_tr_b16 a[52:53], v7 offset:23552
  ds_read_b64_tr_b16 a[54:55], v7 offset:23808
  v_mfma_f32_32x32x16_bf16 v[144:159], a[8:11], a[28:31], v[144:159]
  v_mfma_f32_32x32x16_bf16 v[160:175], a[12:15], a[24:27], v[160:175]
  v_mfma_f32_32x32x16_bf16 v[176:191], a[12:15], a[28:31], v[176:191]
  v_mfma_f32_32x32x16_bf16 v[192:207], a[16:19], a[24:27], v[192:207]
  v_mfma_f32_32x32x16_bf16 v[208:223], a[16:19], a[28:31], v[208:223]
  s_add_u32 s83, s81, s52
  s_add_u32 s83, s83, 65536
  v_mfma_f32_32x32x16_bf16 v[224:239], a[20:23], a[24:27], v[224:239]
  s_add_u32 s81, s81, 24576
  s_cmp_eq_u32 s81, 73728
  s_cselect_b32 s81, 0, s81
  v_mfma_f32_32x32x16_bf16 v[240:255], a[20:23], a[28:31], v[240:255]
  v_add_u32 v30, s81, v31
  s_waitcnt lgkmcnt(0)
  v_mfma_f32_32x32x16_bf16 v[64:79], a[32:35], a[56:59], v[64:79]
  v_mfma_f32_32x32x16_bf16 v[80:95], a[32:35], a[60:63], v[80:95]
  s_waitcnt vmcnt(6)
  s_barrier
  v_mov_b32 v6, v30
  s_mov_b32 s82, s83
  ds_read_b128 a[24:27], v2 offset:0
  ds_read_b128 a[28:31], v2 offset:4096
  ds_read_b64_tr_b16 a[0:1], v6 offset:0
  v_mfma_f32_32x32x16_bf16 v[96:111], a[36:39], a[56:59], v[96:111]
  ds_read_b64_tr_b16 a[2:3], v6 offset:256
  ds_read_b64_tr_b16 a[4:5], v6 offset:4096
  ds_read_b64_tr_b16 a[6:7], v6 offset:4352
  v_mfma_f32_32x32x16_bf16 v[112:127], a[36:39], a[60:63], v[112:127]
  ds_read_b64_tr_b16 a[8:9], v6 offset:8192
  ds_read_b64_tr_b16 a[10:11], v6 offset:8448
  ds_read_b64_tr_b16 a[12:13], v6 offset:12288
  v_mfma_f32_32x32x16_bf16 v[128:143], a[40:43], a[56:59], v[128:143]
  ds_read_b64_tr_b16 a[14:15], v6 offset:12544
  ds_read_b64_tr_b16 a[16:17], v6 offset:16384
  ds_read_b64_tr_b16 a[18:19], v6 offset:16640
  v_mfma_f32_32x32x16_bf16 v[144:159], a[40:43], a[60:63], v[144:159]
  ds_read_b64_tr_b16 a[20:21], v6 offset:20480
  ds_read_b64_tr_b16 a[22:23], v6 offset:20736
  s_add_u32 m0, s50, 32768
  s_add_u32 s55, s49, 0
  buffer_load_dwordx4 v10, s[32:35], s55 offen  lds
  v_mfma_f32_32x32x16_bf16 v[160:175], a[44:47], a[56:59], v[160:175]
  s_add_u32 m0, s50, 33792
  s_add_u32 s55, s49, 10240
  buffer_load_dwordx4 v11, s[32:35], s55 offen  lds
  v_mfma_f32_32x32x16_bf16 v[176:191], a[44:47], a[60:63], v[176:191]
  s_add_u32 m0, s50, 34816
  s_add_u32 s55, s49, 20480
  buffer_load_dwordx4 v10, s[32:35], s55 offen  lds
  v_mfma_f32_32x32x16_bf16 v[192:207], a[48:51], a[56:59], v[192:207]
  s_add_u32 m0, s50, 35840
  s_add_u32 s55, s49, 30720
  buffer_load_dwordx4 v11, s[32:35], s55 offen  lds
  v_mfma_f32_32x32x16_bf16 v[208:223], a[48:51], a[60:63], v[208:223]
  s_add_u32 m0, s50, 36864
  s_add_u32 s55, s49, 40960
  buffer_load_dwordx4 v10, s[32:35], s55 offen  lds
  v_mfma_f32_32x32x16_bf16 v[224:239], a[52:55], a[56:59], v[224:239]
  s_add_u32 m0, s50, 37888
  s_add_u32 s55, s49, 51200
  buffer_load_dwordx4 v11, s[32:35], s55 offen  lds
  v_mfma_f32_32x32x16_bf16 v[240:255], a[52:55], a[60:63], v[240:255]
  s_mov_b32 s80, 0
PL_132:
  s_waitcnt lgkmcnt(0)
  v_mfma_f32_32x32x16_bf16 v[64:79], a[0:3], a[24:27], v[64:79]
  ds_read_b128 a[56:59], v3 offset:0
  ds_read_b128 a[60:63], v3 offset:4096
  ds_read_b64_tr_b16 a[32:33], v6 offset:1024
  v_mfma_f32_32x32x16_bf16 v[80:95], a[0:3], a[28:31], v[80:95]
  ds_read_b64_tr_b16 a[34:35], v6 offset:1280
  ds_read_b64_tr_b16 a[36:37], v6 offset:5120
  ds_read_b64_tr_b16 a[38:39], v6 offset:5376
  v_mfma_f32_32x32x16_bf16 v[96:111], a[4:7], a[24:27], v[96:111]
  ds_read_b64_tr_b16 a[40:41], v6 offset:9216
  ds_read_b64_tr_b16 a[42:43], v6 offset:9472
  ds_read_b64_tr_b16 a[44:45], v6 offset:13312
  v_mfma_f32_32x32x16_bf16 v[112:127], a[4:7], a[28:31], v[112:127]
  ds_read_b64_tr_b16 a[46:47], v6 offset:13568
  ds_read_b64_tr_b16 a[48:49], v6 offset:17408
  ds_read_b64_tr_b16 a[50:51], v6 offset:17664
  v_mfma_f32_32x32x16_bf16 v[128:143], a[8:11], a[24:27], v[128:143]
  ds_read_b64_tr_b16 a[52:53], v6 offset:21504
  ds_read_b64_tr_b16 a[54:55], v6 offset:21760
  v_mfma_f32_32x32x16_bf16 v[144:159], a[8:11], a[28:31], v[144:159]
  v_mfma_f32_32x32x16_bf16 v[160:175], a[12:15], a[24:27], v[160:175]
  s_add_u32 m0, s50, 38912
  s_add_u32 s55, s49, 61440
  buffer_load_dwordx4 v10, s[32:35], s55 offen  lds
  v_mfma_f32_32x32x16_bf16 v[176:191], a[12:15], a[28:31], v[176:191]
  s_add_u32 m0, s50, 39936
  s_add_u32 s55, s49, 71680
  buffer_load_dwordx4 v11, s[32:35], s55 offen  lds
  s_add_u32 s49, s49, 128
  v_mfma_f32_32x32x16_bf16 v[192:207], a[16:19], a[24:27], v[192:207]
  s_add_u32 m0, s82, 0
  s_add_u32 s55, s51, 0
  buffer_load_dwordx4 v12, s[36:39], s55 offen  lds
  v_mfma_f32_32x32x16_bf16 v[208:223], a[16:19], a[28:31], v[208:223]
  s_add_u32 m0, s82, 4096
  s_add_u32 s55, s51, 64
  buffer_load_dwordx4 v12, s[36:39], s55 offen  lds
  v_mfma_f32_32x32x16_bf16 v[224:239], a[20:23], a[24:27], v[224:239]
  s_add_u32 m0, s82, 8192
  s_add_u32 s55, s51, 128
  buffer_load_dwordx4 v12, s[36:39], s55 offen  lds
  v_mfma_f32_32x32x16_bf16 v[240:255], a[20:23], a[28:31], v[240:255]
  s_waitcnt lgkmcnt(0)
  v_mfma_f32_32x32x16_bf16 v[64:79], a[32:35], a[56:59], v[64:79]
  ds_read_b128 a[24:27], v4 offset:0
  ds_read_b128 a[28:31], v4 offset:4096
  ds_read_b64_tr_b16 a[0:1], v6 offset:2048
  v_mfma_f32_32x32x16_bf16 v[80:95], a[32:35], a[60:63], v[80:95]
  ds_read_b64_tr_b16 a[2:3], v6 offset:2304
  ds_read_b64_tr_b16 a[4:5], v6 offset:6144
  ds_read_b64_tr_b16 a[6:7], v6 offset:6400
  v_mfma_f32_32x32x16_bf16 v[96:111], a[36:39], a[56:59], v[96:111]
  ds_read_b64_tr_b16 a[8:9], v6 offset:10240
  ds_read_b64_tr_b16 a[10:11], v6 offset:10496
  ds_read_b64_tr_b16 a[12:13], v6 offset:14336
  v_mfma_f32_32x32x16_bf16 v[112:127], a[36:39], a[60:63], v[112:127]
  ds_read_b64_tr_b16 a[14:15], v6 offset:14592
  ds_read_b64_tr_b16 a[16:17], v6 offset:18432
  ds_read_b64_tr_b16 a[18:19], v6 offset:18688
  v_mfma_f32_32x32x16_bf16 v[128:143], a[40:43], a[56:59], v[128:143]
  ds_read_b64_tr_b16 a[20:21], v6 offset:22528
  ds_read_b64_tr_b16 a[22:23], v6 offset:22784
  v_mfma_f32_32x32x16_bf16 v[144:159], a[40:43], a[60:63], v[144:159]
  v_mfma_f32_32x32x16_bf16 v[160:175], a[44:47], a[56:59], v[160:175]
  v_mfma_f32_32x32x16_bf16 v[176:191], a[44:47], a[60:63], v[176:191]
  v_mfma_f32_32x32x16_bf16 v[192:207], a[48:51], a[56:59], v[192:207]
  s_add_u32 m0, s82, 12288
  s_add_u32 s55, s51, 192
  buffer_load_dwordx4 v12, s[36:39], s55 offen  lds
  v_mfma_f32_32x32x16_bf16 v[208:223], a[48:51], a[60:63], v[208:223]
  s_add_u32 m0, s82, 16384
  s_add_u32 s55, s51, 256
  buffer_load_dwordx4 v12, s[36:39], s55 offen  lds
  v_mfma_f32_32x32x16_bf16 v[224:239], a[52:55], a[56:59], v[224:239]
  s_add_u32 m0, s82, 20480
  s_add_u32 s55, s51, 320
  buffer_load_dwordx4 v12, s[36:39], s55 offen  lds
  s_add_u32 s51, s51, s54
  v_mfma_f32_32x32x16_bf16 v[240:255], a[52:55], a[60:63], v[240:255]
  s_waitcnt lgkmcnt(0)
  v_mfma_f32_32x32x16_bf16 v[64:79], a[0:3], a[24:27], v[64:79]
  ds_read_b128 a[56:59], v5 offset:0
  ds_read_b128 a[60:63], v5 offset:4096
  ds_read_b64_tr_b16 a[32:33], v6 offset:3072
  v_mfma_f32_32x32x16_bf16 v[80:95], a[0:3], a[28:31], v[80:95]
  ds_read_b64_tr_b16 a[34:35], v6 offset:3328
  ds_read_b64_tr_b16 a[36:37], v6 offset:7168
  ds_read_b64_tr_b16 a[38:39], v6 offset:7424
  v_mfma_f32_32x32x16_bf16 v[96:111], a[4:7], a[24:27], v[96:111]
  ds_read_b64_tr_b16 a[40:41], v6 offset:11264
  ds_read_b64_tr_b16 a[42:43], v6 offset:11520
  ds_read_b64_tr_b16 a[44:45], v6 offset:15360
  v_mfma_f32_32x32x16_bf16 v[112:127], a[4:7], a[28:31], v[112:127]
  ds_read_b64_tr_b16 a[46:47], v6 offset:15616
  ds_read_b64_tr_b16 a[48:49], v6 offset:19456
  ds_read_b64_tr_b16 a[50:51], v6 offset:19712
  v_mfma_f32_32x32x16_bf16 v[128:143], a[8:11], a[24:27], v[128:143]
  ds_read_b64_tr_b16 a[52:53], v6 offset:23552
  ds_read_b64_tr_b16 a[54:55], v6 offset:23808
  v_mfma_f32_32x32x16_bf16 v[144:159], a[8:11], a[28:31], v[144:159]
  v_mfma_f32_32x32x16_bf16 v[160:175], a[12:15], a[24:27], v[160:175]
  v_mfma_f32_32x32x16_bf16 v[176:191], a[12:15], a[28:31], v[176:191]
  v_mfma_f32_32x32x16_bf16 v[192:207], a[16:19], a[24:27], v[192:207]
  v_mfma_f32_32x32x16_bf16 v[208:223], a[16:19], a[28:31], v[208:223]
  s_add_u32 s83, s81, s52
  s_add_u32 s83, s83, 65536
  v_mfma_f32_32x32x16_bf16 v[224:239], a[20:23], a[24:27], v[224:239]
  s_add_u32 s81, s81, 24576
  s_cmp_eq_u32 s81, 73728
  s_cselect_b32 s81, 0, s81
  v_mfma_f32_32x32x16_bf16 v[240:255], a[20:23], a[28:31], v[240:255]
  v_add_u32 v30, s81, v31
  s_waitcnt lgkmcnt(0)
  v_mfma_f32_32x32x16_bf16 v[64:79], a[32:35], a[56:59], v[64:79]
  v_mfma_f32_32x32x16_bf16 v[80:95], a[32:35], a[60:63], v[80:95]
  s_waitcnt vmcnt(6)
  s_barrier
  v_mov_b32 v7, v30
  s_mov_b32 s82, s83
  ds_read_b128 a[24:27], v2 offset:32768
  ds_read_b128 a[28:31], v2 offset:36864
  ds_read_b64_tr_b16 a[0:1], v7 offset:0
  v_mfma_f32_32x32x16_bf16 v[96:111], a[36:39], a[56:59], v[96:111]
  ds_read_b64_tr_b16 a[2:3], v7 offset:256
  ds_read_b64_tr_b16 a[4:5], v7 offset:4096
  ds_read_b64_tr_b16 a[6:7], v7 offset:4352
  v_mfma_f32_32x32x16_bf16 v[112:127], a[36:39], a[60:63], v[112:127]
  ds_read_b64_tr_b16 a[8:9], v7 offset:8192
  ds_read_b64_tr_b16 a[10:11], v7 offset:8448
  ds_read_b64_tr_b16 a[12:13], v7 offset:12288
  v_mfma_f32_32x32x16_bf16 v[128:143], a[40:43], a[56:59], v[128:143]
  ds_read_b64_tr_b16 a[14:15], v7 offset:12544
  ds_read_b64_tr_b16 a[16:17], v7 offset:16384
  ds_read_b64_tr_b16 a[18:19], v7 offset:16640
  v_mfma_f32_32x32x16_bf16 v[144:159], a[40:43], a[60:63], v[144:159]
  ds_read_b64_tr_b16 a[20:21], v7 offset:20480
  ds_read_b64_tr_b16 a[22:23], v7 offset:20736
  s_add_u32 m0, s50, 0
  s_add_u32 s55, s49, 0
  buffer_load_dwordx4 v10, s[32:35], s55 offen  lds
  v_mfma_f32_32x32x16_bf16 v[160:175], a[44:47], a[56:59], v[160:175]
  s_add_u32 m0, s50, 1024
  s_add_u32 s55, s49, 10240
  buffer_load_dwordx4 v11, s[32:35], s55 offen  lds
  v_mfma_f32_32x32x16_bf16 v[176:191], a[44:47], a[60:63], v[176:191]
  s_add_u32 m0, s50, 2048
  s_add_u32 s55, s49, 20480
  buffer_load_dwordx4 v10, s[32:35], s55 offen  lds
  v_mfma_f32_32x32x16_bf16 v[192:207], a[48:51], a[56:59], v[192:207]
  s_add_u32 m0, s50, 3072
  s_add_u32 s55, s49, 30720
  buffer_load_dwordx4 v11, s[32:35], s55 offen  lds
  v_mfma_f32_32x32x16_bf16 v[208:223], a[48:51], a[60:63], v[208:223]
  s_add_u32 m0, s50, 4096
  s_add_u32 s55, s49, 40960
  buffer_load_dwordx4 v10, s[32:35], s55 offen  lds
  v_mfma_f32_32x32x16_bf16 v[224:239], a[52:55], a[56:59], v[224:239]
  s_add_u32 m0, s50, 5120
  s_add_u32 s55, s49, 51200
  buffer_load_dwordx4 v11, s[32:35], s55 offen  lds
  v_mfma_f32_32x32x16_bf16 v[240:255], a[52:55], a[60:63], v[240:255]
  s_waitcnt lgkmcnt(0)
  v_mfma_f32_32x32x16_bf16 v[64:79], a[0:3], a[24:27], v[64:79]
  ds_read_b128 a[56:59], v3 offset:32768
  ds_read_b128 a[60:63], v3 offset:36864
  ds_read_b64_tr_b16 a[32:33], v7 offset:1024
  v_mfma_f32_32x32x16_bf16 v[80:95], a[0:3], a[28:31], v[80:95]
  ds_read_b64_tr_b16 a[34:35], v7 offset:1280
  ds_read_b64_tr_b16 a[36:37], v7 offset:5120
  ds_read_b64_tr_b16 a[38:39], v7 offset:5376
  v_mfma_f32_32x32x16_bf16 v[96:111], a[4:7], a[24:27], v[96:111]
  ds_read_b64_tr_b16 a[40:41], v7 offset:9216
  ds_read_b64_tr_b16 a[42:43], v7 offset:9472
  ds_read_b64_tr_b16 a[44:45], v7 offset:13312
  v_mfma_f32_32x32x16_bf16 v[112:127], a[4:7], a[28:31], v[112:127]
  ds_read_b64_tr_b16 a[46:47], v7 offset:13568
  ds_read_b64_tr_b16 a[48:49], v7 offset:17408
  ds_read_b64_tr_b16 a[50:51], v7 offset:17664
  v_mfma_f32_32x32x16_bf16 v[128:143], a[8:11], a[24:27], v[128:143]
  ds_read_b64_tr_b16 a[52:53], v7 offset:21504
  ds_read_b64_tr_b16 a[54:55], v7 offset:21760
  v_mfma_f32_32x32x16_bf16 v[144:159], a[8:11], a[28:31], v[144:159]
  v_mfma_f32_32x32x16_bf16 v[160:175], a[12:15], a[24:27], v[160:175]
  s_add_u32 m0, s50, 6144
  s_add_u32 s55, s49, 61440
  buffer_load_dwordx4 v10, s[32:35], s55 offen  lds
  v_mfma_f32_32x32x16_bf16 v[176:191], a[12:15], a[28:31], v[176:191]
  s_add_u32 m0, s50, 7168
  s_add_u32 s55, s49, 71680
  buffer_load_dwordx4 v11, s[32:35], s55 offen  lds
  s_add_u32 s49, s49, 128
  v_mfma_f32_32x32x16_bf16 v[192:207], a[16:19], a[24:27], v[192:207]
  s_add_u32 m0, s82, 0
  s_add_u32 s55, s51, 0
  buffer_load_dwordx4 v12, s[36:39], s55 offen  lds
  v_mfma_f32_32x32x16_bf16 v[208:223], a[16:19], a[28:31], v[208:223]
  s_add_u32 m0, s82, 4096
  s_add_u32 s55, s51, 64
  buffer_load_dwordx4 v12, s[36:39], s55 offen  lds
  v_mfma_f32_32x32x16_bf16 v[224:239], a[20:23], a[24:27], v[224:239]
  s_add_u32 m0, s82, 8192
  s_add_u32 s55, s51, 128
  buffer_load_dwordx4 v12, s[36:39], s55 offen  lds
  v_mfma_f32_32x32x16_bf16 v[240:255], a[20:23], a[28:31], v[240:255]
  s_waitcnt lgkmcnt(0)
  v_mfma_f32_32x32x16_bf16 v[64:79], a[32:35], a[56:59], v[64:79]
  ds_read_b128 a[24:27], v4 offset:32768
  ds_read_b128 a[28:31], v4 offset:36864
  ds_read_b64_tr_b16 a[0:1], v7 offset:2048
  v_mfma_f32_32x32x16_bf16 v[80:95], a[32:35], a[60:63], v[80:95]
  ds_read_b64_tr_b16 a[2:3], v7 offset:2304
  ds_read_b64_tr_b16 a[4:5], v7 offset:6144
  ds_read_b64_tr_b16 a[6:7], v7 offset:6400
  v_mfma_f32_32x32x16_bf16 v[96:111], a[36:39], a[56:59], v[96:111]
  ds_read_b64_tr_b16 a[8:9], v7 offset:10240
  ds_read_b64_tr_b16 a[10:11], v7 offset:10496
  ds_read_b64_tr_b16 a[12:13], v7 offset:14336
  v_mfma_f32_32x32x16_bf16 v[112:127], a[36:39], a[60:63], v[112:127]
  ds_read_b64_tr_b16 a[14:15], v7 offset:14592
  ds_read_b64_tr_b16 a[16:17], v7 offset:18432
  ds_read_b64_tr_b16 a[18:19], v7 offset:18688
  v_mfma_f32_32x32x16_bf16 v[128:143], a[40:43], a[56:59], v[128:143]
  ds_read_b64_tr_b16 a[20:21], v7 offset:22528
  ds_read_b64_tr_b16 a[22:23], v7 offset:22784
  v_mfma_f32_32x32x16_bf16 v[144:159], a[40:43], a[60:63], v[144:159]
  v_mfma_f32_32x32x16_bf16 v[160:175], a[44:47], a[56:59], v[160:175]
  v_mfma_f32_32x32x16_bf16 v[176:191], a[44:47], a[60:63], v[176:191]
  v_mfma_f32_32x32x16_bf16 v[192:207], a[48:51], a[56:59], v[192:207]
  s_add_u32 m0, s82, 12288
  s_add_u32 s55, s51, 192
  buffer_load_dwordx4 v12, s[36:39], s55 offen  lds
  v_mfma_f32_32x32x16_bf16 v[208:223], a[48:51], a[60:63], v[208:223]
  s_add_u32 m0, s82, 16384
  s_add_u32 s55, s51, 256
  buffer_load_dwordx4 v12, s[36:39], s55 offen  lds
  v_mfma_f32_32x32x16_bf16 v[224:239], a[52:55], a[56:59], v[224:239]
  s_add_u32 m0, s82, 20480
  s_add_u32 s55, s51, 320
  buffer_load_dwordx4 v12, s[36:39], s55 offen  lds
  s_add_u32 s51, s51, s54
  v_mfma_f32_32x32x16_bf16 v[240:255], a[52:55], a[60:63], v[240:255]
  s_waitcnt lgkmcnt(0)
  v_mfma_f32_32x32x16_bf16 v[64:79], a[0:3], a[24:27], v[64:79]
  ds_read_b128 a[56:59], v5 offset:32768
  ds_read_b128 a[60:63], v5 offset:36864
  ds_read_b64_tr_b16 a[32:33], v7 offset:3072
  v_mfma_f32_32x32x16_bf16 v[80:95], a[0:3], a[28:31], v[80:95]
  ds_read_b64_tr_b16 a[34:35], v7 offset:3328
  ds_read_b64_tr_b16 a[36:37], v7 offset:7168
  ds_read_b64_tr_b16 a[38:39], v7 offset:7424
  v_mfma_f32_32x32x16_bf16 v[96:111], a[4:7], a[24:27], v[96:111]
  ds_read_b64_tr_b16 a[40:41], v7 offset:11264
  ds_read_b64_tr_b16 a[42:43], v7 offset:11520
  ds_read_b64_tr_b16 a[44:45], v7 offset:15360
  v_mfma_f32_32x32x16_bf16 v[112:127], a[4:7], a[28:31], v[112:127]
  ds_read_b64_tr_b16 a[46:47], v7 offset:15616
  ds_read_b64_tr_b16 a[48:49], v7 offset:19456
  ds_read_b64_tr_b16 a[50:51], v7 offset:19712
  v_mfma_f32_32x32x16_bf16 v[128:143], a[8:11], a[24:27], v[128:143]
  ds_read_b64_tr_b16 a[52:53], v7 offset:23552
  ds_read_b64_tr_b16 a[54:55], v7 offset:23808
  v_mfma_f32_32x32x16_bf16 v[144:159], a[8:11], a[28:31], v[144:159]
  v_mfma_f32_32x32x16_bf16 v[160:175], a[12:15], a[24:27], v[160:175]
  v_mfma_f32_32x32x16_bf16 v[176:191], a[12:15], a[28:31], v[176:191]
  v_mfma_f32_32x32x16_bf16 v[192:207], a[16:19], a[24:27], v[192:207]
  v_mfma_f32_32x32x16_bf16 v[208:223], a[16:19], a[28:31], v[208:223]
  s_add_u32 s83, s81, s52
  s_add_u32 s83, s83, 65536
  v_mfma_f32_32x32x16_bf16 v[224:239], a[20:23], a[24:27], v[224:239]
  s_add_u32 s81, s81, 24576
  s_cmp_eq_u32 s81, 73728
  s_cselect_b32 s81, 0, s81
  v_mfma_f32_32x32x16_bf16 v[240:255], a[20:23], a[28:31], v[240:255]
  v_add_u32 v30, s81, v31
  s_waitcnt lgkmcnt(0)
  v_mfma_f32_32x32x16_bf16 v[64:79], a[32:35], a[56:59], v[64:79]
  v_mfma_f32_32x32x16_bf16 v[80:95], a[32:35], a[60:63], v[80:95]
  s_waitcnt vmcnt(6)
  s_barrier
  v_mov_b32 v6, v30
  s_mov_b32 s82, s83
  ds_read_b128 a[24:27], v2 offset:0
  ds_read_b128 a[28:31], v2 offset:4096
  ds_read_b64_tr_b16 a[0:1], v6 offset:0
  v_mfma_f32_32x32x16_bf16 v[96:111], a[36:39], a[56:59], v[96:111]
  ds_read_b64_tr_b16 a[2:3], v6 offset:256
  ds_read_b64_tr_b16 a[4:5], v6 offset:4096
  ds_read_b64_tr_b16 a[6:7], v6 offset:4352
  v_mfma_f32_32x32x16_bf16 v[112:127], a[36:39], a[60:63], v[112:127]
  ds_read_b64_tr_b16 a[8:9], v6 offset:8192
  ds_read_b64_tr_b16 a[10:11], v6 offset:8448
  ds_read_b64_tr_b16 a[12:13], v6 offset:12288
  v_mfma_f32_32x32x16_bf16 v[128:143], a[40:43], a[56:59], v[128:143]
  ds_read_b64_tr_b16 a[14:15], v6 offset:12544
  ds_read_b64_tr_b16 a[16:17], v6 offset:16384
  ds_read_b64_tr_b16 a[18:19], v6 offset:16640
  v_mfma_f32_32x32x16_bf16 v[144:159], a[40:43], a[60:63], v[144:159]
  ds_read_b64_tr_b16 a[20:21], v6 offset:20480
  ds_read_b64_tr_b16 a[22:23], v6 offset:20736
  s_add_u32 m0, s50, 32768
  s_add_u32 s55, s49, 0
  buffer_load_dwordx4 v10, s[32:35], s55 offen  lds
  v_mfma_f32_32x32x16_bf16 v[160:175], a[44:47], a[56:59], v[160:175]
  s_add_u32 m0, s50, 33792
  s_add_u32 s55, s49, 10240
  buffer_load_dwordx4 v11, s[32:35], s55 offen  lds
  v_mfma_f32_32x32x16_bf16 v[176:191], a[44:47], a[60:63], v[176:191]
  s_add_u32 m0, s50, 34816
  s_add_u32 s55, s49, 20480
  buffer_load_dwordx4 v10, s[32:35], s55 offen  lds
  v_mfma_f32_32x32x16_bf16 v[192:207], a[48:51], a[56:59], v[192:207]
  s_add_u32 m0, s50, 35840
  s_add_u32 s55, s49, 30720
  buffer_load_dwordx4 v11, s[32:35], s55 offen  lds
  v_mfma_f32_32x32x16_bf16 v[208:223], a[48:51], a[60:63], v[208:223]
  s_add_u32 m0, s50, 36864
  s_add_u32 s55, s49, 40960
  buffer_load_dwordx4 v10, s[32:35], s55 offen  lds
  v_mfma_f32_32x32x16_bf16 v[224:239], a[52:55], a[56:59], v[224:239]
  s_add_u32 m0, s50, 37888
  s_add_u32 s55, s49, 51200
  buffer_load_dwordx4 v11, s[32:35], s55 offen  lds
  v_mfma_f32_32x32x16_bf16 v[240:255], a[52:55], a[60:63], v[240:255]
  s_add_u32 s80, s80, 1
  s_cmp_lt_u32 s80, 3
  s_cbranch_scc1 PL_132
  s_waitcnt lgkmcnt(0)
  v_mfma_f32_32x32x16_bf16 v[64:79], a[0:3], a[24:27], v[64:79]
  ds_read_b128 a[56:59], v3 offset:0
  ds_read_b128 a[60:63], v3 offset:4096
  ds_read_b64_tr_b16 a[32:33], v6 offset:1024
  v_mfma_f32_32x32x16_bf16 v[80:95], a[0:3], a[28:31], v[80:95]
  ds_read_b64_tr_b16 a[34:35], v6 offset:1280
  ds_read_b64_tr_b16 a[36:37], v6 offset:5120
  ds_read_b64_tr_b16 a[38:39], v6 offset:5376
  v_mfma_f32_32x32x16_bf16 v[96:111], a[4:7], a[24:27], v[96:111]
  ds_read_b64_tr_b16 a[40:41], v6 offset:9216
  ds_read_b64_tr_b16 a[42:43], v6 offset:9472
  ds_read_b64_tr_b16 a[44:45], v6 offset:13312
  v_mfma_f32_32x32x16_bf16 v[112:127], a[4:7], a[28:31], v[112:127]
  ds_read_b64_tr_b16 a[46:47], v6 offset:13568
  ds_read_b64_tr_b16 a[48:49], v6 offset:17408
  ds_read_b64_tr_b16 a[50:51], v6 offset:17664
  v_mfma_f32_32x32x16_bf16 v[128:143], a[8:11], a[24:27], v[128:143]
  ds_read_b64_tr_b16 a[52:53], v6 offset:21504
  ds_read_b64_tr_b16 a[54:55], v6 offset:21760
  v_mfma_f32_32x32x16_bf16 v[144:159], a[8:11], a[28:31], v[144:159]
  v_mfma_f32_32x32x16_bf16 v[160:175], a[12:15], a[24:27], v[160:175]
  v_mfma_f32_32x32x16_bf16 v[176:191], a[12:15], a[28:31], v[176:191]
  v_mfma_f32_32x32x16_bf16 v[192:207], a[16:19], a[24:27], v[192:207]
  v_mfma_f32_32x32x16_bf16 v[208:223], a[16:19], a[28:31], v[208:223]
  s_add_u32 m0, s50, 38912
  s_add_u32 s55, s49, 61440
  buffer_load_dwordx4 v10, s[32:35], s55 offen  lds
  v_mfma_f32_32x32x16_bf16 v[224:239], a[20:23], a[24:27], v[224:239]
  s_add_u32 m0, s50, 39936
  s_add_u32 s55, s49, 71680
  buffer_load_dwordx4 v11, s[32:35], s55 offen  lds
  s_add_u32 s49, s49, 128
  v_mfma_f32_32x32x16_bf16 v[240:255], a[20:23], a[28:31], v[240:255]
  s_waitcnt lgkmcnt(0)
  v_mfma_f32_32x32x16_bf16 v[64:79], a[32:35], a[56:59], v[64:79]
  ds_read_b128 a[24:27], v4 offset:0
  ds_read_b128 a[28:31], v4 offset:4096
  ds_read_b64_tr_b16 a[0:1], v6 offset:2048
  v_mfma_f32_32x32x16_bf16 v[80:95], a[32:35], a[60:63], v[80:95]
  ds_read_b64_tr_b16 a[2:3], v6 offset:2304
  ds_read_b64_tr_b16 a[4:5], v6 offset:6144
  ds_read_b64_tr_b16 a[6:7], v6 offset:6400
  v_mfma_f32_32x32x16_bf16 v[96:111], a[36:39], a[56:59], v[96:111]
  ds_read_b64_tr_b16 a[8:9], v6 offset:10240
  ds_read_b64_tr_b16 a[10:11], v6 offset:10496
  ds_read_b64_tr_b16 a[12:13], v6 offset:14336
  v_mfma_f32_32x32x16_bf16 v[112:127], a[36:39], a[60:63], v[112:127]
  ds_read_b64_tr_b16 a[14:15], v6 offset:14592
  ds_read_b64_tr_b16 a[16:17], v6 offset:18432
  ds_read_b64_tr_b16 a[18:19], v6 offset:18688
  v_mfma_f32_32x32x16_bf16 v[128:143], a[40:43], a[56:59], v[128:143]
  ds_read_b64_tr_b16 a[20:21], v6 offset:22528
  ds_read_b64_tr_b16 a[22:23], v6 offset:22784
  v_mfma_f32_32x32x16_bf16 v[144:159], a[40:43], a[60:63], v[144:159]
  v_mfma_f32_32x32x16_bf16 v[160:175], a[44:47], a[56:59], v[160:175]
  v_mfma_f32_32x32x16_bf16 v[176:191], a[44:47], a[60:63], v[176:191]
  v_mfma_f32_32x32x16_bf16 v[192:207], a[48:51], a[56:59], v[192:207]
  v_mfma_f32_32x32x16_bf16 v[208:223], a[48:51], a[60:63], v[208:223]
  v_mfma_f32_32x32x16_bf16 v[224:239], a[52:55], a[56:59], v[224:239]
  v_mfma_f32_32x32x16_bf16 v[240:255], a[52:55], a[60:63], v[240:255]
  s_cmp_eq_u32 s67, 2
  s_cbranch_scc0 CW_133
  s_add_u32 m0, s78, 90112
  s_add_u32 s55, s75, 0
  buffer_load_dwordx4 v15, s[44:47], s55 offen lds
  s_add_u32 m0, s78, 91136
  s_add_u32 s55, s75, 20480
  buffer_load_dwordx4 v15, s[44:47], s55 offen lds
  s_add_u32 m0, s78, 92160
  s_add_u32 s55, s75, 40960
  buffer_load_dwordx4 v15, s[44:47], s55 offen lds
  s_add_u32 m0, s78, 102400
  s_add_u32 s55, s75, 64
  buffer_load_dwordx4 v15, s[44:47], s55 offen lds
  s_add_u32 m0, s78, 103424
  s_add_u32 s55, s75, 20544
  buffer_load_dwordx4 v15, s[44:47], s55 offen lds
  s_add_u32 m0, s78, 104448
  s_add_u32 s55, s75, 41024
  buffer_load_dwordx4 v15, s[44:47], s55 offen lds
  s_add_u32 s75, s75, 128
CW_133:
  s_waitcnt lgkmcnt(0)
  v_mfma_f32_32x32x16_bf16 v[64:79], a[0:3], a[24:27], v[64:79]
  ds_read_b128 a[56:59], v5 offset:0
  ds_read_b128 a[60:63], v5 offset:4096
  ds_read_b64_tr_b16 a[32:33], v6 offset:3072
  v_mfma_f32_32x32x16_bf16 v[80:95], a[0:3], a[28:31], v[80:95]
  ds_read_b64_tr_b16 a[34:35], v6 offset:3328
  ds_read_b64_tr_b16 a[36:37], v6 offset:7168
  ds_read_b64_tr_b16 a[38:39], v6 offset:7424
  v_mfma_f32_32x32x16_bf16 v[96:111], a[4:7], a[24:27], v[96:111]
  ds_read_b64_tr_b16 a[40:41], v6 offset:11264
  ds_read_b64_tr_b16 a[42:43], v6 offset:11520
  ds_read_b64_tr_b16 a[44:45], v6 offset:15360
  v_mfma_f32_32x32x16_bf16 v[112:127], a[4:7], a[28:31], v[112:127]
  ds_read_b64_tr_b16 a[46:47], v6 offset:15616
  ds_read_b64_tr_b16 a[48:49], v6 offset:19456
  ds_read_b64_tr_b16 a[50:51], v6 offset:19712
  v_mfma_f32_32x32x16_bf16 v[128:143], a[8:11], a[24:27], v[128:143]
  ds_read_b64_tr_b16 a[52:53], v6 offset:23552
  ds_read_b64_tr_b16 a[54:55], v6 offset:23808
  v_mfma_f32_32x32x16_bf16 v[144:159], a[8:11], a[28:31], v[144:159]
  v_mfma_f32_32x32x16_bf16 v[160:175], a[12:15], a[24:27], v[160:175]
  v_mfma_f32_32x32x16_bf16 v[176:191], a[12:15], a[28:31], v[176:191]
  v_mfma_f32_32x32x16_bf16 v[192:207], a[16:19], a[24:27], v[192:207]
  v_mfma_f32_32x32x16_bf16 v[208:223], a[16:19], a[28:31], v[208:223]
  s_add_u32 s83, s81, s52
  s_add_u32 s83, s83, 65536
  v_mfma_f32_32x32x16_bf16 v[224:239], a[20:23], a[24:27], v[224:239]
  s_add_u32 s81, s81, 24576
  s_cmp_eq_u32 s81, 73728
  s_cselect_b32 s81, 0, s81
  v_mfma_f32_32x32x16_bf16 v[240:255], a[20:23], a[28:31], v[240:255]
  v_add_u32 v30, s81, v31
  s_waitcnt lgkmcnt(0)
  v_mfma_f32_32x32x16_bf16 v[64:79], a[32:35], a[56:59], v[64:79]
  v_mfma_f32_32x32x16_bf16 v[80:95], a[32:35], a[60:63], v[80:95]
  s_cmp_eq_u32 s67, 2
  s_cbranch_scc1 V8_134
  s_waitcnt vmcnt(0)
  s_branch V9_135
V8_134:
  s_waitcnt vmcnt(6)
V9_135:
  s_barrier
  v_mov_b32 v7, v30
  s_mov_b32 s82, s83
  ds_read_b128 a[24:27], v2 offset:32768
  ds_read_b128 a[28:31], v2 offset:36864
  ds_read_b64_tr_b16 a[0:1], v7 offset:0
  v_mfma_f32_32x32x16_bf16 v[96:111], a[36:39], a[56:59], v[96:111]
  ds_read_b64_tr_b16 a[2:3], v7 offset:256
  ds_read_b64_tr_b16 a[4:5], v7 offset:4096
  ds_read_b64_tr_b16 a[6:7], v7 offset:4352
  v_mfma_f32_32x32x16_bf16 v[112:127], a[36:39], a[60:63], v[112:127]
  ds_read_b64_tr_b16 a[8:9], v7 offset:8192
  ds_read_b64_tr_b16 a[10:11], v7 offset:8448
  ds_read_b64_tr_b16 a[12:13], v7 offset:12288
  v_mfma_f32_32x32x16_bf16 v[128:143], a[40:43], a[56:59], v[128:143]
  ds_read_b64_tr_b16 a[14:15], v7 offset:12544
  ds_read_b64_tr_b16 a[16:17], v7 offset:16384
  ds_read_b64_tr_b16 a[18:19], v7 offset:16640
  v_mfma_f32_32x32x16_bf16 v[144:159], a[40:43], a[60:63], v[144:159]
  ds_read_b64_tr_b16 a[20:21], v7 offset:20480
  ds_read_b64_tr_b16 a[22:23], v7 offset:20736
  v_mfma_f32_32x32x16_bf16 v[160:175], a[44:47], a[56:59], v[160:175]
  v_mfma_f32_32x32x16_bf16 v[176:191], a[44:47], a[60:63], v[176:191]
  v_mfma_f32_32x32x16_bf16 v[192:207], a[48:51], a[56:59], v[192:207]
  v_mfma_f32_32x32x16_bf16 v[208:223], a[48:51], a[60:63], v[208:223]
  v_mfma_f32_32x32x16_bf16 v[224:239], a[52:55], a[56:59], v[224:239]
  v_mfma_f32_32x32x16_bf16 v[240:255], a[52:55], a[60:63], v[240:255]
  s_cmp_eq_u32 s67, 2
  s_cbranch_scc0 CW_136
  s_add_u32 m0, s78, 114688
  s_add_u32 s55, s75, 0
  buffer_load_dwordx4 v15, s[44:47], s55 offen lds
  s_add_u32 m0, s78, 115712
  s_add_u32 s55, s75, 20480
  buffer_load_dwordx4 v15, s[44:47], s55 offen lds
  s_add_u32 m0, s78, 116736
  s_add_u32 s55, s75, 40960
  buffer_load_dwordx4 v15, s[44:47], s55 offen lds
  s_add_u32 m0, s78, 126976
  s_add_u32 s55, s75, 64
  buffer_load_dwordx4 v15, s[44:47], s55 offen lds
  s_add_u32 m0, s78, 128000
  s_add_u32 s55, s75, 20544
  buffer_load_dwordx4 v15, s[44:47], s55 offen lds
  s_add_u32 m0, s78, 129024
  s_add_u32 s55, s75, 41024
  buffer_load_dwordx4 v15, s[44:47], s55 offen lds
  s_add_u32 s75, s75, 128
CW_136:
  s_waitcnt lgkmcnt(0)
  v_mfma_f32_32x32x16_bf16 v[64:79], a[0:3], a[24:27], v[64:79]
  ds_read_b128 a[56:59], v3 offset:32768
  ds_read_b128 a[60:63], v3 offset:36864
  ds_read_b64_tr_b16 a[32:33], v7 offset:1024
  v_mfma_f32_32x32x16_bf16 v[80:95], a[0:3], a[28:31], v[80:95]
  ds_read_b64_tr_b16 a[34:35], v7 offset:1280
  ds_read_b64_tr_b16 a[36:37], v7 offset:5120
  ds_read_b64_tr_b16 a[38:39], v7 offset:5376
  v_mfma_f32_32x32x16_bf16 v[96:111], a[4:7], a[24:27], v[96:111]
  ds_read_b64_tr_b16 a[40:41], v7 offset:9216
  ds_read_b64_tr_b16 a[42:43], v7 offset:9472
  ds_read_b64_tr_b16 a[44:45], v7 offset:13312
  v_mfma_f32_32x32x16_bf16 v[112:127], a[4:7], a[28:31], v[112:127]
  ds_read_b64_tr_b16 a[46:47], v7 offset:13568
  ds_read_b64_tr_b16 a[48:49], v7 offset:17408
  ds_read_b64_tr_b16 a[50:51], v7 offset:17664
  v_mfma_f32_32x32x16_bf16 v[128:143], a[8:11], a[24:27], v[128:143]
  ds_read_b64_tr_b16 a[52:53], v7 offset:21504
  ds_read_b64_tr_b16 a[54:55], v7 offset:21760
  v_mfma_f32_32x32x16_bf16 v[144:159], a[8:11], a[28:31], v[144:159]
  v_mfma_f32_32x32x16_bf16 v[160:175], a[12:15], a[24:27], v[160:175]
  v_mfma_f32_32x32x16_bf16 v[176:191], a[12:15], a[28:31], v[176:191]
  v_mfma_f32_32x32x16_bf16 v[192:207], a[16:19], a[24:27], v[192:207]
  v_mfma_f32_32x32x16_bf16 v[208:223], a[16:19], a[28:31], v[208:223]
  v_mfma_f32_32x32x16_bf16 v[224:239], a[20:23], a[24:27], v[224:239]
  v_mfma_f32_32x32x16_bf16 v[240:255], a[20:23], a[28:31], v[240:255]
  s_waitcnt lgkmcnt(0)
  v_mfma_f32_32x32x16_bf16 v[64:79], a[32:35], a[56:59], v[64:79]
  ds_read_b128 a[24:27], v4 offset:32768
  ds_read_b128 a[28:31], v4 offset:36864
  ds_read_b64_tr_b16 a[0:1], v7 offset:2048
  v_mfma_f32_32x32x16_bf16 v[80:95], a[32:35], a[60:63], v[80:95]
  ds_read_b64_tr_b16 a[2:3], v7 offset:2304
  ds_read_b64_tr_b16 a[4:5], v7 offset:6144
  ds_read_b64_tr_b16 a[6:7], v7 offset:6400
  v_mfma_f32_32x32x16_bf16 v[96:111], a[36:39], a[56:59], v[96:111]
  ds_read_b64_tr_b16 a[8:9], v7 offset:10240
  ds_read_b64_tr_b16 a[10:11], v7 offset:10496
  ds_read_b64_tr_b16 a[12:13], v7 offset:14336
  v_mfma_f32_32x32x16_bf16 v[112:127], a[36:39], a[60:63], v[112:127]
  ds_read_b64_tr_b16 a[14:15], v7 offset:14592
  ds_read_b64_tr_b16 a[16:17], v7 offset:18432
  ds_read_b64_tr_b16 a[18:19], v7 offset:18688
  v_mfma_f32_32x32x16_bf16 v[128:143], a[40:43], a[56:59], v[128:143]
  ds_read_b64_tr_b16 a[20:21], v7 offset:22528
  ds_read_b64_tr_b16 a[22:23], v7 offset:22784
  v_mfma_f32_32x32x16_bf16 v[144:159], a[40:43], a[60:63], v[144:159]
  v_mfma_f32_32x32x16_bf16 v[160:175], a[44:47], a[56:59], v[160:175]
  v_mfma_f32_32x32x16_bf16 v[176:191], a[44:47], a[60:63], v[176:191]
  v_mfma_f32_32x32x16_bf16 v[192:207], a[48:51], a[56:59], v[192:207]
  v_mfma_f32_32x32x16_bf16 v[208:223], a[48:51], a[60:63], v[208:223]
  v_mfma_f32_32x32x16_bf16 v[224:239], a[52:55], a[56:59], v[224:239]
  v_mfma_f32_32x32x16_bf16 v[240:255], a[52:55], a[60:63], v[240:255]
  s_waitcnt lgkmcnt(0)
  v_mfma_f32_32x32x16_bf16 v[64:79], a[0:3], a[24:27], v[64:79]
  ds_read_b128 a[56:59], v5 offset:32768
  ds_read_b128 a[60:63], v5 offset:36864
  ds_read_b64_tr_b16 a[32:33], v7 offset:3072
  v_mfma_f32_32x32x16_bf16 v[80:95], a[0:3], a[28:31], v[80:95]
  ds_read_b64_tr_b16 a[34:35], v7 offset:3328
  ds_read_b64_tr_b16 a[36:37], v7 offset:7168
  ds_read_b64_tr_b16 a[38:39], v7 offset:7424
  v_mfma_f32_32x32x16_bf16 v[96:111], a[4:7], a[24:27], v[96:111]
  ds_read_b64_tr_b16 a[40:41], v7 offset:11264
  ds_read_b64_tr_b16 a[42:43], v7 offset:11520
  ds_read_b64_tr_b16 a[44:45], v7 offset:15360
  v_mfma_f32_32x32x16_bf16 v[112:127], a[4:7], a[28:31], v[112:127]
  ds_read_b64_tr_b16 a[46:47], v7 offset:15616
  ds_read_b64_tr_b16 a[48:49], v7 offset:19456
  ds_read_b64_tr_b16 a[50:51], v7 offset:19712
  v_mfma_f32_32x32x16_bf16 v[128:143], a[8:11], a[24:27], v[128:143]
  ds_read_b64_tr_b16 a[52:53], v7 offset:23552
  ds_read_b64_tr_b16 a[54:55], v7 offset:23808
  v_mfma_f32_32x32x16_bf16 v[144:159], a[8:11], a[28:31], v[144:159]
  v_mfma_f32_32x32x16_bf16 v[160:175], a[12:15], a[24:27], v[160:175]
  v_mfma_f32_32x32x16_bf16 v[176:191], a[12:15], a[28:31], v[176:191]
  v_mfma_f32_32x32x16_bf16 v[192:207], a[16:19], a[24:27], v[192:207]
  v_mfma_f32_32x32x16_bf16 v[208:223], a[16:19], a[28:31], v[208:223]
  v_mfma_f32_32x32x16_bf16 v[224:239], a[20:23], a[24:27], v[224:239]
  v_mfma_f32_32x32x16_bf16 v[240:255], a[20:23], a[28:31], v[240:255]
  s_waitcnt lgkmcnt(0)
  v_mfma_f32_32x32x16_bf16 v[64:79], a[32:35], a[56:59], v[64:79]
  v_mfma_f32_32x32x16_bf16 v[80:95], a[32:35], a[60:63], v[80:95]
  v_mfma_f32_32x32x16_bf16 v[96:111], a[36:39], a[56:59], v[96:111]
  v_mfma_f32_32x32x16_bf16 v[112:127], a[36:39], a[60:63], v[112:127]
  v_mfma_f32_32x32x16_bf16 v[128:143], a[40:43], a[56:59], v[128:143]
  v_mfma_f32_32x32x16_bf16 v[144:159], a[40:43], a[60:63], v[144:159]
  v_mfma_f32_32x32x16_bf16 v[160:175], a[44:47], a[56:59], v[160:175]
  v_mfma_f32_32x32x16_bf16 v[176:191], a[44:47], a[60:63], v[176:191]
  v_mfma_f32_32x32x16_bf16 v[192:207], a[48:51], a[56:59], v[192:207]
  v_mfma_f32_32x32x16_bf16 v[208:223], a[48:51], a[60:63], v[208:223]
  v_mfma_f32_32x32x16_bf16 v[224:239], a[52:55], a[56:59], v[224:239]
  v_mfma_f32_32x32x16_bf16 v[240:255], a[52:55], a[60:63], v[240:255]
  s_cmp_eq_u32 s67, 2
  s_cbranch_scc1 WP_VC
  s_cmp_eq_u32 s67, 3
  s_cbranch_scc1 WP_A1E
  s_nop 7
  s_nop 7
  v_cvt_pk_bf16_f32 v16, v64, v65
  v_cvt_pk_bf16_f32 v17, v66, v67
  v_cvt_pk_bf16_f32 v18, v68, v69
  v_cvt_pk_bf16_f32 v19, v70, v71
  v_cvt_pk_bf16_f32 v20, v72, v73
  v_cvt_pk_bf16_f32 v21, v74, v75
  v_cvt_pk_bf16_f32 v22, v76, v77
  v_cvt_pk_bf16_f32 v23, v78, v79
  s_add_u32 s55, s56, 0
  buffer_store_dwordx4 v[16:19], v13, s[40:43], s55 offen sc1
  s_add_u32 s55, s56, 65536
  buffer_store_dwordx4 v[20:23], v13, s[40:43], s55 offen sc1
  v_cvt_pk_bf16_f32 v24, v80, v81
  v_cvt_pk_bf16_f32 v25, v82, v83
  v_cvt_pk_bf16_f32 v26, v84, v85
  v_cvt_pk_bf16_f32 v27, v86, v87
  v_cvt_pk_bf16_f32 v28, v88, v89
  v_cvt_pk_bf16_f32 v29, v90, v91
  v_cvt_pk_bf16_f32 v30, v92, v93
  v_cvt_pk_bf16_f32 v31, v94, v95
  s_add_u32 s55, s57, 0
  buffer_store_dwordx4 v[24:27], v13, s[40:43], s55 offen sc1
  s_add_u32 s55, s57, 65536
  buffer_store_dwordx4 v[28:31], v13, s[40:43], s55 offen sc1
  v_cvt_pk_bf16_f32 v16, v96, v97
  v_cvt_pk_bf16_f32 v17, v98, v99
  v_cvt_pk_bf16_f32 v18, v100, v101
  v_cvt_pk_bf16_f32 v19, v102, v103
  v_cvt_pk_bf16_f32 v20, v104, v105
  v_cvt_pk_bf16_f32 v21, v106, v107
  v_cvt_pk_bf16_f32 v22, v108, v109
  v_cvt_pk_bf16_f32 v23, v110, v111
  s_add_u32 s55, s56, 131072
  buffer_store_dwordx4 v[16:19], v13, s[40:43], s55 offen sc1
  s_add_u32 s55, s56, 196608
  buffer_store_dwordx4 v[20:23], v13, s[40:43], s55 offen sc1
  v_cvt_pk_bf16_f32 v24, v112, v113
  v_cvt_pk_bf16_f32 v25, v114, v115
  v_cvt_pk_bf16_f32 v26, v116, v117
  v_cvt_pk_bf16_f32 v27, v118, v119
  v_cvt_pk_bf16_f32 v28, v120, v121
  v_cvt_pk_bf16_f32 v29, v122, v123
  v_cvt_pk_bf16_f32 v30, v124, v125
  v_cvt_pk_bf16_f32 v31, v126, v127
  s_add_u32 s55, s57, 131072
  buffer_store_dwordx4 v[24:27], v13, s[40:43], s55 offen sc1
  s_add_u32 s55, s57, 196608
  buffer_store_dwordx4 v[28:31], v13, s[40:43], s55 offen sc1
  v_cvt_pk_bf16_f32 v16, v128, v129
  v_cvt_pk_bf16_f32 v17, v130, v131
  v_cvt_pk_bf16_f32 v18, v132, v133
  v_cvt_pk_bf16_f32 v19, v134, v135
  v_cvt_pk_bf16_f32 v20, v136, v137
  v_cvt_pk_bf16_f32 v21, v138, v139
  v_cvt_pk_bf16_f32 v22, v140, v141
  v_cvt_pk_bf16_f32 v23, v142, v143
  s_add_u32 s55, s56, 262144
  buffer_store_dwordx4 v[16:19], v13, s[40:43], s55 offen sc1
  s_add_u32 s55, s56, 327680
  buffer_store_dwordx4 v[20:23], v13, s[40:43], s55 offen sc1
  v_cvt_pk_bf16_f32 v24, v144, v145
  v_cvt_pk_bf16_f32 v25, v146, v147
  v_cvt_pk_bf16_f32 v26, v148, v149
  v_cvt_pk_bf16_f32 v27, v150, v151
  v_cvt_pk_bf16_f32 v28, v152, v153
  v_cvt_pk_bf16_f32 v29, v154, v155
  v_cvt_pk_bf16_f32 v30, v156, v157
  v_cvt_pk_bf16_f32 v31, v158, v159
  s_add_u32 s55, s57, 262144
  buffer_store_dwordx4 v[24:27], v13, s[40:43], s55 offen sc1
  s_add_u32 s55, s57, 327680
  buffer_store_dwordx4 v[28:31], v13, s[40:43], s55 offen sc1
  v_cvt_pk_bf16_f32 v16, v160, v161
  v_cvt_pk_bf16_f32 v17, v162, v163
  v_cvt_pk_bf16_f32 v18, v164, v165
  v_cvt_pk_bf16_f32 v19, v166, v167
  v_cvt_pk_bf16_f32 v20, v168, v169
  v_cvt_pk_bf16_f32 v21, v170, v171
  v_cvt_pk_bf16_f32 v22, v172, v173
  v_cvt_pk_bf16_f32 v23, v174, v175
  s_add_u32 s55, s56, 393216
  buffer_store_dwordx4 v[16:19], v13, s[40:43], s55 offen sc1
  s_add_u32 s55, s56, 458752
  buffer_store_dwordx4 v[20:23], v13, s[40:43], s55 offen sc1
  v_cvt_pk_bf16_f32 v24, v176, v177
  v_cvt_pk_bf16_f32 v25, v178, v179
  v_cvt_pk_bf16_f32 v26, v180, v181
  v_cvt_pk_bf16_f32 v27, v182, v183
  v_cvt_pk_bf16_f32 v28, v184, v185
  v_cvt_pk_bf16_f32 v29, v186, v187
  v_cvt_pk_bf16_f32 v30, v188, v189
  v_cvt_pk_bf16_f32 v31, v190, v191
  s_add_u32 s55, s57, 393216
  buffer_store_dwordx4 v[24:27], v13, s[40:43], s55 offen sc1
  s_add_u32 s55, s57, 458752
  buffer_store_dwordx4 v[28:31], v13, s[40:43], s55 offen sc1
  v_cvt_pk_bf16_f32 v16, v192, v193
  v_cvt_pk_bf16_f32 v17, v194, v195
  v_cvt_pk_bf16_f32 v18, v196, v197
  v_cvt_pk_bf16_f32 v19, v198, v199
  v_cvt_pk_bf16_f32 v20, v200, v201
  v_cvt_pk_bf16_f32 v21, v202, v203
  v_cvt_pk_bf16_f32 v22, v204, v205
  v_cvt_pk_bf16_f32 v23, v206, v207
  s_add_u32 s55, s56, 524288
  buffer_store_dwordx4 v[16:19], v13, s[40:43], s55 offen sc1
  s_add_u32 s55, s56, 589824
  buffer_store_dwordx4 v[20:23], v13, s[40:43], s55 offen sc1
  v_cvt_pk_bf16_f32 v24, v208, v209
  v_cvt_pk_bf16_f32 v25, v210, v211
  v_cvt_pk_bf16_f32 v26, v212, v213
  v_cvt_pk_bf16_f32 v27, v214, v215
  v_cvt_pk_bf16_f32 v28, v216, v217
  v_cvt_pk_bf16_f32 v29, v218, v219
  v_cvt_pk_bf16_f32 v30, v220, v221
  v_cvt_pk_bf16_f32 v31, v222, v223
  s_add_u32 s55, s57, 524288
  buffer_store_dwordx4 v[24:27], v13, s[40:43], s55 offen sc1
  s_add_u32 s55, s57, 589824
  buffer_store_dwordx4 v[28:31], v13, s[40:43], s55 offen sc1
  v_cvt_pk_bf16_f32 v16, v224, v225
  v_cvt_pk_bf16_f32 v17, v226, v227
  v_cvt_pk_bf16_f32 v18, v228, v229
  v_cvt_pk_bf16_f32 v19, v230, v231
  v_cvt_pk_bf16_f32 v20, v232, v233
  v_cvt_pk_bf16_f32 v21, v234, v235
  v_cvt_pk_bf16_f32 v22, v236, v237
  v_cvt_pk_bf16_f32 v23, v238, v239
  s_add_u32 s55, s56, 655360
  buffer_store_dwordx4 v[16:19], v13, s[40:43], s55 offen sc1
  s_add_u32 s55, s56, 720896
  buffer_store_dwordx4 v[20:23], v13, s[40:43], s55 offen sc1
  v_cvt_pk_bf16_f32 v24, v240, v241
  v_cvt_pk_bf16_f32 v25, v242, v243
  v_cvt_pk_bf16_f32 v26, v244, v245
  v_cvt_pk_bf16_f32 v27, v246, v247
  v_cvt_pk_bf16_f32 v28, v248, v249
  v_cvt_pk_bf16_f32 v29, v250, v251
  v_cvt_pk_bf16_f32 v30, v252, v253
  v_cvt_pk_bf16_f32 v31, v254, v255
  s_add_u32 s55, s57, 655360
  buffer_store_dwordx4 v[24:27], v13, s[40:43], s55 offen sc1
  s_add_u32 s55, s57, 720896
  buffer_store_dwordx4 v[28:31], v13, s[40:43], s55 offen sc1
  s_lshl_b32 s68, s66, 2
  s_mov_b32 s69, 128
  s_cmp_eq_u32 s67, 0
  s_cselect_b32 s69, 96, s69
  s_add_u32 s68, s68, s69
  s_waitcnt vmcnt(0)
  s_barrier
  s_cmp_eq_u32 s48, 0
  s_cbranch_scc0 SG_137
  s_mov_b32 s95, s68
  v_mov_b32 v1, 1
  s_mov_b64 exec, 1
  buffer_atomic_add v1, off, s[96:99], s95
  s_mov_b64 exec, -1
SG_137:
  s_branch WP_DONE
WP_VC:
  v_lshrrev_b32 v14, 2, v1
  v_mul_u32_u24 v14, 1280, v14
  v_and_b32 v15, 3, v1
  v_lshlrev_b32 v15, 4, v15
  v_add_u32 v15, v15, v14
  v_bfe_u32 v12, v1, 4, 1
  v_lshlrev_b32 v12, 16, v12
  v_and_b32 v14, 15, v1
  v_lshl_add_u32 v12, v14, 5, v12
  v_lshrrev_b32 v14, 5, v1
  v_lshl_add_u32 v12, v14, 4, v12
  s_barrier
  s_add_u32 m0, s78, 65536
  s_add_u32 s55, s75, 0
  buffer_load_dwordx4 v15, s[44:47], s55 offen lds
  s_add_u32 m0, s78, 66560
  s_add_u32 s55, s75, 20480
  buffer_load_dwordx4 v15, s[44:47], s55 offen lds
  s_add_u32 m0, s78, 67584
  s_add_u32 s55, s75, 40960
  buffer_load_dwordx4 v15, s[44:47], s55 offen lds
  s_add_u32 m0, s78, 77824
  s_add_u32 s55, s75, 64
  buffer_load_dwordx4 v15, s[44:47], s55 offen lds
  s_add_u32 m0, s78, 78848
  s_add_u32 s55, s75, 20544
  buffer_load_dwordx4 v15, s[44:47], s55 offen lds
  s_add_u32 m0, s78, 79872
  s_add_u32 s55, s75, 41024
  buffer_load_dwordx4 v15, s[44:47], s55 offen lds
  s_add_u32 s75, s75, 128
  v_mov_b32 v2, v8
  v_add_u32 v8, 24576, v2
  s_mov_b32 s81, 24576
  s_nop 7
  s_nop 7
  v_cvt_pk_bf16_f32 v64, v64, v65
  v_cvt_pk_bf16_f32 v65, v66, v67
  v_cvt_pk_bf16_f32 v66, v68, v69
  v_cvt_pk_bf16_f32 v67, v70, v71
  v_cvt_pk_bf16_f32 v68, v72, v73
  v_cvt_pk_bf16_f32 v69, v74, v75
  v_cvt_pk_bf16_f32 v70, v76, v77
  v_cvt_pk_bf16_f32 v71, v78, v79
  v_cvt_pk_bf16_f32 v72, v80, v81
  v_cvt_pk_bf16_f32 v73, v82, v83
  v_cvt_pk_bf16_f32 v74, v84, v85
  v_cvt_pk_bf16_f32 v75, v86, v87
  v_cvt_pk_bf16_f32 v76, v88, v89
  v_cvt_pk_bf16_f32 v77, v90, v91
  v_cvt_pk_bf16_f32 v78, v92, v93
  v_cvt_pk_bf16_f32 v79, v94, v95
  v_cvt_pk_bf16_f32 v80, v96, v97
  v_cvt_pk_bf16_f32 v81, v98, v99
  v_cvt_pk_bf16_f32 v82, v100, v101
  v_cvt_pk_bf16_f32 v83, v102, v103
  v_cvt_pk_bf16_f32 v84, v104, v105
  v_cvt_pk_bf16_f32 v85, v106, v107
  v_cvt_pk_bf16_f32 v86, v108, v109
  v_cvt_pk_bf16_f32 v87, v110, v111
  v_cvt_pk_bf16_f32 v88, v112, v113
  v_cvt_pk_bf16_f32 v89, v114, v115
  v_cvt_pk_bf16_f32 v90, v116, v117
  v_cvt_pk_bf16_f32 v91, v118, v119
  v_cvt_pk_bf16_f32 v92, v120, v121
  v_cvt_pk_bf16_f32 v93, v122, v123
  v_cvt_pk_bf16_f32 v94, v124, v125
  v_cvt_pk_bf16_f32 v95, v126, v127
  v_cvt_pk_bf16_f32 v96, v128, v129
  v_cvt_pk_bf16_f32 v97, v130, v131
  v_cvt_pk_bf16_f32 v98, v132, v133
  v_cvt_pk_bf16_f32 v99, v134, v135
  v_cvt_pk_bf16_f32 v100, v136, v137
  v_cvt_pk_bf16_f32 v101, v138, v139
  v_cvt_pk_bf16_f32 v102, v140, v141
  v_cvt_pk_bf16_f32 v103, v142, v143
  v_cvt_pk_bf16_f32 v104, v144, v145
  v_cvt_pk_bf16_f32 v105, v146, v147
  v_cvt_pk_bf16_f32 v106, v148, v149
  v_cvt_pk_bf16_f32 v107, v150, v151
  v_cvt_pk_bf16_f32 v108, v152, v153
  v_cvt_pk_bf16_f32 v109, v154, v155
  v_cvt_pk_bf16_f32 v110, v156, v157
  v_cvt_pk_bf16_f32 v111, v158, v159
  v_cvt_pk_bf16_f32 v112, v160, v161
  v_cvt_pk_bf16_f32 v113, v162, v163
  v_cvt_pk_bf16_f32 v114, v164, v165
  v_cvt_pk_bf16_f32 v115, v166, v167
  v_cvt_pk_bf16_f32 v116, v168, v169
  v_cvt_pk_bf16_f32 v117, v170, v171
  v_cvt_pk_bf16_f32 v118, v172, v173
  v_cvt_pk_bf16_f32 v119, v174, v175
  v_cvt_pk_bf16_f32 v120, v176, v177
  v_cvt_pk_bf16_f32 v121, v178, v179
  v_cvt_pk_bf16_f32 v122, v180, v181
  v_cvt_pk_bf16_f32 v123, v182, v183
  v_cvt_pk_bf16_f32 v124, v184, v185
  v_cvt_pk_bf16_f32 v125, v186, v187
  v_cvt_pk_bf16_f32 v126, v188, v189
  v_cvt_pk_bf16_f32 v127, v190, v191
  v_cvt_pk_bf16_f32 v128, v192, v193
  v_cvt_pk_bf16_f32 v129, v194, v195
  v_cvt_pk_bf16_f32 v130, v196, v197
  v_cvt_pk_bf16_f32 v131, v198, v199
  v_cvt_pk_bf16_f32 v132, v200, v201
  v_cvt_pk_bf16_f32 v133, v202, v203
  v_cvt_pk_bf16_f32 v134, v204, v205
  v_cvt_pk_bf16_f32 v135, v206, v207
  v_cvt_pk_bf16_f32 v136, v208, v209
  v_cvt_pk_bf16_f32 v137, v210, v211
  v_cvt_pk_bf16_f32 v138, v212, v213
  v_cvt_pk_bf16_f32 v139, v214, v215
  v_cvt_pk_bf16_f32 v140, v216, v217
  v_cvt_pk_bf16_f32 v141, v218, v219
  v_cvt_pk_bf16_f32 v142, v220, v221
  v_cvt_pk_bf16_f32 v143, v222, v223
  v_cvt_pk_bf16_f32 v144, v224, v225
  v_cvt_pk_bf16_f32 v145, v226, v227
  v_cvt_pk_bf16_f32 v146, v228, v229
  v_cvt_pk_bf16_f32 v147, v230, v231
  v_cvt_pk_bf16_f32 v148, v232, v233
  v_cvt_pk_bf16_f32 v149, v234, v235
  v_cvt_pk_bf16_f32 v150, v236, v237
  v_cvt_pk_bf16_f32 v151, v238, v239
  v_cvt_pk_bf16_f32 v152, v240, v241
  v_cvt_pk_bf16_f32 v153, v242, v243
  v_cvt_pk_bf16_f32 v154, v244, v245
  v_cvt_pk_bf16_f32 v155, v246, v247
  v_cvt_pk_bf16_f32 v156, v248, v249
  v_cvt_pk_bf16_f32 v157, v250, v251
  v_cvt_pk_bf16_f32 v158, v252, v253
  v_cvt_pk_bf16_f32 v159, v254, v255
  s_waitcnt vmcnt(12)
  s_barrier
  ds_read_b64_tr_b16 a[0:1], v8 offset:0
  ds_read_b64_tr_b16 a[2:3], v8 offset:256
  ds_read_b64_tr_b16 a[4:5], v8 offset:12288
  ds_read_b64_tr_b16 a[6:7], v8 offset:12544
  ds_read_b64_tr_b16 a[8:9], v8 offset:1024
  ds_read_b64_tr_b16 a[10:11], v8 offset:1280
  ds_read_b64_tr_b16 a[12:13], v8 offset:13312
  ds_read_b64_tr_b16 a[14:15], v8 offset:13568
  s_waitcnt lgkmcnt(4)
  v_mfma_f32_32x32x16_bf16 v[160:175], v[64:67], a[0:3], 0
  ds_read_b64_tr_b16 a[16:17], v8 offset:2048
  v_mfma_f32_32x32x16_bf16 v[176:191], v[64:67], a[4:7], 0
  ds_read_b64_tr_b16 a[18:19], v8 offset:2304
  v_mfma_f32_32x32x16_bf16 v[192:207], v[72:75], a[0:3], 0
  ds_read_b64_tr_b16 a[20:21], v8 offset:14336
  v_mfma_f32_32x32x16_bf16 v[208:223], v[72:75], a[4:7], 0
  ds_read_b64_tr_b16 a[22:23], v8 offset:14592
  s_waitcnt lgkmcnt(4)
  v_mfma_f32_32x32x16_bf16 v[160:175], v[68:71], a[8:11], v[160:175]
  ds_read_b64_tr_b16 a[24:25], v8 offset:3072
  v_mfma_f32_32x32x16_bf16 v[176:191], v[68:71], a[12:15], v[176:191]
  ds_read_b64_tr_b16 a[26:27], v8 offset:3328
  v_mfma_f32_32x32x16_bf16 v[192:207], v[76:79], a[8:11], v[192:207]
  ds_read_b64_tr_b16 a[28:29], v8 offset:15360
  v_mfma_f32_32x32x16_bf16 v[208:223], v[76:79], a[12:15], v[208:223]
  ds_read_b64_tr_b16 a[30:31], v8 offset:15616
  s_waitcnt lgkmcnt(4)
  v_mfma_f32_32x32x16_bf16 v[160:175], v[80:83], a[16:19], v[160:175]
  ds_read_b64_tr_b16 a[32:33], v8 offset:4096
  v_mfma_f32_32x32x16_bf16 v[176:191], v[80:83], a[20:23], v[176:191]
  ds_read_b64_tr_b16 a[34:35], v8 offset:4352
  v_mfma_f32_32x32x16_bf16 v[192:207], v[88:91], a[16:19], v[192:207]
  ds_read_b64_tr_b16 a[36:37], v8 offset:16384
  v_mfma_f32_32x32x16_bf16 v[208:223], v[88:91], a[20:23], v[208:223]
  ds_read_b64_tr_b16 a[38:39], v8 offset:16640
  s_waitcnt lgkmcnt(4)
  v_mfma_f32_32x32x16_bf16 v[160:175], v[84:87], a[24:27], v[160:175]
  ds_read_b64_tr_b16 a[40:41], v8 offset:5120
  v_mfma_f32_32x32x16_bf16 v[176:191], v[84:87], a[28:31], v[176:191]
  ds_read_b64_tr_b16 a[42:43], v8 offset:5376
  v_mfma_f32_32x32x16_bf16 v[192:207], v[92:95], a[24:27], v[192:207]
  ds_read_b64_tr_b16 a[44:45], v8 offset:17408
  v_mfma_f32_32x32x16_bf16 v[208:223], v[92:95], a[28:31], v[208:223]
  ds_read_b64_tr_b16 a[46:47], v8 offset:17664
  s_waitcnt lgkmcnt(4)
  v_mfma_f32_32x32x16_bf16 v[160:175], v[96:99], a[32:35], v[160:175]
  ds_read_b64_tr_b16 a[48:49], v8 offset:6144
  v_mfma_f32_32x32x16_bf16 v[176:191], v[96:99], a[36:39], v[176:191]
  ds_read_b64_tr_b16 a[50:51], v8 offset:6400
  v_mfma_f32_32x32x16_bf16 v[192:207], v[104:107], a[32:35], v[192:207]
  ds_read_b64_tr_b16 a[52:53], v8 offset:18432
  v_mfma_f32_32x32x16_bf16 v[208:223], v[104:107], a[36:39], v[208:223]
  ds_read_b64_tr_b16 a[54:55], v8 offset:18688
  s_waitcnt lgkmcnt(4)
  v_mfma_f32_32x32x16_bf16 v[160:175], v[100:103], a[40:43], v[160:175]
  ds_read_b64_tr_b16 a[56:57], v8 offset:7168
  v_mfma_f32_32x32x16_bf16 v[176:191], v[100:103], a[44:47], v[176:191]
  ds_read_b64_tr_b16 a[58:59], v8 offset:7424
  v_mfma_f32_32x32x16_bf16 v[192:207], v[108:111], a[40:43], v[192:207]
  ds_read_b64_tr_b16 a[60:61], v8 offset:19456
  v_mfma_f32_32x32x16_bf16 v[208:223], v[108:111], a[44:47], v[208:223]
  ds_read_b64_tr_b16 a[62:63], v8 offset:19712
  s_waitcnt lgkmcnt(4)
  v_mfma_f32_32x32x16_bf16 v[160:175], v[112:115], a[48:51], v[160:175]
  ds_read_b64_tr_b16 a[0:1], v8 offset:8192
  v_mfma_f32_32x32x16_bf16 v[176:191], v[112:115], a[52:55], v[176:191]
  ds_read_b64_tr_b16 a[2:3], v8 offset:8448
  v_mfma_f32_32x32x16_bf16 v[192:207], v[120:123], a[48:51], v[192:207]
  ds_read_b64_tr_b16 a[4:5], v8 offset:20480
  v_mfma_f32_32x32x16_bf16 v[208:223], v[120:123], a[52:55], v[208:223]
  ds_read_b64_tr_b16 a[6:7], v8 offset:20736
  s_waitcnt lgkmcnt(4)
  v_mfma_f32_32x32x16_bf16 v[160:175], v[116:119], a[56:59], v[160:175]
  ds_read_b64_tr_b16 a[8:9], v8 offset:9216
  v_mfma_f32_32x32x16_bf16 v[176:191], v[116:119], a[60:63], v[176:191]
  ds_read_b64_tr_b16 a[10:11], v8 offset:9472
  v_mfma_f32_32x32x16_bf16 v[192:207], v[124:127], a[56:59], v[192:207]
  ds_read_b64_tr_b16 a[12:13], v8 offset:21504
  v_mfma_f32_32x32x16_bf16 v[208:223], v[124:127], a[60:63], v[208:223]
  ds_read_b64_tr_b16 a[14:15], v8 offset:21760
  s_waitcnt lgkmcnt(4)
  v_mfma_f32_32x32x16_bf16 v[160:175], v[128:131], a[0:3], v[160:175]
  ds_read_b64_tr_b16 a[16:17], v8 offset:10240
  v_mfma_f32_32x32x16_bf16 v[176:191], v[128:131], a[4:7], v[176:191]
  ds_read_b64_tr_b16 a[18:19], v8 offset:10496
  v_mfma_f32_32x32x16_bf16 v[192:207], v[136:139], a[0:3], v[192:207]
  ds_read_b64_tr_b16 a[20:21], v8 offset:22528
  v_mfma_f32_32x32x16_bf16 v[208:223], v[136:139], a[4:7], v[208:223]
  ds_read_b64_tr_b16 a[22:23], v8 offset:22784
  s_waitcnt lgkmcnt(4)
  v_mfma_f32_32x32x16_bf16 v[160:175], v[132:135], a[8:11], v[160:175]
  ds_read_b64_tr_b16 a[24:25], v8 offset:11264
  v_mfma_f32_32x32x16_bf16 v[176:191], v[132:135], a[12:15], v[176:191]
  ds_read_b64_tr_b16 a[26:27], v8 offset:11520
  v_mfma_f32_32x32x16_bf16 v[192:207], v[140:143], a[8:11], v[192:207]
  ds_read_b64_tr_b16 a[28:29], v8 offset:23552
  v_mfma_f32_32x32x16_bf16 v[208:223], v[140:143], a[12:15], v[208:223]
  ds_read_b64_tr_b16 a[30:31], v8 offset:23808
  s_waitcnt lgkmcnt(0)
  s_add_u32 s82, s81, s78
  s_add_u32 s82, s82, 65536
  s_add_u32 s81, s81, 24576
  s_cmp_eq_u32 s81, 73728
  s_cselect_b32 s81, 0, s81
  v_add_u32 v9, s81, v2
  s_waitcnt vmcnt(6)
  s_barrier
  v_mfma_f32_32x32x16_bf16 v[160:175], v[144:147], a[16:19], v[160:175]
  ds_read_b64_tr_b16 a[0:1], v9 offset:0
  ds_read_b64_tr_b16 a[2:3], v9 offset:256
  v_mfma_f32_32x32x16_bf16 v[176:191], v[144:147], a[20:23], v[176:191]
  ds_read_b64_tr_b16 a[4:5], v9 offset:12288
  ds_read_b64_tr_b16 a[6:7], v9 offset:12544
  v_mfma_f32_32x32x16_bf16 v[192:207], v[152:155], a[16:19], v[192:207]
  s_add_u32 m0, s82, 0
  s_add_u32 s55, s75, 0
  buffer_load_dwordx4 v15, s[44:47], s55 offen lds
  s_add_u32 m0, s82, 1024
  s_add_u32 s55, s75, 20480
  buffer_load_dwordx4 v15, s[44:47], s55 offen lds
  v_mfma_f32_32x32x16_bf16 v[208:223], v[152:155], a[20:23], v[208:223]
  s_add_u32 m0, s82, 2048
  s_add_u32 s55, s75, 40960
  buffer_load_dwordx4 v15, s[44:47], s55 offen lds
  s_waitcnt lgkmcnt(4)
  v_mfma_f32_32x32x16_bf16 v[160:175], v[148:151], a[24:27], v[160:175]
  ds_read_b64_tr_b16 a[8:9], v9 offset:1024
  ds_read_b64_tr_b16 a[10:11], v9 offset:1280
  v_mfma_f32_32x32x16_bf16 v[176:191], v[148:151], a[28:31], v[176:191]
  ds_read_b64_tr_b16 a[12:13], v9 offset:13312
  ds_read_b64_tr_b16 a[14:15], v9 offset:13568
  v_mfma_f32_32x32x16_bf16 v[192:207], v[156:159], a[24:27], v[192:207]
  s_add_u32 m0, s82, 12288
  s_add_u32 s55, s75, 64
  buffer_load_dwordx4 v15, s[44:47], s55 offen lds
  s_add_u32 m0, s82, 13312
  s_add_u32 s55, s75, 20544
  buffer_load_dwordx4 v15, s[44:47], s55 offen lds
  v_mfma_f32_32x32x16_bf16 v[208:223], v[156:159], a[28:31], v[208:223]
  s_add_u32 m0, s82, 14336
  s_add_u32 s55, s75, 41024
  buffer_load_dwordx4 v15, s[44:47], s55 offen lds
  s_add_u32 s75, s75, 128
  s_mov_b32 s80, 0
VL_138:
  s_waitcnt lgkmcnt(4)
  v_mfma_f32_32x32x16_bf16 v[224:239], v[64:67], a[0:3], 0
  ds_read_b64_tr_b16 a[16:17], v9 offset:2048
  v_mfma_f32_32x32x16_bf16 v[240:255], v[64:67], a[4:7], 0
  ds_read_b64_tr_b16 a[18:19], v9 offset:2304
  v_mfma_f32_32x32x16_bf16 v[32:47], v[72:75], a[0:3], 0
  ds_read_b64_tr_b16 a[20:21], v9 offset:14336
  v_mfma_f32_32x32x16_bf16 v[48:63], v[72:75], a[4:7], 0
  ds_read_b64_tr_b16 a[22:23], v9 offset:14592
  s_waitcnt lgkmcnt(4)
  v_mfma_f32_32x32x16_bf16 v[224:239], v[68:71], a[8:11], v[224:239]
  ds_read_b64_tr_b16 a[24:25], v9 offset:3072
  ds_read_b64_tr_b16 a[26:27], v9 offset:3328
  v_mfma_f32_32x32x16_bf16 v[240:255], v[68:71], a[12:15], v[240:255]
  ds_read_b64_tr_b16 a[28:29], v9 offset:15360
  v_mfma_f32_32x32x16_bf16 v[32:47], v[76:79], a[8:11], v[32:47]
  ds_read_b64_tr_b16 a[30:31], v9 offset:15616
  v_cvt_pk_bf16_f32 v16, v160, v161
  v_cvt_pk_bf16_f32 v17, v162, v163
  v_cvt_pk_bf16_f32 v18, v164, v165
  v_cvt_pk_bf16_f32 v19, v166, v167
  v_mfma_f32_32x32x16_bf16 v[48:63], v[76:79], a[12:15], v[48:63]
  v_cvt_pk_bf16_f32 v20, v168, v169
  v_cvt_pk_bf16_f32 v21, v170, v171
  v_cvt_pk_bf16_f32 v22, v172, v173
  v_cvt_pk_bf16_f32 v23, v174, v175
  s_waitcnt lgkmcnt(4)
  v_mfma_f32_32x32x16_bf16 v[224:239], v[80:83], a[16:19], v[224:239]
  ds_read_b64_tr_b16 a[32:33], v9 offset:4096
  ds_read_b64_tr_b16 a[34:35], v9 offset:4352
  v_mfma_f32_32x32x16_bf16 v[240:255], v[80:83], a[20:23], v[240:255]
  ds_read_b64_tr_b16 a[36:37], v9 offset:16384
  v_mfma_f32_32x32x16_bf16 v[32:47], v[88:91], a[16:19], v[32:47]
  ds_read_b64_tr_b16 a[38:39], v9 offset:16640
  s_add_u32 s55, s76, 0
  buffer_store_dwordx4 v[16:19], v12, s[40:43], s55 offen sc1
  v_mfma_f32_32x32x16_bf16 v[48:63], v[88:91], a[20:23], v[48:63]
  buffer_store_dwordx4 v[20:23], v12, s[40:43], s55 offen offset:512 sc1
  s_waitcnt lgkmcnt(4)
  v_mfma_f32_32x32x16_bf16 v[224:239], v[84:87], a[24:27], v[224:239]
  ds_read_b64_tr_b16 a[40:41], v9 offset:5120
  ds_read_b64_tr_b16 a[42:43], v9 offset:5376
  v_mfma_f32_32x32x16_bf16 v[240:255], v[84:87], a[28:31], v[240:255]
  ds_read_b64_tr_b16 a[44:45], v9 offset:17408
  v_mfma_f32_32x32x16_bf16 v[32:47], v[92:95], a[24:27], v[32:47]
  ds_read_b64_tr_b16 a[46:47], v9 offset:17664
  v_cvt_pk_bf16_f32 v24, v176, v177
  v_cvt_pk_bf16_f32 v25, v178, v179
  v_cvt_pk_bf16_f32 v26, v180, v181
  v_cvt_pk_bf16_f32 v27, v182, v183
  v_mfma_f32_32x32x16_bf16 v[48:63], v[92:95], a[28:31], v[48:63]
  v_cvt_pk_bf16_f32 v28, v184, v185
  v_cvt_pk_bf16_f32 v29, v186, v187
  v_cvt_pk_bf16_f32 v30, v188, v189
  v_cvt_pk_bf16_f32 v31, v190, v191
  s_waitcnt lgkmcnt(4)
  v_mfma_f32_32x32x16_bf16 v[224:239], v[96:99], a[32:35], v[224:239]
  ds_read_b64_tr_b16 a[48:49], v9 offset:6144
  ds_read_b64_tr_b16 a[50:51], v9 offset:6400
  v_mfma_f32_32x32x16_bf16 v[240:255], v[96:99], a[36:39], v[240:255]
  ds_read_b64_tr_b16 a[52:53], v9 offset:18432
  v_mfma_f32_32x32x16_bf16 v[32:47], v[104:107], a[32:35], v[32:47]
  ds_read_b64_tr_b16 a[54:55], v9 offset:18688
  s_add_u32 s55, s76, 131072
  buffer_store_dwordx4 v[24:27], v12, s[40:43], s55 offen sc1
  v_mfma_f32_32x32x16_bf16 v[48:63], v[104:107], a[36:39], v[48:63]
  buffer_store_dwordx4 v[28:31], v12, s[40:43], s55 offen offset:512 sc1
  s_waitcnt lgkmcnt(4)
  v_mfma_f32_32x32x16_bf16 v[224:239], v[100:103], a[40:43], v[224:239]
  ds_read_b64_tr_b16 a[56:57], v9 offset:7168
  ds_read_b64_tr_b16 a[58:59], v9 offset:7424
  v_mfma_f32_32x32x16_bf16 v[240:255], v[100:103], a[44:47], v[240:255]
  ds_read_b64_tr_b16 a[60:61], v9 offset:19456
  v_mfma_f32_32x32x16_bf16 v[32:47], v[108:111], a[40:43], v[32:47]
  ds_read_b64_tr_b16 a[62:63], v9 offset:19712
  v_mfma_f32_32x32x16_bf16 v[48:63], v[108:111], a[44:47], v[48:63]
  v_cvt_pk_bf16_f32 v16, v192, v193
  v_cvt_pk_bf16_f32 v17, v194, v195
  v_cvt_pk_bf16_f32 v18, v196, v197
  v_cvt_pk_bf16_f32 v19, v198, v199
  s_waitcnt lgkmcnt(4)
  v_mfma_f32_32x32x16_bf16 v[224:239], v[112:115], a[48:51], v[224:239]
  ds_read_b64_tr_b16 a[0:1], v9 offset:8192
  ds_read_b64_tr_b16 a[2:3], v9 offset:8448
  v_mfma_f32_32x32x16_bf16 v[240:255], v[112:115], a[52:55], v[240:255]
  ds_read_b64_tr_b16 a[4:5], v9 offset:20480
  v_mfma_f32_32x32x16_bf16 v[32:47], v[120:123], a[48:51], v[32:47]
  ds_read_b64_tr_b16 a[6:7], v9 offset:20736
  v_cvt_pk_bf16_f32 v20, v200, v201
  v_cvt_pk_bf16_f32 v21, v202, v203
  v_cvt_pk_bf16_f32 v22, v204, v205
  v_cvt_pk_bf16_f32 v23, v206, v207
  v_mfma_f32_32x32x16_bf16 v[48:63], v[120:123], a[52:55], v[48:63]
  s_add_u32 s55, s77, 0
  buffer_store_dwordx4 v[16:19], v12, s[40:43], s55 offen sc1
  s_waitcnt lgkmcnt(4)
  v_mfma_f32_32x32x16_bf16 v[224:239], v[116:119], a[56:59], v[224:239]
  ds_read_b64_tr_b16 a[8:9], v9 offset:9216
  ds_read_b64_tr_b16 a[10:11], v9 offset:9472
  v_mfma_f32_32x32x16_bf16 v[240:255], v[116:119], a[60:63], v[240:255]
  ds_read_b64_tr_b16 a[12:13], v9 offset:21504
  v_mfma_f32_32x32x16_bf16 v[32:47], v[124:127], a[56:59], v[32:47]
  ds_read_b64_tr_b16 a[14:15], v9 offset:21760
  buffer_store_dwordx4 v[20:23], v12, s[40:43], s55 offen offset:512 sc1
  v_mfma_f32_32x32x16_bf16 v[48:63], v[124:127], a[60:63], v[48:63]
  v_cvt_pk_bf16_f32 v24, v208, v209
  v_cvt_pk_bf16_f32 v25, v210, v211
  v_cvt_pk_bf16_f32 v26, v212, v213
  v_cvt_pk_bf16_f32 v27, v214, v215
  s_waitcnt lgkmcnt(4)
  v_mfma_f32_32x32x16_bf16 v[224:239], v[128:131], a[0:3], v[224:239]
  ds_read_b64_tr_b16 a[16:17], v9 offset:10240
  ds_read_b64_tr_b16 a[18:19], v9 offset:10496
  v_mfma_f32_32x32x16_bf16 v[240:255], v[128:131], a[4:7], v[240:255]
  ds_read_b64_tr_b16 a[20:21], v9 offset:22528
  v_mfma_f32_32x32x16_bf16 v[32:47], v[136:139], a[0:3], v[32:47]
  ds_read_b64_tr_b16 a[22:23], v9 offset:22784
  v_cvt_pk_bf16_f32 v28, v216, v217
  v_cvt_pk_bf16_f32 v29, v218, v219
  v_cvt_pk_bf16_f32 v30, v220, v221
  v_cvt_pk_bf16_f32 v31, v222, v223
  v_mfma_f32_32x32x16_bf16 v[48:63], v[136:139], a[4:7], v[48:63]
  s_add_u32 s55, s77, 131072
  buffer_store_dwordx4 v[24:27], v12, s[40:43], s55 offen sc1
  s_waitcnt lgkmcnt(4)
  v_mfma_f32_32x32x16_bf16 v[224:239], v[132:135], a[8:11], v[224:239]
  ds_read_b64_tr_b16 a[24:25], v9 offset:11264
  ds_read_b64_tr_b16 a[26:27], v9 offset:11520
  v_mfma_f32_32x32x16_bf16 v[240:255], v[132:135], a[12:15], v[240:255]
  ds_read_b64_tr_b16 a[28:29], v9 offset:23552
  v_mfma_f32_32x32x16_bf16 v[32:47], v[140:143], a[8:11], v[32:47]
  ds_read_b64_tr_b16 a[30:31], v9 offset:23808
  v_mfma_f32_32x32x16_bf16 v[48:63], v[140:143], a[12:15], v[48:63]
  buffer_store_dwordx4 v[28:31], v12, s[40:43], s55 offen offset:512 sc1
  s_add_u32 s76, s76, 262144
  s_add_u32 s77, s77, 262144
  s_waitcnt lgkmcnt(0)
  s_add_u32 s82, s81, s78
  s_add_u32 s82, s82, 65536
  s_add_u32 s81, s81, 24576
  s_cmp_eq_u32 s81, 73728
  s_cselect_b32 s81, 0, s81
  v_add_u32 v8, s81, v2
  s_waitcnt vmcnt(14)
  s_barrier
  v_mfma_f32_32x32x16_bf16 v[224:239], v[144:147], a[16:19], v[224:239]
  ds_read_b64_tr_b16 a[0:1], v8 offset:0
  ds_read_b64_tr_b16 a[2:3], v8 offset:256
  v_mfma_f32_32x32x16_bf16 v[240:255], v[144:147], a[20:23], v[240:255]
  ds_read_b64_tr_b16 a[4:5], v8 offset:12288
  ds_read_b64_tr_b16 a[6:7], v8 offset:12544
  v_mfma_f32_32x32x16_bf16 v[32:47], v[152:155], a[16:19], v[32:47]
  s_add_u32 m0, s82, 0
  s_add_u32 s55, s75, 0
  buffer_load_dwordx4 v15, s[44:47], s55 offen lds
  s_add_u32 m0, s82, 1024
  s_add_u32 s55, s75, 20480
  buffer_load_dwordx4 v15, s[44:47], s55 offen lds
  v_mfma_f32_32x32x16_bf16 v[48:63], v[152:155], a[20:23], v[48:63]
  s_add_u32 m0, s82, 2048
  s_add_u32 s55, s75, 40960
  buffer_load_dwordx4 v15, s[44:47], s55 offen lds
  s_waitcnt lgkmcnt(4)
  v_mfma_f32_32x32x16_bf16 v[224:239], v[148:151], a[24:27], v[224:239]
  ds_read_b64_tr_b16 a[8:9], v8 offset:1024
  ds_read_b64_tr_b16 a[10:11], v8 offset:1280
  v_mfma_f32_32x32x16_bf16 v[240:255], v[148:151], a[28:31], v[240:255]
  ds_read_b64_tr_b16 a[12:13], v8 offset:13312
  ds_read_b64_tr_b16 a[14:15], v8 offset:13568
  v_mfma_f32_32x32x16_bf16 v[32:47], v[156:159], a[24:27], v[32:47]
  s_add_u32 m0, s82, 12288
  s_add_u32 s55, s75, 64
  buffer_load_dwordx4 v15, s[44:47], s55 offen lds
  s_add_u32 m0, s82, 13312
  s_add_u32 s55, s75, 20544
  buffer_load_dwordx4 v15, s[44:47], s55 offen lds
  v_mfma_f32_32x32x16_bf16 v[48:63], v[156:159], a[28:31], v[48:63]
  s_add_u32 m0, s82, 14336
  s_add_u32 s55, s75, 41024
  buffer_load_dwordx4 v15, s[44:47], s55 offen lds
  s_add_u32 s75, s75, 128
  s_waitcnt lgkmcnt(4)
  v_mfma_f32_32x32x16_bf16 v[160:175], v[64:67], a[0:3], 0
  ds_read_b64_tr_b16 a[16:17], v8 offset:2048
  v_mfma_f32_32x32x16_bf16 v[176:191], v[64:67], a[4:7], 0
  ds_read_b64_tr_b16 a[18:19], v8 offset:2304
  v_mfma_f32_32x32x16_bf16 v[192:207], v[72:75], a[0:3], 0
  ds_read_b64_tr_b16 a[20:21], v8 offset:14336
  v_mfma_f32_32x32x16_bf16 v[208:223], v[72:75], a[4:7], 0
  ds_read_b64_tr_b16 a[22:23], v8 offset:14592
  s_waitcnt lgkmcnt(4)
  v_mfma_f32_32x32x16_bf16 v[160:175], v[68:71], a[8:11], v[160:175]
  ds_read_b64_tr_b16 a[24:25], v8 offset:3072
  ds_read_b64_tr_b16 a[26:27], v8 offset:3328
  v_mfma_f32_32x32x16_bf16 v[176:191], v[68:71], a[12:15], v[176:191]
  ds_read_b64_tr_b16 a[28:29], v8 offset:15360
  v_mfma_f32_32x32x16_bf16 v[192:207], v[76:79], a[8:11], v[192:207]
  ds_read_b64_tr_b16 a[30:31], v8 offset:15616
  v_cvt_pk_bf16_f32 v16, v224, v225
  v_cvt_pk_bf16_f32 v17, v226, v227
  v_cvt_pk_bf16_f32 v18, v228, v229
  v_cvt_pk_bf16_f32 v19, v230, v231
  v_mfma_f32_32x32x16_bf16 v[208:223], v[76:79], a[12:15], v[208:223]
  v_cvt_pk_bf16_f32 v20, v232, v233
  v_cvt_pk_bf16_f32 v21, v234, v235
  v_cvt_pk_bf16_f32 v22, v236, v237
  v_cvt_pk_bf16_f32 v23, v238, v239
  s_waitcnt lgkmcnt(4)
  v_mfma_f32_32x32x16_bf16 v[160:175], v[80:83], a[16:19], v[160:175]
  ds_read_b64_tr_b16 a[32:33], v8 offset:4096
  ds_read_b64_tr_b16 a[34:35], v8 offset:4352
  v_mfma_f32_32x32x16_bf16 v[176:191], v[80:83], a[20:23], v[176:191]
  ds_read_b64_tr_b16 a[36:37], v8 offset:16384
  v_mfma_f32_32x32x16_bf16 v[192:207], v[88:91], a[16:19], v[192:207]
  ds_read_b64_tr_b16 a[38:39], v8 offset:16640
  s_add_u32 s55, s76, 0
  buffer_store_dwordx4 v[16:19], v12, s[40:43], s55 offen sc1
  v_mfma_f32_32x32x16_bf16 v[208:223], v[88:91], a[20:23], v[208:223]
  buffer_store_dwordx4 v[20:23], v12, s[40:43], s55 offen offset:512 sc1
  s_waitcnt lgkmcnt(4)
  v_mfma_f32_32x32x16_bf16 v[160:175], v[84:87], a[24:27], v[160:175]
  ds_read_b64_tr_b16 a[40:41], v8 offset:5120
  ds_read_b64_tr_b16 a[42:43], v8 offset:5376
  v_mfma_f32_32x32x16_bf16 v[176:191], v[84:87], a[28:31], v[176:191]
  ds_read_b64_tr_b16 a[44:45], v8 offset:17408
  v_mfma_f32_32x32x16_bf16 v[192:207], v[92:95], a[24:27], v[192:207]
  ds_read_b64_tr_b16 a[46:47], v8 offset:17664
  v_cvt_pk_bf16_f32 v24, v240, v241
  v_cvt_pk_bf16_f32 v25, v242, v243
  v_cvt_pk_bf16_f32 v26, v244, v245
  v_cvt_pk_bf16_f32 v27, v246, v247
  v_mfma_f32_32x32x16_bf16 v[208:223], v[92:95], a[28:31], v[208:223]
  v_cvt_pk_bf16_f32 v28, v248, v249
  v_cvt_pk_bf16_f32 v29, v250, v251
  v_cvt_pk_bf16_f32 v30, v252, v253
  v_cvt_pk_bf16_f32 v31, v254, v255
  s_waitcnt lgkmcnt(4)
  v_mfma_f32_32x32x16_bf16 v[160:175], v[96:99], a[32:35], v[160:175]
  ds_read_b64_tr_b16 a[48:49], v8 offset:6144
  ds_read_b64_tr_b16 a[50:51], v8 offset:6400
  v_mfma_f32_32x32x16_bf16 v[176:191], v[96:99], a[36:39], v[176:191]
  ds_read_b64_tr_b16 a[52:53], v8 offset:18432
  v_mfma_f32_32x32x16_bf16 v[192:207], v[104:107], a[32:35], v[192:207]
  ds_read_b64_tr_b16 a[54:55], v8 offset:18688
  s_add_u32 s55, s76, 131072
  buffer_store_dwordx4 v[24:27], v12, s[40:43], s55 offen sc1
  v_mfma_f32_32x32x16_bf16 v[208:223], v[104:107], a[36:39], v[208:223]
  buffer_store_dwordx4 v[28:31], v12, s[40:43], s55 offen offset:512 sc1
  s_waitcnt lgkmcnt(4)
  v_mfma_f32_32x32x16_bf16 v[160:175], v[100:103], a[40:43], v[160:175]
  ds_read_b64_tr_b16 a[56:57], v8 offset:7168
  ds_read_b64_tr_b16 a[58:59], v8 offset:7424
  v_mfma_f32_32x32x16_bf16 v[176:191], v[100:103], a[44:47], v[176:191]
  ds_read_b64_tr_b16 a[60:61], v8 offset:19456
  v_mfma_f32_32x32x16_bf16 v[192:207], v[108:111], a[40:43], v[192:207]
  ds_read_b64_tr_b16 a[62:63], v8 offset:19712
  v_mfma_f32_32x32x16_bf16 v[208:223], v[108:111], a[44:47], v[208:223]
  v_cvt_pk_bf16_f32 v16, v32, v33
  v_cvt_pk_bf16_f32 v17, v34, v35
  v_cvt_pk_bf16_f32 v18, v36, v37
  v_cvt_pk_bf16_f32 v19, v38, v39
  s_waitcnt lgkmcnt(4)
  v_mfma_f32_32x32x16_bf16 v[160:175], v[112:115], a[48:51], v[160:175]
  ds_read_b64_tr_b16 a[0:1], v8 offset:8192
  ds_read_b64_tr_b16 a[2:3], v8 offset:8448
  v_mfma_f32_32x32x16_bf16 v[176:191], v[112:115], a[52:55], v[176:191]
  ds_read_b64_tr_b16 a[4:5], v8 offset:20480
  v_mfma_f32_32x32x16_bf16 v[192:207], v[120:123], a[48:51], v[192:207]
  ds_read_b64_tr_b16 a[6:7], v8 offset:20736
  v_cvt_pk_bf16_f32 v20, v40, v41
  v_cvt_pk_bf16_f32 v21, v42, v43
  v_cvt_pk_bf16_f32 v22, v44, v45
  v_cvt_pk_bf16_f32 v23, v46, v47
  v_mfma_f32_32x32x16_bf16 v[208:223], v[120:123], a[52:55], v[208:223]
  s_add_u32 s55, s77, 0
  buffer_store_dwordx4 v[16:19], v12, s[40:43], s55 offen sc1
  s_waitcnt lgkmcnt(4)
  v_mfma_f32_32x32x16_bf16 v[160:175], v[116:119], a[56:59], v[160:175]
  ds_read_b64_tr_b16 a[8:9], v8 offset:9216
  ds_read_b64_tr_b16 a[10:11], v8 offset:9472
  v_mfma_f32_32x32x16_bf16 v[176:191], v[116:119], a[60:63], v[176:191]
  ds_read_b64_tr_b16 a[12:13], v8 offset:21504
  v_mfma_f32_32x32x16_bf16 v[192:207], v[124:127], a[56:59], v[192:207]
  ds_read_b64_tr_b16 a[14:15], v8 offset:21760
  buffer_store_dwordx4 v[20:23], v12, s[40:43], s55 offen offset:512 sc1
  v_mfma_f32_32x32x16_bf16 v[208:223], v[124:127], a[60:63], v[208:223]
  v_cvt_pk_bf16_f32 v24, v48, v49
  v_cvt_pk_bf16_f32 v25, v50, v51
  v_cvt_pk_bf16_f32 v26, v52, v53
  v_cvt_pk_bf16_f32 v27, v54, v55
  s_waitcnt lgkmcnt(4)
  v_mfma_f32_32x32x16_bf16 v[160:175], v[128:131], a[0:3], v[160:175]
  ds_read_b64_tr_b16 a[16:17], v8 offset:10240
  ds_read_b64_tr_b16 a[18:19], v8 offset:10496
  v_mfma_f32_32x32x16_bf16 v[176:191], v[128:131], a[4:7], v[176:191]
  ds_read_b64_tr_b16 a[20:21], v8 offset:22528
  v_mfma_f32_32x32x16_bf16 v[192:207], v[136:139], a[0:3], v[192:207]
  ds_read_b64_tr_b16 a[22:23], v8 offset:22784
  v_cvt_pk_bf16_f32 v28, v56, v57
  v_cvt_pk_bf16_f32 v29, v58, v59
  v_cvt_pk_bf16_f32 v30, v60, v61
  v_cvt_pk_bf16_f32 v31, v62, v63
  v_mfma_f32_32x32x16_bf16 v[208:223], v[136:139], a[4:7], v[208:223]
  s_add_u32 s55, s77, 131072
  buffer_store_dwordx4 v[24:27], v12, s[40:43], s55 offen sc1
  s_waitcnt lgkmcnt(4)
  v_mfma_f32_32x32x16_bf16 v[160:175], v[132:135], a[8:11], v[160:175]
  ds_read_b64_tr_b16 a[24:25], v8 offset:11264
  ds_read_b64_tr_b16 a[26:27], v8 offset:11520
  v_mfma_f32_32x32x16_bf16 v[176:191], v[132:135], a[12:15], v[176:191]
  ds_read_b64_tr_b16 a[28:29], v8 offset:23552
  v_mfma_f32_32x32x16_bf16 v[192:207], v[140:143], a[8:11], v[192:207]
  ds_read_b64_tr_b16 a[30:31], v8 offset:23808
  v_mfma_f32_32x32x16_bf16 v[208:223], v[140:143], a[12:15], v[208:223]
  buffer_store_dwordx4 v[28:31], v12, s[40:43], s55 offen offset:512 sc1
  s_add_u32 s76, s76, 262144
  s_add_u32 s77, s77, 262144
  s_waitcnt lgkmcnt(0)
  s_add_u32 s82, s81, s78
  s_add_u32 s82, s82, 65536
  s_add_u32 s81, s81, 24576
  s_cmp_eq_u32 s81, 73728
  s_cselect_b32 s81, 0, s81
  v_add_u32 v9, s81, v2
  s_waitcnt vmcnt(22)
  s_barrier
  v_mfma_f32_32x32x16_bf16 v[160:175], v[144:147], a[16:19], v[160:175]
  ds_read_b64_tr_b16 a[0:1], v9 offset:0
  ds_read_b64_tr_b16 a[2:3], v9 offset:256
  v_mfma_f32_32x32x16_bf16 v[176:191], v[144:147], a[20:23], v[176:191]
  ds_read_b64_tr_b16 a[4:5], v9 offset:12288
  ds_read_b64_tr_b16 a[6:7], v9 offset:12544
  v_mfma_f32_32x32x16_bf16 v[192:207], v[152:155], a[16:19], v[192:207]
  s_add_u32 m0, s82, 0
  s_add_u32 s55, s75, 0
  buffer_load_dwordx4 v15, s[44:47], s55 offen lds
  s_add_u32 m0, s82, 1024
  s_add_u32 s55, s75, 20480
  buffer_load_dwordx4 v15, s[44:47], s55 offen lds
  v_mfma_f32_32x32x16_bf16 v[208:223], v[152:155], a[20:23], v[208:223]
  s_add_u32 m0, s82, 2048
  s_add_u32 s55, s75, 40960
  buffer_load_dwordx4 v15, s[44:47], s55 offen lds
  s_waitcnt lgkmcnt(4)
  v_mfma_f32_32x32x16_bf16 v[160:175], v[148:151], a[24:27], v[160:175]
  ds_read_b64_tr_b16 a[8:9], v9 offset:1024
  ds_read_b64_tr_b16 a[10:11], v9 offset:1280
  v_mfma_f32_32x32x16_bf16 v[176:191], v[148:151], a[28:31], v[176:191]
  ds_read_b64_tr_b16 a[12:13], v9 offset:13312
  ds_read_b64_tr_b16 a[14:15], v9 offset:13568
  v_mfma_f32_32x32x16_bf16 v[192:207], v[156:159], a[24:27], v[192:207]
  s_add_u32 m0, s82, 12288
  s_add_u32 s55, s75, 64
  buffer_load_dwordx4 v15, s[44:47], s55 offen lds
  s_add_u32 m0, s82, 13312
  s_add_u32 s55, s75, 20544
  buffer_load_dwordx4 v15, s[44:47], s55 offen lds
  v_mfma_f32_32x32x16_bf16 v[208:223], v[156:159], a[28:31], v[208:223]
  s_add_u32 m0, s82, 14336
  s_add_u32 s55, s75, 41024
  buffer_load_dwordx4 v15, s[44:47], s55 offen lds
  s_add_u32 s75, s75, 128
  s_add_u32 s80, s80, 1
  s_cmp_lt_u32 s80, 4
  s_cbranch_scc1 VL_138
  s_waitcnt lgkmcnt(4)
  v_mfma_f32_32x32x16_bf16 v[224:239], v[64:67], a[0:3], 0
  ds_read_b64_tr_b16 a[16:17], v9 offset:2048
  v_mfma_f32_32x32x16_bf16 v[240:255], v[64:67], a[4:7], 0
  ds_read_b64_tr_b16 a[18:19], v9 offset:2304
  v_mfma_f32_32x32x16_bf16 v[32:47], v[72:75], a[0:3], 0
  ds_read_b64_tr_b16 a[20:21], v9 offset:14336
  v_mfma_f32_32x32x16_bf16 v[48:63], v[72:75], a[4:7], 0
  ds_read_b64_tr_b16 a[22:23], v9 offset:14592
  s_waitcnt lgkmcnt(4)
  v_mfma_f32_32x32x16_bf16 v[224:239], v[68:71], a[8:11], v[224:239]
  ds_read_b64_tr_b16 a[24:25], v9 offset:3072
  ds_read_b64_tr_b16 a[26:27], v9 offset:3328
  v_mfma_f32_32x32x16_bf16 v[240:255], v[68:71], a[12:15], v[240:255]
  ds_read_b64_tr_b16 a[28:29], v9 offset:15360
  v_mfma_f32_32x32x16_bf16 v[32:47], v[76:79], a[8:11], v[32:47]
  ds_read_b64_tr_b16 a[30:31], v9 offset:15616
  v_cvt_pk_bf16_f32 v16, v160, v161
  v_cvt_pk_bf16_f32 v17, v162, v163
  v_cvt_pk_bf16_f32 v18, v164, v165
  v_cvt_pk_bf16_f32 v19, v166, v167
  v_mfma_f32_32x32x16_bf16 v[48:63], v[76:79], a[12:15], v[48:63]
  v_cvt_pk_bf16_f32 v20, v168, v169
  v_cvt_pk_bf16_f32 v21, v170, v171
  v_cvt_pk_bf16_f32 v22, v172, v173
  v_cvt_pk_bf16_f32 v23, v174, v175
  s_waitcnt lgkmcnt(4)
  v_mfma_f32_32x32x16_bf16 v[224:239], v[80:83], a[16:19], v[224:239]
  ds_read_b64_tr_b16 a[32:33], v9 offset:4096
  ds_read_b64_tr_b16 a[34:35], v9 offset:4352
  v_mfma_f32_32x32x16_bf16 v[240:255], v[80:83], a[20:23], v[240:255]
  ds_read_b64_tr_b16 a[36:37], v9 offset:16384
  v_mfma_f32_32x32x16_bf16 v[32:47], v[88:91], a[16:19], v[32:47]
  ds_read_b64_tr_b16 a[38:39], v9 offset:16640
  s_add_u32 s55, s76, 0
  buffer_store_dwordx4 v[16:19], v12, s[40:43], s55 offen sc1
  v_mfma_f32_32x32x16_bf16 v[48:63], v[88:91], a[20:23], v[48:63]
  buffer_store_dwordx4 v[20:23], v12, s[40:43], s55 offen offset:512 sc1
  s_waitcnt lgkmcnt(4)
  v_mfma_f32_32x32x16_bf16 v[224:239], v[84:87], a[24:27], v[224:239]
  ds_read_b64_tr_b16 a[40:41], v9 offset:5120
  ds_read_b64_tr_b16 a[42:43], v9 offset:5376
  v_mfma_f32_32x32x16_bf16 v[240:255], v[84:87], a[28:31], v[240:255]
  ds_read_b64_tr_b16 a[44:45], v9 offset:17408
  v_mfma_f32_32x32x16_bf16 v[32:47], v[92:95], a[24:27], v[32:47]
  ds_read_b64_tr_b16 a[46:47], v9 offset:17664
  v_cvt_pk_bf16_f32 v24, v176, v177
  v_cvt_pk_bf16_f32 v25, v178, v179
  v_cvt_pk_bf16_f32 v26, v180, v181
  v_cvt_pk_bf16_f32 v27, v182, v183
  v_mfma_f32_32x32x16_bf16 v[48:63], v[92:95], a[28:31], v[48:63]
  v_cvt_pk_bf16_f32 v28, v184, v185
  v_cvt_pk_bf16_f32 v29, v186, v187
  v_cvt_pk_bf16_f32 v30, v188, v189
  v_cvt_pk_bf16_f32 v31, v190, v191
  s_waitcnt lgkmcnt(4)
  v_mfma_f32_32x32x16_bf16 v[224:239], v[96:99], a[32:35], v[224:239]
  ds_read_b64_tr_b16 a[48:49], v9 offset:6144
  ds_read_b64_tr_b16 a[50:51], v9 offset:6400
  v_mfma_f32_32x32x16_bf16 v[240:255], v[96:99], a[36:39], v[240:255]
  ds_read_b64_tr_b16 a[52:53], v9 offset:18432
  v_mfma_f32_32x32x16_bf16 v[32:47], v[104:107], a[32:35], v[32:47]
  ds_read_b64_tr_b16 a[54:55], v9 offset:18688
  s_add_u32 s55, s76, 131072
  buffer_store_dwordx4 v[24:27], v12, s[40:43], s55 offen sc1
  v_mfma_f32_32x32x16_bf16 v[48:63], v[104:107], a[36:39], v[48:63]
  buffer_store_dwordx4 v[28:31], v12, s[40:43], s55 offen offset:512 sc1
  s_waitcnt lgkmcnt(4)
  v_mfma_f32_32x32x16_bf16 v[224:239], v[100:103], a[40:43], v[224:239]
  ds_read_b64_tr_b16 a[56:57], v9 offset:7168
  ds_read_b64_tr_b16 a[58:59], v9 offset:7424
  v_mfma_f32_32x32x16_bf16 v[240:255], v[100:103], a[44:47], v[240:255]
  ds_read_b64_tr_b16 a[60:61], v9 offset:19456
  v_mfma_f32_32x32x16_bf16 v[32:47], v[108:111], a[40:43], v[32:47]
  ds_read_b64_tr_b16 a[62:63], v9 offset:19712
  v_mfma_f32_32x32x16_bf16 v[48:63], v[108:111], a[44:47], v[48:63]
  v_cvt_pk_bf16_f32 v16, v192, v193
  v_cvt_pk_bf16_f32 v17, v194, v195
  v_cvt_pk_bf16_f32 v18, v196, v197
  v_cvt_pk_bf16_f32 v19, v198, v199
  s_waitcnt lgkmcnt(4)
  v_mfma_f32_32x32x16_bf16 v[224:239], v[112:115], a[48:51], v[224:239]
  ds_read_b64_tr_b16 a[0:1], v9 offset:8192
  ds_read_b64_tr_b16 a[2:3], v9 offset:8448
  v_mfma_f32_32x32x16_bf16 v[240:255], v[112:115], a[52:55], v[240:255]
  ds_read_b64_tr_b16 a[4:5], v9 offset:20480
  v_mfma_f32_32x32x16_bf16 v[32:47], v[120:123], a[48:51], v[32:47]
  ds_read_b64_tr_b16 a[6:7], v9 offset:20736
  v_cvt_pk_bf16_f32 v20, v200, v201
  v_cvt_pk_bf16_f32 v21, v202, v203
  v_cvt_pk_bf16_f32 v22, v204, v205
  v_cvt_pk_bf16_f32 v23, v206, v207
  v_mfma_f32_32x32x16_bf16 v[48:63], v[120:123], a[52:55], v[48:63]
  s_add_u32 s55, s77, 0
  buffer_store_dwordx4 v[16:19], v12, s[40:43], s55 offen sc1
  s_waitcnt lgkmcnt(4)
  v_mfma_f32_32x32x16_bf16 v[224:239], v[116:119], a[56:59], v[224:239]
  ds_read_b64_tr_b16 a[8:9], v9 offset:9216
  ds_read_b64_tr_b16 a[10:11], v9 offset:9472
  v_mfma_f32_32x32x16_bf16 v[240:255], v[116:119], a[60:63], v[240:255]
  ds_read_b64_tr_b16 a[12:13], v9 offset:21504
  v_mfma_f32_32x32x16_bf16 v[32:47], v[124:127], a[56:59], v[32:47]
  ds_read_b64_tr_b16 a[14:15], v9 offset:21760
  buffer_store_dwordx4 v[20:23], v12, s[40:43], s55 offen offset:512 sc1
  v_mfma_f32_32x32x16_bf16 v[48:63], v[124:127], a[60:63], v[48:63]
  v_cvt_pk_bf16_f32 v24, v208, v209
  v_cvt_pk_bf16_f32 v25, v210, v211
  v_cvt_pk_bf16_f32 v26, v212, v213
  v_cvt_pk_bf16_f32 v27, v214, v215
  s_waitcnt lgkmcnt(4)
  v_mfma_f32_32x32x16_bf16 v[224:239], v[128:131], a[0:3], v[224:239]
  ds_read_b64_tr_b16 a[16:17], v9 offset:10240
  ds_read_b64_tr_b16 a[18:19], v9 offset:10496
  v_mfma_f32_32x32x16_bf16 v[240:255], v[128:131], a[4:7], v[240:255]
  ds_read_b64_tr_b16 a[20:21], v9 offset:22528
  v_mfma_f32_32x32x16_bf16 v[32:47], v[136:139], a[0:3], v[32:47]
  ds_read_b64_tr_b16 a[22:23], v9 offset:22784
  v_cvt_pk_bf16_f32 v28, v216, v217
  v_cvt_pk_bf16_f32 v29, v218, v219
  v_cvt_pk_bf16_f32 v30, v220, v221
  v_cvt_pk_bf16_f32 v31, v222, v223
  v_mfma_f32_32x32x16_bf16 v[48:63], v[136:139], a[4:7], v[48:63]
  s_add_u32 s55, s77, 131072
  buffer_store_dwordx4 v[24:27], v12, s[40:43], s55 offen sc1
  s_waitcnt lgkmcnt(4)
  v_mfma_f32_32x32x16_bf16 v[224:239], v[132:135], a[8:11], v[224:239]
  ds_read_b64_tr_b16 a[24:25], v9 offset:11264
  ds_read_b64_tr_b16 a[26:27], v9 offset:11520
  v_mfma_f32_32x32x16_bf16 v[240:255], v[132:135], a[12:15], v[240:255]
  ds_read_b64_tr_b16 a[28:29], v9 offset:23552
  v_mfma_f32_32x32x16_bf16 v[32:47], v[140:143], a[8:11], v[32:47]
  ds_read_b64_tr_b16 a[30:31], v9 offset:23808
  v_mfma_f32_32x32x16_bf16 v[48:63], v[140:143], a[12:15], v[48:63]
  buffer_store_dwordx4 v[28:31], v12, s[40:43], s55 offen offset:512 sc1
  s_add_u32 s76, s76, 262144
  s_add_u32 s77, s77, 262144
  s_waitcnt lgkmcnt(0)
  v_mfma_f32_32x32x16_bf16 v[224:239], v[144:147], a[16:19], v[224:239]
  v_mfma_f32_32x32x16_bf16 v[240:255], v[144:147], a[20:23], v[240:255]
  v_mfma_f32_32x32x16_bf16 v[32:47], v[152:155], a[16:19], v[32:47]
  v_mfma_f32_32x32x16_bf16 v[48:63], v[152:155], a[20:23], v[48:63]
  s_waitcnt lgkmcnt(0)
  v_mfma_f32_32x32x16_bf16 v[224:239], v[148:151], a[24:27], v[224:239]
  v_mfma_f32_32x32x16_bf16 v[240:255], v[148:151], a[28:31], v[240:255]
  v_mfma_f32_32x32x16_bf16 v[32:47], v[156:159], a[24:27], v[32:47]
  v_mfma_f32_32x32x16_bf16 v[48:63], v[156:159], a[28:31], v[48:63]
  s_nop 7
  s_nop 7
  v_cvt_pk_bf16_f32 v16, v224, v225
  v_cvt_pk_bf16_f32 v17, v226, v227
  v_cvt_pk_bf16_f32 v18, v228, v229
  v_cvt_pk_bf16_f32 v19, v230, v231
  v_cvt_pk_bf16_f32 v20, v232, v233
  v_cvt_pk_bf16_f32 v21, v234, v235
  v_cvt_pk_bf16_f32 v22, v236, v237
  v_cvt_pk_bf16_f32 v23, v238, v239
  s_add_u32 s55, s76, 0
  buffer_store_dwordx4 v[16:19], v12, s[40:43], s55 offen sc1
  buffer_store_dwordx4 v[20:23], v12, s[40:43], s55 offen offset:512 sc1
  v_cvt_pk_bf16_f32 v24, v240, v241
  v_cvt_pk_bf16_f32 v25, v242, v243
  v_cvt_pk_bf16_f32 v26, v244, v245
  v_cvt_pk_bf16_f32 v27, v246, v247
  v_cvt_pk_bf16_f32 v28, v248, v249
  v_cvt_pk_bf16_f32 v29, v250, v251
  v_cvt_pk_bf16_f32 v30, v252, v253
  v_cvt_pk_bf16_f32 v31, v254, v255
  s_add_u32 s55, s76, 131072
  buffer_store_dwordx4 v[24:27], v12, s[40:43], s55 offen sc1
  buffer_store_dwordx4 v[28:31], v12, s[40:43], s55 offen offset:512 sc1
  v_cvt_pk_bf16_f32 v16, v32, v33
  v_cvt_pk_bf16_f32 v17, v34, v35
  v_cvt_pk_bf16_f32 v18, v36, v37
  v_cvt_pk_bf16_f32 v19, v38, v39
  v_cvt_pk_bf16_f32 v20, v40, v41
  v_cvt_pk_bf16_f32 v21, v42, v43
  v_cvt_pk_bf16_f32 v22, v44, v45
  v_cvt_pk_bf16_f32 v23, v46, v47
  s_add_u32 s55, s77, 0
  buffer_store_dwordx4 v[16:19], v12, s[40:43], s55 offen sc1
  buffer_store_dwordx4 v[20:23], v12, s[40:43], s55 offen offset:512 sc1
  v_cvt_pk_bf16_f32 v24, v48, v49
  v_cvt_pk_bf16_f32 v25, v50, v51
  v_cvt_pk_bf16_f32 v26, v52, v53
  v_cvt_pk_bf16_f32 v27, v54, v55
  v_cvt_pk_bf16_f32 v28, v56, v57
  v_cvt_pk_bf16_f32 v29, v58, v59
  v_cvt_pk_bf16_f32 v30, v60, v61
  v_cvt_pk_bf16_f32 v31, v62, v63
  s_add_u32 s55, s77, 131072
  buffer_store_dwordx4 v[24:27], v12, s[40:43], s55 offen sc1
  buffer_store_dwordx4 v[28:31], v12, s[40:43], s55 offen offset:512 sc1
  s_add_u32 s76, s76, 262144
  s_add_u32 s77, s77, 262144
  s_lshl_b32 s68, s66, 2
  s_add_u32 s68, s68, 96
  s_waitcnt vmcnt(0)
  s_barrier
  s_cmp_eq_u32 s48, 0
  s_cbranch_scc0 SG_139
  s_mov_b32 s95, s68
  v_mov_b32 v1, 1
  s_mov_b64 exec, 1
  buffer_atomic_add v1, off, s[96:99], s95
  s_mov_b64 exec, -1
SG_139:
  s_branch WP_DONE
WP_A1E:
  s_mul_i32 s79, s65, 6
  s_nop 7
  s_nop 7
  s_mov_b32 s64, 0x3fb8aa3b
  v_mov_b32 v14, 0x358637bd
  s_add_u32 s63, s79, 0
  s_cmp_ge_u32 s63, 40
  s_cbranch_scc1 PH_140
  v_min_f32 v16, 0, v64
  v_mul_f32 v16, s64, v16
  v_exp_f32 v16, v16
  v_max_f32 v64, 0, v64
  v_add_f32 v64, v64, v14
  v_add_f32 v64, v64, v16
  v_min_f32 v17, 0, v65
  v_mul_f32 v17, s64, v17
  v_exp_f32 v17, v17
  v_max_f32 v65, 0, v65
  v_add_f32 v65, v65, v14
  v_add_f32 v65, v65, v17
  v_min_f32 v18, 0, v66
  v_mul_f32 v18, s64, v18
  v_exp_f32 v18, v18
  v_max_f32 v66, 0, v66
  v_add_f32 v66, v66, v14
  v_add_f32 v66, v66, v18
  v_min_f32 v19, 0, v67
  v_mul_f32 v19, s64, v19
  v_exp_f32 v19, v19
  v_max_f32 v67, 0, v67
  v_add_f32 v67, v67, v14
  v_add_f32 v67, v67, v19
  v_min_f32 v20, 0, v68
  v_mul_f32 v20, s64, v20
  v_exp_f32 v20, v20
  v_max_f32 v68, 0, v68
  v_add_f32 v68, v68, v14
  v_add_f32 v68, v68, v20
  v_min_f32 v21, 0, v69
  v_mul_f32 v21, s64, v21
  v_exp_f32 v21, v21
  v_max_f32 v69, 0, v69
  v_add_f32 v69, v69, v14
  v_add_f32 v69, v69, v21
  v_min_f32 v22, 0, v70
  v_mul_f32 v22, s64, v22
  v_exp_f32 v22, v22
  v_max_f32 v70, 0, v70
  v_add_f32 v70, v70, v14
  v_add_f32 v70, v70, v22
  v_min_f32 v23, 0, v71
  v_mul_f32 v23, s64, v23
  v_exp_f32 v23, v23
  v_max_f32 v71, 0, v71
  v_add_f32 v71, v71, v14
  v_add_f32 v71, v71, v23
  v_min_f32 v16, 0, v72
  v_mul_f32 v16, s64, v16
  v_exp_f32 v16, v16
  v_max_f32 v72, 0, v72
  v_add_f32 v72, v72, v14
  v_add_f32 v72, v72, v16
  v_min_f32 v17, 0, v73
  v_mul_f32 v17, s64, v17
  v_exp_f32 v17, v17
  v_max_f32 v73, 0, v73
  v_add_f32 v73, v73, v14
  v_add_f32 v73, v73, v17
  v_min_f32 v18, 0, v74
  v_mul_f32 v18, s64, v18
  v_exp_f32 v18, v18
  v_max_f32 v74, 0, v74
  v_add_f32 v74, v74, v14
  v_add_f32 v74, v74, v18
  v_min_f32 v19, 0, v75
  v_mul_f32 v19, s64, v19
  v_exp_f32 v19, v19
  v_max_f32 v75, 0, v75
  v_add_f32 v75, v75, v14
  v_add_f32 v75, v75, v19
  v_min_f32 v20, 0, v76
  v_mul_f32 v20, s64, v20
  v_exp_f32 v20, v20
  v_max_f32 v76, 0, v76
  v_add_f32 v76, v76, v14
  v_add_f32 v76, v76, v20
  v_min_f32 v21, 0, v77
  v_mul_f32 v21, s64, v21
  v_exp_f32 v21, v21
  v_max_f32 v77, 0, v77
  v_add_f32 v77, v77, v14
  v_add_f32 v77, v77, v21
  v_min_f32 v22, 0, v78
  v_mul_f32 v22, s64, v22
  v_exp_f32 v22, v22
  v_max_f32 v78, 0, v78
  v_add_f32 v78, v78, v14
  v_add_f32 v78, v78, v22
  v_min_f32 v23, 0, v79
  v_mul_f32 v23, s64, v23
  v_exp_f32 v23, v23
  v_max_f32 v79, 0, v79
  v_add_f32 v79, v79, v14
  v_add_f32 v79, v79, v23
  v_min_f32 v16, 0, v80
  v_mul_f32 v16, s64, v16
  v_exp_f32 v16, v16
  v_max_f32 v80, 0, v80
  v_add_f32 v80, v80, v14
  v_add_f32 v80, v80, v16
  v_min_f32 v17, 0, v81
  v_mul_f32 v17, s64, v17
  v_exp_f32 v17, v17
  v_max_f32 v81, 0, v81
  v_add_f32 v81, v81, v14
  v_add_f32 v81, v81, v17
  v_min_f32 v18, 0, v82
  v_mul_f32 v18, s64, v18
  v_exp_f32 v18, v18
  v_max_f32 v82, 0, v82
  v_add_f32 v82, v82, v14
  v_add_f32 v82, v82, v18
  v_min_f32 v19, 0, v83
  v_mul_f32 v19, s64, v19
  v_exp_f32 v19, v19
  v_max_f32 v83, 0, v83
  v_add_f32 v83, v83, v14
  v_add_f32 v83, v83, v19
  v_min_f32 v20, 0, v84
  v_mul_f32 v20, s64, v20
  v_exp_f32 v20, v20
  v_max_f32 v84, 0, v84
  v_add_f32 v84, v84, v14
  v_add_f32 v84, v84, v20
  v_min_f32 v21, 0, v85
  v_mul_f32 v21, s64, v21
  v_exp_f32 v21, v21
  v_max_f32 v85, 0, v85
  v_add_f32 v85, v85, v14
  v_add_f32 v85, v85, v21
  v_min_f32 v22, 0, v86
  v_mul_f32 v22, s64, v22
  v_exp_f32 v22, v22
  v_max_f32 v86, 0, v86
  v_add_f32 v86, v86, v14
  v_add_f32 v86, v86, v22
  v_min_f32 v23, 0, v87
  v_mul_f32 v23, s64, v23
  v_exp_f32 v23, v23
  v_max_f32 v87, 0, v87
  v_add_f32 v87, v87, v14
  v_add_f32 v87, v87, v23
  v_min_f32 v16, 0, v88
  v_mul_f32 v16, s64, v16
  v_exp_f32 v16, v16
  v_max_f32 v88, 0, v88
  v_add_f32 v88, v88, v14
  v_add_f32 v88, v88, v16
  v_min_f32 v17, 0, v89
  v_mul_f32 v17, s64, v17
  v_exp_f32 v17, v17
  v_max_f32 v89, 0, v89
  v_add_f32 v89, v89, v14
  v_add_f32 v89, v89, v17
  v_min_f32 v18, 0, v90
  v_mul_f32 v18, s64, v18
  v_exp_f32 v18, v18
  v_max_f32 v90, 0, v90
  v_add_f32 v90, v90, v14
  v_add_f32 v90, v90, v18
  v_min_f32 v19, 0, v91
  v_mul_f32 v19, s64, v19
  v_exp_f32 v19, v19
  v_max_f32 v91, 0, v91
  v_add_f32 v91, v91, v14
  v_add_f32 v91, v91, v19
  v_min_f32 v20, 0, v92
  v_mul_f32 v20, s64, v20
  v_exp_f32 v20, v20
  v_max_f32 v92, 0, v92
  v_add_f32 v92, v92, v14
  v_add_f32 v92, v92, v20
  v_min_f32 v21, 0, v93
  v_mul_f32 v21, s64, v21
  v_exp_f32 v21, v21
  v_max_f32 v93, 0, v93
  v_add_f32 v93, v93, v14
  v_add_f32 v93, v93, v21
  v_min_f32 v22, 0, v94
  v_mul_f32 v22, s64, v22
  v_exp_f32 v22, v22
  v_max_f32 v94, 0, v94
  v_add_f32 v94, v94, v14
  v_add_f32 v94, v94, v22
  v_min_f32 v23, 0, v95
  v_mul_f32 v23, s64, v23
  v_exp_f32 v23, v23
  v_max_f32 v95, 0, v95
  v_add_f32 v95, v95, v14
  v_add_f32 v95, v95, v23
PH_140:
  v_cvt_pk_bf16_f32 v16, v64, v65
  v_cvt_pk_bf16_f32 v17, v66, v67
  v_cvt_pk_bf16_f32 v18, v68, v69
  v_cvt_pk_bf16_f32 v19, v70, v71
  v_cvt_pk_bf16_f32 v20, v72, v73
  v_cvt_pk_bf16_f32 v21, v74, v75
  v_cvt_pk_bf16_f32 v22, v76, v77
  v_cvt_pk_bf16_f32 v23, v78, v79
  s_add_u32 s55, s56, 0
  buffer_store_dwordx4 v[16:19], v13, s[40:43], s55 offen sc1
  s_add_u32 s55, s56, 65536
  buffer_store_dwordx4 v[20:23], v13, s[40:43], s55 offen sc1
  v_cvt_pk_bf16_f32 v24, v80, v81
  v_cvt_pk_bf16_f32 v25, v82, v83
  v_cvt_pk_bf16_f32 v26, v84, v85
  v_cvt_pk_bf16_f32 v27, v86, v87
  v_cvt_pk_bf16_f32 v28, v88, v89
  v_cvt_pk_bf16_f32 v29, v90, v91
  v_cvt_pk_bf16_f32 v30, v92, v93
  v_cvt_pk_bf16_f32 v31, v94, v95
  s_add_u32 s55, s57, 0
  buffer_store_dwordx4 v[24:27], v13, s[40:43], s55 offen sc1
  s_add_u32 s55, s57, 65536
  buffer_store_dwordx4 v[28:31], v13, s[40:43], s55 offen sc1
  s_add_u32 s63, s79, 1
  s_cmp_ge_u32 s63, 40
  s_cbranch_scc1 PH_141
  v_min_f32 v16, 0, v96
  v_mul_f32 v16, s64, v16
  v_exp_f32 v16, v16
  v_max_f32 v96, 0, v96
  v_add_f32 v96, v96, v14
  v_add_f32 v96, v96, v16
  v_min_f32 v17, 0, v97
  v_mul_f32 v17, s64, v17
  v_exp_f32 v17, v17
  v_max_f32 v97, 0, v97
  v_add_f32 v97, v97, v14
  v_add_f32 v97, v97, v17
  v_min_f32 v18, 0, v98
  v_mul_f32 v18, s64, v18
  v_exp_f32 v18, v18
  v_max_f32 v98, 0, v98
  v_add_f32 v98, v98, v14
  v_add_f32 v98, v98, v18
  v_min_f32 v19, 0, v99
  v_mul_f32 v19, s64, v19
  v_exp_f32 v19, v19
  v_max_f32 v99, 0, v99
  v_add_f32 v99, v99, v14
  v_add_f32 v99, v99, v19
  v_min_f32 v20, 0, v100
  v_mul_f32 v20, s64, v20
  v_exp_f32 v20, v20
  v_max_f32 v100, 0, v100
  v_add_f32 v100, v100, v14
  v_add_f32 v100, v100, v20
  v_min_f32 v21, 0, v101
  v_mul_f32 v21, s64, v21
  v_exp_f32 v21, v21
  v_max_f32 v101, 0, v101
  v_add_f32 v101, v101, v14
  v_add_f32 v101, v101, v21
  v_min_f32 v22, 0, v102
  v_mul_f32 v22, s64, v22
  v_exp_f32 v22, v22
  v_max_f32 v102, 0, v102
  v_add_f32 v102, v102, v14
  v_add_f32 v102, v102, v22
  v_min_f32 v23, 0, v103
  v_mul_f32 v23, s64, v23
  v_exp_f32 v23, v23
  v_max_f32 v103, 0, v103
  v_add_f32 v103, v103, v14
  v_add_f32 v103, v103, v23
  v_min_f32 v16, 0, v104
  v_mul_f32 v16, s64, v16
  v_exp_f32 v16, v16
  v_max_f32 v104, 0, v104
  v_add_f32 v104, v104, v14
  v_add_f32 v104, v104, v16
  v_min_f32 v17, 0, v105
  v_mul_f32 v17, s64, v17
  v_exp_f32 v17, v17
  v_max_f32 v105, 0, v105
  v_add_f32 v105, v105, v14
  v_add_f32 v105, v105, v17
  v_min_f32 v18, 0, v106
  v_mul_f32 v18, s64, v18
  v_exp_f32 v18, v18
  v_max_f32 v106, 0, v106
  v_add_f32 v106, v106, v14
  v_add_f32 v106, v106, v18
  v_min_f32 v19, 0, v107
  v_mul_f32 v19, s64, v19
  v_exp_f32 v19, v19
  v_max_f32 v107, 0, v107
  v_add_f32 v107, v107, v14
  v_add_f32 v107, v107, v19
  v_min_f32 v20, 0, v108
  v_mul_f32 v20, s64, v20
  v_exp_f32 v20, v20
  v_max_f32 v108, 0, v108
  v_add_f32 v108, v108, v14
  v_add_f32 v108, v108, v20
  v_min_f32 v21, 0, v109
  v_mul_f32 v21, s64, v21
  v_exp_f32 v21, v21
  v_max_f32 v109, 0, v109
  v_add_f32 v109, v109, v14
  v_add_f32 v109, v109, v21
  v_min_f32 v22, 0, v110
  v_mul_f32 v22, s64, v22
  v_exp_f32 v22, v22
  v_max_f32 v110, 0, v110
  v_add_f32 v110, v110, v14
  v_add_f32 v110, v110, v22
  v_min_f32 v23, 0, v111
  v_mul_f32 v23, s64, v23
  v_exp_f32 v23, v23
  v_max_f32 v111, 0, v111
  v_add_f32 v111, v111, v14
  v_add_f32 v111, v111, v23
  v_min_f32 v16, 0, v112
  v_mul_f32 v16, s64, v16
  v_exp_f32 v16, v16
  v_max_f32 v112, 0, v112
  v_add_f32 v112, v112, v14
  v_add_f32 v112, v112, v16
  v_min_f32 v17, 0, v113
  v_mul_f32 v17, s64, v17
  v_exp_f32 v17, v17
  v_max_f32 v113, 0, v113
  v_add_f32 v113, v113, v14
  v_add_f32 v113, v113, v17
  v_min_f32 v18, 0, v114
  v_mul_f32 v18, s64, v18
  v_exp_f32 v18, v18
  v_max_f32 v114, 0, v114
  v_add_f32 v114, v114, v14
  v_add_f32 v114, v114, v18
  v_min_f32 v19, 0, v115
  v_mul_f32 v19, s64, v19
  v_exp_f32 v19, v19
  v_max_f32 v115, 0, v115
  v_add_f32 v115, v115, v14
  v_add_f32 v115, v115, v19
  v_min_f32 v20, 0, v116
  v_mul_f32 v20, s64, v20
  v_exp_f32 v20, v20
  v_max_f32 v116, 0, v116
  v_add_f32 v116, v116, v14
  v_add_f32 v116, v116, v20
  v_min_f32 v21, 0, v117
  v_mul_f32 v21, s64, v21
  v_exp_f32 v21, v21
  v_max_f32 v117, 0, v117
  v_add_f32 v117, v117, v14
  v_add_f32 v117, v117, v21
  v_min_f32 v22, 0, v118
  v_mul_f32 v22, s64, v22
  v_exp_f32 v22, v22
  v_max_f32 v118, 0, v118
  v_add_f32 v118, v118, v14
  v_add_f32 v118, v118, v22
  v_min_f32 v23, 0, v119
  v_mul_f32 v23, s64, v23
  v_exp_f32 v23, v23
  v_max_f32 v119, 0, v119
  v_add_f32 v119, v119, v14
  v_add_f32 v119, v119, v23
  v_min_f32 v16, 0, v120
  v_mul_f32 v16, s64, v16
  v_exp_f32 v16, v16
  v_max_f32 v120, 0, v120
  v_add_f32 v120, v120, v14
  v_add_f32 v120, v120, v16
  v_min_f32 v17, 0, v121
  v_mul_f32 v17, s64, v17
  v_exp_f32 v17, v17
  v_max_f32 v121, 0, v121
  v_add_f32 v121, v121, v14
  v_add_f32 v121, v121, v17
  v_min_f32 v18, 0, v122
  v_mul_f32 v18, s64, v18
  v_exp_f32 v18, v18
  v_max_f32 v122, 0, v122
  v_add_f32 v122, v122, v14
  v_add_f32 v122, v122, v18
  v_min_f32 v19, 0, v123
  v_mul_f32 v19, s64, v19
  v_exp_f32 v19, v19
  v_max_f32 v123, 0, v123
  v_add_f32 v123, v123, v14
  v_add_f32 v123, v123, v19
  v_min_f32 v20, 0, v124
  v_mul_f32 v20, s64, v20
  v_exp_f32 v20, v20
  v_max_f32 v124, 0, v124
  v_add_f32 v124, v124, v14
  v_add_f32 v124, v124, v20
  v_min_f32 v21, 0, v125
  v_mul_f32 v21, s64, v21
  v_exp_f32 v21, v21
  v_max_f32 v125, 0, v125
  v_add_f32 v125, v125, v14
  v_add_f32 v125, v125, v21
  v_min_f32 v22, 0, v126
  v_mul_f32 v22, s64, v22
  v_exp_f32 v22, v22
  v_max_f32 v126, 0, v126
  v_add_f32 v126, v126, v14
  v_add_f32 v126, v126, v22
  v_min_f32 v23, 0, v127
  v_mul_f32 v23, s64, v23
  v_exp_f32 v23, v23
  v_max_f32 v127, 0, v127
  v_add_f32 v127, v127, v14
  v_add_f32 v127, v127, v23
PH_141:
  v_cvt_pk_bf16_f32 v16, v96, v97
  v_cvt_pk_bf16_f32 v17, v98, v99
  v_cvt_pk_bf16_f32 v18, v100, v101
  v_cvt_pk_bf16_f32 v19, v102, v103
  v_cvt_pk_bf16_f32 v20, v104, v105
  v_cvt_pk_bf16_f32 v21, v106, v107
  v_cvt_pk_bf16_f32 v22, v108, v109
  v_cvt_pk_bf16_f32 v23, v110, v111
  s_add_u32 s55, s56, 131072
  buffer_store_dwordx4 v[16:19], v13, s[40:43], s55 offen sc1
  s_add_u32 s55, s56, 196608
  buffer_store_dwordx4 v[20:23], v13, s[40:43], s55 offen sc1
  v_cvt_pk_bf16_f32 v24, v112, v113
  v_cvt_pk_bf16_f32 v25, v114, v115
  v_cvt_pk_bf16_f32 v26, v116, v117
  v_cvt_pk_bf16_f32 v27, v118, v119
  v_cvt_pk_bf16_f32 v28, v120, v121
  v_cvt_pk_bf16_f32 v29, v122, v123
  v_cvt_pk_bf16_f32 v30, v124, v125
  v_cvt_pk_bf16_f32 v31, v126, v127
  s_add_u32 s55, s57, 131072
  buffer_store_dwordx4 v[24:27], v13, s[40:43], s55 offen sc1
  s_add_u32 s55, s57, 196608
  buffer_store_dwordx4 v[28:31], v13, s[40:43], s55 offen sc1
  s_add_u32 s63, s79, 2
  s_cmp_ge_u32 s63, 40
  s_cbranch_scc1 PH_142
  v_min_f32 v16, 0, v128
  v_mul_f32 v16, s64, v16
  v_exp_f32 v16, v16
  v_max_f32 v128, 0, v128
  v_add_f32 v128, v128, v14
  v_add_f32 v128, v128, v16
  v_min_f32 v17, 0, v129
  v_mul_f32 v17, s64, v17
  v_exp_f32 v17, v17
  v_max_f32 v129, 0, v129
  v_add_f32 v129, v129, v14
  v_add_f32 v129, v129, v17
  v_min_f32 v18, 0, v130
  v_mul_f32 v18, s64, v18
  v_exp_f32 v18, v18
  v_max_f32 v130, 0, v130
  v_add_f32 v130, v130, v14
  v_add_f32 v130, v130, v18
  v_min_f32 v19, 0, v131
  v_mul_f32 v19, s64, v19
  v_exp_f32 v19, v19
  v_max_f32 v131, 0, v131
  v_add_f32 v131, v131, v14
  v_add_f32 v131, v131, v19
  v_min_f32 v20, 0, v132
  v_mul_f32 v20, s64, v20
  v_exp_f32 v20, v20
  v_max_f32 v132, 0, v132
  v_add_f32 v132, v132, v14
  v_add_f32 v132, v132, v20
  v_min_f32 v21, 0, v133
  v_mul_f32 v21, s64, v21
  v_exp_f32 v21, v21
  v_max_f32 v133, 0, v133
  v_add_f32 v133, v133, v14
  v_add_f32 v133, v133, v21
  v_min_f32 v22, 0, v134
  v_mul_f32 v22, s64, v22
  v_exp_f32 v22, v22
  v_max_f32 v134, 0, v134
  v_add_f32 v134, v134, v14
  v_add_f32 v134, v134, v22
  v_min_f32 v23, 0, v135
  v_mul_f32 v23, s64, v23
  v_exp_f32 v23, v23
  v_max_f32 v135, 0, v135
  v_add_f32 v135, v135, v14
  v_add_f32 v135, v135, v23
  v_min_f32 v16, 0, v136
  v_mul_f32 v16, s64, v16
  v_exp_f32 v16, v16
  v_max_f32 v136, 0, v136
  v_add_f32 v136, v136, v14
  v_add_f32 v136, v136, v16
  v_min_f32 v17, 0, v137
  v_mul_f32 v17, s64, v17
  v_exp_f32 v17, v17
  v_max_f32 v137, 0, v137
  v_add_f32 v137, v137, v14
  v_add_f32 v137, v137, v17
  v_min_f32 v18, 0, v138
  v_mul_f32 v18, s64, v18
  v_exp_f32 v18, v18
  v_max_f32 v138, 0, v138
  v_add_f32 v138, v138, v14
  v_add_f32 v138, v138, v18
  v_min_f32 v19, 0, v139
  v_mul_f32 v19, s64, v19
  v_exp_f32 v19, v19
  v_max_f32 v139, 0, v139
  v_add_f32 v139, v139, v14
  v_add_f32 v139, v139, v19
  v_min_f32 v20, 0, v140
  v_mul_f32 v20, s64, v20
  v_exp_f32 v20, v20
  v_max_f32 v140, 0, v140
  v_add_f32 v140, v140, v14
  v_add_f32 v140, v140, v20
  v_min_f32 v21, 0, v141
  v_mul_f32 v21, s64, v21
  v_exp_f32 v21, v21
  v_max_f32 v141, 0, v141
  v_add_f32 v141, v141, v14
  v_add_f32 v141, v141, v21
  v_min_f32 v22, 0, v142
  v_mul_f32 v22, s64, v22
  v_exp_f32 v22, v22
  v_max_f32 v142, 0, v142
  v_add_f32 v142, v142, v14
  v_add_f32 v142, v142, v22
  v_min_f32 v23, 0, v143
  v_mul_f32 v23, s64, v23
  v_exp_f32 v23, v23
  v_max_f32 v143, 0, v143
  v_add_f32 v143, v143, v14
  v_add_f32 v143, v143, v23
  v_min_f32 v16, 0, v144
  v_mul_f32 v16, s64, v16
  v_exp_f32 v16, v16
  v_max_f32 v144, 0, v144
  v_add_f32 v144, v144, v14
  v_add_f32 v144, v144, v16
  v_min_f32 v17, 0, v145
  v_mul_f32 v17, s64, v17
  v_exp_f32 v17, v17
  v_max_f32 v145, 0, v145
  v_add_f32 v145, v145, v14
  v_add_f32 v145, v145, v17
  v_min_f32 v18, 0, v146
  v_mul_f32 v18, s64, v18
  v_exp_f32 v18, v18
  v_max_f32 v146, 0, v146
  v_add_f32 v146, v146, v14
  v_add_f32 v146, v146, v18
  v_min_f32 v19, 0, v147
  v_mul_f32 v19, s64, v19
  v_exp_f32 v19, v19
  v_max_f32 v147, 0, v147
  v_add_f32 v147, v147, v14
  v_add_f32 v147, v147, v19
  v_min_f32 v20, 0, v148
  v_mul_f32 v20, s64, v20
  v_exp_f32 v20, v20
  v_max_f32 v148, 0, v148
  v_add_f32 v148, v148, v14
  v_add_f32 v148, v148, v20
  v_min_f32 v21, 0, v149
  v_mul_f32 v21, s64, v21
  v_exp_f32 v21, v21
  v_max_f32 v149, 0, v149
  v_add_f32 v149, v149, v14
  v_add_f32 v149, v149, v21
  v_min_f32 v22, 0, v150
  v_mul_f32 v22, s64, v22
  v_exp_f32 v22, v22
  v_max_f32 v150, 0, v150
  v_add_f32 v150, v150, v14
  v_add_f32 v150, v150, v22
  v_min_f32 v23, 0, v151
  v_mul_f32 v23, s64, v23
  v_exp_f32 v23, v23
  v_max_f32 v151, 0, v151
  v_add_f32 v151, v151, v14
  v_add_f32 v151, v151, v23
  v_min_f32 v16, 0, v152
  v_mul_f32 v16, s64, v16
  v_exp_f32 v16, v16
  v_max_f32 v152, 0, v152
  v_add_f32 v152, v152, v14
  v_add_f32 v152, v152, v16
  v_min_f32 v17, 0, v153
  v_mul_f32 v17, s64, v17
  v_exp_f32 v17, v17
  v_max_f32 v153, 0, v153
  v_add_f32 v153, v153, v14
  v_add_f32 v153, v153, v17
  v_min_f32 v18, 0, v154
  v_mul_f32 v18, s64, v18
  v_exp_f32 v18, v18
  v_max_f32 v154, 0, v154
  v_add_f32 v154, v154, v14
  v_add_f32 v154, v154, v18
  v_min_f32 v19, 0, v155
  v_mul_f32 v19, s64, v19
  v_exp_f32 v19, v19
  v_max_f32 v155, 0, v155
  v_add_f32 v155, v155, v14
  v_add_f32 v155, v155, v19
  v_min_f32 v20, 0, v156
  v_mul_f32 v20, s64, v20
  v_exp_f32 v20, v20
  v_max_f32 v156, 0, v156
  v_add_f32 v156, v156, v14
  v_add_f32 v156, v156, v20
  v_min_f32 v21, 0, v157
  v_mul_f32 v21, s64, v21
  v_exp_f32 v21, v21
  v_max_f32 v157, 0, v157
  v_add_f32 v157, v157, v14
  v_add_f32 v157, v157, v21
  v_min_f32 v22, 0, v158
  v_mul_f32 v22, s64, v22
  v_exp_f32 v22, v22
  v_max_f32 v158, 0, v158
  v_add_f32 v158, v158, v14
  v_add_f32 v158, v158, v22
  v_min_f32 v23, 0, v159
  v_mul_f32 v23, s64, v23
  v_exp_f32 v23, v23
  v_max_f32 v159, 0, v159
  v_add_f32 v159, v159, v14
  v_add_f32 v159, v159, v23
PH_142:
  v_cvt_pk_bf16_f32 v16, v128, v129
  v_cvt_pk_bf16_f32 v17, v130, v131
  v_cvt_pk_bf16_f32 v18, v132, v133
  v_cvt_pk_bf16_f32 v19, v134, v135
  v_cvt_pk_bf16_f32 v20, v136, v137
  v_cvt_pk_bf16_f32 v21, v138, v139
  v_cvt_pk_bf16_f32 v22, v140, v141
  v_cvt_pk_bf16_f32 v23, v142, v143
  s_add_u32 s55, s56, 262144
  buffer_store_dwordx4 v[16:19], v13, s[40:43], s55 offen sc1
  s_add_u32 s55, s56, 327680
  buffer_store_dwordx4 v[20:23], v13, s[40:43], s55 offen sc1
  v_cvt_pk_bf16_f32 v24, v144, v145
  v_cvt_pk_bf16_f32 v25, v146, v147
  v_cvt_pk_bf16_f32 v26, v148, v149
  v_cvt_pk_bf16_f32 v27, v150, v151
  v_cvt_pk_bf16_f32 v28, v152, v153
  v_cvt_pk_bf16_f32 v29, v154, v155
  v_cvt_pk_bf16_f32 v30, v156, v157
  v_cvt_pk_bf16_f32 v31, v158, v159
  s_add_u32 s55, s57, 262144
  buffer_store_dwordx4 v[24:27], v13, s[40:43], s55 offen sc1
  s_add_u32 s55, s57, 327680
  buffer_store_dwordx4 v[28:31], v13, s[40:43], s55 offen sc1
  s_add_u32 s63, s79, 3
  s_cmp_ge_u32 s63, 40
  s_cbranch_scc1 PH_143
  v_min_f32 v16, 0, v160
  v_mul_f32 v16, s64, v16
  v_exp_f32 v16, v16
  v_max_f32 v160, 0, v160
  v_add_f32 v160, v160, v14
  v_add_f32 v160, v160, v16
  v_min_f32 v17, 0, v161
  v_mul_f32 v17, s64, v17
  v_exp_f32 v17, v17
  v_max_f32 v161, 0, v161
  v_add_f32 v161, v161, v14
  v_add_f32 v161, v161, v17
  v_min_f32 v18, 0, v162
  v_mul_f32 v18, s64, v18
  v_exp_f32 v18, v18
  v_max_f32 v162, 0, v162
  v_add_f32 v162, v162, v14
  v_add_f32 v162, v162, v18
  v_min_f32 v19, 0, v163
  v_mul_f32 v19, s64, v19
  v_exp_f32 v19, v19
  v_max_f32 v163, 0, v163
  v_add_f32 v163, v163, v14
  v_add_f32 v163, v163, v19
  v_min_f32 v20, 0, v164
  v_mul_f32 v20, s64, v20
  v_exp_f32 v20, v20
  v_max_f32 v164, 0, v164
  v_add_f32 v164, v164, v14
  v_add_f32 v164, v164, v20
  v_min_f32 v21, 0, v165
  v_mul_f32 v21, s64, v21
  v_exp_f32 v21, v21
  v_max_f32 v165, 0, v165
  v_add_f32 v165, v165, v14
  v_add_f32 v165, v165, v21
  v_min_f32 v22, 0, v166
  v_mul_f32 v22, s64, v22
  v_exp_f32 v22, v22
  v_max_f32 v166, 0, v166
  v_add_f32 v166, v166, v14
  v_add_f32 v166, v166, v22
  v_min_f32 v23, 0, v167
  v_mul_f32 v23, s64, v23
  v_exp_f32 v23, v23
  v_max_f32 v167, 0, v167
  v_add_f32 v167, v167, v14
  v_add_f32 v167, v167, v23
  v_min_f32 v16, 0, v168
  v_mul_f32 v16, s64, v16
  v_exp_f32 v16, v16
  v_max_f32 v168, 0, v168
  v_add_f32 v168, v168, v14
  v_add_f32 v168, v168, v16
  v_min_f32 v17, 0, v169
  v_mul_f32 v17, s64, v17
  v_exp_f32 v17, v17
  v_max_f32 v169, 0, v169
  v_add_f32 v169, v169, v14
  v_add_f32 v169, v169, v17
  v_min_f32 v18, 0, v170
  v_mul_f32 v18, s64, v18
  v_exp_f32 v18, v18
  v_max_f32 v170, 0, v170
  v_add_f32 v170, v170, v14
  v_add_f32 v170, v170, v18
  v_min_f32 v19, 0, v171
  v_mul_f32 v19, s64, v19
  v_exp_f32 v19, v19
  v_max_f32 v171, 0, v171
  v_add_f32 v171, v171, v14
  v_add_f32 v171, v171, v19
  v_min_f32 v20, 0, v172
  v_mul_f32 v20, s64, v20
  v_exp_f32 v20, v20
  v_max_f32 v172, 0, v172
  v_add_f32 v172, v172, v14
  v_add_f32 v172, v172, v20
  v_min_f32 v21, 0, v173
  v_mul_f32 v21, s64, v21
  v_exp_f32 v21, v21
  v_max_f32 v173, 0, v173
  v_add_f32 v173, v173, v14
  v_add_f32 v173, v173, v21
  v_min_f32 v22, 0, v174
  v_mul_f32 v22, s64, v22
  v_exp_f32 v22, v22
  v_max_f32 v174, 0, v174
  v_add_f32 v174, v174, v14
  v_add_f32 v174, v174, v22
  v_min_f32 v23, 0, v175
  v_mul_f32 v23, s64, v23
  v_exp_f32 v23, v23
  v_max_f32 v175, 0, v175
  v_add_f32 v175, v175, v14
  v_add_f32 v175, v175, v23
  v_min_f32 v16, 0, v176
  v_mul_f32 v16, s64, v16
  v_exp_f32 v16, v16
  v_max_f32 v176, 0, v176
  v_add_f32 v176, v176, v14
  v_add_f32 v176, v176, v16
  v_min_f32 v17, 0, v177
  v_mul_f32 v17, s64, v17
  v_exp_f32 v17, v17
  v_max_f32 v177, 0, v177
  v_add_f32 v177, v177, v14
  v_add_f32 v177, v177, v17
  v_min_f32 v18, 0, v178
  v_mul_f32 v18, s64, v18
  v_exp_f32 v18, v18
  v_max_f32 v178, 0, v178
  v_add_f32 v178, v178, v14
  v_add_f32 v178, v178, v18
  v_min_f32 v19, 0, v179
  v_mul_f32 v19, s64, v19
  v_exp_f32 v19, v19
  v_max_f32 v179, 0, v179
  v_add_f32 v179, v179, v14
  v_add_f32 v179, v179, v19
  v_min_f32 v20, 0, v180
  v_mul_f32 v20, s64, v20
  v_exp_f32 v20, v20
  v_max_f32 v180, 0, v180
  v_add_f32 v180, v180, v14
  v_add_f32 v180, v180, v20
  v_min_f32 v21, 0, v181
  v_mul_f32 v21, s64, v21
  v_exp_f32 v21, v21
  v_max_f32 v181, 0, v181
  v_add_f32 v181, v181, v14
  v_add_f32 v181, v181, v21
  v_min_f32 v22, 0, v182
  v_mul_f32 v22, s64, v22
  v_exp_f32 v22, v22
  v_max_f32 v182, 0, v182
  v_add_f32 v182, v182, v14
  v_add_f32 v182, v182, v22
  v_min_f32 v23, 0, v183
  v_mul_f32 v23, s64, v23
  v_exp_f32 v23, v23
  v_max_f32 v183, 0, v183
  v_add_f32 v183, v183, v14
  v_add_f32 v183, v183, v23
  v_min_f32 v16, 0, v184
  v_mul_f32 v16, s64, v16
  v_exp_f32 v16, v16
  v_max_f32 v184, 0, v184
  v_add_f32 v184, v184, v14
  v_add_f32 v184, v184, v16
  v_min_f32 v17, 0, v185
  v_mul_f32 v17, s64, v17
  v_exp_f32 v17, v17
  v_max_f32 v185, 0, v185
  v_add_f32 v185, v185, v14
  v_add_f32 v185, v185, v17
  v_min_f32 v18, 0, v186
  v_mul_f32 v18, s64, v18
  v_exp_f32 v18, v18
  v_max_f32 v186, 0, v186
  v_add_f32 v186, v186, v14
  v_add_f32 v186, v186, v18
  v_min_f32 v19, 0, v187
  v_mul_f32 v19, s64, v19
  v_exp_f32 v19, v19
  v_max_f32 v187, 0, v187
  v_add_f32 v187, v187, v14
  v_add_f32 v187, v187, v19
  v_min_f32 v20, 0, v188
  v_mul_f32 v20, s64, v20
  v_exp_f32 v20, v20
  v_max_f32 v188, 0, v188
  v_add_f32 v188, v188, v14
  v_add_f32 v188, v188, v20
  v_min_f32 v21, 0, v189
  v_mul_f32 v21, s64, v21
  v_exp_f32 v21, v21
  v_max_f32 v189, 0, v189
  v_add_f32 v189, v189, v14
  v_add_f32 v189, v189, v21
  v_min_f32 v22, 0, v190
  v_mul_f32 v22, s64, v22
  v_exp_f32 v22, v22
  v_max_f32 v190, 0, v190
  v_add_f32 v190, v190, v14
  v_add_f32 v190, v190, v22
  v_min_f32 v23, 0, v191
  v_mul_f32 v23, s64, v23
  v_exp_f32 v23, v23
  v_max_f32 v191, 0, v191
  v_add_f32 v191, v191, v14
  v_add_f32 v191, v191, v23
PH_143:
  v_cvt_pk_bf16_f32 v16, v160, v161
  v_cvt_pk_bf16_f32 v17, v162, v163
  v_cvt_pk_bf16_f32 v18, v164, v165
  v_cvt_pk_bf16_f32 v19, v166, v167
  v_cvt_pk_bf16_f32 v20, v168, v169
  v_cvt_pk_bf16_f32 v21, v170, v171
  v_cvt_pk_bf16_f32 v22, v172, v173
  v_cvt_pk_bf16_f32 v23, v174, v175
  s_add_u32 s55, s56, 393216
  buffer_store_dwordx4 v[16:19], v13, s[40:43], s55 offen sc1
  s_add_u32 s55, s56, 458752
  buffer_store_dwordx4 v[20:23], v13, s[40:43], s55 offen sc1
  v_cvt_pk_bf16_f32 v24, v176, v177
  v_cvt_pk_bf16_f32 v25, v178, v179
  v_cvt_pk_bf16_f32 v26, v180, v181
  v_cvt_pk_bf16_f32 v27, v182, v183
  v_cvt_pk_bf16_f32 v28, v184, v185
  v_cvt_pk_bf16_f32 v29, v186, v187
  v_cvt_pk_bf16_f32 v30, v188, v189
  v_cvt_pk_bf16_f32 v31, v190, v191
  s_add_u32 s55, s57, 393216
  buffer_store_dwordx4 v[24:27], v13, s[40:43], s55 offen sc1
  s_add_u32 s55, s57, 458752
  buffer_store_dwordx4 v[28:31], v13, s[40:43], s55 offen sc1
  s_add_u32 s63, s79, 4
  s_cmp_ge_u32 s63, 40
  s_cbranch_scc1 PH_144
  v_min_f32 v16, 0, v192
  v_mul_f32 v16, s64, v16
  v_exp_f32 v16, v16
  v_max_f32 v192, 0, v192
  v_add_f32 v192, v192, v14
  v_add_f32 v192, v192, v16
  v_min_f32 v17, 0, v193
  v_mul_f32 v17, s64, v17
  v_exp_f32 v17, v17
  v_max_f32 v193, 0, v193
  v_add_f32 v193, v193, v14
  v_add_f32 v193, v193, v17
  v_min_f32 v18, 0, v194
  v_mul_f32 v18, s64, v18
  v_exp_f32 v18, v18
  v_max_f32 v194, 0, v194
  v_add_f32 v194, v194, v14
  v_add_f32 v194, v194, v18
  v_min_f32 v19, 0, v195
  v_mul_f32 v19, s64, v19
  v_exp_f32 v19, v19
  v_max_f32 v195, 0, v195
  v_add_f32 v195, v195, v14
  v_add_f32 v195, v195, v19
  v_min_f32 v20, 0, v196
  v_mul_f32 v20, s64, v20
  v_exp_f32 v20, v20
  v_max_f32 v196, 0, v196
  v_add_f32 v196, v196, v14
  v_add_f32 v196, v196, v20
  v_min_f32 v21, 0, v197
  v_mul_f32 v21, s64, v21
  v_exp_f32 v21, v21
  v_max_f32 v197, 0, v197
  v_add_f32 v197, v197, v14
  v_add_f32 v197, v197, v21
  v_min_f32 v22, 0, v198
  v_mul_f32 v22, s64, v22
  v_exp_f32 v22, v22
  v_max_f32 v198, 0, v198
  v_add_f32 v198, v198, v14
  v_add_f32 v198, v198, v22
  v_min_f32 v23, 0, v199
  v_mul_f32 v23, s64, v23
  v_exp_f32 v23, v23
  v_max_f32 v199, 0, v199
  v_add_f32 v199, v199, v14
  v_add_f32 v199, v199, v23
  v_min_f32 v16, 0, v200
  v_mul_f32 v16, s64, v16
  v_exp_f32 v16, v16
  v_max_f32 v200, 0, v200
  v_add_f32 v200, v200, v14
  v_add_f32 v200, v200, v16
  v_min_f32 v17, 0, v201
  v_mul_f32 v17, s64, v17
  v_exp_f32 v17, v17
  v_max_f32 v201, 0, v201
  v_add_f32 v201, v201, v14
  v_add_f32 v201, v201, v17
  v_min_f32 v18, 0, v202
  v_mul_f32 v18, s64, v18
  v_exp_f32 v18, v18
  v_max_f32 v202, 0, v202
  v_add_f32 v202, v202, v14
  v_add_f32 v202, v202, v18
  v_min_f32 v19, 0, v203
  v_mul_f32 v19, s64, v19
  v_exp_f32 v19, v19
  v_max_f32 v203, 0, v203
  v_add_f32 v203, v203, v14
  v_add_f32 v203, v203, v19
  v_min_f32 v20, 0, v204
  v_mul_f32 v20, s64, v20
  v_exp_f32 v20, v20
  v_max_f32 v204, 0, v204
  v_add_f32 v204, v204, v14
  v_add_f32 v204, v204, v20
  v_min_f32 v21, 0, v205
  v_mul_f32 v21, s64, v21
  v_exp_f32 v21, v21
  v_max_f32 v205, 0, v205
  v_add_f32 v205, v205, v14
  v_add_f32 v205, v205, v21
  v_min_f32 v22, 0, v206
  v_mul_f32 v22, s64, v22
  v_exp_f32 v22, v22
  v_max_f32 v206, 0, v206
  v_add_f32 v206, v206, v14
  v_add_f32 v206, v206, v22
  v_min_f32 v23, 0, v207
  v_mul_f32 v23, s64, v23
  v_exp_f32 v23, v23
  v_max_f32 v207, 0, v207
  v_add_f32 v207, v207, v14
  v_add_f32 v207, v207, v23
  v_min_f32 v16, 0, v208
  v_mul_f32 v16, s64, v16
  v_exp_f32 v16, v16
  v_max_f32 v208, 0, v208
  v_add_f32 v208, v208, v14
  v_add_f32 v208, v208, v16
  v_min_f32 v17, 0, v209
  v_mul_f32 v17, s64, v17
  v_exp_f32 v17, v17
  v_max_f32 v209, 0, v209
  v_add_f32 v209, v209, v14
  v_add_f32 v209, v209, v17
  v_min_f32 v18, 0, v210
  v_mul_f32 v18, s64, v18
  v_exp_f32 v18, v18
  v_max_f32 v210, 0, v210
  v_add_f32 v210, v210, v14
  v_add_f32 v210, v210, v18
  v_min_f32 v19, 0, v211
  v_mul_f32 v19, s64, v19
  v_exp_f32 v19, v19
  v_max_f32 v211, 0, v211
  v_add_f32 v211, v211, v14
  v_add_f32 v211, v211, v19
  v_min_f32 v20, 0, v212
  v_mul_f32 v20, s64, v20
  v_exp_f32 v20, v20
  v_max_f32 v212, 0, v212
  v_add_f32 v212, v212, v14
  v_add_f32 v212, v212, v20
  v_min_f32 v21, 0, v213
  v_mul_f32 v21, s64, v21
  v_exp_f32 v21, v21
  v_max_f32 v213, 0, v213
  v_add_f32 v213, v213, v14
  v_add_f32 v213, v213, v21
  v_min_f32 v22, 0, v214
  v_mul_f32 v22, s64, v22
  v_exp_f32 v22, v22
  v_max_f32 v214, 0, v214
  v_add_f32 v214, v214, v14
  v_add_f32 v214, v214, v22
  v_min_f32 v23, 0, v215
  v_mul_f32 v23, s64, v23
  v_exp_f32 v23, v23
  v_max_f32 v215, 0, v215
  v_add_f32 v215, v215, v14
  v_add_f32 v215, v215, v23
  v_min_f32 v16, 0, v216
  v_mul_f32 v16, s64, v16
  v_exp_f32 v16, v16
  v_max_f32 v216, 0, v216
  v_add_f32 v216, v216, v14
  v_add_f32 v216, v216, v16
  v_min_f32 v17, 0, v217
  v_mul_f32 v17, s64, v17
  v_exp_f32 v17, v17
  v_max_f32 v217, 0, v217
  v_add_f32 v217, v217, v14
  v_add_f32 v217, v217, v17
  v_min_f32 v18, 0, v218
  v_mul_f32 v18, s64, v18
  v_exp_f32 v18, v18
  v_max_f32 v218, 0, v218
  v_add_f32 v218, v218, v14
  v_add_f32 v218, v218, v18
  v_min_f32 v19, 0, v219
  v_mul_f32 v19, s64, v19
  v_exp_f32 v19, v19
  v_max_f32 v219, 0, v219
  v_add_f32 v219, v219, v14
  v_add_f32 v219, v219, v19
  v_min_f32 v20, 0, v220
  v_mul_f32 v20, s64, v20
  v_exp_f32 v20, v20
  v_max_f32 v220, 0, v220
  v_add_f32 v220, v220, v14
  v_add_f32 v220, v220, v20
  v_min_f32 v21, 0, v221
  v_mul_f32 v21, s64, v21
  v_exp_f32 v21, v21
  v_max_f32 v221, 0, v221
  v_add_f32 v221, v221, v14
  v_add_f32 v221, v221, v21
  v_min_f32 v22, 0, v222
  v_mul_f32 v22, s64, v22
  v_exp_f32 v22, v22
  v_max_f32 v222, 0, v222
  v_add_f32 v222, v222, v14
  v_add_f32 v222, v222, v22
  v_min_f32 v23, 0, v223
  v_mul_f32 v23, s64, v23
  v_exp_f32 v23, v23
  v_max_f32 v223, 0, v223
  v_add_f32 v223, v223, v14
  v_add_f32 v223, v223, v23
PH_144:
  v_cvt_pk_bf16_f32 v16, v192, v193
  v_cvt_pk_bf16_f32 v17, v194, v195
  v_cvt_pk_bf16_f32 v18, v196, v197
  v_cvt_pk_bf16_f32 v19, v198, v199
  v_cvt_pk_bf16_f32 v20, v200, v201
  v_cvt_pk_bf16_f32 v21, v202, v203
  v_cvt_pk_bf16_f32 v22, v204, v205
  v_cvt_pk_bf16_f32 v23, v206, v207
  s_add_u32 s55, s56, 524288
  buffer_store_dwordx4 v[16:19], v13, s[40:43], s55 offen sc1
  s_add_u32 s55, s56, 589824
  buffer_store_dwordx4 v[20:23], v13, s[40:43], s55 offen sc1
  v_cvt_pk_bf16_f32 v24, v208, v209
  v_cvt_pk_bf16_f32 v25, v210, v211
  v_cvt_pk_bf16_f32 v26, v212, v213
  v_cvt_pk_bf16_f32 v27, v214, v215
  v_cvt_pk_bf16_f32 v28, v216, v217
  v_cvt_pk_bf16_f32 v29, v218, v219
  v_cvt_pk_bf16_f32 v30, v220, v221
  v_cvt_pk_bf16_f32 v31, v222, v223
  s_add_u32 s55, s57, 524288
  buffer_store_dwordx4 v[24:27], v13, s[40:43], s55 offen sc1
  s_add_u32 s55, s57, 589824
  buffer_store_dwordx4 v[28:31], v13, s[40:43], s55 offen sc1
  s_add_u32 s63, s79, 5
  s_cmp_ge_u32 s63, 40
  s_cbranch_scc1 PH_145
  v_min_f32 v16, 0, v224
  v_mul_f32 v16, s64, v16
  v_exp_f32 v16, v16
  v_max_f32 v224, 0, v224
  v_add_f32 v224, v224, v14
  v_add_f32 v224, v224, v16
  v_min_f32 v17, 0, v225
  v_mul_f32 v17, s64, v17
  v_exp_f32 v17, v17
  v_max_f32 v225, 0, v225
  v_add_f32 v225, v225, v14
  v_add_f32 v225, v225, v17
  v_min_f32 v18, 0, v226
  v_mul_f32 v18, s64, v18
  v_exp_f32 v18, v18
  v_max_f32 v226, 0, v226
  v_add_f32 v226, v226, v14
  v_add_f32 v226, v226, v18
  v_min_f32 v19, 0, v227
  v_mul_f32 v19, s64, v19
  v_exp_f32 v19, v19
  v_max_f32 v227, 0, v227
  v_add_f32 v227, v227, v14
  v_add_f32 v227, v227, v19
  v_min_f32 v20, 0, v228
  v_mul_f32 v20, s64, v20
  v_exp_f32 v20, v20
  v_max_f32 v228, 0, v228
  v_add_f32 v228, v228, v14
  v_add_f32 v228, v228, v20
  v_min_f32 v21, 0, v229
  v_mul_f32 v21, s64, v21
  v_exp_f32 v21, v21
  v_max_f32 v229, 0, v229
  v_add_f32 v229, v229, v14
  v_add_f32 v229, v229, v21
  v_min_f32 v22, 0, v230
  v_mul_f32 v22, s64, v22
  v_exp_f32 v22, v22
  v_max_f32 v230, 0, v230
  v_add_f32 v230, v230, v14
  v_add_f32 v230, v230, v22
  v_min_f32 v23, 0, v231
  v_mul_f32 v23, s64, v23
  v_exp_f32 v23, v23
  v_max_f32 v231, 0, v231
  v_add_f32 v231, v231, v14
  v_add_f32 v231, v231, v23
  v_min_f32 v16, 0, v232
  v_mul_f32 v16, s64, v16
  v_exp_f32 v16, v16
  v_max_f32 v232, 0, v232
  v_add_f32 v232, v232, v14
  v_add_f32 v232, v232, v16
  v_min_f32 v17, 0, v233
  v_mul_f32 v17, s64, v17
  v_exp_f32 v17, v17
  v_max_f32 v233, 0, v233
  v_add_f32 v233, v233, v14
  v_add_f32 v233, v233, v17
  v_min_f32 v18, 0, v234
  v_mul_f32 v18, s64, v18
  v_exp_f32 v18, v18
  v_max_f32 v234, 0, v234
  v_add_f32 v234, v234, v14
  v_add_f32 v234, v234, v18
  v_min_f32 v19, 0, v235
  v_mul_f32 v19, s64, v19
  v_exp_f32 v19, v19
  v_max_f32 v235, 0, v235
  v_add_f32 v235, v235, v14
  v_add_f32 v235, v235, v19
  v_min_f32 v20, 0, v236
  v_mul_f32 v20, s64, v20
  v_exp_f32 v20, v20
  v_max_f32 v236, 0, v236
  v_add_f32 v236, v236, v14
  v_add_f32 v236, v236, v20
  v_min_f32 v21, 0, v237
  v_mul_f32 v21, s64, v21
  v_exp_f32 v21, v21
  v_max_f32 v237, 0, v237
  v_add_f32 v237, v237, v14
  v_add_f32 v237, v237, v21
  v_min_f32 v22, 0, v238
  v_mul_f32 v22, s64, v22
  v_exp_f32 v22, v22
  v_max_f32 v238, 0, v238
  v_add_f32 v238, v238, v14
  v_add_f32 v238, v238, v22
  v_min_f32 v23, 0, v239
  v_mul_f32 v23, s64, v23
  v_exp_f32 v23, v23
  v_max_f32 v239, 0, v239
  v_add_f32 v239, v239, v14
  v_add_f32 v239, v239, v23
  v_min_f32 v16, 0, v240
  v_mul_f32 v16, s64, v16
  v_exp_f32 v16, v16
  v_max_f32 v240, 0, v240
  v_add_f32 v240, v240, v14
  v_add_f32 v240, v240, v16
  v_min_f32 v17, 0, v241
  v_mul_f32 v17, s64, v17
  v_exp_f32 v17, v17
  v_max_f32 v241, 0, v241
  v_add_f32 v241, v241, v14
  v_add_f32 v241, v241, v17
  v_min_f32 v18, 0, v242
  v_mul_f32 v18, s64, v18
  v_exp_f32 v18, v18
  v_max_f32 v242, 0, v242
  v_add_f32 v242, v242, v14
  v_add_f32 v242, v242, v18
  v_min_f32 v19, 0, v243
  v_mul_f32 v19, s64, v19
  v_exp_f32 v19, v19
  v_max_f32 v243, 0, v243
  v_add_f32 v243, v243, v14
  v_add_f32 v243, v243, v19
  v_min_f32 v20, 0, v244
  v_mul_f32 v20, s64, v20
  v_exp_f32 v20, v20
  v_max_f32 v244, 0, v244
  v_add_f32 v244, v244, v14
  v_add_f32 v244, v244, v20
  v_min_f32 v21, 0, v245
  v_mul_f32 v21, s64, v21
  v_exp_f32 v21, v21
  v_max_f32 v245, 0, v245
  v_add_f32 v245, v245, v14
  v_add_f32 v245, v245, v21
  v_min_f32 v22, 0, v246
  v_mul_f32 v22, s64, v22
  v_exp_f32 v22, v22
  v_max_f32 v246, 0, v246
  v_add_f32 v246, v246, v14
  v_add_f32 v246, v246, v22
  v_min_f32 v23, 0, v247
  v_mul_f32 v23, s64, v23
  v_exp_f32 v23, v23
  v_max_f32 v247, 0, v247
  v_add_f32 v247, v247, v14
  v_add_f32 v247, v247, v23
  v_min_f32 v16, 0, v248
  v_mul_f32 v16, s64, v16
  v_exp_f32 v16, v16
  v_max_f32 v248, 0, v248
  v_add_f32 v248, v248, v14
  v_add_f32 v248, v248, v16
  v_min_f32 v17, 0, v249
  v_mul_f32 v17, s64, v17
  v_exp_f32 v17, v17
  v_max_f32 v249, 0, v249
  v_add_f32 v249, v249, v14
  v_add_f32 v249, v249, v17
  v_min_f32 v18, 0, v250
  v_mul_f32 v18, s64, v18
  v_exp_f32 v18, v18
  v_max_f32 v250, 0, v250
  v_add_f32 v250, v250, v14
  v_add_f32 v250, v250, v18
  v_min_f32 v19, 0, v251
  v_mul_f32 v19, s64, v19
  v_exp_f32 v19, v19
  v_max_f32 v251, 0, v251
  v_add_f32 v251, v251, v14
  v_add_f32 v251, v251, v19
  v_min_f32 v20, 0, v252
  v_mul_f32 v20, s64, v20
  v_exp_f32 v20, v20
  v_max_f32 v252, 0, v252
  v_add_f32 v252, v252, v14
  v_add_f32 v252, v252, v20
  v_min_f32 v21, 0, v253
  v_mul_f32 v21, s64, v21
  v_exp_f32 v21, v21
  v_max_f32 v253, 0, v253
  v_add_f32 v253, v253, v14
  v_add_f32 v253, v253, v21
  v_min_f32 v22, 0, v254
  v_mul_f32 v22, s64, v22
  v_exp_f32 v22, v22
  v_max_f32 v254, 0, v254
  v_add_f32 v254, v254, v14
  v_add_f32 v254, v254, v22
  v_min_f32 v23, 0, v255
  v_mul_f32 v23, s64, v23
  v_exp_f32 v23, v23
  v_max_f32 v255, 0, v255
  v_add_f32 v255, v255, v14
  v_add_f32 v255, v255, v23
PH_145:
  v_cvt_pk_bf16_f32 v16, v224, v225
  v_cvt_pk_bf16_f32 v17, v226, v227
  v_cvt_pk_bf16_f32 v18, v228, v229
  v_cvt_pk_bf16_f32 v19, v230, v231
  v_cvt_pk_bf16_f32 v20, v232, v233
  v_cvt_pk_bf16_f32 v21, v234, v235
  v_cvt_pk_bf16_f32 v22, v236, v237
  v_cvt_pk_bf16_f32 v23, v238, v239
  s_add_u32 s55, s56, 655360
  buffer_store_dwordx4 v[16:19], v13, s[40:43], s55 offen sc1
  s_add_u32 s55, s56, 720896
  buffer_store_dwordx4 v[20:23], v13, s[40:43], s55 offen sc1
  v_cvt_pk_bf16_f32 v24, v240, v241
  v_cvt_pk_bf16_f32 v25, v242, v243
  v_cvt_pk_bf16_f32 v26, v244, v245
  v_cvt_pk_bf16_f32 v27, v246, v247
  v_cvt_pk_bf16_f32 v28, v248, v249
  v_cvt_pk_bf16_f32 v29, v250, v251
  v_cvt_pk_bf16_f32 v30, v252, v253
  v_cvt_pk_bf16_f32 v31, v254, v255
  s_add_u32 s55, s57, 655360
  buffer_store_dwordx4 v[24:27], v13, s[40:43], s55 offen sc1
  s_add_u32 s55, s57, 720896
  buffer_store_dwordx4 v[28:31], v13, s[40:43], s55 offen sc1
  s_waitcnt vmcnt(0)
  s_barrier
  s_cmp_eq_u32 s48, 0
  s_cbranch_scc0 SG_146
  s_mov_b32 s95, 160
  v_mov_b32 v1, 1
  s_mov_b64 exec, 1
  buffer_atomic_add v1, off, s[96:99], s95
  s_mov_b64 exec, -1
SG_146:
WP_DONE:
W_LOOP_T:
  s_branch W_LOOP_T1
W_P1_T:
  v_and_b32 v1, 63, v0
  v_lshrrev_b32 v14, 6, v0
  s_nop 0
  v_readfirstlane_b32 s48, v14
  v_and_b32 v14, 31, v1
  v_and_b32 v16, 0x13, v14
  v_and_b32 v17, 4, v14
  v_lshl_add_u32 v16, v17, 1, v16
  v_and_b32 v17, 8, v14
  v_lshrrev_b32 v17, 1, v17
  v_add_u32 v14, v16, v17
  v_lshrrev_b32 v15, 5, v1
  v_lshrrev_b32 v16, 1, v14
  v_and_b32 v16, 7, v16
  s_mul_i32 s55, s48, 4096
  v_lshlrev_b32 v17, 7, v14
  v_add_u32 v17, s55, v17
  v_add_u32 v18, 0, v15
  v_xor_b32 v18, v18, v16
  v_lshlrev_b32 v18, 4, v18
  v_add_u32 v2, v17, v18
  v_add_u32 v18, 2, v15
  v_xor_b32 v18, v18, v16
  v_lshlrev_b32 v18, 4, v18
  v_add_u32 v3, v17, v18
  v_add_u32 v18, 4, v15
  v_xor_b32 v18, v18, v16
  v_lshlrev_b32 v18, 4, v18
  v_add_u32 v4, v17, v18
  v_add_u32 v18, 6, v15
  v_xor_b32 v18, v18, v16
  v_lshlrev_b32 v18, 4, v18
  v_add_u32 v5, v17, v18
  v_lshlrev_b32 v13, 5, v14
  v_lshlrev_b32 v18, 4, v15
  v_add_u32 v13, v13, v18
  v_and_b32 v16, 15, v1
  v_lshrrev_b32 v17, 2, v16
  v_and_b32 v18, 3, v16
  v_lshrrev_b32 v22, 1, v18
  v_and_b32 v18, 1, v18
  v_lshl_add_u32 v18, v18, 1, v22
  v_lshrrev_b32 v19, 4, v1
  v_and_b32 v20, 1, v19
  v_lshlrev_b32 v20, 5, v20
  v_lshlrev_b32 v18, 3, v18
  v_add_u32 v20, v20, v18
  v_lshlrev_b32 v21, 3, v15
  v_add_u32 v21, v21, v17
  v_lshlrev_b32 v21, 6, v21
  v_add_u32 v21, v21, v20
  v_add_u32 v6, 65536, v21
  v_add_u32 v7, 90112, v21
  v_and_b32 v18, 3, v16
  v_lshlrev_b32 v18, 3, v18
  v_and_b32 v20, 1, v19
  v_lshlrev_b32 v20, 5, v20
  v_add_u32 v20, v20, v18
  v_lshlrev_b32 v21, 3, v15
  v_add_u32 v21, v21, v17
  v_lshlrev_b32 v21, 6, v21
  v_add_u32 v21, v21, v20
  v_add_u32 v8, 65536, v21
  v_add_u32 v9, 90112, v21
  v_lshrrev_b32 v16, 4, v1
  v_add_u32 v16, 0, v16
  v_and_b32 v17, 7, v1
  v_xor_b32 v16, v16, v17
  v_lshlrev_b32 v16, 4, v16
  v_lshrrev_b32 v17, 3, v1
  v_mul_u32_u24 v17, 1280, v17
  v_add_u32 v10, v16, v17
  v_lshrrev_b32 v16, 4, v1
  v_add_u32 v16, 4, v16
  v_and_b32 v17, 7, v1
  v_xor_b32 v16, v16, v17
  v_lshlrev_b32 v16, 4, v16
  v_lshrrev_b32 v17, 3, v1
  v_mul_u32_u24 v17, 1280, v17
  v_add_u32 v11, v16, v17
  s_mul_i32 s50, s48, 4096
  s_lshl_b32 s52, s48, 10
  s_mov_b32 s32, s10
  s_mov_b32 s33, s11
  s_mov_b32 s34, 2621440
  s_mov_b32 s35, 0x20000
  s_mov_b32 s44, s20
  s_mov_b32 s45, s21
  s_mov_b32 s46, 7864320
  s_mov_b32 s47, 0x20000
  s_mul_i32 s78, s48, 3072
  s_lshr_b32 s66, s93, 6
  s_lshl_b32 s58, s66, 7
  s_and_b32 s65, s93, 31
  s_bitcmp1_b32 s93, 5
  s_cselect_b32 s67, 0, 2
  s_mul_i32 s59, s65, 384
  s_mov_b32 s53, 12288
  s_mov_b32 s36, s18
  s_mov_b32 s37, s19
  s_mov_b32 s60, 0
  s_cmp_eq_u32 s67, 0
  s_cselect_b32 s36, s16, s36
  s_cselect_b32 s37, s17, s37
  s_cselect_b32 s60, 0, s60
  s_cmp_eq_u32 s67, 1
  s_cselect_b32 s36, s14, s36
  s_cselect_b32 s37, s15, s37
  s_cselect_b32 s60, 25165824, s60
  s_mov_b32 s38, 7864320
  s_mov_b32 s39, 0x20000
  s_mul_i32 s55, s48, 32
  s_add_u32 s55, s55, s58
  s_mul_i32 s49, s55, 1280
  s_lshl_b32 s55, s48, 4
  s_mul_i32 s51, s55, s53
  s_add_u32 s51, s51, s59
  s_lshl_b32 s54, s53, 6
  v_lshrrev_b32 v14, 2, v1
  v_mul_lo_u32 v14, v14, s53
  v_and_b32 v15, 3, v1
  v_lshlrev_b32 v15, 4, v15
  v_add_u32 v12, v14, v15
  s_lshr_b32 s63, s58, 5
  s_mul_i32 s64, s48, 1
  s_add_u32 s63, s63, s64
  s_mul_i32 s68, s65, 768
  s_add_u32 s68, s68, s63
  s_lshl_b32 s68, s68, 10
  s_add_u32 s56, s68, s60
  s_add_u32 s57, s56, 1024
  s_mul_i32 s68, s65, 2560
  s_add_u32 s68, s68, s63
  s_lshl_b32 s68, s68, 10
  s_add_u32 s76, s68, 50331648
  s_add_u32 s77, s76, 1024
  s_mul_i32 s68, s65, 192
  s_mul_i32 s69, s48, 48
  s_add_u32 s68, s68, s69
  s_mul_i32 s75, s68, 1280
  v_lshrrev_b32 v14, 2, v1
  v_mul_u32_u24 v14, 1280, v14
  v_and_b32 v15, 3, v1
  v_lshlrev_b32 v15, 4, v15
  v_add_u32 v15, v15, v14
  v_mov_b32 v31, v6
  s_add_u32 m0, s50, 0
  s_add_u32 s55, s49, 0
  buffer_load_dwordx4 v10, s[32:35], s55 offen  lds
  s_add_u32 m0, s50, 1024
  s_add_u32 s55, s49, 10240
  buffer_load_dwordx4 v11, s[32:35], s55 offen  lds
  s_add_u32 m0, s50, 2048
  s_add_u32 s55, s49, 20480
  buffer_load_dwordx4 v10, s[32:35], s55 offen  lds
  s_add_u32 m0, s50, 3072
  s_add_u32 s55, s49, 30720
  buffer_load_dwordx4 v11, s[32:35], s55 offen  lds
  s_add_u32 s49, s49, 128
  s_add_u32 m0, s52, 65536
  s_add_u32 s55, s51, 0
  buffer_load_dwordx4 v12, s[36:39], s55 offen  lds
  s_add_u32 m0, s52, 69632
  s_add_u32 s55, s51, 64
  buffer_load_dwordx4 v12, s[36:39], s55 offen  lds
  s_add_u32 m0, s52, 73728
  s_add_u32 s55, s51, 128
  buffer_load_dwordx4 v12, s[36:39], s55 offen  lds
  s_add_u32 m0, s52, 77824
  s_add_u32 s55, s51, 192
  buffer_load_dwordx4 v12, s[36:39], s55 offen  lds
  s_add_u32 m0, s52, 81920
  s_add_u32 s55, s51, 256
  buffer_load_dwordx4 v12, s[36:39], s55 offen  lds
  s_add_u32 m0, s52, 86016
  s_add_u32 s55, s51, 320
  buffer_load_dwordx4 v12, s[36:39], s55 offen  lds
  s_add_u32 s51, s51, s54
  s_add_u32 m0, s50, 32768
  s_add_u32 s55, s49, 0
  buffer_load_dwordx4 v10, s[32:35], s55 offen  lds
  s_add_u32 m0, s50, 33792
  s_add_u32 s55, s49, 10240
  buffer_load_dwordx4 v11, s[32:35], s55 offen  lds
  s_add_u32 m0, s50, 34816
  s_add_u32 s55, s49, 20480
  buffer_load_dwordx4 v10, s[32:35], s55 offen  lds
  s_add_u32 m0, s50, 35840
  s_add_u32 s55, s49, 30720
  buffer_load_dwordx4 v11, s[32:35], s55 offen  lds
  s_add_u32 s49, s49, 128
  s_add_u32 m0, s52, 90112
  s_add_u32 s55, s51, 0
  buffer_load_dwordx4 v12, s[36:39], s55 offen  lds
  s_add_u32 m0, s52, 94208
  s_add_u32 s55, s51, 64
  buffer_load_dwordx4 v12, s[36:39], s55 offen  lds
  s_add_u32 m0, s52, 98304
  s_add_u32 s55, s51, 128
  buffer_load_dwordx4 v12, s[36:39], s55 offen  lds
  s_add_u32 m0, s52, 102400
  s_add_u32 s55, s51, 192
  buffer_load_dwordx4 v12, s[36:39], s55 offen  lds
  s_add_u32 m0, s52, 106496
  s_add_u32 s55, s51, 256
  buffer_load_dwordx4 v12, s[36:39], s55 offen  lds
  s_add_u32 m0, s52, 110592
  s_add_u32 s55, s51, 320
  buffer_load_dwordx4 v12, s[36:39], s55 offen  lds
  s_add_u32 s51, s51, s54
  s_add_u32 m0, s52, 114688
  s_add_u32 s55, s51, 0
  buffer_load_dwordx4 v12, s[36:39], s55 offen  lds
  s_add_u32 m0, s52, 118784
  s_add_u32 s55, s51, 64
  buffer_load_dwordx4 v12, s[36:39], s55 offen  lds
  s_add_u32 m0, s52, 122880
  s_add_u32 s55, s51, 128
  buffer_load_dwordx4 v12, s[36:39], s55 offen  lds
  s_add_u32 m0, s52, 126976
  s_add_u32 s55, s51, 192
  buffer_load_dwordx4 v12, s[36:39], s55 offen  lds
  s_add_u32 m0, s52, 131072
  s_add_u32 s55, s51, 256
  buffer_load_dwordx4 v12, s[36:39], s55 offen  lds
  s_add_u32 m0, s52, 135168
  s_add_u32 s55, s51, 320
  buffer_load_dwordx4 v12, s[36:39], s55 offen  lds
  s_add_u32 s51, s51, s54
  s_mov_b32 s81, 0
  s_waitcnt vmcnt(16)
  s_barrier
  ds_read_b128 a[24:27], v2 offset:0
  ds_read_b64_tr_b16 a[0:1], v6 offset:0
  ds_read_b64_tr_b16 a[2:3], v6 offset:256
  ds_read_b64_tr_b16 a[4:5], v6 offset:4096
  ds_read_b64_tr_b16 a[6:7], v6 offset:4352
  ds_read_b64_tr_b16 a[8:9], v6 offset:8192
  ds_read_b64_tr_b16 a[10:11], v6 offset:8448
  ds_read_b64_tr_b16 a[12:13], v6 offset:12288
  ds_read_b64_tr_b16 a[14:15], v6 offset:12544
  ds_read_b64_tr_b16 a[16:17], v6 offset:16384
  ds_read_b64_tr_b16 a[18:19], v6 offset:16640
  ds_read_b64_tr_b16 a[20:21], v6 offset:20480
  ds_read_b64_tr_b16 a[22:23], v6 offset:20736
  s_waitcnt lgkmcnt(0)
  v_mfma_f32_32x32x16_bf16 v[64:79], a[0:3], a[24:27], 0
  ds_read_b128 a[56:59], v3 offset:0
  ds_read_b64_tr_b16 a[32:33], v6 offset:1024
  ds_read_b64_tr_b16 a[34:35], v6 offset:1280
  v_mfma_f32_32x32x16_bf16 v[80:95], a[4:7], a[24:27], 0
  ds_read_b64_tr_b16 a[36:37], v6 offset:5120
  ds_read_b64_tr_b16 a[38:39], v6 offset:5376
  ds_read_b64_tr_b16 a[40:41], v6 offset:9216
  v_mfma_f32_32x32x16_bf16 v[96:111], a[8:11], a[24:27], 0
  ds_read_b64_tr_b16 a[42:43], v6 offset:9472
  ds_read_b64_tr_b16 a[44:45], v6 offset:13312
  ds_read_b64_tr_b16 a[46:47], v6 offset:13568
  v_mfma_f32_32x32x16_bf16 v[112:127], a[12:15], a[24:27], 0
  ds_read_b64_tr_b16 a[48:49], v6 offset:17408
  ds_read_b64_tr_b16 a[50:51], v6 offset:17664
  ds_read_b64_tr_b16 a[52:53], v6 offset:21504
  v_mfma_f32_32x32x16_bf16 v[128:143], a[16:19], a[24:27], 0
  ds_read_b64_tr_b16 a[54:55], v6 offset:21760
  v_mfma_f32_32x32x16_bf16 v[144:159], a[20:23], a[24:27], 0
  s_waitcnt lgkmcnt(0)
  v_mfma_f32_32x32x16_bf16 v[64:79], a[32:35], a[56:59], v[64:79]
  ds_read_b128 a[24:27], v4 offset:0
  ds_read_b64_tr_b16 a[0:1], v6 offset:2048
  ds_read_b64_tr_b16 a[2:3], v6 offset:2304
  v_mfma_f32_32x32x16_bf16 v[80:95], a[36:39], a[56:59], v[80:95]
  ds_read_b64_tr_b16 a[4:5], v6 offset:6144
  ds_read_b64_tr_b16 a[6:7], v6 offset:6400
  ds_read_b64_tr_b16 a[8:9], v6 offset:10240
  v_mfma_f32_32x32x16_bf16 v[96:111], a[40:43], a[56:59], v[96:111]
  ds_read_b64_tr_b16 a[10:11], v6 offset:10496
  ds_read_b64_tr_b16 a[12:13], v6 offset:14336
  ds_read_b64_tr_b16 a[14:15], v6 offset:14592
  v_mfma_f32_32x32x16_bf16 v[112:127], a[44:47], a[56:59], v[112:127]
  ds_read_b64_tr_b16 a[16:17], v6 offset:18432
  ds_read_b64_tr_b16 a[18:19], v6 offset:18688
  ds_read_b64_tr_b16 a[20:21], v6 offset:22528
  v_mfma_f32_32x32x16_bf16 v[128:143], a[48:51], a[56:59], v[128:143]
  ds_read_b64_tr_b16 a[22:23], v6 offset:22784
  v_mfma_f32_32x32x16_bf16 v[144:159], a[52:55], a[56:59], v[144:159]
  s_waitcnt lgkmcnt(0)
  v_mfma_f32_32x32x16_bf16 v[64:79], a[0:3], a[24:27], v[64:79]
  ds_read_b128 a[56:59], v5 offset:0
  ds_read_b64_tr_b16 a[32:33], v6 offset:3072
  ds_read_b64_tr_b16 a[34:35], v6 offset:3328
  v_mfma_f32_32x32x16_bf16 v[80:95], a[4:7], a[24:27], v[80:95]
  ds_read_b64_tr_b16 a[36:37], v6 offset:7168
  ds_read_b64_tr_b16 a[38:39], v6 offset:7424
  ds_read_b64_tr_b16 a[40:41], v6 offset:11264
  v_mfma_f32_32x32x16_bf16 v[96:111], a[8:11], a[24:27], v[96:111]
  ds_read_b64_tr_b16 a[42:43], v6 offset:11520
  ds_read_b64_tr_b16 a[44:45], v6 offset:15360
  ds_read_b64_tr_b16 a[46:47], v6 offset:15616
  v_mfma_f32_32x32x16_bf16 v[112:127], a[12:15], a[24:27], v[112:127]
  ds_read_b64_tr_b16 a[48:49], v6 offset:19456
  ds_read_b64_tr_b16 a[50:51], v6 offset:19712
  ds_read_b64_tr_b16 a[52:53], v6 offset:23552
  s_add_u32 s83, s81, s52
  s_add_u32 s83, s83, 65536
  v_mfma_f32_32x32x16_bf16 v[128:143], a[16:19], a[24:27], v[128:143]
  ds_read_b64_tr_b16 a[54:55], v6 offset:23808
  s_add_u32 s81, s81, 24576
  s_cmp_eq_u32 s81, 73728
  s_cselect_b32 s81, 0, s81
  v_mfma_f32_32x32x16_bf16 v[144:159], a[20:23], a[24:27], v[144:159]
  v_add_u32 v30, s81, v31
  s_waitcnt lgkmcnt(0)
  v_mfma_f32_32x32x16_bf16 v[64:79], a[32:35], a[56:59], v[64:79]
  v_mfma_f32_32x32x16_bf16 v[80:95], a[36:39], a[56:59], v[80:95]
  s_waitcnt vmcnt(6)
  s_barrier
  v_mov_b32 v7, v30
  s_mov_b32 s82, s83
  ds_read_b128 a[24:27], v2 offset:32768
  ds_read_b64_tr_b16 a[0:1], v7 offset:0
  ds_read_b64_tr_b16 a[2:3], v7 offset:256
  s_add_u32 m0, s50, 0
  s_add_u32 s55, s49, 0
  buffer_load_dwordx4 v10, s[32:35], s55 offen  lds
  v_mfma_f32_32x32x16_bf16 v[96:111], a[40:43], a[56:59], v[96:111]
  ds_read_b64_tr_b16 a[4:5], v7 offset:4096
  ds_read_b64_tr_b16 a[6:7], v7 offset:4352
  ds_read_b64_tr_b16 a[8:9], v7 offset:8192
  s_add_u32 m0, s50, 1024
  s_add_u32 s55, s49, 10240
  buffer_load_dwordx4 v11, s[32:35], s55 offen  lds
  v_mfma_f32_32x32x16_bf16 v[112:127], a[44:47], a[56:59], v[112:127]
  ds_read_b64_tr_b16 a[10:11], v7 offset:8448
  ds_read_b64_tr_b16 a[12:13], v7 offset:12288
  ds_read_b64_tr_b16 a[14:15], v7 offset:12544
  s_add_u32 m0, s50, 2048
  s_add_u32 s55, s49, 20480
  buffer_load_dwordx4 v10, s[32:35], s55 offen  lds
  v_mfma_f32_32x32x16_bf16 v[128:143], a[48:51], a[56:59], v[128:143]
  ds_read_b64_tr_b16 a[16:17], v7 offset:16384
  ds_read_b64_tr_b16 a[18:19], v7 offset:16640
  ds_read_b64_tr_b16 a[20:21], v7 offset:20480
  s_add_u32 m0, s50, 3072
  s_add_u32 s55, s49, 30720
  buffer_load_dwordx4 v11, s[32:35], s55 offen  lds
  s_add_u32 s49, s49, 128
  v_mfma_f32_32x32x16_bf16 v[144:159], a[52:55], a[56:59], v[144:159]
  ds_read_b64_tr_b16 a[22:23], v7 offset:20736
  s_waitcnt lgkmcnt(0)
  v_mfma_f32_32x32x16_bf16 v[64:79], a[0:3], a[24:27], v[64:79]
  ds_read_b128 a[56:59], v3 offset:32768
  ds_read_b64_tr_b16 a[32:33], v7 offset:1024
  ds_read_b64_tr_b16 a[34:35], v7 offset:1280
  s_add_u32 m0, s82, 0
  s_add_u32 s55, s51, 0
  buffer_load_dwordx4 v12, s[36:39], s55 offen  lds
  v_mfma_f32_32x32x16_bf16 v[80:95], a[4:7], a[24:27], v[80:95]
  ds_read_b64_tr_b16 a[36:37], v7 offset:5120
  ds_read_b64_tr_b16 a[38:39], v7 offset:5376
  ds_read_b64_tr_b16 a[40:41], v7 offset:9216
  s_add_u32 m0, s82, 4096
  s_add_u32 s55, s51, 64
  buffer_load_dwordx4 v12, s[36:39], s55 offen  lds
  v_mfma_f32_32x32x16_bf16 v[96:111], a[8:11], a[24:27], v[96:111]
  ds_read_b64_tr_b16 a[42:43], v7 offset:9472
  ds_read_b64_tr_b16 a[44:45], v7 offset:13312
  ds_read_b64_tr_b16 a[46:47], v7 offset:13568
  s_add_u32 m0, s82, 8192
  s_add_u32 s55, s51, 128
  buffer_load_dwordx4 v12, s[36:39], s55 offen  lds
  v_mfma_f32_32x32x16_bf16 v[112:127], a[12:15], a[24:27], v[112:127]
  ds_read_b64_tr_b16 a[48:49], v7 offset:17408
  ds_read_b64_tr_b16 a[50:51], v7 offset:17664
  ds_read_b64_tr_b16 a[52:53], v7 offset:21504
  s_add_u32 m0, s82, 12288
  s_add_u32 s55, s51, 192
  buffer_load_dwordx4 v12, s[36:39], s55 offen  lds
  v_mfma_f32_32x32x16_bf16 v[128:143], a[16:19], a[24:27], v[128:143]
  ds_read_b64_tr_b16 a[54:55], v7 offset:21760
  s_add_u32 m0, s82, 16384
  s_add_u32 s55, s51, 256
  buffer_load_dwordx4 v12, s[36:39], s55 offen  lds
  v_mfma_f32_32x32x16_bf16 v[144:159], a[20:23], a[24:27], v[144:159]
  s_waitcnt lgkmcnt(0)
  v_mfma_f32_32x32x16_bf16 v[64:79], a[32:35], a[56:59], v[64:79]
  ds_read_b128 a[24:27], v4 offset:32768
  ds_read_b64_tr_b16 a[0:1], v7 offset:2048
  ds_read_b64_tr_b16 a[2:3], v7 offset:2304
  v_mfma_f32_32x32x16_bf16 v[80:95], a[36:39], a[56:59], v[80:95]
  ds_read_b64_tr_b16 a[4:5], v7 offset:6144
  ds_read_b64_tr_b16 a[6:7], v7 offset:6400
  ds_read_b64_tr_b16 a[8:9], v7 offset:10240
  v_mfma_f32_32x32x16_bf16 v[96:111], a[40:43], a[56:59], v[96:111]
  ds_read_b64_tr_b16 a[10:11], v7 offset:10496
  ds_read_b64_tr_b16 a[12:13], v7 offset:14336
  ds_read_b64_tr_b16 a[14:15], v7 offset:14592
  v_mfma_f32_32x32x16_bf16 v[112:127], a[44:47], a[56:59], v[112:127]
  ds_read_b64_tr_b16 a[16:17], v7 offset:18432
  ds_read_b64_tr_b16 a[18:19], v7 offset:18688
  ds_read_b64_tr_b16 a[20:21], v7 offset:22528
  v_mfma_f32_32x32x16_bf16 v[128:143], a[48:51], a[56:59], v[128:143]
  ds_read_b64_tr_b16 a[22:23], v7 offset:22784
  s_add_u32 m0, s82, 20480
  s_add_u32 s55, s51, 320
  buffer_load_dwordx4 v12, s[36:39], s55 offen  lds
  s_add_u32 s51, s51, s54
  v_mfma_f32_32x32x16_bf16 v[144:159], a[52:55], a[56:59], v[144:159]
  s_waitcnt lgkmcnt(0)
  v_mfma_f32_32x32x16_bf16 v[64:79], a[0:3], a[24:27], v[64:79]
  ds_read_b128 a[56:59], v5 offset:32768
  ds_read_b64_tr_b16 a[32:33], v7 offset:3072
  ds_read_b64_tr_b16 a[34:35], v7 offset:3328
  v_mfma_f32_32x32x16_bf16 v[80:95], a[4:7], a[24:27], v[80:95]
  ds_read_b64_tr_b16 a[36:37], v7 offset:7168
  ds_read_b64_tr_b16 a[38:39], v7 offset:7424
  ds_read_b64_tr_b16 a[40:41], v7 offset:11264
  v_mfma_f32_32x32x16_bf16 v[96:111], a[8:11], a[24:27], v[96:111]
  ds_read_b64_tr_b16 a[42:43], v7 offset:11520
  ds_read_b64_tr_b16 a[44:45], v7 offset:15360
  ds_read_b64_tr_b16 a[46:47], v7 offset:15616
  v_mfma_f32_32x32x16_bf16 v[112:127], a[12:15], a[24:27], v[112:127]
  ds_read_b64_tr_b16 a[48:49], v7 offset:19456
  ds_read_b64_tr_b16 a[50:51], v7 offset:19712
  ds_read_b64_tr_b16 a[52:53], v7 offset:23552
  s_add_u32 s83, s81, s52
  s_add_u32 s83, s83, 65536
  v_mfma_f32_32x32x16_bf16 v[128:143], a[16:19], a[24:27], v[128:143]
  ds_read_b64_tr_b16 a[54:55], v7 offset:23808
  s_add_u32 s81, s81, 24576
  s_cmp_eq_u32 s81, 73728
  s_cselect_b32 s81, 0, s81
  v_mfma_f32_32x32x16_bf16 v[144:159], a[20:23], a[24:27], v[144:159]
  v_add_u32 v30, s81, v31
  s_waitcnt lgkmcnt(0)
  v_mfma_f32_32x32x16_bf16 v[64:79], a[32:35], a[56:59], v[64:79]
  v_mfma_f32_32x32x16_bf16 v[80:95], a[36:39], a[56:59], v[80:95]
  s_waitcnt vmcnt(6)
  s_barrier
  v_mov_b32 v6, v30
  s_mov_b32 s82, s83
  ds_read_b128 a[24:27], v2 offset:0
  ds_read_b64_tr_b16 a[0:1], v6 offset:0
  ds_read_b64_tr_b16 a[2:3], v6 offset:256
  s_add_u32 m0, s50, 32768
  s_add_u32 s55, s49, 0
  buffer_load_dwordx4 v10, s[32:35], s55 offen  lds
  v_mfma_f32_32x32x16_bf16 v[96:111], a[40:43], a[56:59], v[96:111]
  ds_read_b64_tr_b16 a[4:5], v6 offset:4096
  ds_read_b64_tr_b16 a[6:7], v6 offset:4352
  ds_read_b64_tr_b16 a[8:9], v6 offset:8192
  s_add_u32 m0, s50, 33792
  s_add_u32 s55, s49, 10240
  buffer_load_dwordx4 v11, s[32:35], s55 offen  lds
  v_mfma_f32_32x32x16_bf16 v[112:127], a[44:47], a[56:59], v[112:127]
  ds_read_b64_tr_b16 a[10:11], v6 offset:8448
  ds_read_b64_tr_b16 a[12:13], v6 offset:12288
  ds_read_b64_tr_b16 a[14:15], v6 offset:12544
  s_add_u32 m0, s50, 34816
  s_add_u32 s55, s49, 20480
  buffer_load_dwordx4 v10, s[32:35], s55 offen  lds
  v_mfma_f32_32x32x16_bf16 v[128:143], a[48:51], a[56:59], v[128:143]
  ds_read_b64_tr_b16 a[16:17], v6 offset:16384
  ds_read_b64_tr_b16 a[18:19], v6 offset:16640
  ds_read_b64_tr_b16 a[20:21], v6 offset:20480
  s_add_u32 m0, s50, 35840
  s_add_u32 s55, s49, 30720
  buffer_load_dwordx4 v11, s[32:35], s55 offen  lds
  s_add_u32 s49, s49, 128
  v_mfma_f32_32x32x16_bf16 v[144:159], a[52:55], a[56:59], v[144:159]
  ds_read_b64_tr_b16 a[22:23], v6 offset:20736
  s_mov_b32 s80, 0
PL_147:
  s_waitcnt lgkmcnt(0)
  v_mfma_f32_32x32x16_bf16 v[64:79], a[0:3], a[24:27], v[64:79]
  ds_read_b128 a[56:59], v3 offset:0
  ds_read_b64_tr_b16 a[32:33], v6 offset:1024
  ds_read_b64_tr_b16 a[34:35], v6 offset:1280
  s_add_u32 m0, s82, 0
  s_add_u32 s55, s51, 0
  buffer_load_dwordx4 v12, s[36:39], s55 offen  lds
  v_mfma_f32_32x32x16_bf16 v[80:95], a[4:7], a[24:27], v[80:95]
  ds_read_b64_tr_b16 a[36:37], v6 offset:5120
  ds_read_b64_tr_b16 a[38:39], v6 offset:5376
  ds_read_b64_tr_b16 a[40:41], v6 offset:9216
  s_add_u32 m0, s82, 4096
  s_add_u32 s55, s51, 64
  buffer_load_dwordx4 v12, s[36:39], s55 offen  lds
  v_mfma_f32_32x32x16_bf16 v[96:111], a[8:11], a[24:27], v[96:111]
  ds_read_b64_tr_b16 a[42:43], v6 offset:9472
  ds_read_b64_tr_b16 a[44:45], v6 offset:13312
  ds_read_b64_tr_b16 a[46:47], v6 offset:13568
  s_add_u32 m0, s82, 8192
  s_add_u32 s55, s51, 128
  buffer_load_dwordx4 v12, s[36:39], s55 offen  lds
  v_mfma_f32_32x32x16_bf16 v[112:127], a[12:15], a[24:27], v[112:127]
  ds_read_b64_tr_b16 a[48:49], v6 offset:17408
  ds_read_b64_tr_b16 a[50:51], v6 offset:17664
  ds_read_b64_tr_b16 a[52:53], v6 offset:21504
  s_add_u32 m0, s82, 12288
  s_add_u32 s55, s51, 192
  buffer_load_dwordx4 v12, s[36:39], s55 offen  lds
  v_mfma_f32_32x32x16_bf16 v[128:143], a[16:19], a[24:27], v[128:143]
  ds_read_b64_tr_b16 a[54:55], v6 offset:21760
  s_add_u32 m0, s82, 16384
  s_add_u32 s55, s51, 256
  buffer_load_dwordx4 v12, s[36:39], s55 offen  lds
  v_mfma_f32_32x32x16_bf16 v[144:159], a[20:23], a[24:27], v[144:159]
  s_waitcnt lgkmcnt(0)
  v_mfma_f32_32x32x16_bf16 v[64:79], a[32:35], a[56:59], v[64:79]
  ds_read_b128 a[24:27], v4 offset:0
  ds_read_b64_tr_b16 a[0:1], v6 offset:2048
  ds_read_b64_tr_b16 a[2:3], v6 offset:2304
  v_mfma_f32_32x32x16_bf16 v[80:95], a[36:39], a[56:59], v[80:95]
  ds_read_b64_tr_b16 a[4:5], v6 offset:6144
  ds_read_b64_tr_b16 a[6:7], v6 offset:6400
  ds_read_b64_tr_b16 a[8:9], v6 offset:10240
  v_mfma_f32_32x32x16_bf16 v[96:111], a[40:43], a[56:59], v[96:111]
  ds_read_b64_tr_b16 a[10:11], v6 offset:10496
  ds_read_b64_tr_b16 a[12:13], v6 offset:14336
  ds_read_b64_tr_b16 a[14:15], v6 offset:14592
  v_mfma_f32_32x32x16_bf16 v[112:127], a[44:47], a[56:59], v[112:127]
  ds_read_b64_tr_b16 a[16:17], v6 offset:18432
  ds_read_b64_tr_b16 a[18:19], v6 offset:18688
  ds_read_b64_tr_b16 a[20:21], v6 offset:22528
  v_mfma_f32_32x32x16_bf16 v[128:143], a[48:51], a[56:59], v[128:143]
  ds_read_b64_tr_b16 a[22:23], v6 offset:22784
  s_add_u32 m0, s82, 20480
  s_add_u32 s55, s51, 320
  buffer_load_dwordx4 v12, s[36:39], s55 offen  lds
  s_add_u32 s51, s51, s54
  v_mfma_f32_32x32x16_bf16 v[144:159], a[52:55], a[56:59], v[144:159]
  s_waitcnt lgkmcnt(0)
  v_mfma_f32_32x32x16_bf16 v[64:79], a[0:3], a[24:27], v[64:79]
  ds_read_b128 a[56:59], v5 offset:0
  ds_read_b64_tr_b16 a[32:33], v6 offset:3072
  ds_read_b64_tr_b16 a[34:35], v6 offset:3328
  v_mfma_f32_32x32x16_bf16 v[80:95], a[4:7], a[24:27], v[80:95]
  ds_read_b64_tr_b16 a[36:37], v6 offset:7168
  ds_read_b64_tr_b16 a[38:39], v6 offset:7424
  ds_read_b64_tr_b16 a[40:41], v6 offset:11264
  v_mfma_f32_32x32x16_bf16 v[96:111], a[8:11], a[24:27], v[96:111]
  ds_read_b64_tr_b16 a[42:43], v6 offset:11520
  ds_read_b64_tr_b16 a[44:45], v6 offset:15360
  ds_read_b64_tr_b16 a[46:47], v6 offset:15616
  v_mfma_f32_32x32x16_bf16 v[112:127], a[12:15], a[24:27], v[112:127]
  ds_read_b64_tr_b16 a[48:49], v6 offset:19456
  ds_read_b64_tr_b16 a[50:51], v6 offset:19712
  ds_read_b64_tr_b16 a[52:53], v6 offset:23552
  s_add_u32 s83, s81, s52
  s_add_u32 s83, s83, 65536
  v_mfma_f32_32x32x16_bf16 v[128:143], a[16:19], a[24:27], v[128:143]
  ds_read_b64_tr_b16 a[54:55], v6 offset:23808
  s_add_u32 s81, s81, 24576
  s_cmp_eq_u32 s81, 73728
  s_cselect_b32 s81, 0, s81
  v_mfma_f32_32x32x16_bf16 v[144:159], a[20:23], a[24:27], v[144:159]
  v_add_u32 v30, s81, v31
  s_waitcnt lgkmcnt(0)
  v_mfma_f32_32x32x16_bf16 v[64:79], a[32:35], a[56:59], v[64:79]
  v_mfma_f32_32x32x16_bf16 v[80:95], a[36:39], a[56:59], v[80:95]
  s_waitcnt vmcnt(6)
  s_barrier
  v_mov_b32 v7, v30
  s_mov_b32 s82, s83
  ds_read_b128 a[24:27], v2 offset:32768
  ds_read_b64_tr_b16 a[0:1], v7 offset:0
  ds_read_b64_tr_b16 a[2:3], v7 offset:256
  s_add_u32 m0, s50, 0
  s_add_u32 s55, s49, 0
  buffer_load_dwordx4 v10, s[32:35], s55 offen  lds
  v_mfma_f32_32x32x16_bf16 v[96:111], a[40:43], a[56:59], v[96:111]
  ds_read_b64_tr_b16 a[4:5], v7 offset:4096
  ds_read_b64_tr_b16 a[6:7], v7 offset:4352
  ds_read_b64_tr_b16 a[8:9], v7 offset:8192
  s_add_u32 m0, s50, 1024
  s_add_u32 s55, s49, 10240
  buffer_load_dwordx4 v11, s[32:35], s55 offen  lds
  v_mfma_f32_32x32x16_bf16 v[112:127], a[44:47], a[56:59], v[112:127]
  ds_read_b64_tr_b16 a[10:11], v7 offset:8448
  ds_read_b64_tr_b16 a[12:13], v7 offset:12288
  ds_read_b64_tr_b16 a[14:15], v7 offset:12544
  s_add_u32 m0, s50, 2048
  s_add_u32 s55, s49, 20480
  buffer_load_dwordx4 v10, s[32:35], s55 offen  lds
  v_mfma_f32_32x32x16_bf16 v[128:143], a[48:51], a[56:59], v[128:143]
  ds_read_b64_tr_b16 a[16:17], v7 offset:16384
  ds_read_b64_tr_b16 a[18:19], v7 offset:16640
  ds_read_b64_tr_b16 a[20:21], v7 offset:20480
  s_add_u32 m0, s50, 3072
  s_add_u32 s55, s49, 30720
  buffer_load_dwordx4 v11, s[32:35], s55 offen  lds
  s_add_u32 s49, s49, 128
  v_mfma_f32_32x32x16_bf16 v[144:159], a[52:55], a[56:59], v[144:159]
  ds_read_b64_tr_b16 a[22:23], v7 offset:20736
  s_waitcnt lgkmcnt(0)
  v_mfma_f32_32x32x16_bf16 v[64:79], a[0:3], a[24:27], v[64:79]
  ds_read_b128 a[56:59], v3 offset:32768
  ds_read_b64_tr_b16 a[32:33], v7 offset:1024
  ds_read_b64_tr_b16 a[34:35], v7 offset:1280
  s_add_u32 m0, s82, 0
  s_add_u32 s55, s51, 0
  buffer_load_dwordx4 v12, s[36:39], s55 offen  lds
  v_mfma_f32_32x32x16_bf16 v[80:95], a[4:7], a[24:27], v[80:95]
  ds_read_b64_tr_b16 a[36:37], v7 offset:5120
  ds_read_b64_tr_b16 a[38:39], v7 offset:5376
  ds_read_b64_tr_b16 a[40:41], v7 offset:9216
  s_add_u32 m0, s82, 4096
  s_add_u32 s55, s51, 64
  buffer_load_dwordx4 v12, s[36:39], s55 offen  lds
  v_mfma_f32_32x32x16_bf16 v[96:111], a[8:11], a[24:27], v[96:111]
  ds_read_b64_tr_b16 a[42:43], v7 offset:9472
  ds_read_b64_tr_b16 a[44:45], v7 offset:13312
  ds_read_b64_tr_b16 a[46:47], v7 offset:13568
  s_add_u32 m0, s82, 8192
  s_add_u32 s55, s51, 128
  buffer_load_dwordx4 v12, s[36:39], s55 offen  lds
  v_mfma_f32_32x32x16_bf16 v[112:127], a[12:15], a[24:27], v[112:127]
  ds_read_b64_tr_b16 a[48:49], v7 offset:17408
  ds_read_b64_tr_b16 a[50:51], v7 offset:17664
  ds_read_b64_tr_b16 a[52:53], v7 offset:21504
  s_add_u32 m0, s82, 12288
  s_add_u32 s55, s51, 192
  buffer_load_dwordx4 v12, s[36:39], s55 offen  lds
  v_mfma_f32_32x32x16_bf16 v[128:143], a[16:19], a[24:27], v[128:143]
  ds_read_b64_tr_b16 a[54:55], v7 offset:21760
  s_add_u32 m0, s82, 16384
  s_add_u32 s55, s51, 256
  buffer_load_dwordx4 v12, s[36:39], s55 offen  lds
  v_mfma_f32_32x32x16_bf16 v[144:159], a[20:23], a[24:27], v[144:159]
  s_waitcnt lgkmcnt(0)
  v_mfma_f32_32x32x16_bf16 v[64:79], a[32:35], a[56:59], v[64:79]
  ds_read_b128 a[24:27], v4 offset:32768
  ds_read_b64_tr_b16 a[0:1], v7 offset:2048
  ds_read_b64_tr_b16 a[2:3], v7 offset:2304
  v_mfma_f32_32x32x16_bf16 v[80:95], a[36:39], a[56:59], v[80:95]
  ds_read_b64_tr_b16 a[4:5], v7 offset:6144
  ds_read_b64_tr_b16 a[6:7], v7 offset:6400
  ds_read_b64_tr_b16 a[8:9], v7 offset:10240
  v_mfma_f32_32x32x16_bf16 v[96:111], a[40:43], a[56:59], v[96:111]
  ds_read_b64_tr_b16 a[10:11], v7 offset:10496
  ds_read_b64_tr_b16 a[12:13], v7 offset:14336
  ds_read_b64_tr_b16 a[14:15], v7 offset:14592
  v_mfma_f32_32x32x16_bf16 v[112:127], a[44:47], a[56:59], v[112:127]
  ds_read_b64_tr_b16 a[16:17], v7 offset:18432
  ds_read_b64_tr_b16 a[18:19], v7 offset:18688
  ds_read_b64_tr_b16 a[20:21], v7 offset:22528
  v_mfma_f32_32x32x16_bf16 v[128:143], a[48:51], a[56:59], v[128:143]
  ds_read_b64_tr_b16 a[22:23], v7 offset:22784
  s_add_u32 m0, s82, 20480
  s_add_u32 s55, s51, 320
  buffer_load_dwordx4 v12, s[36:39], s55 offen  lds
  s_add_u32 s51, s51, s54
  v_mfma_f32_32x32x16_bf16 v[144:159], a[52:55], a[56:59], v[144:159]
  s_waitcnt lgkmcnt(0)
  v_mfma_f32_32x32x16_bf16 v[64:79], a[0:3], a[24:27], v[64:79]
  ds_read_b128 a[56:59], v5 offset:32768
  ds_read_b64_tr_b16 a[32:33], v7 offset:3072
  ds_read_b64_tr_b16 a[34:35], v7 offset:3328
  v_mfma_f32_32x32x16_bf16 v[80:95], a[4:7], a[24:27], v[80:95]
  ds_read_b64_tr_b16 a[36:37], v7 offset:7168
  ds_read_b64_tr_b16 a[38:39], v7 offset:7424
  ds_read_b64_tr_b16 a[40:41], v7 offset:11264
  v_mfma_f32_32x32x16_bf16 v[96:111], a[8:11], a[24:27], v[96:111]
  ds_read_b64_tr_b16 a[42:43], v7 offset:11520
  ds_read_b64_tr_b16 a[44:45], v7 offset:15360
  ds_read_b64_tr_b16 a[46:47], v7 offset:15616
  v_mfma_f32_32x32x16_bf16 v[112:127], a[12:15], a[24:27], v[112:127]
  ds_read_b64_tr_b16 a[48:49], v7 offset:19456
  ds_read_b64_tr_b16 a[50:51], v7 offset:19712
  ds_read_b64_tr_b16 a[52:53], v7 offset:23552
  s_add_u32 s83, s81, s52
  s_add_u32 s83, s83, 65536
  v_mfma_f32_32x32x16_bf16 v[128:143], a[16:19], a[24:27], v[128:143]
  ds_read_b64_tr_b16 a[54:55], v7 offset:23808
  s_add_u32 s81, s81, 24576
  s_cmp_eq_u32 s81, 73728
  s_cselect_b32 s81, 0, s81
  v_mfma_f32_32x32x16_bf16 v[144:159], a[20:23], a[24:27], v[144:159]
  v_add_u32 v30, s81, v31
  s_waitcnt lgkmcnt(0)
  v_mfma_f32_32x32x16_bf16 v[64:79], a[32:35], a[56:59], v[64:79]
  v_mfma_f32_32x32x16_bf16 v[80:95], a[36:39], a[56:59], v[80:95]
  s_waitcnt vmcnt(6)
  s_barrier
  v_mov_b32 v6, v30
  s_mov_b32 s82, s83
  ds_read_b128 a[24:27], v2 offset:0
  ds_read_b64_tr_b16 a[0:1], v6 offset:0
  ds_read_b64_tr_b16 a[2:3], v6 offset:256
  s_add_u32 m0, s50, 32768
  s_add_u32 s55, s49, 0
  buffer_load_dwordx4 v10, s[32:35], s55 offen  lds
  v_mfma_f32_32x32x16_bf16 v[96:111], a[40:43], a[56:59], v[96:111]
  ds_read_b64_tr_b16 a[4:5], v6 offset:4096
  ds_read_b64_tr_b16 a[6:7], v6 offset:4352
  ds_read_b64_tr_b16 a[8:9], v6 offset:8192
  s_add_u32 m0, s50, 33792
  s_add_u32 s55, s49, 10240
  buffer_load_dwordx4 v11, s[32:35], s55 offen  lds
  v_mfma_f32_32x32x16_bf16 v[112:127], a[44:47], a[56:59], v[112:127]
  ds_read_b64_tr_b16 a[10:11], v6 offset:8448
  ds_read_b64_tr_b16 a[12:13], v6 offset:12288
  ds_read_b64_tr_b16 a[14:15], v6 offset:12544
  s_add_u32 m0, s50, 34816
  s_add_u32 s55, s49, 20480
  buffer_load_dwordx4 v10, s[32:35], s55 offen  lds
  v_mfma_f32_32x32x16_bf16 v[128:143], a[48:51], a[56:59], v[128:143]
  ds_read_b64_tr_b16 a[16:17], v6 offset:16384
  ds_read_b64_tr_b16 a[18:19], v6 offset:16640
  ds_read_b64_tr_b16 a[20:21], v6 offset:20480
  s_add_u32 m0, s50, 35840
  s_add_u32 s55, s49, 30720
  buffer_load_dwordx4 v11, s[32:35], s55 offen  lds
  s_add_u32 s49, s49, 128
  v_mfma_f32_32x32x16_bf16 v[144:159], a[52:55], a[56:59], v[144:159]
  ds_read_b64_tr_b16 a[22:23], v6 offset:20736
  s_add_u32 s80, s80, 1
  s_cmp_lt_u32 s80, 3
  s_cbranch_scc1 PL_147
  s_waitcnt lgkmcnt(0)
  v_mfma_f32_32x32x16_bf16 v[64:79], a[0:3], a[24:27], v[64:79]
  ds_read_b128 a[56:59], v3 offset:0
  ds_read_b64_tr_b16 a[32:33], v6 offset:1024
  ds_read_b64_tr_b16 a[34:35], v6 offset:1280
  v_mfma_f32_32x32x16_bf16 v[80:95], a[4:7], a[24:27], v[80:95]
  ds_read_b64_tr_b16 a[36:37], v6 offset:5120
  ds_read_b64_tr_b16 a[38:39], v6 offset:5376
  ds_read_b64_tr_b16 a[40:41], v6 offset:9216
  v_mfma_f32_32x32x16_bf16 v[96:111], a[8:11], a[24:27], v[96:111]
  ds_read_b64_tr_b16 a[42:43], v6 offset:9472
  ds_read_b64_tr_b16 a[44:45], v6 offset:13312
  ds_read_b64_tr_b16 a[46:47], v6 offset:13568
  v_mfma_f32_32x32x16_bf16 v[112:127], a[12:15], a[24:27], v[112:127]
  ds_read_b64_tr_b16 a[48:49], v6 offset:17408
  ds_read_b64_tr_b16 a[50:51], v6 offset:17664
  ds_read_b64_tr_b16 a[52:53], v6 offset:21504
  v_mfma_f32_32x32x16_bf16 v[128:143], a[16:19], a[24:27], v[128:143]
  ds_read_b64_tr_b16 a[54:55], v6 offset:21760
  v_mfma_f32_32x32x16_bf16 v[144:159], a[20:23], a[24:27], v[144:159]
  s_waitcnt lgkmcnt(0)
  v_mfma_f32_32x32x16_bf16 v[64:79], a[32:35], a[56:59], v[64:79]
  ds_read_b128 a[24:27], v4 offset:0
  ds_read_b64_tr_b16 a[0:1], v6 offset:2048
  ds_read_b64_tr_b16 a[2:3], v6 offset:2304
  v_mfma_f32_32x32x16_bf16 v[80:95], a[36:39], a[56:59], v[80:95]
  ds_read_b64_tr_b16 a[4:5], v6 offset:6144
  ds_read_b64_tr_b16 a[6:7], v6 offset:6400
  ds_read_b64_tr_b16 a[8:9], v6 offset:10240
  v_mfma_f32_32x32x16_bf16 v[96:111], a[40:43], a[56:59], v[96:111]
  ds_read_b64_tr_b16 a[10:11], v6 offset:10496
  ds_read_b64_tr_b16 a[12:13], v6 offset:14336
  ds_read_b64_tr_b16 a[14:15], v6 offset:14592
  v_mfma_f32_32x32x16_bf16 v[112:127], a[44:47], a[56:59], v[112:127]
  ds_read_b64_tr_b16 a[16:17], v6 offset:18432
  ds_read_b64_tr_b16 a[18:19], v6 offset:18688
  ds_read_b64_tr_b16 a[20:21], v6 offset:22528
  v_mfma_f32_32x32x16_bf16 v[128:143], a[48:51], a[56:59], v[128:143]
  ds_read_b64_tr_b16 a[22:23], v6 offset:22784
  v_mfma_f32_32x32x16_bf16 v[144:159], a[52:55], a[56:59], v[144:159]
  s_cmp_eq_u32 s67, 2
  s_cbranch_scc0 CW_148
  s_add_u32 m0, s78, 90112
  s_add_u32 s55, s75, 0
  buffer_load_dwordx4 v15, s[44:47], s55 offen lds
  s_add_u32 m0, s78, 91136
  s_add_u32 s55, s75, 20480
  buffer_load_dwordx4 v15, s[44:47], s55 offen lds
  s_add_u32 m0, s78, 92160
  s_add_u32 s55, s75, 40960
  buffer_load_dwordx4 v15, s[44:47], s55 offen lds
  s_add_u32 m0, s78, 102400
  s_add_u32 s55, s75, 64
  buffer_load_dwordx4 v15, s[44:47], s55 offen lds
  s_add_u32 m0, s78, 103424
  s_add_u32 s55, s75, 20544
  buffer_load_dwordx4 v15, s[44:47], s55 offen lds
  s_add_u32 m0, s78, 104448
  s_add_u32 s55, s75, 41024
  buffer_load_dwordx4 v15, s[44:47], s55 offen lds
  s_add_u32 s75, s75, 128
CW_148:
  s_waitcnt lgkmcnt(0)
  v_mfma_f32_32x32x16_bf16 v[64:79], a[0:3], a[24:27], v[64:79]
  ds_read_b128 a[56:59], v5 offset:0
  ds_read_b64_tr_b16 a[32:33], v6 offset:3072
  ds_read_b64_tr_b16 a[34:35], v6 offset:3328
  v_mfma_f32_32x32x16_bf16 v[80:95], a[4:7], a[24:27], v[80:95]
  ds_read_b64_tr_b16 a[36:37], v6 offset:7168
  ds_read_b64_tr_b16 a[38:39], v6 offset:7424
  ds_read_b64_tr_b16 a[40:41], v6 offset:11264
  v_mfma_f32_32x32x16_bf16 v[96:111], a[8:11], a[24:27], v[96:111]
  ds_read_b64_tr_b16 a[42:43], v6 offset:11520
  ds_read_b64_tr_b16 a[44:45], v6 offset:15360
  ds_read_b64_tr_b16 a[46:47], v6 offset:15616
  v_mfma_f32_32x32x16_bf16 v[112:127], a[12:15], a[24:27], v[112:127]
  ds_read_b64_tr_b16 a[48:49], v6 offset:19456
  ds_read_b64_tr_b16 a[50:51], v6 offset:19712
  ds_read_b64_tr_b16 a[52:53], v6 offset:23552
  s_add_u32 s83, s81, s52
  s_add_u32 s83, s83, 65536
  v_mfma_f32_32x32x16_bf16 v[128:143], a[16:19], a[24:27], v[128:143]
  ds_read_b64_tr_b16 a[54:55], v6 offset:23808
  s_add_u32 s81, s81, 24576
  s_cmp_eq_u32 s81, 73728
  s_cselect_b32 s81, 0, s81
  v_mfma_f32_32x32x16_bf16 v[144:159], a[20:23], a[24:27], v[144:159]
  v_add_u32 v30, s81, v31
  s_waitcnt lgkmcnt(0)
  v_mfma_f32_32x32x16_bf16 v[64:79], a[32:35], a[56:59], v[64:79]
  v_mfma_f32_32x32x16_bf16 v[80:95], a[36:39], a[56:59], v[80:95]
  s_cmp_eq_u32 s67, 2
  s_cbranch_scc1 V8_149
  s_waitcnt vmcnt(0)
  s_branch V9_150
V8_149:
  s_waitcnt vmcnt(6)
V9_150:
  s_barrier
  v_mov_b32 v7, v30
  s_mov_b32 s82, s83
  ds_read_b128 a[24:27], v2 offset:32768
  ds_read_b64_tr_b16 a[0:1], v7 offset:0
  ds_read_b64_tr_b16 a[2:3], v7 offset:256
  v_mfma_f32_32x32x16_bf16 v[96:111], a[40:43], a[56:59], v[96:111]
  ds_read_b64_tr_b16 a[4:5], v7 offset:4096
  ds_read_b64_tr_b16 a[6:7], v7 offset:4352
  ds_read_b64_tr_b16 a[8:9], v7 offset:8192
  v_mfma_f32_32x32x16_bf16 v[112:127], a[44:47], a[56:59], v[112:127]
  ds_read_b64_tr_b16 a[10:11], v7 offset:8448
  ds_read_b64_tr_b16 a[12:13], v7 offset:12288
  ds_read_b64_tr_b16 a[14:15], v7 offset:12544
  v_mfma_f32_32x32x16_bf16 v[128:143], a[48:51], a[56:59], v[128:143]
  ds_read_b64_tr_b16 a[16:17], v7 offset:16384
  ds_read_b64_tr_b16 a[18:19], v7 offset:16640
  ds_read_b64_tr_b16 a[20:21], v7 offset:20480
  v_mfma_f32_32x32x16_bf16 v[144:159], a[52:55], a[56:59], v[144:159]
  ds_read_b64_tr_b16 a[22:23], v7 offset:20736
  s_cmp_eq_u32 s67, 2
  s_cbranch_scc0 CW_151
  s_add_u32 m0, s78, 114688
  s_add_u32 s55, s75, 0
  buffer_load_dwordx4 v15, s[44:47], s55 offen lds
  s_add_u32 m0, s78, 115712
  s_add_u32 s55, s75, 20480
  buffer_load_dwordx4 v15, s[44:47], s55 offen lds
  s_add_u32 m0, s78, 116736
  s_add_u32 s55, s75, 40960
  buffer_load_dwordx4 v15, s[44:47], s55 offen lds
  s_add_u32 m0, s78, 126976
  s_add_u32 s55, s75, 64
  buffer_load_dwordx4 v15, s[44:47], s55 offen lds
  s_add_u32 m0, s78, 128000
  s_add_u32 s55, s75, 20544
  buffer_load_dwordx4 v15, s[44:47], s55 offen lds
  s_add_u32 m0, s78, 129024
  s_add_u32 s55, s75, 41024
  buffer_load_dwordx4 v15, s[44:47], s55 offen lds
  s_add_u32 s75, s75, 128
CW_151:
  s_waitcnt lgkmcnt(0)
  v_mfma_f32_32x32x16_bf16 v[64:79], a[0:3], a[24:27], v[64:79]
  ds_read_b128 a[56:59], v3 offset:32768
  ds_read_b64_tr_b16 a[32:33], v7 offset:1024
  ds_read_b64_tr_b16 a[34:35], v7 offset:1280
  v_mfma_f32_32x32x16_bf16 v[80:95], a[4:7], a[24:27], v[80:95]
  ds_read_b64_tr_b16 a[36:37], v7 offset:5120
  ds_read_b64_tr_b16 a[38:39], v7 offset:5376
  ds_read_b64_tr_b16 a[40:41], v7 offset:9216
  v_mfma_f32_32x32x16_bf16 v[96:111], a[8:11], a[24:27], v[96:111]
  ds_read_b64_tr_b16 a[42:43], v7 offset:9472
  ds_read_b64_tr_b16 a[44:45], v7 offset:13312
  ds_read_b64_tr_b16 a[46:47], v7 offset:13568
  v_mfma_f32_32x32x16_bf16 v[112:127], a[12:15], a[24:27], v[112:127]
  ds_read_b64_tr_b16 a[48:49], v7 offset:17408
  ds_read_b64_tr_b16 a[50:51], v7 offset:17664
  ds_read_b64_tr_b16 a[52:53], v7 offset:21504
  v_mfma_f32_32x32x16_bf16 v[128:143], a[16:19], a[24:27], v[128:143]
  ds_read_b64_tr_b16 a[54:55], v7 offset:21760
  v_mfma_f32_32x32x16_bf16 v[144:159], a[20:23], a[24:27], v[144:159]
  s_waitcnt lgkmcnt(0)
  v_mfma_f32_32x32x16_bf16 v[64:79], a[32:35], a[56:59], v[64:79]
  ds_read_b128 a[24:27], v4 offset:32768
  ds_read_b64_tr_b16 a[0:1], v7 offset:2048
  ds_read_b64_tr_b16 a[2:3], v7 offset:2304
  v_mfma_f32_32x32x16_bf16 v[80:95], a[36:39], a[56:59], v[80:95]
  ds_read_b64_tr_b16 a[4:5], v7 offset:6144
  ds_read_b64_tr_b16 a[6:7], v7 offset:6400
  ds_read_b64_tr_b16 a[8:9], v7 offset:10240
  v_mfma_f32_32x32x16_bf16 v[96:111], a[40:43], a[56:59], v[96:111]
  ds_read_b64_tr_b16 a[10:11], v7 offset:10496
  ds_read_b64_tr_b16 a[12:13], v7 offset:14336
  ds_read_b64_tr_b16 a[14:15], v7 offset:14592
  v_mfma_f32_32x32x16_bf16 v[112:127], a[44:47], a[56:59], v[112:127]
  ds_read_b64_tr_b16 a[16:17], v7 offset:18432
  ds_read_b64_tr_b16 a[18:19], v7 offset:18688
  ds_read_b64_tr_b16 a[20:21], v7 offset:22528
  v_mfma_f32_32x32x16_bf16 v[128:143], a[48:51], a[56:59], v[128:143]
  ds_read_b64_tr_b16 a[22:23], v7 offset:22784
  v_mfma_f32_32x32x16_bf16 v[144:159], a[52:55], a[56:59], v[144:159]
  s_waitcnt lgkmcnt(0)
  v_mfma_f32_32x32x16_bf16 v[64:79], a[0:3], a[24:27], v[64:79]
  ds_read_b128 a[56:59], v5 offset:32768
  ds_read_b64_tr_b16 a[32:33], v7 offset:3072
  ds_read_b64_tr_b16 a[34:35], v7 offset:3328
  v_mfma_f32_32x32x16_bf16 v[80:95], a[4:7], a[24:27], v[80:95]
  ds_read_b64_tr_b16 a[36:37], v7 offset:7168
  ds_read_b64_tr_b16 a[38:39], v7 offset:7424
  ds_read_b64_tr_b16 a[40:41], v7 offset:11264
  v_mfma_f32_32x32x16_bf16 v[96:111], a[8:11], a[24:27], v[96:111]
  ds_read_b64_tr_b16 a[42:43], v7 offset:11520
  ds_read_b64_tr_b16 a[44:45], v7 offset:15360
  ds_read_b64_tr_b16 a[46:47], v7 offset:15616
  v_mfma_f32_32x32x16_bf16 v[112:127], a[12:15], a[24:27], v[112:127]
  ds_read_b64_tr_b16 a[48:49], v7 offset:19456
  ds_read_b64_tr_b16 a[50:51], v7 offset:19712
  ds_read_b64_tr_b16 a[52:53], v7 offset:23552
  v_mfma_f32_32x32x16_bf16 v[128:143], a[16:19], a[24:27], v[128:143]
  ds_read_b64_tr_b16 a[54:55], v7 offset:23808
  v_mfma_f32_32x32x16_bf16 v[144:159], a[20:23], a[24:27], v[144:159]
  s_waitcnt lgkmcnt(0)
  v_mfma_f32_32x32x16_bf16 v[64:79], a[32:35], a[56:59], v[64:79]
  v_mfma_f32_32x32x16_bf16 v[80:95], a[36:39], a[56:59], v[80:95]
  v_mfma_f32_32x32x16_bf16 v[96:111], a[40:43], a[56:59], v[96:111]
  v_mfma_f32_32x32x16_bf16 v[112:127], a[44:47], a[56:59], v[112:127]
  v_mfma_f32_32x32x16_bf16 v[128:143], a[48:51], a[56:59], v[128:143]
  v_mfma_f32_32x32x16_bf16 v[144:159], a[52:55], a[56:59], v[144:159]
  s_cmp_eq_u32 s67, 2
  s_cbranch_scc1 W1_VC
  s_nop 7
  s_nop 7
  v_cvt_pk_bf16_f32 v16, v64, v65
  v_cvt_pk_bf16_f32 v17, v66, v67
  v_cvt_pk_bf16_f32 v18, v68, v69
  v_cvt_pk_bf16_f32 v19, v70, v71
  v_cvt_pk_bf16_f32 v20, v72, v73
  v_cvt_pk_bf16_f32 v21, v74, v75
  v_cvt_pk_bf16_f32 v22, v76, v77
  v_cvt_pk_bf16_f32 v23, v78, v79
  s_add_u32 s55, s56, 0
  buffer_store_dwordx4 v[16:19], v13, s[40:43], s55 offen sc1
  s_add_u32 s55, s56, 65536
  buffer_store_dwordx4 v[20:23], v13, s[40:43], s55 offen sc1
  v_cvt_pk_bf16_f32 v24, v80, v81
  v_cvt_pk_bf16_f32 v25, v82, v83
  v_cvt_pk_bf16_f32 v26, v84, v85
  v_cvt_pk_bf16_f32 v27, v86, v87
  v_cvt_pk_bf16_f32 v28, v88, v89
  v_cvt_pk_bf16_f32 v29, v90, v91
  v_cvt_pk_bf16_f32 v30, v92, v93
  v_cvt_pk_bf16_f32 v31, v94, v95
  s_add_u32 s55, s56, 131072
  buffer_store_dwordx4 v[24:27], v13, s[40:43], s55 offen sc1
  s_add_u32 s55, s56, 196608
  buffer_store_dwordx4 v[28:31], v13, s[40:43], s55 offen sc1
  v_cvt_pk_bf16_f32 v16, v96, v97
  v_cvt_pk_bf16_f32 v17, v98, v99
  v_cvt_pk_bf16_f32 v18, v100, v101
  v_cvt_pk_bf16_f32 v19, v102, v103
  v_cvt_pk_bf16_f32 v20, v104, v105
  v_cvt_pk_bf16_f32 v21, v106, v107
  v_cvt_pk_bf16_f32 v22, v108, v109
  v_cvt_pk_bf16_f32 v23, v110, v111
  s_add_u32 s55, s56, 262144
  buffer_store_dwordx4 v[16:19], v13, s[40:43], s55 offen sc1
  s_add_u32 s55, s56, 327680
  buffer_store_dwordx4 v[20:23], v13, s[40:43], s55 offen sc1
  v_cvt_pk_bf16_f32 v24, v112, v113
  v_cvt_pk_bf16_f32 v25, v114, v115
  v_cvt_pk_bf16_f32 v26, v116, v117
  v_cvt_pk_bf16_f32 v27, v118, v119
  v_cvt_pk_bf16_f32 v28, v120, v121
  v_cvt_pk_bf16_f32 v29, v122, v123
  v_cvt_pk_bf16_f32 v30, v124, v125
  v_cvt_pk_bf16_f32 v31, v126, v127
  s_add_u32 s55, s56, 393216
  buffer_store_dwordx4 v[24:27], v13, s[40:43], s55 offen sc1
  s_add_u32 s55, s56, 458752
  buffer_store_dwordx4 v[28:31], v13, s[40:43], s55 offen sc1
  v_cvt_pk_bf16_f32 v16, v128, v129
  v_cvt_pk_bf16_f32 v17, v130, v131
  v_cvt_pk_bf16_f32 v18, v132, v133
  v_cvt_pk_bf16_f32 v19, v134, v135
  v_cvt_pk_bf16_f32 v20, v136, v137
  v_cvt_pk_bf16_f32 v21, v138, v139
  v_cvt_pk_bf16_f32 v22, v140, v141
  v_cvt_pk_bf16_f32 v23, v142, v143
  s_add_u32 s55, s56, 524288
  buffer_store_dwordx4 v[16:19], v13, s[40:43], s55 offen sc1
  s_add_u32 s55, s56, 589824
  buffer_store_dwordx4 v[20:23], v13, s[40:43], s55 offen sc1
  v_cvt_pk_bf16_f32 v24, v144, v145
  v_cvt_pk_bf16_f32 v25, v146, v147
  v_cvt_pk_bf16_f32 v26, v148, v149
  v_cvt_pk_bf16_f32 v27, v150, v151
  v_cvt_pk_bf16_f32 v28, v152, v153
  v_cvt_pk_bf16_f32 v29, v154, v155
  v_cvt_pk_bf16_f32 v30, v156, v157
  v_cvt_pk_bf16_f32 v31, v158, v159
  s_add_u32 s55, s56, 655360
  buffer_store_dwordx4 v[24:27], v13, s[40:43], s55 offen sc1
  s_add_u32 s55, s56, 720896
  buffer_store_dwordx4 v[28:31], v13, s[40:43], s55 offen sc1
  s_lshl_b32 s68, s66, 2
  s_mov_b32 s69, 128
  s_cmp_eq_u32 s67, 0
  s_cselect_b32 s69, 96, s69
  s_add_u32 s68, s68, s69
  s_waitcnt vmcnt(0)
  s_barrier
  s_cmp_eq_u32 s66, 0
  s_cbranch_scc0 H0_152
  s_cmp_eq_u32 s48, 0
  s_cbranch_scc0 H0_152
  s_mov_b32 s95, 172
  v_mov_b32 v1, 1
  s_mov_b64 exec, 1
  buffer_atomic_add v1, off, s[96:99], s95
  s_mov_b64 exec, -1
H0_152:
  s_waitcnt vmcnt(0)
  s_barrier
  s_cmp_eq_u32 s48, 0
  s_cbranch_scc0 SG_153
  s_mov_b32 s95, 96
  v_mov_b32 v1, 1
  s_mov_b64 exec, 1
  buffer_atomic_add v1, off, s[96:99], s95
  s_mov_b64 exec, -1
SG_153:
  s_branch W1_DONE
W1_VC:
  v_lshrrev_b32 v14, 2, v1
  v_mul_u32_u24 v14, 1280, v14
  v_and_b32 v15, 3, v1
  v_lshlrev_b32 v15, 4, v15
  v_add_u32 v15, v15, v14
  v_bfe_u32 v12, v1, 4, 1
  v_lshlrev_b32 v12, 16, v12
  v_and_b32 v14, 15, v1
  v_lshl_add_u32 v12, v14, 5, v12
  v_lshrrev_b32 v14, 5, v1
  v_lshl_add_u32 v12, v14, 4, v12
  s_barrier
  s_add_u32 m0, s78, 65536
  s_add_u32 s55, s75, 0
  buffer_load_dwordx4 v15, s[44:47], s55 offen lds
  s_add_u32 m0, s78, 66560
  s_add_u32 s55, s75, 20480
  buffer_load_dwordx4 v15, s[44:47], s55 offen lds
  s_add_u32 m0, s78, 67584
  s_add_u32 s55, s75, 40960
  buffer_load_dwordx4 v15, s[44:47], s55 offen lds
  s_add_u32 m0, s78, 77824
  s_add_u32 s55, s75, 64
  buffer_load_dwordx4 v15, s[44:47], s55 offen lds
  s_add_u32 m0, s78, 78848
  s_add_u32 s55, s75, 20544
  buffer_load_dwordx4 v15, s[44:47], s55 offen lds
  s_add_u32 m0, s78, 79872
  s_add_u32 s55, s75, 41024
  buffer_load_dwordx4 v15, s[44:47], s55 offen lds
  s_add_u32 s75, s75, 128
  v_mov_b32 v2, v8
  v_add_u32 v8, 24576, v2
  s_mov_b32 s81, 24576
  s_nop 7
  s_nop 7
  v_cvt_pk_bf16_f32 v64, v64, v65
  v_cvt_pk_bf16_f32 v65, v66, v67
  v_cvt_pk_bf16_f32 v66, v68, v69
  v_cvt_pk_bf16_f32 v67, v70, v71
  v_cvt_pk_bf16_f32 v68, v72, v73
  v_cvt_pk_bf16_f32 v69, v74, v75
  v_cvt_pk_bf16_f32 v70, v76, v77
  v_cvt_pk_bf16_f32 v71, v78, v79
  v_cvt_pk_bf16_f32 v72, v80, v81
  v_cvt_pk_bf16_f32 v73, v82, v83
  v_cvt_pk_bf16_f32 v74, v84, v85
  v_cvt_pk_bf16_f32 v75, v86, v87
  v_cvt_pk_bf16_f32 v76, v88, v89
  v_cvt_pk_bf16_f32 v77, v90, v91
  v_cvt_pk_bf16_f32 v78, v92, v93
  v_cvt_pk_bf16_f32 v79, v94, v95
  v_cvt_pk_bf16_f32 v80, v96, v97
  v_cvt_pk_bf16_f32 v81, v98, v99
  v_cvt_pk_bf16_f32 v82, v100, v101
  v_cvt_pk_bf16_f32 v83, v102, v103
  v_cvt_pk_bf16_f32 v84, v104, v105
  v_cvt_pk_bf16_f32 v85, v106, v107
  v_cvt_pk_bf16_f32 v86, v108, v109
  v_cvt_pk_bf16_f32 v87, v110, v111
  v_cvt_pk_bf16_f32 v88, v112, v113
  v_cvt_pk_bf16_f32 v89, v114, v115
  v_cvt_pk_bf16_f32 v90, v116, v117
  v_cvt_pk_bf16_f32 v91, v118, v119
  v_cvt_pk_bf16_f32 v92, v120, v121
  v_cvt_pk_bf16_f32 v93, v122, v123
  v_cvt_pk_bf16_f32 v94, v124, v125
  v_cvt_pk_bf16_f32 v95, v126, v127
  v_cvt_pk_bf16_f32 v96, v128, v129
  v_cvt_pk_bf16_f32 v97, v130, v131
  v_cvt_pk_bf16_f32 v98, v132, v133
  v_cvt_pk_bf16_f32 v99, v134, v135
  v_cvt_pk_bf16_f32 v100, v136, v137
  v_cvt_pk_bf16_f32 v101, v138, v139
  v_cvt_pk_bf16_f32 v102, v140, v141
  v_cvt_pk_bf16_f32 v103, v142, v143
  v_cvt_pk_bf16_f32 v104, v144, v145
  v_cvt_pk_bf16_f32 v105, v146, v147
  v_cvt_pk_bf16_f32 v106, v148, v149
  v_cvt_pk_bf16_f32 v107, v150, v151
  v_cvt_pk_bf16_f32 v108, v152, v153
  v_cvt_pk_bf16_f32 v109, v154, v155
  v_cvt_pk_bf16_f32 v110, v156, v157
  v_cvt_pk_bf16_f32 v111, v158, v159
  s_waitcnt vmcnt(12)
  s_barrier
  ds_read_b64_tr_b16 a[0:1], v8 offset:0
  ds_read_b64_tr_b16 a[2:3], v8 offset:256
  ds_read_b64_tr_b16 a[4:5], v8 offset:12288
  ds_read_b64_tr_b16 a[6:7], v8 offset:12544
  ds_read_b64_tr_b16 a[8:9], v8 offset:1024
  ds_read_b64_tr_b16 a[10:11], v8 offset:1280
  ds_read_b64_tr_b16 a[12:13], v8 offset:13312
  ds_read_b64_tr_b16 a[14:15], v8 offset:13568
  s_waitcnt lgkmcnt(4)
  v_mfma_f32_32x32x16_bf16 v[160:175], v[64:67], a[0:3], 0
  ds_read_b64_tr_b16 a[16:17], v8 offset:2048
  ds_read_b64_tr_b16 a[18:19], v8 offset:2304
  v_mfma_f32_32x32x16_bf16 v[176:191], v[64:67], a[4:7], 0
  ds_read_b64_tr_b16 a[20:21], v8 offset:14336
  ds_read_b64_tr_b16 a[22:23], v8 offset:14592
  s_waitcnt lgkmcnt(4)
  v_mfma_f32_32x32x16_bf16 v[160:175], v[68:71], a[8:11], v[160:175]
  ds_read_b64_tr_b16 a[24:25], v8 offset:3072
  ds_read_b64_tr_b16 a[26:27], v8 offset:3328
  v_mfma_f32_32x32x16_bf16 v[176:191], v[68:71], a[12:15], v[176:191]
  ds_read_b64_tr_b16 a[28:29], v8 offset:15360
  ds_read_b64_tr_b16 a[30:31], v8 offset:15616
  s_waitcnt lgkmcnt(4)
  v_mfma_f32_32x32x16_bf16 v[160:175], v[72:75], a[16:19], v[160:175]
  ds_read_b64_tr_b16 a[32:33], v8 offset:4096
  ds_read_b64_tr_b16 a[34:35], v8 offset:4352
  v_mfma_f32_32x32x16_bf16 v[176:191], v[72:75], a[20:23], v[176:191]
  ds_read_b64_tr_b16 a[36:37], v8 offset:16384
  ds_read_b64_tr_b16 a[38:39], v8 offset:16640
  s_waitcnt lgkmcnt(4)
  v_mfma_f32_32x32x16_bf16 v[160:175], v[76:79], a[24:27], v[160:175]
  ds_read_b64_tr_b16 a[40:41], v8 offset:5120
  ds_read_b64_tr_b16 a[42:43], v8 offset:5376
  v_mfma_f32_32x32x16_bf16 v[176:191], v[76:79], a[28:31], v[176:191]
  ds_read_b64_tr_b16 a[44:45], v8 offset:17408
  ds_read_b64_tr_b16 a[46:47], v8 offset:17664
  s_waitcnt lgkmcnt(4)
  v_mfma_f32_32x32x16_bf16 v[160:175], v[80:83], a[32:35], v[160:175]
  ds_read_b64_tr_b16 a[48:49], v8 offset:6144
  ds_read_b64_tr_b16 a[50:51], v8 offset:6400
  v_mfma_f32_32x32x16_bf16 v[176:191], v[80:83], a[36:39], v[176:191]
  ds_read_b64_tr_b16 a[52:53], v8 offset:18432
  ds_read_b64_tr_b16 a[54:55], v8 offset:18688
  s_waitcnt lgkmcnt(4)
  v_mfma_f32_32x32x16_bf16 v[160:175], v[84:87], a[40:43], v[160:175]
  ds_read_b64_tr_b16 a[56:57], v8 offset:7168
  ds_read_b64_tr_b16 a[58:59], v8 offset:7424
  v_mfma_f32_32x32x16_bf16 v[176:191], v[84:87], a[44:47], v[176:191]
  ds_read_b64_tr_b16 a[60:61], v8 offset:19456
  ds_read_b64_tr_b16 a[62:63], v8 offset:19712
  s_waitcnt lgkmcnt(4)
  v_mfma_f32_32x32x16_bf16 v[160:175], v[88:91], a[48:51], v[160:175]
  ds_read_b64_tr_b16 a[0:1], v8 offset:8192
  ds_read_b64_tr_b16 a[2:3], v8 offset:8448
  v_mfma_f32_32x32x16_bf16 v[176:191], v[88:91], a[52:55], v[176:191]
  ds_read_b64_tr_b16 a[4:5], v8 offset:20480
  ds_read_b64_tr_b16 a[6:7], v8 offset:20736
  s_waitcnt lgkmcnt(4)
  v_mfma_f32_32x32x16_bf16 v[160:175], v[92:95], a[56:59], v[160:175]
  ds_read_b64_tr_b16 a[8:9], v8 offset:9216
  ds_read_b64_tr_b16 a[10:11], v8 offset:9472
  v_mfma_f32_32x32x16_bf16 v[176:191], v[92:95], a[60:63], v[176:191]
  ds_read_b64_tr_b16 a[12:13], v8 offset:21504
  ds_read_b64_tr_b16 a[14:15], v8 offset:21760
  s_waitcnt lgkmcnt(4)
  v_mfma_f32_32x32x16_bf16 v[160:175], v[96:99], a[0:3], v[160:175]
  ds_read_b64_tr_b16 a[16:17], v8 offset:10240
  ds_read_b64_tr_b16 a[18:19], v8 offset:10496
  v_mfma_f32_32x32x16_bf16 v[176:191], v[96:99], a[4:7], v[176:191]
  ds_read_b64_tr_b16 a[20:21], v8 offset:22528
  ds_read_b64_tr_b16 a[22:23], v8 offset:22784
  s_waitcnt lgkmcnt(4)
  v_mfma_f32_32x32x16_bf16 v[160:175], v[100:103], a[8:11], v[160:175]
  ds_read_b64_tr_b16 a[24:25], v8 offset:11264
  ds_read_b64_tr_b16 a[26:27], v8 offset:11520
  v_mfma_f32_32x32x16_bf16 v[176:191], v[100:103], a[12:15], v[176:191]
  ds_read_b64_tr_b16 a[28:29], v8 offset:23552
  ds_read_b64_tr_b16 a[30:31], v8 offset:23808
  s_waitcnt lgkmcnt(0)
  s_add_u32 s82, s81, s78
  s_add_u32 s82, s82, 65536
  s_add_u32 s81, s81, 24576
  s_cmp_eq_u32 s81, 73728
  s_cselect_b32 s81, 0, s81
  v_add_u32 v9, s81, v2
  s_waitcnt vmcnt(6)
  s_barrier
  v_mfma_f32_32x32x16_bf16 v[160:175], v[104:107], a[16:19], v[160:175]
  ds_read_b64_tr_b16 a[0:1], v9 offset:0
  ds_read_b64_tr_b16 a[2:3], v9 offset:256
  ds_read_b64_tr_b16 a[4:5], v9 offset:12288
  ds_read_b64_tr_b16 a[6:7], v9 offset:12544
  v_mfma_f32_32x32x16_bf16 v[176:191], v[104:107], a[20:23], v[176:191]
  s_add_u32 m0, s82, 0
  s_add_u32 s55, s75, 0
  buffer_load_dwordx4 v15, s[44:47], s55 offen lds
  s_add_u32 m0, s82, 1024
  s_add_u32 s55, s75, 20480
  buffer_load_dwordx4 v15, s[44:47], s55 offen lds
  s_add_u32 m0, s82, 2048
  s_add_u32 s55, s75, 40960
  buffer_load_dwordx4 v15, s[44:47], s55 offen lds
  s_waitcnt lgkmcnt(4)
  v_mfma_f32_32x32x16_bf16 v[160:175], v[108:111], a[24:27], v[160:175]
  ds_read_b64_tr_b16 a[8:9], v9 offset:1024
  ds_read_b64_tr_b16 a[10:11], v9 offset:1280
  ds_read_b64_tr_b16 a[12:13], v9 offset:13312
  ds_read_b64_tr_b16 a[14:15], v9 offset:13568
  v_mfma_f32_32x32x16_bf16 v[176:191], v[108:111], a[28:31], v[176:191]
  s_add_u32 m0, s82, 12288
  s_add_u32 s55, s75, 64
  buffer_load_dwordx4 v15, s[44:47], s55 offen lds
  s_add_u32 m0, s82, 13312
  s_add_u32 s55, s75, 20544
  buffer_load_dwordx4 v15, s[44:47], s55 offen lds
  s_add_u32 m0, s82, 14336
  s_add_u32 s55, s75, 41024
  buffer_load_dwordx4 v15, s[44:47], s55 offen lds
  s_add_u32 s75, s75, 128
  s_mov_b32 s80, 0
VL_154:
  s_waitcnt lgkmcnt(4)
  v_mfma_f32_32x32x16_bf16 v[192:207], v[64:67], a[0:3], 0
  ds_read_b64_tr_b16 a[16:17], v9 offset:2048
  ds_read_b64_tr_b16 a[18:19], v9 offset:2304
  v_mfma_f32_32x32x16_bf16 v[208:223], v[64:67], a[4:7], 0
  ds_read_b64_tr_b16 a[20:21], v9 offset:14336
  ds_read_b64_tr_b16 a[22:23], v9 offset:14592
  s_waitcnt lgkmcnt(4)
  v_mfma_f32_32x32x16_bf16 v[192:207], v[68:71], a[8:11], v[192:207]
  ds_read_b64_tr_b16 a[24:25], v9 offset:3072
  ds_read_b64_tr_b16 a[26:27], v9 offset:3328
  ds_read_b64_tr_b16 a[28:29], v9 offset:15360
  v_mfma_f32_32x32x16_bf16 v[208:223], v[68:71], a[12:15], v[208:223]
  ds_read_b64_tr_b16 a[30:31], v9 offset:15616
  v_cvt_pk_bf16_f32 v16, v160, v161
  v_cvt_pk_bf16_f32 v17, v162, v163
  v_cvt_pk_bf16_f32 v18, v164, v165
  v_cvt_pk_bf16_f32 v19, v166, v167
  s_waitcnt lgkmcnt(4)
  v_mfma_f32_32x32x16_bf16 v[192:207], v[72:75], a[16:19], v[192:207]
  ds_read_b64_tr_b16 a[32:33], v9 offset:4096
  ds_read_b64_tr_b16 a[34:35], v9 offset:4352
  ds_read_b64_tr_b16 a[36:37], v9 offset:16384
  v_mfma_f32_32x32x16_bf16 v[208:223], v[72:75], a[20:23], v[208:223]
  ds_read_b64_tr_b16 a[38:39], v9 offset:16640
  v_cvt_pk_bf16_f32 v20, v168, v169
  v_cvt_pk_bf16_f32 v21, v170, v171
  v_cvt_pk_bf16_f32 v22, v172, v173
  v_cvt_pk_bf16_f32 v23, v174, v175
  s_waitcnt lgkmcnt(4)
  v_mfma_f32_32x32x16_bf16 v[192:207], v[76:79], a[24:27], v[192:207]
  ds_read_b64_tr_b16 a[40:41], v9 offset:5120
  ds_read_b64_tr_b16 a[42:43], v9 offset:5376
  ds_read_b64_tr_b16 a[44:45], v9 offset:17408
  v_mfma_f32_32x32x16_bf16 v[208:223], v[76:79], a[28:31], v[208:223]
  ds_read_b64_tr_b16 a[46:47], v9 offset:17664
  s_add_u32 s55, s76, 0
  buffer_store_dwordx4 v[16:19], v12, s[40:43], s55 offen sc1
  s_waitcnt lgkmcnt(4)
  v_mfma_f32_32x32x16_bf16 v[192:207], v[80:83], a[32:35], v[192:207]
  ds_read_b64_tr_b16 a[48:49], v9 offset:6144
  ds_read_b64_tr_b16 a[50:51], v9 offset:6400
  ds_read_b64_tr_b16 a[52:53], v9 offset:18432
  v_mfma_f32_32x32x16_bf16 v[208:223], v[80:83], a[36:39], v[208:223]
  ds_read_b64_tr_b16 a[54:55], v9 offset:18688
  buffer_store_dwordx4 v[20:23], v12, s[40:43], s55 offen offset:512 sc1
  s_waitcnt lgkmcnt(4)
  v_mfma_f32_32x32x16_bf16 v[192:207], v[84:87], a[40:43], v[192:207]
  ds_read_b64_tr_b16 a[56:57], v9 offset:7168
  ds_read_b64_tr_b16 a[58:59], v9 offset:7424
  ds_read_b64_tr_b16 a[60:61], v9 offset:19456
  v_mfma_f32_32x32x16_bf16 v[208:223], v[84:87], a[44:47], v[208:223]
  ds_read_b64_tr_b16 a[62:63], v9 offset:19712
  v_cvt_pk_bf16_f32 v24, v176, v177
  v_cvt_pk_bf16_f32 v25, v178, v179
  v_cvt_pk_bf16_f32 v26, v180, v181
  v_cvt_pk_bf16_f32 v27, v182, v183
  s_waitcnt lgkmcnt(4)
  v_mfma_f32_32x32x16_bf16 v[192:207], v[88:91], a[48:51], v[192:207]
  ds_read_b64_tr_b16 a[0:1], v9 offset:8192
  ds_read_b64_tr_b16 a[2:3], v9 offset:8448
  ds_read_b64_tr_b16 a[4:5], v9 offset:20480
  v_mfma_f32_32x32x16_bf16 v[208:223], v[88:91], a[52:55], v[208:223]
  ds_read_b64_tr_b16 a[6:7], v9 offset:20736
  v_cvt_pk_bf16_f32 v28, v184, v185
  v_cvt_pk_bf16_f32 v29, v186, v187
  v_cvt_pk_bf16_f32 v30, v188, v189
  v_cvt_pk_bf16_f32 v31, v190, v191
  s_waitcnt lgkmcnt(4)
  v_mfma_f32_32x32x16_bf16 v[192:207], v[92:95], a[56:59], v[192:207]
  ds_read_b64_tr_b16 a[8:9], v9 offset:9216
  ds_read_b64_tr_b16 a[10:11], v9 offset:9472
  ds_read_b64_tr_b16 a[12:13], v9 offset:21504
  v_mfma_f32_32x32x16_bf16 v[208:223], v[92:95], a[60:63], v[208:223]
  ds_read_b64_tr_b16 a[14:15], v9 offset:21760
  s_add_u32 s55, s76, 131072
  buffer_store_dwordx4 v[24:27], v12, s[40:43], s55 offen sc1
  s_waitcnt lgkmcnt(4)
  v_mfma_f32_32x32x16_bf16 v[192:207], v[96:99], a[0:3], v[192:207]
  ds_read_b64_tr_b16 a[16:17], v9 offset:10240
  ds_read_b64_tr_b16 a[18:19], v9 offset:10496
  ds_read_b64_tr_b16 a[20:21], v9 offset:22528
  v_mfma_f32_32x32x16_bf16 v[208:223], v[96:99], a[4:7], v[208:223]
  ds_read_b64_tr_b16 a[22:23], v9 offset:22784
  buffer_store_dwordx4 v[28:31], v12, s[40:43], s55 offen offset:512 sc1
  s_add_u32 s76, s76, 262144
  s_add_u32 s77, s77, 262144
  s_waitcnt lgkmcnt(4)
  v_mfma_f32_32x32x16_bf16 v[192:207], v[100:103], a[8:11], v[192:207]
  ds_read_b64_tr_b16 a[24:25], v9 offset:11264
  ds_read_b64_tr_b16 a[26:27], v9 offset:11520
  v_mfma_f32_32x32x16_bf16 v[208:223], v[100:103], a[12:15], v[208:223]
  ds_read_b64_tr_b16 a[28:29], v9 offset:23552
  ds_read_b64_tr_b16 a[30:31], v9 offset:23808
  s_waitcnt lgkmcnt(0)
  s_add_u32 s82, s81, s78
  s_add_u32 s82, s82, 65536
  s_add_u32 s81, s81, 24576
  s_cmp_eq_u32 s81, 73728
  s_cselect_b32 s81, 0, s81
  v_add_u32 v8, s81, v2
  s_waitcnt vmcnt(10)
  s_barrier
  v_mfma_f32_32x32x16_bf16 v[192:207], v[104:107], a[16:19], v[192:207]
  ds_read_b64_tr_b16 a[0:1], v8 offset:0
  ds_read_b64_tr_b16 a[2:3], v8 offset:256
  ds_read_b64_tr_b16 a[4:5], v8 offset:12288
  ds_read_b64_tr_b16 a[6:7], v8 offset:12544
  v_mfma_f32_32x32x16_bf16 v[208:223], v[104:107], a[20:23], v[208:223]
  s_add_u32 m0, s82, 0
  s_add_u32 s55, s75, 0
  buffer_load_dwordx4 v15, s[44:47], s55 offen lds
  s_add_u32 m0, s82, 1024
  s_add_u32 s55, s75, 20480
  buffer_load_dwordx4 v15, s[44:47], s55 offen lds
  s_add_u32 m0, s82, 2048
  s_add_u32 s55, s75, 40960
  buffer_load_dwordx4 v15, s[44:47], s55 offen lds
  s_waitcnt lgkmcnt(4)
  v_mfma_f32_32x32x16_bf16 v[192:207], v[108:111], a[24:27], v[192:207]
  ds_read_b64_tr_b16 a[8:9], v8 offset:1024
  ds_read_b64_tr_b16 a[10:11], v8 offset:1280
  ds_read_b64_tr_b16 a[12:13], v8 offset:13312
  ds_read_b64_tr_b16 a[14:15], v8 offset:13568
  v_mfma_f32_32x32x16_bf16 v[208:223], v[108:111], a[28:31], v[208:223]
  s_add_u32 m0, s82, 12288
  s_add_u32 s55, s75, 64
  buffer_load_dwordx4 v15, s[44:47], s55 offen lds
  s_add_u32 m0, s82, 13312
  s_add_u32 s55, s75, 20544
  buffer_load_dwordx4 v15, s[44:47], s55 offen lds
  s_add_u32 m0, s82, 14336
  s_add_u32 s55, s75, 41024
  buffer_load_dwordx4 v15, s[44:47], s55 offen lds
  s_add_u32 s75, s75, 128
  s_waitcnt lgkmcnt(4)
  v_mfma_f32_32x32x16_bf16 v[160:175], v[64:67], a[0:3], 0
  ds_read_b64_tr_b16 a[16:17], v8 offset:2048
  ds_read_b64_tr_b16 a[18:19], v8 offset:2304
  v_mfma_f32_32x32x16_bf16 v[176:191], v[64:67], a[4:7], 0
  ds_read_b64_tr_b16 a[20:21], v8 offset:14336
  ds_read_b64_tr_b16 a[22:23], v8 offset:14592
  s_waitcnt lgkmcnt(4)
  v_mfma_f32_32x32x16_bf16 v[160:175], v[68:71], a[8:11], v[160:175]
  ds_read_b64_tr_b16 a[24:25], v8 offset:3072
  ds_read_b64_tr_b16 a[26:27], v8 offset:3328
  ds_read_b64_tr_b16 a[28:29], v8 offset:15360
  v_mfma_f32_32x32x16_bf16 v[176:191], v[68:71], a[12:15], v[176:191]
  ds_read_b64_tr_b16 a[30:31], v8 offset:15616
  v_cvt_pk_bf16_f32 v16, v192, v193
  v_cvt_pk_bf16_f32 v17, v194, v195
  v_cvt_pk_bf16_f32 v18, v196, v197
  v_cvt_pk_bf16_f32 v19, v198, v199
  s_waitcnt lgkmcnt(4)
  v_mfma_f32_32x32x16_bf16 v[160:175], v[72:75], a[16:19], v[160:175]
  ds_read_b64_tr_b16 a[32:33], v8 offset:4096
  ds_read_b64_tr_b16 a[34:35], v8 offset:4352
  ds_read_b64_tr_b16 a[36:37], v8 offset:16384
  v_mfma_f32_32x32x16_bf16 v[176:191], v[72:75], a[20:23], v[176:191]
  ds_read_b64_tr_b16 a[38:39], v8 offset:16640
  v_cvt_pk_bf16_f32 v20, v200, v201
  v_cvt_pk_bf16_f32 v21, v202, v203
  v_cvt_pk_bf16_f32 v22, v204, v205
  v_cvt_pk_bf16_f32 v23, v206, v207
  s_waitcnt lgkmcnt(4)
  v_mfma_f32_32x32x16_bf16 v[160:175], v[76:79], a[24:27], v[160:175]
  ds_read_b64_tr_b16 a[40:41], v8 offset:5120
  ds_read_b64_tr_b16 a[42:43], v8 offset:5376
  ds_read_b64_tr_b16 a[44:45], v8 offset:17408
  v_mfma_f32_32x32x16_bf16 v[176:191], v[76:79], a[28:31], v[176:191]
  ds_read_b64_tr_b16 a[46:47], v8 offset:17664
  s_add_u32 s55, s76, 0
  buffer_store_dwordx4 v[16:19], v12, s[40:43], s55 offen sc1
  s_waitcnt lgkmcnt(4)
  v_mfma_f32_32x32x16_bf16 v[160:175], v[80:83], a[32:35], v[160:175]
  ds_read_b64_tr_b16 a[48:49], v8 offset:6144
  ds_read_b64_tr_b16 a[50:51], v8 offset:6400
  ds_read_b64_tr_b16 a[52:53], v8 offset:18432
  v_mfma_f32_32x32x16_bf16 v[176:191], v[80:83], a[36:39], v[176:191]
  ds_read_b64_tr_b16 a[54:55], v8 offset:18688
  buffer_store_dwordx4 v[20:23], v12, s[40:43], s55 offen offset:512 sc1
  s_waitcnt lgkmcnt(4)
  v_mfma_f32_32x32x16_bf16 v[160:175], v[84:87], a[40:43], v[160:175]
  ds_read_b64_tr_b16 a[56:57], v8 offset:7168
  ds_read_b64_tr_b16 a[58:59], v8 offset:7424
  ds_read_b64_tr_b16 a[60:61], v8 offset:19456
  v_mfma_f32_32x32x16_bf16 v[176:191], v[84:87], a[44:47], v[176:191]
  ds_read_b64_tr_b16 a[62:63], v8 offset:19712
  v_cvt_pk_bf16_f32 v24, v208, v209
  v_cvt_pk_bf16_f32 v25, v210, v211
  v_cvt_pk_bf16_f32 v26, v212, v213
  v_cvt_pk_bf16_f32 v27, v214, v215
  s_waitcnt lgkmcnt(4)
  v_mfma_f32_32x32x16_bf16 v[160:175], v[88:91], a[48:51], v[160:175]
  ds_read_b64_tr_b16 a[0:1], v8 offset:8192
  ds_read_b64_tr_b16 a[2:3], v8 offset:8448
  ds_read_b64_tr_b16 a[4:5], v8 offset:20480
  v_mfma_f32_32x32x16_bf16 v[176:191], v[88:91], a[52:55], v[176:191]
  ds_read_b64_tr_b16 a[6:7], v8 offset:20736
  v_cvt_pk_bf16_f32 v28, v216, v217
  v_cvt_pk_bf16_f32 v29, v218, v219
  v_cvt_pk_bf16_f32 v30, v220, v221
  v_cvt_pk_bf16_f32 v31, v222, v223
  s_waitcnt lgkmcnt(4)
  v_mfma_f32_32x32x16_bf16 v[160:175], v[92:95], a[56:59], v[160:175]
  ds_read_b64_tr_b16 a[8:9], v8 offset:9216
  ds_read_b64_tr_b16 a[10:11], v8 offset:9472
  ds_read_b64_tr_b16 a[12:13], v8 offset:21504
  v_mfma_f32_32x32x16_bf16 v[176:191], v[92:95], a[60:63], v[176:191]
  ds_read_b64_tr_b16 a[14:15], v8 offset:21760
  s_add_u32 s55, s76, 131072
  buffer_store_dwordx4 v[24:27], v12, s[40:43], s55 offen sc1
  s_waitcnt lgkmcnt(4)
  v_mfma_f32_32x32x16_bf16 v[160:175], v[96:99], a[0:3], v[160:175]
  ds_read_b64_tr_b16 a[16:17], v8 offset:10240
  ds_read_b64_tr_b16 a[18:19], v8 offset:10496
  ds_read_b64_tr_b16 a[20:21], v8 offset:22528
  v_mfma_f32_32x32x16_bf16 v[176:191], v[96:99], a[4:7], v[176:191]
  ds_read_b64_tr_b16 a[22:23], v8 offset:22784
  buffer_store_dwordx4 v[28:31], v12, s[40:43], s55 offen offset:512 sc1
  s_add_u32 s76, s76, 262144
  s_add_u32 s77, s77, 262144
  s_waitcnt lgkmcnt(4)
  v_mfma_f32_32x32x16_bf16 v[160:175], v[100:103], a[8:11], v[160:175]
  ds_read_b64_tr_b16 a[24:25], v8 offset:11264
  ds_read_b64_tr_b16 a[26:27], v8 offset:11520
  v_mfma_f32_32x32x16_bf16 v[176:191], v[100:103], a[12:15], v[176:191]
  ds_read_b64_tr_b16 a[28:29], v8 offset:23552
  ds_read_b64_tr_b16 a[30:31], v8 offset:23808
  s_waitcnt lgkmcnt(0)
  s_add_u32 s82, s81, s78
  s_add_u32 s82, s82, 65536
  s_add_u32 s81, s81, 24576
  s_cmp_eq_u32 s81, 73728
  s_cselect_b32 s81, 0, s81
  v_add_u32 v9, s81, v2
  s_waitcnt vmcnt(14)
  s_barrier
  v_mfma_f32_32x32x16_bf16 v[160:175], v[104:107], a[16:19], v[160:175]
  ds_read_b64_tr_b16 a[0:1], v9 offset:0
  ds_read_b64_tr_b16 a[2:3], v9 offset:256
  ds_read_b64_tr_b16 a[4:5], v9 offset:12288
  ds_read_b64_tr_b16 a[6:7], v9 offset:12544
  v_mfma_f32_32x32x16_bf16 v[176:191], v[104:107], a[20:23], v[176:191]
  s_add_u32 m0, s82, 0
  s_add_u32 s55, s75, 0
  buffer_load_dwordx4 v15, s[44:47], s55 offen lds
  s_add_u32 m0, s82, 1024
  s_add_u32 s55, s75, 20480
  buffer_load_dwordx4 v15, s[44:47], s55 offen lds
  s_add_u32 m0, s82, 2048
  s_add_u32 s55, s75, 40960
  buffer_load_dwordx4 v15, s[44:47], s55 offen lds
  s_waitcnt lgkmcnt(4)
  v_mfma_f32_32x32x16_bf16 v[160:175], v[108:111], a[24:27], v[160:175]
  ds_read_b64_tr_b16 a[8:9], v9 offset:1024
  ds_read_b64_tr_b16 a[10:11], v9 offset:1280
  ds_read_b64_tr_b16 a[12:13], v9 offset:13312
  ds_read_b64_tr_b16 a[14:15], v9 offset:13568
  v_mfma_f32_32x32x16_bf16 v[176:191], v[108:111], a[28:31], v[176:191]
  s_add_u32 m0, s82, 12288
  s_add_u32 s55, s75, 64
  buffer_load_dwordx4 v15, s[44:47], s55 offen lds
  s_add_u32 m0, s82, 13312
  s_add_u32 s55, s75, 20544
  buffer_load_dwordx4 v15, s[44:47], s55 offen lds
  s_add_u32 m0, s82, 14336
  s_add_u32 s55, s75, 41024
  buffer_load_dwordx4 v15, s[44:47], s55 offen lds
  s_add_u32 s75, s75, 128
  s_add_u32 s80, s80, 1
  s_cmp_lt_u32 s80, 4
  s_cbranch_scc1 VL_154
  s_waitcnt lgkmcnt(4)
  v_mfma_f32_32x32x16_bf16 v[192:207], v[64:67], a[0:3], 0
  ds_read_b64_tr_b16 a[16:17], v9 offset:2048
  ds_read_b64_tr_b16 a[18:19], v9 offset:2304
  v_mfma_f32_32x32x16_bf16 v[208:223], v[64:67], a[4:7], 0
  ds_read_b64_tr_b16 a[20:21], v9 offset:14336
  ds_read_b64_tr_b16 a[22:23], v9 offset:14592
  s_waitcnt lgkmcnt(4)
  v_mfma_f32_32x32x16_bf16 v[192:207], v[68:71], a[8:11], v[192:207]
  ds_read_b64_tr_b16 a[24:25], v9 offset:3072
  ds_read_b64_tr_b16 a[26:27], v9 offset:3328
  ds_read_b64_tr_b16 a[28:29], v9 offset:15360
  v_mfma_f32_32x32x16_bf16 v[208:223], v[68:71], a[12:15], v[208:223]
  ds_read_b64_tr_b16 a[30:31], v9 offset:15616
  v_cvt_pk_bf16_f32 v16, v160, v161
  v_cvt_pk_bf16_f32 v17, v162, v163
  v_cvt_pk_bf16_f32 v18, v164, v165
  v_cvt_pk_bf16_f32 v19, v166, v167
  s_waitcnt lgkmcnt(4)
  v_mfma_f32_32x32x16_bf16 v[192:207], v[72:75], a[16:19], v[192:207]
  ds_read_b64_tr_b16 a[32:33], v9 offset:4096
  ds_read_b64_tr_b16 a[34:35], v9 offset:4352
  ds_read_b64_tr_b16 a[36:37], v9 offset:16384
  v_mfma_f32_32x32x16_bf16 v[208:223], v[72:75], a[20:23], v[208:223]
  ds_read_b64_tr_b16 a[38:39], v9 offset:16640
  v_cvt_pk_bf16_f32 v20, v168, v169
  v_cvt_pk_bf16_f32 v21, v170, v171
  v_cvt_pk_bf16_f32 v22, v172, v173
  v_cvt_pk_bf16_f32 v23, v174, v175
  s_waitcnt lgkmcnt(4)
  v_mfma_f32_32x32x16_bf16 v[192:207], v[76:79], a[24:27], v[192:207]
  ds_read_b64_tr_b16 a[40:41], v9 offset:5120
  ds_read_b64_tr_b16 a[42:43], v9 offset:5376
  ds_read_b64_tr_b16 a[44:45], v9 offset:17408
  v_mfma_f32_32x32x16_bf16 v[208:223], v[76:79], a[28:31], v[208:223]
  ds_read_b64_tr_b16 a[46:47], v9 offset:17664
  s_add_u32 s55, s76, 0
  buffer_store_dwordx4 v[16:19], v12, s[40:43], s55 offen sc1
  s_waitcnt lgkmcnt(4)
  v_mfma_f32_32x32x16_bf16 v[192:207], v[80:83], a[32:35], v[192:207]
  ds_read_b64_tr_b16 a[48:49], v9 offset:6144
  ds_read_b64_tr_b16 a[50:51], v9 offset:6400
  ds_read_b64_tr_b16 a[52:53], v9 offset:18432
  v_mfma_f32_32x32x16_bf16 v[208:223], v[80:83], a[36:39], v[208:223]
  ds_read_b64_tr_b16 a[54:55], v9 offset:18688
  buffer_store_dwordx4 v[20:23], v12, s[40:43], s55 offen offset:512 sc1
  s_waitcnt lgkmcnt(4)
  v_mfma_f32_32x32x16_bf16 v[192:207], v[84:87], a[40:43], v[192:207]
  ds_read_b64_tr_b16 a[56:57], v9 offset:7168
  ds_read_b64_tr_b16 a[58:59], v9 offset:7424
  ds_read_b64_tr_b16 a[60:61], v9 offset:19456
  v_mfma_f32_32x32x16_bf16 v[208:223], v[84:87], a[44:47], v[208:223]
  ds_read_b64_tr_b16 a[62:63], v9 offset:19712
  v_cvt_pk_bf16_f32 v24, v176, v177
  v_cvt_pk_bf16_f32 v25, v178, v179
  v_cvt_pk_bf16_f32 v26, v180, v181
  v_cvt_pk_bf16_f32 v27, v182, v183
  s_waitcnt lgkmcnt(4)
  v_mfma_f32_32x32x16_bf16 v[192:207], v[88:91], a[48:51], v[192:207]
  ds_read_b64_tr_b16 a[0:1], v9 offset:8192
  ds_read_b64_tr_b16 a[2:3], v9 offset:8448
  ds_read_b64_tr_b16 a[4:5], v9 offset:20480
  v_mfma_f32_32x32x16_bf16 v[208:223], v[88:91], a[52:55], v[208:223]
  ds_read_b64_tr_b16 a[6:7], v9 offset:20736
  v_cvt_pk_bf16_f32 v28, v184, v185
  v_cvt_pk_bf16_f32 v29, v186, v187
  v_cvt_pk_bf16_f32 v30, v188, v189
  v_cvt_pk_bf16_f32 v31, v190, v191
  s_waitcnt lgkmcnt(4)
  v_mfma_f32_32x32x16_bf16 v[192:207], v[92:95], a[56:59], v[192:207]
  ds_read_b64_tr_b16 a[8:9], v9 offset:9216
  ds_read_b64_tr_b16 a[10:11], v9 offset:9472
  ds_read_b64_tr_b16 a[12:13], v9 offset:21504
  v_mfma_f32_32x32x16_bf16 v[208:223], v[92:95], a[60:63], v[208:223]
  ds_read_b64_tr_b16 a[14:15], v9 offset:21760
  s_add_u32 s55, s76, 131072
  buffer_store_dwordx4 v[24:27], v12, s[40:43], s55 offen sc1
  s_waitcnt lgkmcnt(4)
  v_mfma_f32_32x32x16_bf16 v[192:207], v[96:99], a[0:3], v[192:207]
  ds_read_b64_tr_b16 a[16:17], v9 offset:10240
  ds_read_b64_tr_b16 a[18:19], v9 offset:10496
  ds_read_b64_tr_b16 a[20:21], v9 offset:22528
  v_mfma_f32_32x32x16_bf16 v[208:223], v[96:99], a[4:7], v[208:223]
  ds_read_b64_tr_b16 a[22:23], v9 offset:22784
  buffer_store_dwordx4 v[28:31], v12, s[40:43], s55 offen offset:512 sc1
  s_add_u32 s76, s76, 262144
  s_add_u32 s77, s77, 262144
  s_waitcnt lgkmcnt(4)
  v_mfma_f32_32x32x16_bf16 v[192:207], v[100:103], a[8:11], v[192:207]
  ds_read_b64_tr_b16 a[24:25], v9 offset:11264
  ds_read_b64_tr_b16 a[26:27], v9 offset:11520
  v_mfma_f32_32x32x16_bf16 v[208:223], v[100:103], a[12:15], v[208:223]
  ds_read_b64_tr_b16 a[28:29], v9 offset:23552
  ds_read_b64_tr_b16 a[30:31], v9 offset:23808
  s_waitcnt lgkmcnt(0)
  v_mfma_f32_32x32x16_bf16 v[192:207], v[104:107], a[16:19], v[192:207]
  v_mfma_f32_32x32x16_bf16 v[208:223], v[104:107], a[20:23], v[208:223]
  s_waitcnt lgkmcnt(0)
  v_mfma_f32_32x32x16_bf16 v[192:207], v[108:111], a[24:27], v[192:207]
  v_mfma_f32_32x32x16_bf16 v[208:223], v[108:111], a[28:31], v[208:223]
  s_nop 7
  s_nop 7
  v_cvt_pk_bf16_f32 v16, v192, v193
  v_cvt_pk_bf16_f32 v17, v194, v195
  v_cvt_pk_bf16_f32 v18, v196, v197
  v_cvt_pk_bf16_f32 v19, v198, v199
  v_cvt_pk_bf16_f32 v20, v200, v201
  v_cvt_pk_bf16_f32 v21, v202, v203
  v_cvt_pk_bf16_f32 v22, v204, v205
  v_cvt_pk_bf16_f32 v23, v206, v207
  s_add_u32 s55, s76, 0
  buffer_store_dwordx4 v[16:19], v12, s[40:43], s55 offen sc1
  buffer_store_dwordx4 v[20:23], v12, s[40:43], s55 offen offset:512 sc1
  v_cvt_pk_bf16_f32 v24, v208, v209
  v_cvt_pk_bf16_f32 v25, v210, v211
  v_cvt_pk_bf16_f32 v26, v212, v213
  v_cvt_pk_bf16_f32 v27, v214, v215
  v_cvt_pk_bf16_f32 v28, v216, v217
  v_cvt_pk_bf16_f32 v29, v218, v219
  v_cvt_pk_bf16_f32 v30, v220, v221
  v_cvt_pk_bf16_f32 v31, v222, v223
  s_add_u32 s55, s76, 131072
  buffer_store_dwordx4 v[24:27], v12, s[40:43], s55 offen sc1
  buffer_store_dwordx4 v[28:31], v12, s[40:43], s55 offen offset:512 sc1
  s_add_u32 s76, s76, 262144
  s_add_u32 s77, s77, 262144
  s_lshl_b32 s68, s66, 2
  s_add_u32 s68, s68, 96
  s_waitcnt vmcnt(0)
  s_barrier
  s_cmp_eq_u32 s66, 0
  s_cbranch_scc0 H0_155
  s_cmp_eq_u32 s48, 0
  s_cbranch_scc0 H0_155
  s_mov_b32 s95, 172
  v_mov_b32 v1, 1
  s_mov_b64 exec, 1
  buffer_atomic_add v1, off, s[96:99], s95
  s_mov_b64 exec, -1
H0_155:
  s_waitcnt vmcnt(0)
  s_barrier
  s_cmp_eq_u32 s48, 0
  s_cbranch_scc0 SG_156
  s_mov_b32 s95, 96
  v_mov_b32 v1, 1
  s_mov_b64 exec, 1
  buffer_atomic_add v1, off, s[96:99], s95
  s_mov_b64 exec, -1
SG_156:
W1_DONE:
W_LOOP_T1:
  s_branch W_LOOP_T2
W_A2_T:
  s_cmp_eq_u32 s48, 0
  s_cbranch_scc0 WX_159
  s_mov_b32 s95, 160
WG_157:
  buffer_load_dword v1, off, s[96:99], s95 sc1
  s_waitcnt vmcnt(0)
  v_cmp_gt_u32 vcc, 80, v1
  s_cbranch_vccz WX_159
  s_sleep 16
  s_sub_u32 s101, s101, 1
  s_cbranch_scc0 WG_157
  s_mov_b32 s101, 0
WX_159:
  s_barrier
  s_mov_b32 s49, s93
  v_and_b32 v1, 63, v0
  v_lshrrev_b32 v5, 6, v0
  s_nop 0
  v_readfirstlane_b32 s48, v5
  v_lshlrev_b32 v4, 4, v1
  v_lshrrev_b32 v9, 5, v1
  v_and_b32 v5, 15, v1
  v_lshrrev_b32 v6, 2, v5
  v_lshl_add_u32 v6, v9, 3, v6
  v_lshlrev_b32 v2, 5, v6
  v_and_b32 v5, 3, v5
  v_lshl_add_u32 v2, v5, 3, v2
  v_bfe_u32 v6, v1, 4, 1
  v_lshl_add_u32 v2, v6, 10, v2
  s_mul_i32 s57, s48, 32768
  v_add_u32 v2, s57, v2
  v_and_b32 v5, 15, v1
  v_lshrrev_b32 v7, 2, v5
  v_lshl_add_u32 v7, v9, 2, v7
  v_lshlrev_b32 v3, 6, v7
  v_lshl_add_u32 v3, v6, 5, v3
  v_and_b32 v5, 3, v5
  v_lshl_add_u32 v3, v5, 3, v3
  v_add_u32 v3, s57, v3
  v_mov_b32 v48, 0x3f803f80
  v_mov_b32 v49, 0x3f803f80
  v_mov_b32 v50, 0x3f803f80
  v_mov_b32 v51, 0x3f803f80
  s_lshl_b32 s51, s49, 1
  s_add_u32 s53, s51, 40
  s_lshl_b32 s53, s53, 16
  s_add_u32 s53, s53, 161480704
  s_sub_u32 s52, s49, 1
  s_max_i32 s52, s52, 0
  s_lshl_b32 s54, s52, 1
  s_add_u32 s54, s54, 80
  s_lshl_b32 s54, s54, 16
  s_add_u32 s54, s54, 161480704
  s_add_u32 s55, s51, 80
  s_lshl_b32 s55, s55, 16
  s_add_u32 s55, s55, 161480704
  s_add_u32 s52, s49, 1
  s_min_u32 s52, s52, 19
  s_lshl_b32 s56, s52, 1
  s_add_u32 s56, s56, 80
  s_lshl_b32 s56, s56, 16
  s_add_u32 s56, s56, 161480704
  s_lshl_b32 s58, s48, 14
  v_mov_b32 v64, 0
  v_mov_b32 v65, 0
  v_mov_b32 v66, 0
  v_mov_b32 v67, 0
  v_mov_b32 v68, 0
  v_mov_b32 v69, 0
  v_mov_b32 v70, 0
  v_mov_b32 v71, 0
  v_mov_b32 v72, 0
  v_mov_b32 v73, 0
  v_mov_b32 v74, 0
  v_mov_b32 v75, 0
  v_mov_b32 v76, 0
  v_mov_b32 v77, 0
  v_mov_b32 v78, 0
  v_mov_b32 v79, 0
  v_mov_b32 v80, 0
  v_mov_b32 v81, 0
  v_mov_b32 v82, 0
  v_mov_b32 v83, 0
  v_mov_b32 v84, 0
  v_mov_b32 v85, 0
  v_mov_b32 v86, 0
  v_mov_b32 v87, 0
  v_mov_b32 v88, 0
  v_mov_b32 v89, 0
  v_mov_b32 v90, 0
  v_mov_b32 v91, 0
  v_mov_b32 v92, 0
  v_mov_b32 v93, 0
  v_mov_b32 v94, 0
  v_mov_b32 v95, 0
  v_mov_b32 v96, 0
  v_mov_b32 v97, 0
  v_mov_b32 v98, 0
  v_mov_b32 v99, 0
  v_mov_b32 v100, 0
  v_mov_b32 v101, 0
  v_mov_b32 v102, 0
  v_mov_b32 v103, 0
  v_mov_b32 v104, 0
  v_mov_b32 v105, 0
  v_mov_b32 v106, 0
  v_mov_b32 v107, 0
  v_mov_b32 v108, 0
  v_mov_b32 v109, 0
  v_mov_b32 v110, 0
  v_mov_b32 v111, 0
  v_mov_b32 v112, 0
  v_mov_b32 v113, 0
  v_mov_b32 v114, 0
  v_mov_b32 v115, 0
  v_mov_b32 v116, 0
  v_mov_b32 v117, 0
  v_mov_b32 v118, 0
  v_mov_b32 v119, 0
  v_mov_b32 v120, 0
  v_mov_b32 v121, 0
  v_mov_b32 v122, 0
  v_mov_b32 v123, 0
  v_mov_b32 v124, 0
  v_mov_b32 v125, 0
  v_mov_b32 v126, 0
  v_mov_b32 v127, 0
  s_mov_b32 s59, 0
A2_LOOP:
  s_add_u32 m0, s57, 0
  s_add_u32 s51, s53, s58
  s_add_u32 s51, s51, 0
  buffer_load_dwordx4 v4, s[40:43], s51 offen sc1 lds
  s_add_u32 m0, s57, 1024
  s_add_u32 s51, s53, s58
  s_add_u32 s51, s51, 65536
  buffer_load_dwordx4 v4, s[40:43], s51 offen sc1 lds
  s_add_u32 m0, s57, 2048
  s_add_u32 s51, s54, s58
  s_add_u32 s51, s51, 0
  buffer_load_dwordx4 v4, s[40:43], s51 offen sc1 lds
  s_add_u32 m0, s57, 3072
  s_add_u32 s51, s54, s58
  s_add_u32 s51, s51, 65536
  buffer_load_dwordx4 v4, s[40:43], s51 offen sc1 lds
  s_add_u32 m0, s57, 4096
  s_add_u32 s51, s55, s58
  s_add_u32 s51, s51, 0
  buffer_load_dwordx4 v4, s[40:43], s51 offen sc1 lds
  s_add_u32 m0, s57, 5120
  s_add_u32 s51, s55, s58
  s_add_u32 s51, s51, 65536
  buffer_load_dwordx4 v4, s[40:43], s51 offen sc1 lds
  s_add_u32 m0, s57, 6144
  s_add_u32 s51, s56, s58
  s_add_u32 s51, s51, 0
  buffer_load_dwordx4 v4, s[40:43], s51 offen sc1 lds
  s_add_u32 m0, s57, 7168
  s_add_u32 s51, s56, s58
  s_add_u32 s51, s51, 65536
  buffer_load_dwordx4 v4, s[40:43], s51 offen sc1 lds
  s_add_u32 m0, s57, 8192
  s_add_u32 s51, s53, s58
  s_add_u32 s51, s51, 1024
  buffer_load_dwordx4 v4, s[40:43], s51 offen sc1 lds
  s_add_u32 m0, s57, 9216
  s_add_u32 s51, s53, s58
  s_add_u32 s51, s51, 66560
  buffer_load_dwordx4 v4, s[40:43], s51 offen sc1 lds
  s_add_u32 m0, s57, 10240
  s_add_u32 s51, s54, s58
  s_add_u32 s51, s51, 1024
  buffer_load_dwordx4 v4, s[40:43], s51 offen sc1 lds
  s_add_u32 m0, s57, 11264
  s_add_u32 s51, s54, s58
  s_add_u32 s51, s51, 66560
  buffer_load_dwordx4 v4, s[40:43], s51 offen sc1 lds
  s_add_u32 m0, s57, 12288
  s_add_u32 s51, s55, s58
  s_add_u32 s51, s51, 1024
  buffer_load_dwordx4 v4, s[40:43], s51 offen sc1 lds
  s_add_u32 m0, s57, 13312
  s_add_u32 s51, s55, s58
  s_add_u32 s51, s51, 66560
  buffer_load_dwordx4 v4, s[40:43], s51 offen sc1 lds
  s_add_u32 m0, s57, 14336
  s_add_u32 s51, s56, s58
  s_add_u32 s51, s51, 1024
  buffer_load_dwordx4 v4, s[40:43], s51 offen sc1 lds
  s_add_u32 m0, s57, 15360
  s_add_u32 s51, s56, s58
  s_add_u32 s51, s51, 66560
  buffer_load_dwordx4 v4, s[40:43], s51 offen sc1 lds
  s_add_u32 m0, s57, 16384
  s_add_u32 s51, s53, s58
  s_add_u32 s51, s51, 2048
  buffer_load_dwordx4 v4, s[40:43], s51 offen sc1 lds
  s_add_u32 m0, s57, 17408
  s_add_u32 s51, s53, s58
  s_add_u32 s51, s51, 67584
  buffer_load_dwordx4 v4, s[40:43], s51 offen sc1 lds
  s_add_u32 m0, s57, 18432
  s_add_u32 s51, s54, s58
  s_add_u32 s51, s51, 2048
  buffer_load_dwordx4 v4, s[40:43], s51 offen sc1 lds
  s_add_u32 m0, s57, 19456
  s_add_u32 s51, s54, s58
  s_add_u32 s51, s51, 67584
  buffer_load_dwordx4 v4, s[40:43], s51 offen sc1 lds
  s_add_u32 m0, s57, 20480
  s_add_u32 s51, s55, s58
  s_add_u32 s51, s51, 2048
  buffer_load_dwordx4 v4, s[40:43], s51 offen sc1 lds
  s_add_u32 m0, s57, 21504
  s_add_u32 s51, s55, s58
  s_add_u32 s51, s51, 67584
  buffer_load_dwordx4 v4, s[40:43], s51 offen sc1 lds
  s_add_u32 m0, s57, 22528
  s_add_u32 s51, s56, s58
  s_add_u32 s51, s51, 2048
  buffer_load_dwordx4 v4, s[40:43], s51 offen sc1 lds
  s_add_u32 m0, s57, 23552
  s_add_u32 s51, s56, s58
  s_add_u32 s51, s51, 67584
  buffer_load_dwordx4 v4, s[40:43], s51 offen sc1 lds
  s_add_u32 m0, s57, 24576
  s_add_u32 s51, s53, s58
  s_add_u32 s51, s51, 3072
  buffer_load_dwordx4 v4, s[40:43], s51 offen sc1 lds
  s_add_u32 m0, s57, 25600
  s_add_u32 s51, s53, s58
  s_add_u32 s51, s51, 68608
  buffer_load_dwordx4 v4, s[40:43], s51 offen sc1 lds
  s_add_u32 m0, s57, 26624
  s_add_u32 s51, s54, s58
  s_add_u32 s51, s51, 3072
  buffer_load_dwordx4 v4, s[40:43], s51 offen sc1 lds
  s_add_u32 m0, s57, 27648
  s_add_u32 s51, s54, s58
  s_add_u32 s51, s51, 68608
  buffer_load_dwordx4 v4, s[40:43], s51 offen sc1 lds
  s_add_u32 m0, s57, 28672
  s_add_u32 s51, s55, s58
  s_add_u32 s51, s51, 3072
  buffer_load_dwordx4 v4, s[40:43], s51 offen sc1 lds
  s_add_u32 m0, s57, 29696
  s_add_u32 s51, s55, s58
  s_add_u32 s51, s51, 68608
  buffer_load_dwordx4 v4, s[40:43], s51 offen sc1 lds
  s_add_u32 m0, s57, 30720
  s_add_u32 s51, s56, s58
  s_add_u32 s51, s51, 3072
  buffer_load_dwordx4 v4, s[40:43], s51 offen sc1 lds
  s_add_u32 m0, s57, 31744
  s_add_u32 s51, s56, s58
  s_add_u32 s51, s51, 68608
  buffer_load_dwordx4 v4, s[40:43], s51 offen sc1 lds
  s_waitcnt vmcnt(0)
  ds_read_b64_tr_b16 v[16:17], v2 offset:0
  ds_read_b64_tr_b16 v[18:19], v2 offset:128
  ds_read_b64_tr_b16 v[20:21], v2 offset:2048
  ds_read_b64_tr_b16 v[22:23], v2 offset:2176
  ds_read_b64_tr_b16 v[24:25], v2 offset:4096
  ds_read_b64_tr_b16 v[26:27], v2 offset:4224
  ds_read_b64_tr_b16 v[28:29], v2 offset:6144
  ds_read_b64_tr_b16 v[30:31], v2 offset:6272
  s_waitcnt lgkmcnt(0)
  v_mfma_f32_32x32x16_bf16 v[64:79], v[20:23], v[16:19], v[64:79]
  v_mfma_f32_32x32x16_bf16 v[80:95], v[24:27], v[16:19], v[80:95]
  v_mfma_f32_32x32x16_bf16 v[96:111], v[28:31], v[16:19], v[96:111]
  v_mfma_f32_32x32x16_bf16 v[112:127], v[48:51], v[16:19], v[112:127]
  s_nop 3
  ds_read_b64_tr_b16 v[16:17], v2 offset:512
  ds_read_b64_tr_b16 v[18:19], v2 offset:640
  ds_read_b64_tr_b16 v[20:21], v2 offset:2560
  ds_read_b64_tr_b16 v[22:23], v2 offset:2688
  ds_read_b64_tr_b16 v[24:25], v2 offset:4608
  ds_read_b64_tr_b16 v[26:27], v2 offset:4736
  ds_read_b64_tr_b16 v[28:29], v2 offset:6656
  ds_read_b64_tr_b16 v[30:31], v2 offset:6784
  s_waitcnt lgkmcnt(0)
  v_mfma_f32_32x32x16_bf16 v[64:79], v[20:23], v[16:19], v[64:79]
  v_mfma_f32_32x32x16_bf16 v[80:95], v[24:27], v[16:19], v[80:95]
  v_mfma_f32_32x32x16_bf16 v[96:111], v[28:31], v[16:19], v[96:111]
  v_mfma_f32_32x32x16_bf16 v[112:127], v[48:51], v[16:19], v[112:127]
  s_nop 3
  ds_read_b64_tr_b16 v[16:17], v2 offset:8192
  ds_read_b64_tr_b16 v[18:19], v2 offset:8320
  ds_read_b64_tr_b16 v[20:21], v2 offset:10240
  ds_read_b64_tr_b16 v[22:23], v2 offset:10368
  ds_read_b64_tr_b16 v[24:25], v2 offset:12288
  ds_read_b64_tr_b16 v[26:27], v2 offset:12416
  ds_read_b64_tr_b16 v[28:29], v2 offset:14336
  ds_read_b64_tr_b16 v[30:31], v2 offset:14464
  s_waitcnt lgkmcnt(0)
  v_mfma_f32_32x32x16_bf16 v[64:79], v[20:23], v[16:19], v[64:79]
  v_mfma_f32_32x32x16_bf16 v[80:95], v[24:27], v[16:19], v[80:95]
  v_mfma_f32_32x32x16_bf16 v[96:111], v[28:31], v[16:19], v[96:111]
  v_mfma_f32_32x32x16_bf16 v[112:127], v[48:51], v[16:19], v[112:127]
  s_nop 3
  ds_read_b64_tr_b16 v[16:17], v2 offset:8704
  ds_read_b64_tr_b16 v[18:19], v2 offset:8832
  ds_read_b64_tr_b16 v[20:21], v2 offset:10752
  ds_read_b64_tr_b16 v[22:23], v2 offset:10880
  ds_read_b64_tr_b16 v[24:25], v2 offset:12800
  ds_read_b64_tr_b16 v[26:27], v2 offset:12928
  ds_read_b64_tr_b16 v[28:29], v2 offset:14848
  ds_read_b64_tr_b16 v[30:31], v2 offset:14976
  s_waitcnt lgkmcnt(0)
  v_mfma_f32_32x32x16_bf16 v[64:79], v[20:23], v[16:19], v[64:79]
  v_mfma_f32_32x32x16_bf16 v[80:95], v[24:27], v[16:19], v[80:95]
  v_mfma_f32_32x32x16_bf16 v[96:111], v[28:31], v[16:19], v[96:111]
  v_mfma_f32_32x32x16_bf16 v[112:127], v[48:51], v[16:19], v[112:127]
  s_nop 3
  ds_read_b64_tr_b16 v[16:17], v2 offset:16384
  ds_read_b64_tr_b16 v[18:19], v2 offset:16512
  ds_read_b64_tr_b16 v[20:21], v2 offset:18432
  ds_read_b64_tr_b16 v[22:23], v2 offset:18560
  ds_read_b64_tr_b16 v[24:25], v2 offset:20480
  ds_read_b64_tr_b16 v[26:27], v2 offset:20608
  ds_read_b64_tr_b16 v[28:29], v2 offset:22528
  ds_read_b64_tr_b16 v[30:31], v2 offset:22656
  s_waitcnt lgkmcnt(0)
  v_mfma_f32_32x32x16_bf16 v[64:79], v[20:23], v[16:19], v[64:79]
  v_mfma_f32_32x32x16_bf16 v[80:95], v[24:27], v[16:19], v[80:95]
  v_mfma_f32_32x32x16_bf16 v[96:111], v[28:31], v[16:19], v[96:111]
  v_mfma_f32_32x32x16_bf16 v[112:127], v[48:51], v[16:19], v[112:127]
  s_nop 3
  ds_read_b64_tr_b16 v[16:17], v2 offset:16896
  ds_read_b64_tr_b16 v[18:19], v2 offset:17024
  ds_read_b64_tr_b16 v[20:21], v2 offset:18944
  ds_read_b64_tr_b16 v[22:23], v2 offset:19072
  ds_read_b64_tr_b16 v[24:25], v2 offset:20992
  ds_read_b64_tr_b16 v[26:27], v2 offset:21120
  ds_read_b64_tr_b16 v[28:29], v2 offset:23040
  ds_read_b64_tr_b16 v[30:31], v2 offset:23168
  s_waitcnt lgkmcnt(0)
  v_mfma_f32_32x32x16_bf16 v[64:79], v[20:23], v[16:19], v[64:79]
  v_mfma_f32_32x32x16_bf16 v[80:95], v[24:27], v[16:19], v[80:95]
  v_mfma_f32_32x32x16_bf16 v[96:111], v[28:31], v[16:19], v[96:111]
  v_mfma_f32_32x32x16_bf16 v[112:127], v[48:51], v[16:19], v[112:127]
  s_nop 3
  ds_read_b64_tr_b16 v[16:17], v2 offset:24576
  ds_read_b64_tr_b16 v[18:19], v2 offset:24704
  ds_read_b64_tr_b16 v[20:21], v2 offset:26624
  ds_read_b64_tr_b16 v[22:23], v2 offset:26752
  ds_read_b64_tr_b16 v[24:25], v2 offset:28672
  ds_read_b64_tr_b16 v[26:27], v2 offset:28800
  ds_read_b64_tr_b16 v[28:29], v2 offset:30720
  ds_read_b64_tr_b16 v[30:31], v2 offset:30848
  s_waitcnt lgkmcnt(0)
  v_mfma_f32_32x32x16_bf16 v[64:79], v[20:23], v[16:19], v[64:79]
  v_mfma_f32_32x32x16_bf16 v[80:95], v[24:27], v[16:19], v[80:95]
  v_mfma_f32_32x32x16_bf16 v[96:111], v[28:31], v[16:19], v[96:111]
  v_mfma_f32_32x32x16_bf16 v[112:127], v[48:51], v[16:19], v[112:127]
  s_nop 3
  ds_read_b64_tr_b16 v[16:17], v2 offset:25088
  ds_read_b64_tr_b16 v[18:19], v2 offset:25216
  ds_read_b64_tr_b16 v[20:21], v2 offset:27136
  ds_read_b64_tr_b16 v[22:23], v2 offset:27264
  ds_read_b64_tr_b16 v[24:25], v2 offset:29184
  ds_read_b64_tr_b16 v[26:27], v2 offset:29312
  ds_read_b64_tr_b16 v[28:29], v2 offset:31232
  ds_read_b64_tr_b16 v[30:31], v2 offset:31360
  s_waitcnt lgkmcnt(0)
  v_mfma_f32_32x32x16_bf16 v[64:79], v[20:23], v[16:19], v[64:79]
  v_mfma_f32_32x32x16_bf16 v[80:95], v[24:27], v[16:19], v[80:95]
  v_mfma_f32_32x32x16_bf16 v[96:111], v[28:31], v[16:19], v[96:111]
  v_mfma_f32_32x32x16_bf16 v[112:127], v[48:51], v[16:19], v[112:127]
  s_nop 3
  s_add_u32 s58, s58, 4096
  s_add_u32 s59, s59, 1
  s_cmp_lt_u32 s59, 4
  s_cbranch_scc1 A2_LOOP
  s_nop 7
  s_nop 7
  s_barrier
  s_lshl_b32 s51, s48, 14
  v_add_u32 v5, s51, v4
  ds_write_b128 v5, v[64:67] offset:0
  ds_write_b128 v5, v[68:71] offset:1024
  ds_write_b128 v5, v[72:75] offset:2048
  ds_write_b128 v5, v[76:79] offset:3072
  ds_write_b128 v5, v[80:83] offset:4096
  ds_write_b128 v5, v[84:87] offset:5120
  ds_write_b128 v5, v[88:91] offset:6144
  ds_write_b128 v5, v[92:95] offset:7168
  ds_write_b128 v5, v[96:99] offset:8192
  ds_write_b128 v5, v[100:103] offset:9216
  ds_write_b128 v5, v[104:107] offset:10240
  ds_write_b128 v5, v[108:111] offset:11264
  ds_write_b128 v5, v[112:115] offset:12288
  ds_write_b128 v5, v[116:119] offset:13312
  ds_write_b128 v5, v[120:123] offset:14336
  ds_write_b128 v5, v[124:127] offset:15360
  s_waitcnt lgkmcnt(0)
  s_barrier
  s_lshl_b32 s51, s48, 12
  v_add_u32 v5, s51, v4
  ds_read_b128 v[160:163], v5 offset:0
  ds_read_b128 v[164:167], v5 offset:1024
  ds_read_b128 v[168:171], v5 offset:2048
  ds_read_b128 v[172:175], v5 offset:3072
  ds_read_b128 v[176:179], v5 offset:16384
  ds_read_b128 v[180:183], v5 offset:17408
  ds_read_b128 v[184:187], v5 offset:18432
  ds_read_b128 v[188:191], v5 offset:19456
  ds_read_b128 v[192:195], v5 offset:32768
  ds_read_b128 v[196:199], v5 offset:33792
  ds_read_b128 v[200:203], v5 offset:34816
  ds_read_b128 v[204:207], v5 offset:35840
  ds_read_b128 v[208:211], v5 offset:49152
  ds_read_b128 v[212:215], v5 offset:50176
  ds_read_b128 v[216:219], v5 offset:51200
  ds_read_b128 v[220:223], v5 offset:52224
  s_waitcnt lgkmcnt(0)
  v_pk_add_f32 v[160:161], v[160:161], v[176:177]
  v_pk_add_f32 v[192:193], v[192:193], v[208:209]
  v_pk_add_f32 v[162:163], v[162:163], v[178:179]
  v_pk_add_f32 v[194:195], v[194:195], v[210:211]
  v_pk_add_f32 v[164:165], v[164:165], v[180:181]
  v_pk_add_f32 v[196:197], v[196:197], v[212:213]
  v_pk_add_f32 v[166:167], v[166:167], v[182:183]
  v_pk_add_f32 v[198:199], v[198:199], v[214:215]
  v_pk_add_f32 v[168:169], v[168:169], v[184:185]
  v_pk_add_f32 v[200:201], v[200:201], v[216:217]
  v_pk_add_f32 v[170:171], v[170:171], v[186:187]
  v_pk_add_f32 v[202:203], v[202:203], v[218:219]
  v_pk_add_f32 v[172:173], v[172:173], v[188:189]
  v_pk_add_f32 v[204:205], v[204:205], v[220:221]
  v_pk_add_f32 v[174:175], v[174:175], v[190:191]
  v_pk_add_f32 v[206:207], v[206:207], v[222:223]
  v_pk_add_f32 v[160:161], v[160:161], v[192:193]
  v_pk_add_f32 v[162:163], v[162:163], v[194:195]
  v_pk_add_f32 v[164:165], v[164:165], v[196:197]
  v_pk_add_f32 v[166:167], v[166:167], v[198:199]
  v_pk_add_f32 v[168:169], v[168:169], v[200:201]
  v_pk_add_f32 v[170:171], v[170:171], v[202:203]
  v_pk_add_f32 v[172:173], v[172:173], v[204:205]
  v_pk_add_f32 v[174:175], v[174:175], v[206:207]
  s_barrier
  s_cmp_eq_u32 s48, 3
  s_cbranch_scc1 AZ_160
  v_and_b32 v5, 31, v1
  s_lshl_b32 s51, s49, 5
  v_add_u32 v5, s51, v5
  v_mul_u32_u24 v8, 3277, v5
  v_lshrrev_b32 v8, 16, v8
  s_add_u32 s51, s49, s48
  s_sub_u32 s51, s51, 1
  s_lshl_b32 s52, s51, 5
  v_lshlrev_b32 v6, 2, v9
  v_add_u32 v6, s52, v6
  v_add_u32 v7, 0, v6
  v_max_i32 v5, 0, v7
  v_mul_u32_u24 v5, 3277, v5
  v_lshrrev_b32 v5, 16, v5
  v_cmp_eq_u32 vcc, v5, v8
  v_cmp_le_i32 s[60:61], 0, v7
  s_nop 1
  s_and_b64 vcc, vcc, s[60:61]
  s_nop 1
  v_cndmask_b32 v160, 0, v160, vcc
  v_add_u32 v7, 1, v6
  v_max_i32 v5, 0, v7
  v_mul_u32_u24 v5, 3277, v5
  v_lshrrev_b32 v5, 16, v5
  v_cmp_eq_u32 vcc, v5, v8
  v_cmp_le_i32 s[60:61], 0, v7
  s_nop 1
  s_and_b64 vcc, vcc, s[60:61]
  s_nop 1
  v_cndmask_b32 v161, 0, v161, vcc
  v_add_u32 v7, 2, v6
  v_max_i32 v5, 0, v7
  v_mul_u32_u24 v5, 3277, v5
  v_lshrrev_b32 v5, 16, v5
  v_cmp_eq_u32 vcc, v5, v8
  v_cmp_le_i32 s[60:61], 0, v7
  s_nop 1
  s_and_b64 vcc, vcc, s[60:61]
  s_nop 1
  v_cndmask_b32 v162, 0, v162, vcc
  v_add_u32 v7, 3, v6
  v_max_i32 v5, 0, v7
  v_mul_u32_u24 v5, 3277, v5
  v_lshrrev_b32 v5, 16, v5
  v_cmp_eq_u32 vcc, v5, v8
  v_cmp_le_i32 s[60:61], 0, v7
  s_nop 1
  s_and_b64 vcc, vcc, s[60:61]
  s_nop 1
  v_cndmask_b32 v163, 0, v163, vcc
  v_add_u32 v7, 8, v6
  v_max_i32 v5, 0, v7
  v_mul_u32_u24 v5, 3277, v5
  v_lshrrev_b32 v5, 16, v5
  v_cmp_eq_u32 vcc, v5, v8
  v_cmp_le_i32 s[60:61], 0, v7
  s_nop 1
  s_and_b64 vcc, vcc, s[60:61]
  s_nop 1
  v_cndmask_b32 v164, 0, v164, vcc
  v_add_u32 v7, 9, v6
  v_max_i32 v5, 0, v7
  v_mul_u32_u24 v5, 3277, v5
  v_lshrrev_b32 v5, 16, v5
  v_cmp_eq_u32 vcc, v5, v8
  v_cmp_le_i32 s[60:61], 0, v7
  s_nop 1
  s_and_b64 vcc, vcc, s[60:61]
  s_nop 1
  v_cndmask_b32 v165, 0, v165, vcc
  v_add_u32 v7, 10, v6
  v_max_i32 v5, 0, v7
  v_mul_u32_u24 v5, 3277, v5
  v_lshrrev_b32 v5, 16, v5
  v_cmp_eq_u32 vcc, v5, v8
  v_cmp_le_i32 s[60:61], 0, v7
  s_nop 1
  s_and_b64 vcc, vcc, s[60:61]
  s_nop 1
  v_cndmask_b32 v166, 0, v166, vcc
  v_add_u32 v7, 11, v6
  v_max_i32 v5, 0, v7
  v_mul_u32_u24 v5, 3277, v5
  v_lshrrev_b32 v5, 16, v5
  v_cmp_eq_u32 vcc, v5, v8
  v_cmp_le_i32 s[60:61], 0, v7
  s_nop 1
  s_and_b64 vcc, vcc, s[60:61]
  s_nop 1
  v_cndmask_b32 v167, 0, v167, vcc
  v_add_u32 v7, 16, v6
  v_max_i32 v5, 0, v7
  v_mul_u32_u24 v5, 3277, v5
  v_lshrrev_b32 v5, 16, v5
  v_cmp_eq_u32 vcc, v5, v8
  v_cmp_le_i32 s[60:61], 0, v7
  s_nop 1
  s_and_b64 vcc, vcc, s[60:61]
  s_nop 1
  v_cndmask_b32 v168, 0, v168, vcc
  v_add_u32 v7, 17, v6
  v_max_i32 v5, 0, v7
  v_mul_u32_u24 v5, 3277, v5
  v_lshrrev_b32 v5, 16, v5
  v_cmp_eq_u32 vcc, v5, v8
  v_cmp_le_i32 s[60:61], 0, v7
  s_nop 1
  s_and_b64 vcc, vcc, s[60:61]
  s_nop 1
  v_cndmask_b32 v169, 0, v169, vcc
  v_add_u32 v7, 18, v6
  v_max_i32 v5, 0, v7
  v_mul_u32_u24 v5, 3277, v5
  v_lshrrev_b32 v5, 16, v5
  v_cmp_eq_u32 vcc, v5, v8
  v_cmp_le_i32 s[60:61], 0, v7
  s_nop 1
  s_and_b64 vcc, vcc, s[60:61]
  s_nop 1
  v_cndmask_b32 v170, 0, v170, vcc
  v_add_u32 v7, 19, v6
  v_max_i32 v5, 0, v7
  v_mul_u32_u24 v5, 3277, v5
  v_lshrrev_b32 v5, 16, v5
  v_cmp_eq_u32 vcc, v5, v8
  v_cmp_le_i32 s[60:61], 0, v7
  s_nop 1
  s_and_b64 vcc, vcc, s[60:61]
  s_nop 1
  v_cndmask_b32 v171, 0, v171, vcc
  v_add_u32 v7, 24, v6
  v_max_i32 v5, 0, v7
  v_mul_u32_u24 v5, 3277, v5
  v_lshrrev_b32 v5, 16, v5
  v_cmp_eq_u32 vcc, v5, v8
  v_cmp_le_i32 s[60:61], 0, v7
  s_nop 1
  s_and_b64 vcc, vcc, s[60:61]
  s_nop 1
  v_cndmask_b32 v172, 0, v172, vcc
  v_add_u32 v7, 25, v6
  v_max_i32 v5, 0, v7
  v_mul_u32_u24 v5, 3277, v5
  v_lshrrev_b32 v5, 16, v5
  v_cmp_eq_u32 vcc, v5, v8
  v_cmp_le_i32 s[60:61], 0, v7
  s_nop 1
  s_and_b64 vcc, vcc, s[60:61]
  s_nop 1
  v_cndmask_b32 v173, 0, v173, vcc
  v_add_u32 v7, 26, v6
  v_max_i32 v5, 0, v7
  v_mul_u32_u24 v5, 3277, v5
  v_lshrrev_b32 v5, 16, v5
  v_cmp_eq_u32 vcc, v5, v8
  v_cmp_le_i32 s[60:61], 0, v7
  s_nop 1
  s_and_b64 vcc, vcc, s[60:61]
  s_nop 1
  v_cndmask_b32 v174, 0, v174, vcc
  v_add_u32 v7, 27, v6
  v_max_i32 v5, 0, v7
  v_mul_u32_u24 v5, 3277, v5
  v_lshrrev_b32 v5, 16, v5
  v_cmp_eq_u32 vcc, v5, v8
  v_cmp_le_i32 s[60:61], 0, v7
  s_nop 1
  s_and_b64 vcc, vcc, s[60:61]
  s_nop 1
  v_cndmask_b32 v175, 0, v175, vcc
  v_cvt_pk_bf16_f32 v176, v160, v161
  v_cvt_pk_bf16_f32 v177, v162, v163
  v_cvt_pk_bf16_f32 v178, v164, v165
  v_cvt_pk_bf16_f32 v179, v166, v167
  v_cvt_pk_bf16_f32 v180, v168, v169
  v_cvt_pk_bf16_f32 v181, v170, v171
  v_cvt_pk_bf16_f32 v182, v172, v173
  v_cvt_pk_bf16_f32 v183, v174, v175
  s_lshl_b32 s51, s48, 11
  s_add_u32 s51, s51, 131072
  v_add_u32 v5, s51, v4
  ds_write_b128 v5, v[176:179] offset:0
  ds_write_b128 v5, v[180:183] offset:1024
  s_branch AN_161
AZ_160:
  v_lshlrev_b32 v5, 2, v1
  s_lshl_b32 s51, s49, 7
  s_add_u32 s51, s51, 189792256
  s_mov_b32 exec_hi, 0
  buffer_store_dword v160, v5, s[40:43], s51 offen sc1
  s_mov_b64 exec, -1
AN_161:
  s_mov_b32 s36, s8
  s_mov_b32 s37, s9
  s_mov_b32 s38, 819200
  s_mov_b32 s39, 0x20000
  v_lshrrev_b32 v5, 2, v1
  v_mul_u32_u24 v10, 1280, v5
  v_and_b32 v5, 3, v1
  v_lshl_add_u32 v10, v5, 4, v10
  s_sub_u32 s52, s49, 1
  s_max_i32 s52, s52, 0
  s_add_u32 s60, s49, 0
  s_sub_u32 s60, s60, 1
  s_max_i32 s60, s60, 0
  s_min_u32 s60, s60, 19
  s_mul_i32 s60, s60, 40960
  s_mul_i32 s61, s48, 320
  s_add_u32 s60, s60, s61
  s_add_u32 m0, s57, 0
  s_add_u32 s51, s60, 0
  buffer_load_dwordx4 v10, s[36:39], s51 offen lds
  s_add_u32 m0, s57, 1024
  s_add_u32 s51, s60, 20480
  buffer_load_dwordx4 v10, s[36:39], s51 offen lds
  s_add_u32 m0, s57, 6144
  s_add_u32 s51, s60, 64
  buffer_load_dwordx4 v10, s[36:39], s51 offen lds
  s_add_u32 m0, s57, 7168
  s_add_u32 s51, s60, 20544
  buffer_load_dwordx4 v10, s[36:39], s51 offen lds
  s_add_u32 m0, s57, 12288
  s_add_u32 s51, s60, 128
  buffer_load_dwordx4 v10, s[36:39], s51 offen lds
  s_add_u32 m0, s57, 13312
  s_add_u32 s51, s60, 20608
  buffer_load_dwordx4 v10, s[36:39], s51 offen lds
  s_add_u32 m0, s57, 18432
  s_add_u32 s51, s60, 192
  buffer_load_dwordx4 v10, s[36:39], s51 offen lds
  s_add_u32 m0, s57, 19456
  s_add_u32 s51, s60, 20672
  buffer_load_dwordx4 v10, s[36:39], s51 offen lds
  s_add_u32 m0, s57, 24576
  s_add_u32 s51, s60, 256
  buffer_load_dwordx4 v10, s[36:39], s51 offen lds
  s_add_u32 m0, s57, 25600
  s_add_u32 s51, s60, 20736
  buffer_load_dwordx4 v10, s[36:39], s51 offen lds
  s_add_u32 s60, s49, 1
  s_sub_u32 s60, s60, 1
  s_max_i32 s60, s60, 0
  s_min_u32 s60, s60, 19
  s_mul_i32 s60, s60, 40960
  s_mul_i32 s61, s48, 320
  s_add_u32 s60, s60, s61
  s_add_u32 m0, s57, 2048
  s_add_u32 s51, s60, 0
  buffer_load_dwordx4 v10, s[36:39], s51 offen lds
  s_add_u32 m0, s57, 3072
  s_add_u32 s51, s60, 20480
  buffer_load_dwordx4 v10, s[36:39], s51 offen lds
  s_add_u32 m0, s57, 8192
  s_add_u32 s51, s60, 64
  buffer_load_dwordx4 v10, s[36:39], s51 offen lds
  s_add_u32 m0, s57, 9216
  s_add_u32 s51, s60, 20544
  buffer_load_dwordx4 v10, s[36:39], s51 offen lds
  s_add_u32 m0, s57, 14336
  s_add_u32 s51, s60, 128
  buffer_load_dwordx4 v10, s[36:39], s51 offen lds
  s_add_u32 m0, s57, 15360
  s_add_u32 s51, s60, 20608
  buffer_load_dwordx4 v10, s[36:39], s51 offen lds
  s_add_u32 m0, s57, 20480
  s_add_u32 s51, s60, 192
  buffer_load_dwordx4 v10, s[36:39], s51 offen lds
  s_add_u32 m0, s57, 21504
  s_add_u32 s51, s60, 20672
  buffer_load_dwordx4 v10, s[36:39], s51 offen lds
  s_add_u32 m0, s57, 26624
  s_add_u32 s51, s60, 256
  buffer_load_dwordx4 v10, s[36:39], s51 offen lds
  s_add_u32 m0, s57, 27648
  s_add_u32 s51, s60, 20736
  buffer_load_dwordx4 v10, s[36:39], s51 offen lds
  s_add_u32 s60, s49, 2
  s_sub_u32 s60, s60, 1
  s_max_i32 s60, s60, 0
  s_min_u32 s60, s60, 19
  s_mul_i32 s60, s60, 40960
  s_mul_i32 s61, s48, 320
  s_add_u32 s60, s60, s61
  s_add_u32 m0, s57, 4096
  s_add_u32 s51, s60, 0
  buffer_load_dwordx4 v10, s[36:39], s51 offen lds
  s_add_u32 m0, s57, 5120
  s_add_u32 s51, s60, 20480
  buffer_load_dwordx4 v10, s[36:39], s51 offen lds
  s_add_u32 m0, s57, 10240
  s_add_u32 s51, s60, 64
  buffer_load_dwordx4 v10, s[36:39], s51 offen lds
  s_add_u32 m0, s57, 11264
  s_add_u32 s51, s60, 20544
  buffer_load_dwordx4 v10, s[36:39], s51 offen lds
  s_add_u32 m0, s57, 16384
  s_add_u32 s51, s60, 128
  buffer_load_dwordx4 v10, s[36:39], s51 offen lds
  s_add_u32 m0, s57, 17408
  s_add_u32 s51, s60, 20608
  buffer_load_dwordx4 v10, s[36:39], s51 offen lds
  s_add_u32 m0, s57, 22528
  s_add_u32 s51, s60, 192
  buffer_load_dwordx4 v10, s[36:39], s51 offen lds
  s_add_u32 m0, s57, 23552
  s_add_u32 s51, s60, 20672
  buffer_load_dwordx4 v10, s[36:39], s51 offen lds
  s_add_u32 m0, s57, 28672
  s_add_u32 s51, s60, 256
  buffer_load_dwordx4 v10, s[36:39], s51 offen lds
  s_add_u32 m0, s57, 29696
  s_add_u32 s51, s60, 20736
  buffer_load_dwordx4 v10, s[36:39], s51 offen lds
  s_waitcnt vmcnt(0) lgkmcnt(0)
  s_barrier
  v_add_u32 v5, 131072, v4
  ds_read_b128 v[128:131], v5 offset:0
  ds_read_b128 v[132:135], v5 offset:1024
  ds_read_b128 v[136:139], v5 offset:2048
  ds_read_b128 v[140:143], v5 offset:3072
  ds_read_b128 v[144:147], v5 offset:4096
  ds_read_b128 v[148:151], v5 offset:5120
  ds_read_b64_tr_b16 v[16:17], v3 offset:0
  ds_read_b64_tr_b16 v[18:19], v3 offset:512
  s_waitcnt lgkmcnt(0)
  v_mfma_f32_32x32x16_bf16 v[64:79], v[16:19], v[128:131], 0
  ds_read_b64_tr_b16 v[20:21], v3 offset:1024
  ds_read_b64_tr_b16 v[22:23], v3 offset:1536
  s_waitcnt lgkmcnt(0)
  v_mfma_f32_32x32x16_bf16 v[64:79], v[20:23], v[132:135], v[64:79]
  ds_read_b64_tr_b16 v[16:17], v3 offset:2048
  ds_read_b64_tr_b16 v[18:19], v3 offset:2560
  s_waitcnt lgkmcnt(0)
  v_mfma_f32_32x32x16_bf16 v[64:79], v[16:19], v[136:139], v[64:79]
  ds_read_b64_tr_b16 v[20:21], v3 offset:3072
  ds_read_b64_tr_b16 v[22:23], v3 offset:3584
  s_waitcnt lgkmcnt(0)
  v_mfma_f32_32x32x16_bf16 v[64:79], v[20:23], v[140:143], v[64:79]
  ds_read_b64_tr_b16 v[16:17], v3 offset:4096
  ds_read_b64_tr_b16 v[18:19], v3 offset:4608
  s_waitcnt lgkmcnt(0)
  v_mfma_f32_32x32x16_bf16 v[64:79], v[16:19], v[144:147], v[64:79]
  ds_read_b64_tr_b16 v[20:21], v3 offset:5120
  ds_read_b64_tr_b16 v[22:23], v3 offset:5632
  s_waitcnt lgkmcnt(0)
  v_mfma_f32_32x32x16_bf16 v[64:79], v[20:23], v[148:151], v[64:79]
  s_nop 7
  s_nop 7
  v_cvt_pk_bf16_f32 v160, v64, v65
  v_cvt_pk_bf16_f32 v161, v66, v67
  v_cvt_pk_bf16_f32 v162, v68, v69
  v_cvt_pk_bf16_f32 v163, v70, v71
  v_cvt_pk_bf16_f32 v164, v72, v73
  v_cvt_pk_bf16_f32 v165, v74, v75
  v_cvt_pk_bf16_f32 v166, v76, v77
  v_cvt_pk_bf16_f32 v167, v78, v79
  s_nop 1
  v_permlane32_swap_b32 v160, v162
  v_permlane32_swap_b32 v161, v163
  v_permlane32_swap_b32 v164, v166
  v_permlane32_swap_b32 v165, v167
  v_and_b32 v5, 31, v1
  v_mul_u32_u24 v11, 1280, v5
  v_lshl_add_u32 v11, v9, 4, v11
  s_mul_i32 s60, s49, 40960
  s_mul_i32 s61, s48, 320
  s_add_u32 s60, s60, s61
  s_add_u32 s60, s60, 188743680
  buffer_store_dwordx4 v[160:163], v11, s[40:43], s60 offen offset:0 sc1
  buffer_store_dwordx4 v[164:167], v11, s[40:43], s60 offen offset:32 sc1
  ds_read_b64_tr_b16 v[16:17], v3 offset:6144
  ds_read_b64_tr_b16 v[18:19], v3 offset:6656
  s_waitcnt lgkmcnt(0)
  v_mfma_f32_32x32x16_bf16 v[80:95], v[16:19], v[128:131], 0
  ds_read_b64_tr_b16 v[20:21], v3 offset:7168
  ds_read_b64_tr_b16 v[22:23], v3 offset:7680
  s_waitcnt lgkmcnt(0)
  v_mfma_f32_32x32x16_bf16 v[80:95], v[20:23], v[132:135], v[80:95]
  ds_read_b64_tr_b16 v[16:17], v3 offset:8192
  ds_read_b64_tr_b16 v[18:19], v3 offset:8704
  s_waitcnt lgkmcnt(0)
  v_mfma_f32_32x32x16_bf16 v[80:95], v[16:19], v[136:139], v[80:95]
  ds_read_b64_tr_b16 v[20:21], v3 offset:9216
  ds_read_b64_tr_b16 v[22:23], v3 offset:9728
  s_waitcnt lgkmcnt(0)
  v_mfma_f32_32x32x16_bf16 v[80:95], v[20:23], v[140:143], v[80:95]
  ds_read_b64_tr_b16 v[16:17], v3 offset:10240
  ds_read_b64_tr_b16 v[18:19], v3 offset:10752
  s_waitcnt lgkmcnt(0)
  v_mfma_f32_32x32x16_bf16 v[80:95], v[16:19], v[144:147], v[80:95]
  ds_read_b64_tr_b16 v[20:21], v3 offset:11264
  ds_read_b64_tr_b16 v[22:23], v3 offset:11776
  s_waitcnt lgkmcnt(0)
  v_mfma_f32_32x32x16_bf16 v[80:95], v[20:23], v[148:151], v[80:95]
  s_nop 7
  s_nop 7
  v_cvt_pk_bf16_f32 v160, v80, v81
  v_cvt_pk_bf16_f32 v161, v82, v83
  v_cvt_pk_bf16_f32 v162, v84, v85
  v_cvt_pk_bf16_f32 v163, v86, v87
  v_cvt_pk_bf16_f32 v164, v88, v89
  v_cvt_pk_bf16_f32 v165, v90, v91
  v_cvt_pk_bf16_f32 v166, v92, v93
  v_cvt_pk_bf16_f32 v167, v94, v95
  s_nop 1
  v_permlane32_swap_b32 v160, v162
  v_permlane32_swap_b32 v161, v163
  v_permlane32_swap_b32 v164, v166
  v_permlane32_swap_b32 v165, v167
  buffer_store_dwordx4 v[160:163], v11, s[40:43], s60 offen offset:64 sc1
  buffer_store_dwordx4 v[164:167], v11, s[40:43], s60 offen offset:96 sc1
  ds_read_b64_tr_b16 v[16:17], v3 offset:12288
  ds_read_b64_tr_b16 v[18:19], v3 offset:12800
  s_waitcnt lgkmcnt(0)
  v_mfma_f32_32x32x16_bf16 v[64:79], v[16:19], v[128:131], 0
  ds_read_b64_tr_b16 v[20:21], v3 offset:13312
  ds_read_b64_tr_b16 v[22:23], v3 offset:13824
  s_waitcnt lgkmcnt(0)
  v_mfma_f32_32x32x16_bf16 v[64:79], v[20:23], v[132:135], v[64:79]
  ds_read_b64_tr_b16 v[16:17], v3 offset:14336
  ds_read_b64_tr_b16 v[18:19], v3 offset:14848
  s_waitcnt lgkmcnt(0)
  v_mfma_f32_32x32x16_bf16 v[64:79], v[16:19], v[136:139], v[64:79]
  ds_read_b64_tr_b16 v[20:21], v3 offset:15360
  ds_read_b64_tr_b16 v[22:23], v3 offset:15872
  s_waitcnt lgkmcnt(0)
  v_mfma_f32_32x32x16_bf16 v[64:79], v[20:23], v[140:143], v[64:79]
  ds_read_b64_tr_b16 v[16:17], v3 offset:16384
  ds_read_b64_tr_b16 v[18:19], v3 offset:16896
  s_waitcnt lgkmcnt(0)
  v_mfma_f32_32x32x16_bf16 v[64:79], v[16:19], v[144:147], v[64:79]
  ds_read_b64_tr_b16 v[20:21], v3 offset:17408
  ds_read_b64_tr_b16 v[22:23], v3 offset:17920
  s_waitcnt lgkmcnt(0)
  v_mfma_f32_32x32x16_bf16 v[64:79], v[20:23], v[148:151], v[64:79]
  s_nop 7
  s_nop 7
  v_cvt_pk_bf16_f32 v160, v64, v65
  v_cvt_pk_bf16_f32 v161, v66, v67
  v_cvt_pk_bf16_f32 v162, v68, v69
  v_cvt_pk_bf16_f32 v163, v70, v71
  v_cvt_pk_bf16_f32 v164, v72, v73
  v_cvt_pk_bf16_f32 v165, v74, v75
  v_cvt_pk_bf16_f32 v166, v76, v77
  v_cvt_pk_bf16_f32 v167, v78, v79
  s_nop 1
  v_permlane32_swap_b32 v160, v162
  v_permlane32_swap_b32 v161, v163
  v_permlane32_swap_b32 v164, v166
  v_permlane32_swap_b32 v165, v167
  buffer_store_dwordx4 v[160:163], v11, s[40:43], s60 offen offset:128 sc1
  buffer_store_dwordx4 v[164:167], v11, s[40:43], s60 offen offset:160 sc1
  ds_read_b64_tr_b16 v[16:17], v3 offset:18432
  ds_read_b64_tr_b16 v[18:19], v3 offset:18944
  s_waitcnt lgkmcnt(0)
  v_mfma_f32_32x32x16_bf16 v[80:95], v[16:19], v[128:131], 0
  ds_read_b64_tr_b16 v[20:21], v3 offset:19456
  ds_read_b64_tr_b16 v[22:23], v3 offset:19968
  s_waitcnt lgkmcnt(0)
  v_mfma_f32_32x32x16_bf16 v[80:95], v[20:23], v[132:135], v[80:95]
  ds_read_b64_tr_b16 v[16:17], v3 offset:20480
  ds_read_b64_tr_b16 v[18:19], v3 offset:20992
  s_waitcnt lgkmcnt(0)
  v_mfma_f32_32x32x16_bf16 v[80:95], v[16:19], v[136:139], v[80:95]
  ds_read_b64_tr_b16 v[20:21], v3 offset:21504
  ds_read_b64_tr_b16 v[22:23], v3 offset:22016
  s_waitcnt lgkmcnt(0)
  v_mfma_f32_32x32x16_bf16 v[80:95], v[20:23], v[140:143], v[80:95]
  ds_read_b64_tr_b16 v[16:17], v3 offset:22528
  ds_read_b64_tr_b16 v[18:19], v3 offset:23040
  s_waitcnt lgkmcnt(0)
  v_mfma_f32_32x32x16_bf16 v[80:95], v[16:19], v[144:147], v[80:95]
  ds_read_b64_tr_b16 v[20:21], v3 offset:23552
  ds_read_b64_tr_b16 v[22:23], v3 offset:24064
  s_waitcnt lgkmcnt(0)
  v_mfma_f32_32x32x16_bf16 v[80:95], v[20:23], v[148:151], v[80:95]
  s_nop 7
  s_nop 7
  v_cvt_pk_bf16_f32 v160, v80, v81
  v_cvt_pk_bf16_f32 v161, v82, v83
  v_cvt_pk_bf16_f32 v162, v84, v85
  v_cvt_pk_bf16_f32 v163, v86, v87
  v_cvt_pk_bf16_f32 v164, v88, v89
  v_cvt_pk_bf16_f32 v165, v90, v91
  v_cvt_pk_bf16_f32 v166, v92, v93
  v_cvt_pk_bf16_f32 v167, v94, v95
  s_nop 1
  v_permlane32_swap_b32 v160, v162
  v_permlane32_swap_b32 v161, v163
  v_permlane32_swap_b32 v164, v166
  v_permlane32_swap_b32 v165, v167
  buffer_store_dwordx4 v[160:163], v11, s[40:43], s60 offen offset:192 sc1
  buffer_store_dwordx4 v[164:167], v11, s[40:43], s60 offen offset:224 sc1
  ds_read_b64_tr_b16 v[16:17], v3 offset:24576
  ds_read_b64_tr_b16 v[18:19], v3 offset:25088
  s_waitcnt lgkmcnt(0)
  v_mfma_f32_32x32x16_bf16 v[64:79], v[16:19], v[128:131], 0
  ds_read_b64_tr_b16 v[20:21], v3 offset:25600
  ds_read_b64_tr_b16 v[22:23], v3 offset:26112
  s_waitcnt lgkmcnt(0)
  v_mfma_f32_32x32x16_bf16 v[64:79], v[20:23], v[132:135], v[64:79]
  ds_read_b64_tr_b16 v[16:17], v3 offset:26624
  ds_read_b64_tr_b16 v[18:19], v3 offset:27136
  s_waitcnt lgkmcnt(0)
  v_mfma_f32_32x32x16_bf16 v[64:79], v[16:19], v[136:139], v[64:79]
  ds_read_b64_tr_b16 v[20:21], v3 offset:27648
  ds_read_b64_tr_b16 v[22:23], v3 offset:28160
  s_waitcnt lgkmcnt(0)
  v_mfma_f32_32x32x16_bf16 v[64:79], v[20:23], v[140:143], v[64:79]
  ds_read_b64_tr_b16 v[16:17], v3 offset:28672
  ds_read_b64_tr_b16 v[18:19], v3 offset:29184
  s_waitcnt lgkmcnt(0)
  v_mfma_f32_32x32x16_bf16 v[64:79], v[16:19], v[144:147], v[64:79]
  ds_read_b64_tr_b16 v[20:21], v3 offset:29696
  ds_read_b64_tr_b16 v[22:23], v3 offset:30208
  s_waitcnt lgkmcnt(0)
  v_mfma_f32_32x32x16_bf16 v[64:79], v[20:23], v[148:151], v[64:79]
  s_nop 7
  s_nop 7
  v_cvt_pk_bf16_f32 v160, v64, v65
  v_cvt_pk_bf16_f32 v161, v66, v67
  v_cvt_pk_bf16_f32 v162, v68, v69
  v_cvt_pk_bf16_f32 v163, v70, v71
  v_cvt_pk_bf16_f32 v164, v72, v73
  v_cvt_pk_bf16_f32 v165, v74, v75
  v_cvt_pk_bf16_f32 v166, v76, v77
  v_cvt_pk_bf16_f32 v167, v78, v79
  s_nop 1
  v_permlane32_swap_b32 v160, v162
  v_permlane32_swap_b32 v161, v163
  v_permlane32_swap_b32 v164, v166
  v_permlane32_swap_b32 v165, v167
  buffer_store_dwordx4 v[160:163], v11, s[40:43], s60 offen offset:256 sc1
  buffer_store_dwordx4 v[164:167], v11, s[40:43], s60 offen offset:288 sc1
  s_waitcnt vmcnt(0)
  s_barrier
  s_cmp_eq_u32 s48, 0
  s_cbranch_scc0 SG_162
  s_mov_b32 s95, 164
  v_mov_b32 v1, 1
  s_mov_b64 exec, 1
  buffer_atomic_add v1, off, s[96:99], s95
  s_mov_b64 exec, -1
SG_162:
W_LOOP_T2:
  s_branch W_LOOP_T3
W_AS_T:
  s_cmp_eq_u32 s48, 0
  s_cbranch_scc0 WX_165
  s_mov_b32 s95, 164
WG_163:
  buffer_load_dword v1, off, s[96:99], s95 sc1
  s_waitcnt vmcnt(0)
  v_cmp_gt_u32 vcc, 20, v1
  s_cbranch_vccz WX_165
  s_sleep 16
  s_sub_u32 s101, s101, 1
  s_cbranch_scc0 WG_163
  s_mov_b32 s101, 0
WX_165:
  s_barrier
  s_mov_b32 s49, s93
  v_and_b32 v1, 31, v0
  v_lshrrev_b32 v2, 5, v0
  v_mul_u32_u24 v3, 327680, v2
  v_lshl_add_u32 v3, v1, 5, v3
  v_mul_u32_u24 v4, 320, v2
  v_mul_u32_u24 v5, 1280, v1
  v_mul_u32_u24 v2, 160, v2
  v_add_u32 v5, v5, v2
  s_lshl_b32 s51, s49, 10
  s_add_u32 s51, s51, 161480704
  s_add_u32 s52, s51, 0
  buffer_load_dwordx4 v[8:11], v3, s[40:43], s52 offen sc1
  buffer_load_dwordx4 v[12:15], v3, s[40:43], s52 offen offset:16 sc1
  s_add_u32 s52, s51, 65536
  buffer_load_dwordx4 v[16:19], v3, s[40:43], s52 offen sc1
  buffer_load_dwordx4 v[20:23], v3, s[40:43], s52 offen offset:16 sc1
  s_add_u32 s52, s51, 131072
  buffer_load_dwordx4 v[24:27], v3, s[40:43], s52 offen sc1
  buffer_load_dwordx4 v[28:31], v3, s[40:43], s52 offen offset:16 sc1
  s_add_u32 s52, s51, 196608
  buffer_load_dwordx4 v[32:35], v3, s[40:43], s52 offen sc1
  buffer_load_dwordx4 v[36:39], v3, s[40:43], s52 offen offset:16 sc1
  s_add_u32 s52, s51, 262144
  buffer_load_dwordx4 v[40:43], v3, s[40:43], s52 offen sc1
  buffer_load_dwordx4 v[44:47], v3, s[40:43], s52 offen offset:16 sc1
  s_mov_b32 s52, 189792256
  buffer_load_dwordx4 v[48:51], v4, s[40:43], s52 offen offset:0 sc1
  buffer_load_dwordx4 v[52:55], v4, s[40:43], s52 offen offset:16 sc1
  buffer_load_dwordx4 v[56:59], v4, s[40:43], s52 offen offset:32 sc1
  buffer_load_dwordx4 v[60:63], v4, s[40:43], s52 offen offset:48 sc1
  buffer_load_dwordx4 v[64:67], v4, s[40:43], s52 offen offset:64 sc1
  buffer_load_dwordx4 v[68:71], v4, s[40:43], s52 offen offset:80 sc1
  buffer_load_dwordx4 v[72:75], v4, s[40:43], s52 offen offset:96 sc1
  buffer_load_dwordx4 v[76:79], v4, s[40:43], s52 offen offset:112 sc1
  buffer_load_dwordx4 v[80:83], v4, s[40:43], s52 offen offset:128 sc1
  buffer_load_dwordx4 v[84:87], v4, s[40:43], s52 offen offset:144 sc1
  buffer_load_dwordx4 v[88:91], v4, s[40:43], s52 offen offset:160 sc1
  buffer_load_dwordx4 v[92:95], v4, s[40:43], s52 offen offset:176 sc1
  buffer_load_dwordx4 v[96:99], v4, s[40:43], s52 offen offset:192 sc1
  buffer_load_dwordx4 v[100:103], v4, s[40:43], s52 offen offset:208 sc1
  buffer_load_dwordx4 v[104:107], v4, s[40:43], s52 offen offset:224 sc1
  buffer_load_dwordx4 v[108:111], v4, s[40:43], s52 offen offset:240 sc1
  buffer_load_dwordx4 v[112:115], v4, s[40:43], s52 offen offset:256 sc1
  buffer_load_dwordx4 v[116:119], v4, s[40:43], s52 offen offset:272 sc1
  buffer_load_dwordx4 v[120:123], v4, s[40:43], s52 offen offset:288 sc1
  buffer_load_dwordx4 v[124:127], v4, s[40:43], s52 offen offset:304 sc1
  s_waitcnt vmcnt(0)
  v_lshlrev_b32 v128, 16, v8
  v_and_b32 v129, 0xffff0000, v8
  v_lshlrev_b32 v130, 16, v9
  v_and_b32 v131, 0xffff0000, v9
  v_lshlrev_b32 v132, 16, v10
  v_and_b32 v133, 0xffff0000, v10
  v_lshlrev_b32 v134, 16, v11
  v_and_b32 v135, 0xffff0000, v11
  v_lshlrev_b32 v136, 16, v12
  v_and_b32 v137, 0xffff0000, v12
  v_lshlrev_b32 v138, 16, v13
  v_and_b32 v139, 0xffff0000, v13
  v_lshlrev_b32 v140, 16, v14
  v_and_b32 v141, 0xffff0000, v14
  v_lshlrev_b32 v142, 16, v15
  v_and_b32 v143, 0xffff0000, v15
  v_lshlrev_b32 v144, 16, v16
  v_and_b32 v145, 0xffff0000, v16
  v_lshlrev_b32 v146, 16, v17
  v_and_b32 v147, 0xffff0000, v17
  v_lshlrev_b32 v148, 16, v18
  v_and_b32 v149, 0xffff0000, v18
  v_lshlrev_b32 v150, 16, v19
  v_and_b32 v151, 0xffff0000, v19
  v_lshlrev_b32 v152, 16, v20
  v_and_b32 v153, 0xffff0000, v20
  v_lshlrev_b32 v154, 16, v21
  v_and_b32 v155, 0xffff0000, v21
  v_lshlrev_b32 v156, 16, v22
  v_and_b32 v157, 0xffff0000, v22
  v_lshlrev_b32 v158, 16, v23
  v_and_b32 v159, 0xffff0000, v23
  v_lshlrev_b32 v160, 16, v24
  v_and_b32 v161, 0xffff0000, v24
  v_lshlrev_b32 v162, 16, v25
  v_and_b32 v163, 0xffff0000, v25
  v_lshlrev_b32 v164, 16, v26
  v_and_b32 v165, 0xffff0000, v26
  v_lshlrev_b32 v166, 16, v27
  v_and_b32 v167, 0xffff0000, v27
  v_lshlrev_b32 v168, 16, v28
  v_and_b32 v169, 0xffff0000, v28
  v_lshlrev_b32 v170, 16, v29
  v_and_b32 v171, 0xffff0000, v29
  v_lshlrev_b32 v172, 16, v30
  v_and_b32 v173, 0xffff0000, v30
  v_lshlrev_b32 v174, 16, v31
  v_and_b32 v175, 0xffff0000, v31
  v_lshlrev_b32 v176, 16, v32
  v_and_b32 v177, 0xffff0000, v32
  v_lshlrev_b32 v178, 16, v33
  v_and_b32 v179, 0xffff0000, v33
  v_lshlrev_b32 v180, 16, v34
  v_and_b32 v181, 0xffff0000, v34
  v_lshlrev_b32 v182, 16, v35
  v_and_b32 v183, 0xffff0000, v35
  v_lshlrev_b32 v184, 16, v36
  v_and_b32 v185, 0xffff0000, v36
  v_lshlrev_b32 v186, 16, v37
  v_and_b32 v187, 0xffff0000, v37
  v_lshlrev_b32 v188, 16, v38
  v_and_b32 v189, 0xffff0000, v38
  v_lshlrev_b32 v190, 16, v39
  v_and_b32 v191, 0xffff0000, v39
  v_lshlrev_b32 v192, 16, v40
  v_and_b32 v193, 0xffff0000, v40
  v_lshlrev_b32 v194, 16, v41
  v_and_b32 v195, 0xffff0000, v41
  v_lshlrev_b32 v196, 16, v42
  v_and_b32 v197, 0xffff0000, v42
  v_lshlrev_b32 v198, 16, v43
  v_and_b32 v199, 0xffff0000, v43
  v_lshlrev_b32 v200, 16, v44
  v_and_b32 v201, 0xffff0000, v44
  v_lshlrev_b32 v202, 16, v45
  v_and_b32 v203, 0xffff0000, v45
  v_lshlrev_b32 v204, 16, v46
  v_and_b32 v205, 0xffff0000, v46
  v_lshlrev_b32 v206, 16, v47
  v_and_b32 v207, 0xffff0000, v47
  v_mov_b32 v208, 0x358637bd
  v_fmac_f32 v208, v128, v48
  v_fmac_f32 v208, v129, v49
  v_fmac_f32 v208, v130, v50
  v_fmac_f32 v208, v131, v51
  v_fmac_f32 v208, v132, v52
  v_fmac_f32 v208, v133, v53
  v_fmac_f32 v208, v134, v54
  v_fmac_f32 v208, v135, v55
  v_fmac_f32 v208, v136, v56
  v_fmac_f32 v208, v137, v57
  v_fmac_f32 v208, v138, v58
  v_fmac_f32 v208, v139, v59
  v_fmac_f32 v208, v140, v60
  v_fmac_f32 v208, v141, v61
  v_fmac_f32 v208, v142, v62
  v_fmac_f32 v208, v143, v63
  v_fmac_f32 v208, v144, v64
  v_fmac_f32 v208, v145, v65
  v_fmac_f32 v208, v146, v66
  v_fmac_f32 v208, v147, v67
  v_rcp_f32 v208, v208
  v_mov_b32 v209, 0x358637bd
  v_fmac_f32 v209, v148, v68
  v_fmac_f32 v209, v149, v69
  v_fmac_f32 v209, v150, v70
  v_fmac_f32 v209, v151, v71
  v_fmac_f32 v209, v152, v72
  v_fmac_f32 v209, v153, v73
  v_fmac_f32 v209, v154, v74
  v_fmac_f32 v209, v155, v75
  v_fmac_f32 v209, v156, v76
  v_fmac_f32 v209, v157, v77
  v_fmac_f32 v209, v158, v78
  v_fmac_f32 v209, v159, v79
  v_fmac_f32 v209, v160, v80
  v_fmac_f32 v209, v161, v81
  v_fmac_f32 v209, v162, v82
  v_fmac_f32 v209, v163, v83
  v_fmac_f32 v209, v164, v84
  v_fmac_f32 v209, v165, v85
  v_fmac_f32 v209, v166, v86
  v_fmac_f32 v209, v167, v87
  v_rcp_f32 v209, v209
  v_mov_b32 v210, 0x358637bd
  v_fmac_f32 v210, v168, v88
  v_fmac_f32 v210, v169, v89
  v_fmac_f32 v210, v170, v90
  v_fmac_f32 v210, v171, v91
  v_fmac_f32 v210, v172, v92
  v_fmac_f32 v210, v173, v93
  v_fmac_f32 v210, v174, v94
  v_fmac_f32 v210, v175, v95
  v_fmac_f32 v210, v176, v96
  v_fmac_f32 v210, v177, v97
  v_fmac_f32 v210, v178, v98
  v_fmac_f32 v210, v179, v99
  v_fmac_f32 v210, v180, v100
  v_fmac_f32 v210, v181, v101
  v_fmac_f32 v210, v182, v102
  v_fmac_f32 v210, v183, v103
  v_fmac_f32 v210, v184, v104
  v_fmac_f32 v210, v185, v105
  v_fmac_f32 v210, v186, v106
  v_fmac_f32 v210, v187, v107
  v_rcp_f32 v210, v210
  v_mov_b32 v211, 0x358637bd
  v_fmac_f32 v211, v188, v108
  v_fmac_f32 v211, v189, v109
  v_fmac_f32 v211, v190, v110
  v_fmac_f32 v211, v191, v111
  v_fmac_f32 v211, v192, v112
  v_fmac_f32 v211, v193, v113
  v_fmac_f32 v211, v194, v114
  v_fmac_f32 v211, v195, v115
  v_fmac_f32 v211, v196, v116
  v_fmac_f32 v211, v197, v117
  v_fmac_f32 v211, v198, v118
  v_fmac_f32 v211, v199, v119
  v_fmac_f32 v211, v200, v120
  v_fmac_f32 v211, v201, v121
  v_fmac_f32 v211, v202, v122
  v_fmac_f32 v211, v203, v123
  v_fmac_f32 v211, v204, v124
  v_fmac_f32 v211, v205, v125
  v_fmac_f32 v211, v206, v126
  v_fmac_f32 v211, v207, v127
  v_rcp_f32 v211, v211
  s_nop 0
  v_mul_f32 v128, v128, v208
  v_mul_f32 v129, v129, v208
  v_mul_f32 v130, v130, v208
  v_mul_f32 v131, v131, v208
  v_mul_f32 v132, v132, v208
  v_mul_f32 v133, v133, v208
  v_mul_f32 v134, v134, v208
  v_mul_f32 v135, v135, v208
  v_mul_f32 v136, v136, v208
  v_mul_f32 v137, v137, v208
  v_mul_f32 v138, v138, v208
  v_mul_f32 v139, v139, v208
  v_mul_f32 v140, v140, v208
  v_mul_f32 v141, v141, v208
  v_mul_f32 v142, v142, v208
  v_mul_f32 v143, v143, v208
  v_mul_f32 v144, v144, v208
  v_mul_f32 v145, v145, v208
  v_mul_f32 v146, v146, v208
  v_mul_f32 v147, v147, v208
  v_mul_f32 v148, v148, v209
  v_mul_f32 v149, v149, v209
  v_mul_f32 v150, v150, v209
  v_mul_f32 v151, v151, v209
  v_mul_f32 v152, v152, v209
  v_mul_f32 v153, v153, v209
  v_mul_f32 v154, v154, v209
  v_mul_f32 v155, v155, v209
  v_mul_f32 v156, v156, v209
  v_mul_f32 v157, v157, v209
  v_mul_f32 v158, v158, v209
  v_mul_f32 v159, v159, v209
  v_mul_f32 v160, v160, v209
  v_mul_f32 v161, v161, v209
  v_mul_f32 v162, v162, v209
  v_mul_f32 v163, v163, v209
  v_mul_f32 v164, v164, v209
  v_mul_f32 v165, v165, v209
  v_mul_f32 v166, v166, v209
  v_mul_f32 v167, v167, v209
  v_mul_f32 v168, v168, v210
  v_mul_f32 v169, v169, v210
  v_mul_f32 v170, v170, v210
  v_mul_f32 v171, v171, v210
  v_mul_f32 v172, v172, v210
  v_mul_f32 v173, v173, v210
  v_mul_f32 v174, v174, v210
  v_mul_f32 v175, v175, v210
  v_mul_f32 v176, v176, v210
  v_mul_f32 v177, v177, v210
  v_mul_f32 v178, v178, v210
  v_mul_f32 v179, v179, v210
  v_mul_f32 v180, v180, v210
  v_mul_f32 v181, v181, v210
  v_mul_f32 v182, v182, v210
  v_mul_f32 v183, v183, v210
  v_mul_f32 v184, v184, v210
  v_mul_f32 v185, v185, v210
  v_mul_f32 v186, v186, v210
  v_mul_f32 v187, v187, v210
  v_mul_f32 v188, v188, v211
  v_mul_f32 v189, v189, v211
  v_mul_f32 v190, v190, v211
  v_mul_f32 v191, v191, v211
  v_mul_f32 v192, v192, v211
  v_mul_f32 v193, v193, v211
  v_mul_f32 v194, v194, v211
  v_mul_f32 v195, v195, v211
  v_mul_f32 v196, v196, v211
  v_mul_f32 v197, v197, v211
  v_mul_f32 v198, v198, v211
  v_mul_f32 v199, v199, v211
  v_mul_f32 v200, v200, v211
  v_mul_f32 v201, v201, v211
  v_mul_f32 v202, v202, v211
  v_mul_f32 v203, v203, v211
  v_mul_f32 v204, v204, v211
  v_mul_f32 v205, v205, v211
  v_mul_f32 v206, v206, v211
  v_mul_f32 v207, v207, v211
  v_cvt_pk_bf16_f32 v8, v128, v129
  v_cvt_pk_bf16_f32 v9, v130, v131
  v_cvt_pk_bf16_f32 v10, v132, v133
  v_cvt_pk_bf16_f32 v11, v134, v135
  v_cvt_pk_bf16_f32 v12, v136, v137
  v_cvt_pk_bf16_f32 v13, v138, v139
  v_cvt_pk_bf16_f32 v14, v140, v141
  v_cvt_pk_bf16_f32 v15, v142, v143
  v_cvt_pk_bf16_f32 v16, v144, v145
  v_cvt_pk_bf16_f32 v17, v146, v147
  v_cvt_pk_bf16_f32 v18, v148, v149
  v_cvt_pk_bf16_f32 v19, v150, v151
  v_cvt_pk_bf16_f32 v20, v152, v153
  v_cvt_pk_bf16_f32 v21, v154, v155
  v_cvt_pk_bf16_f32 v22, v156, v157
  v_cvt_pk_bf16_f32 v23, v158, v159
  v_cvt_pk_bf16_f32 v24, v160, v161
  v_cvt_pk_bf16_f32 v25, v162, v163
  v_cvt_pk_bf16_f32 v26, v164, v165
  v_cvt_pk_bf16_f32 v27, v166, v167
  v_cvt_pk_bf16_f32 v28, v168, v169
  v_cvt_pk_bf16_f32 v29, v170, v171
  v_cvt_pk_bf16_f32 v30, v172, v173
  v_cvt_pk_bf16_f32 v31, v174, v175
  v_cvt_pk_bf16_f32 v32, v176, v177
  v_cvt_pk_bf16_f32 v33, v178, v179
  v_cvt_pk_bf16_f32 v34, v180, v181
  v_cvt_pk_bf16_f32 v35, v182, v183
  v_cvt_pk_bf16_f32 v36, v184, v185
  v_cvt_pk_bf16_f32 v37, v186, v187
  v_cvt_pk_bf16_f32 v38, v188, v189
  v_cvt_pk_bf16_f32 v39, v190, v191
  v_cvt_pk_bf16_f32 v40, v192, v193
  v_cvt_pk_bf16_f32 v41, v194, v195
  v_cvt_pk_bf16_f32 v42, v196, v197
  v_cvt_pk_bf16_f32 v43, v198, v199
  v_cvt_pk_bf16_f32 v44, v200, v201
  v_cvt_pk_bf16_f32 v45, v202, v203
  v_cvt_pk_bf16_f32 v46, v204, v205
  v_cvt_pk_bf16_f32 v47, v206, v207
  s_mul_i32 s52, s49, 40960
  s_add_u32 s52, s52, 184549376
  buffer_store_dwordx4 v[8:11], v5, s[40:43], s52 offen offset:0 sc1
  buffer_store_dwordx4 v[12:15], v5, s[40:43], s52 offen offset:16 sc1
  buffer_store_dwordx4 v[16:19], v5, s[40:43], s52 offen offset:32 sc1
  buffer_store_dwordx4 v[20:23], v5, s[40:43], s52 offen offset:48 sc1
  buffer_store_dwordx4 v[24:27], v5, s[40:43], s52 offen offset:64 sc1
  buffer_store_dwordx4 v[28:31], v5, s[40:43], s52 offen offset:80 sc1
  buffer_store_dwordx4 v[32:35], v5, s[40:43], s52 offen offset:96 sc1
  buffer_store_dwordx4 v[36:39], v5, s[40:43], s52 offen offset:112 sc1
  buffer_store_dwordx4 v[40:43], v5, s[40:43], s52 offen offset:128 sc1
  buffer_store_dwordx4 v[44:47], v5, s[40:43], s52 offen offset:144 sc1
  s_waitcnt vmcnt(0)
  s_barrier
  s_cmp_eq_u32 s48, 0
  s_cbranch_scc0 SG_166
  s_mov_b32 s95, 168
  v_mov_b32 v1, 1
  s_mov_b64 exec, 1
  buffer_atomic_add v1, off, s[96:99], s95
  s_mov_b64 exec, -1
SG_166:
W_LOOP_T3:
  s_branch W_LOOP_T4
W_A3_T:
  s_cmp_eq_u32 s48, 0
  s_cbranch_scc0 WX_169
  s_mov_b32 s95, 168
WG_167:
  buffer_load_dword v1, off, s[96:99], s95 sc1
  s_waitcnt vmcnt(0)
  v_cmp_gt_u32 vcc, 64, v1
  s_cbranch_vccz WX_169
  s_sleep 16
  s_sub_u32 s101, s101, 1
  s_cbranch_scc0 WG_167
  s_mov_b32 s101, 0
WX_169:
  s_barrier
  v_and_b32 v1, 63, v0
  v_lshrrev_b32 v14, 6, v0
  s_nop 0
  v_readfirstlane_b32 s48, v14
  v_and_b32 v14, 31, v1
  v_and_b32 v16, 0x13, v14
  v_and_b32 v17, 4, v14
  v_lshl_add_u32 v16, v17, 1, v16
  v_and_b32 v17, 8, v14
  v_lshrrev_b32 v17, 1, v17
  v_add_u32 v14, v16, v17
  v_lshrrev_b32 v15, 5, v1
  v_lshrrev_b32 v16, 1, v14
  v_and_b32 v16, 7, v16
  s_mul_i32 s55, s48, 8192
  v_lshlrev_b32 v17, 7, v14
  v_add_u32 v17, s55, v17
  v_add_u32 v18, 0, v15
  v_xor_b32 v18, v18, v16
  v_lshlrev_b32 v18, 4, v18
  v_add_u32 v2, v17, v18
  v_add_u32 v18, 2, v15
  v_xor_b32 v18, v18, v16
  v_lshlrev_b32 v18, 4, v18
  v_add_u32 v3, v17, v18
  v_add_u32 v18, 4, v15
  v_xor_b32 v18, v18, v16
  v_lshlrev_b32 v18, 4, v18
  v_add_u32 v4, v17, v18
  v_add_u32 v18, 6, v15
  v_xor_b32 v18, v18, v16
  v_lshlrev_b32 v18, 4, v18
  v_add_u32 v5, v17, v18
  v_lshlrev_b32 v13, 5, v14
  v_lshlrev_b32 v18, 4, v15
  v_add_u32 v13, v13, v18
  v_and_b32 v16, 15, v1
  v_lshrrev_b32 v17, 2, v16
  v_and_b32 v18, 3, v16
  v_lshrrev_b32 v22, 1, v18
  v_and_b32 v18, 1, v18
  v_lshl_add_u32 v18, v18, 1, v22
  v_lshrrev_b32 v19, 4, v1
  v_and_b32 v20, 1, v19
  v_lshlrev_b32 v20, 5, v20
  v_lshlrev_b32 v18, 3, v18
  v_add_u32 v20, v20, v18
  v_lshlrev_b32 v21, 3, v15
  v_add_u32 v21, v21, v17
  v_lshlrev_b32 v21, 6, v21
  v_add_u32 v21, v21, v20
  v_add_u32 v6, 65536, v21
  v_add_u32 v7, 90112, v21
  v_and_b32 v18, 3, v16
  v_lshlrev_b32 v18, 3, v18
  v_and_b32 v20, 1, v19
  v_lshlrev_b32 v20, 5, v20
  v_add_u32 v20, v20, v18
  v_lshlrev_b32 v21, 3, v15
  v_add_u32 v21, v21, v17
  v_lshlrev_b32 v21, 6, v21
  v_add_u32 v21, v21, v20
  v_add_u32 v8, 65536, v21
  v_add_u32 v9, 90112, v21
  v_lshrrev_b32 v16, 4, v1
  v_add_u32 v16, 0, v16
  v_and_b32 v17, 7, v1
  v_xor_b32 v16, v16, v17
  v_lshlrev_b32 v16, 4, v16
  v_lshrrev_b32 v17, 3, v1
  v_mul_u32_u24 v17, 1280, v17
  v_add_u32 v10, v16, v17
  v_lshrrev_b32 v16, 4, v1
  v_add_u32 v16, 4, v16
  v_and_b32 v17, 7, v1
  v_xor_b32 v16, v16, v17
  v_lshlrev_b32 v16, 4, v16
  v_lshrrev_b32 v17, 3, v1
  v_mul_u32_u24 v17, 1280, v17
  v_add_u32 v11, v16, v17
  s_mul_i32 s50, s48, 8192
  s_lshl_b32 s52, s48, 10
  s_mov_b32 s32, s28
  s_mov_b32 s33, s29
  s_mov_b32 s34, 268435456
  s_mov_b32 s35, 0x20000
  s_mov_b32 s36, s28
  s_mov_b32 s37, s29
  s_mov_b32 s38, 268435456
  s_mov_b32 s39, 0x20000
  s_mov_b32 s44, s24
  s_mov_b32 s45, s25
  s_mov_b32 s46, 5242880
  s_mov_b32 s47, 0x20000
  s_mov_b32 s68, s93
  s_lshr_b32 s66, s68, 2
  s_and_b32 s65, s68, 3
  s_lshl_b32 s58, s66, 8
  s_mul_i32 s59, s65, 320
  s_add_u32 s59, s59, 188743680
  s_mov_b32 s53, 1280
  s_mul_i32 s55, s48, 64
  s_add_u32 s55, s55, s58
  s_mul_i32 s49, s55, 1280
  s_lshl_b32 s55, s48, 4
  s_mul_i32 s51, s55, s53
  s_add_u32 s51, s51, s59
  s_lshl_b32 s54, s53, 6
  v_lshrrev_b32 v14, 2, v1
  v_mul_lo_u32 v14, v14, s53
  v_and_b32 v15, 3, v1
  v_lshlrev_b32 v15, 4, v15
  v_add_u32 v12, v14, v15
  s_add_u32 s49, s49, 184549376
  s_mul_i32 s63, s48, 64
  s_add_u32 s63, s63, s58
  s_mul_i32 s56, s63, 2560
  s_mul_i32 s64, s65, 320
  s_add_u32 s56, s56, s64
  s_add_u32 s57, s56, 81920
  v_lshrrev_b32 v15, 5, v13
  v_mul_u32_u24 v15, 2560, v15
  v_lshrrev_b32 v14, 5, v1
  v_lshl_add_u32 v15, v14, 4, v15
  v_mov_b32 v31, v6
  s_add_u32 m0, s50, 0
  s_add_u32 s55, s49, 0
  buffer_load_dwordx4 v10, s[32:35], s55 offen sc1 lds
  s_add_u32 m0, s50, 1024
  s_add_u32 s55, s49, 10240
  buffer_load_dwordx4 v11, s[32:35], s55 offen sc1 lds
  s_add_u32 m0, s50, 2048
  s_add_u32 s55, s49, 20480
  buffer_load_dwordx4 v10, s[32:35], s55 offen sc1 lds
  s_add_u32 m0, s50, 3072
  s_add_u32 s55, s49, 30720
  buffer_load_dwordx4 v11, s[32:35], s55 offen sc1 lds
  s_add_u32 m0, s50, 4096
  s_add_u32 s55, s49, 40960
  buffer_load_dwordx4 v10, s[32:35], s55 offen sc1 lds
  s_add_u32 m0, s50, 5120
  s_add_u32 s55, s49, 51200
  buffer_load_dwordx4 v11, s[32:35], s55 offen sc1 lds
  s_add_u32 m0, s50, 6144
  s_add_u32 s55, s49, 61440
  buffer_load_dwordx4 v10, s[32:35], s55 offen sc1 lds
  s_add_u32 m0, s50, 7168
  s_add_u32 s55, s49, 71680
  buffer_load_dwordx4 v11, s[32:35], s55 offen sc1 lds
  s_add_u32 s49, s49, 128
  s_add_u32 m0, s52, 65536
  s_add_u32 s55, s51, 0
  buffer_load_dwordx4 v12, s[36:39], s55 offen sc1 lds
  s_add_u32 m0, s52, 69632
  s_add_u32 s55, s51, 64
  buffer_load_dwordx4 v12, s[36:39], s55 offen sc1 lds
  s_add_u32 m0, s52, 73728
  s_add_u32 s55, s51, 128
  buffer_load_dwordx4 v12, s[36:39], s55 offen sc1 lds
  s_add_u32 m0, s52, 77824
  s_add_u32 s55, s51, 192
  buffer_load_dwordx4 v12, s[36:39], s55 offen sc1 lds
  s_add_u32 m0, s52, 81920
  s_add_u32 s55, s51, 256
  buffer_load_dwordx4 v12, s[36:39], s55 offen sc1 lds
  s_add_u32 s51, s51, s54
  s_add_u32 m0, s50, 32768
  s_add_u32 s55, s49, 0
  buffer_load_dwordx4 v10, s[32:35], s55 offen sc1 lds
  s_add_u32 m0, s50, 33792
  s_add_u32 s55, s49, 10240
  buffer_load_dwordx4 v11, s[32:35], s55 offen sc1 lds
  s_add_u32 m0, s50, 34816
  s_add_u32 s55, s49, 20480
  buffer_load_dwordx4 v10, s[32:35], s55 offen sc1 lds
  s_add_u32 m0, s50, 35840
  s_add_u32 s55, s49, 30720
  buffer_load_dwordx4 v11, s[32:35], s55 offen sc1 lds
  s_add_u32 m0, s50, 36864
  s_add_u32 s55, s49, 40960
  buffer_load_dwordx4 v10, s[32:35], s55 offen sc1 lds
  s_add_u32 m0, s50, 37888
  s_add_u32 s55, s49, 51200
  buffer_load_dwordx4 v11, s[32:35], s55 offen sc1 lds
  s_add_u32 m0, s50, 38912
  s_add_u32 s55, s49, 61440
  buffer_load_dwordx4 v10, s[32:35], s55 offen sc1 lds
  s_add_u32 m0, s50, 39936
  s_add_u32 s55, s49, 71680
  buffer_load_dwordx4 v11, s[32:35], s55 offen sc1 lds
  s_add_u32 s49, s49, 128
  s_add_u32 m0, s52, 90112
  s_add_u32 s55, s51, 0
  buffer_load_dwordx4 v12, s[36:39], s55 offen sc1 lds
  s_add_u32 m0, s52, 94208
  s_add_u32 s55, s51, 64
  buffer_load_dwordx4 v12, s[36:39], s55 offen sc1 lds
  s_add_u32 m0, s52, 98304
  s_add_u32 s55, s51, 128
  buffer_load_dwordx4 v12, s[36:39], s55 offen sc1 lds
  s_add_u32 m0, s52, 102400
  s_add_u32 s55, s51, 192
  buffer_load_dwordx4 v12, s[36:39], s55 offen sc1 lds
  s_add_u32 m0, s52, 106496
  s_add_u32 s55, s51, 256
  buffer_load_dwordx4 v12, s[36:39], s55 offen sc1 lds
  s_add_u32 s51, s51, s54
  s_add_u32 m0, s52, 114688
  s_add_u32 s55, s51, 0
  buffer_load_dwordx4 v12, s[36:39], s55 offen sc1 lds
  s_add_u32 m0, s52, 118784
  s_add_u32 s55, s51, 64
  buffer_load_dwordx4 v12, s[36:39], s55 offen sc1 lds
  s_add_u32 m0, s52, 122880
  s_add_u32 s55, s51, 128
  buffer_load_dwordx4 v12, s[36:39], s55 offen sc1 lds
  s_add_u32 m0, s52, 126976
  s_add_u32 s55, s51, 192
  buffer_load_dwordx4 v12, s[36:39], s55 offen sc1 lds
  s_add_u32 m0, s52, 131072
  s_add_u32 s55, s51, 256
  buffer_load_dwordx4 v12, s[36:39], s55 offen sc1 lds
  s_add_u32 s51, s51, s54
  s_mov_b32 s81, 0
  s_waitcnt vmcnt(18)
  s_barrier
  ds_read_b128 a[24:27], v2 offset:0
  ds_read_b128 a[28:31], v2 offset:4096
  ds_read_b64_tr_b16 a[0:1], v6 offset:0
  ds_read_b64_tr_b16 a[2:3], v6 offset:256
  ds_read_b64_tr_b16 a[4:5], v6 offset:4096
  ds_read_b64_tr_b16 a[6:7], v6 offset:4352
  ds_read_b64_tr_b16 a[8:9], v6 offset:8192
  ds_read_b64_tr_b16 a[10:11], v6 offset:8448
  ds_read_b64_tr_b16 a[12:13], v6 offset:12288
  ds_read_b64_tr_b16 a[14:15], v6 offset:12544
  ds_read_b64_tr_b16 a[16:17], v6 offset:16384
  ds_read_b64_tr_b16 a[18:19], v6 offset:16640
  s_waitcnt lgkmcnt(0)
  v_mfma_f32_32x32x16_bf16 v[64:79], a[0:3], a[24:27], 0
  ds_read_b128 a[56:59], v3 offset:0
  ds_read_b128 a[60:63], v3 offset:4096
  ds_read_b64_tr_b16 a[32:33], v6 offset:1024
  v_mfma_f32_32x32x16_bf16 v[80:95], a[0:3], a[28:31], 0
  ds_read_b64_tr_b16 a[34:35], v6 offset:1280
  ds_read_b64_tr_b16 a[36:37], v6 offset:5120
  ds_read_b64_tr_b16 a[38:39], v6 offset:5376
  v_mfma_f32_32x32x16_bf16 v[96:111], a[4:7], a[24:27], 0
  ds_read_b64_tr_b16 a[40:41], v6 offset:9216
  ds_read_b64_tr_b16 a[42:43], v6 offset:9472
  ds_read_b64_tr_b16 a[44:45], v6 offset:13312
  v_mfma_f32_32x32x16_bf16 v[112:127], a[4:7], a[28:31], 0
  ds_read_b64_tr_b16 a[46:47], v6 offset:13568
  ds_read_b64_tr_b16 a[48:49], v6 offset:17408
  ds_read_b64_tr_b16 a[50:51], v6 offset:17664
  v_mfma_f32_32x32x16_bf16 v[128:143], a[8:11], a[24:27], 0
  v_mfma_f32_32x32x16_bf16 v[144:159], a[8:11], a[28:31], 0
  v_mfma_f32_32x32x16_bf16 v[160:175], a[12:15], a[24:27], 0
  v_mfma_f32_32x32x16_bf16 v[176:191], a[12:15], a[28:31], 0
  v_mfma_f32_32x32x16_bf16 v[192:207], a[16:19], a[24:27], 0
  v_mfma_f32_32x32x16_bf16 v[208:223], a[16:19], a[28:31], 0
  s_waitcnt lgkmcnt(0)
  v_mfma_f32_32x32x16_bf16 v[64:79], a[32:35], a[56:59], v[64:79]
  ds_read_b128 a[24:27], v4 offset:0
  ds_read_b128 a[28:31], v4 offset:4096
  ds_read_b64_tr_b16 a[0:1], v6 offset:2048
  v_mfma_f32_32x32x16_bf16 v[80:95], a[32:35], a[60:63], v[80:95]
  ds_read_b64_tr_b16 a[2:3], v6 offset:2304
  ds_read_b64_tr_b16 a[4:5], v6 offset:6144
  ds_read_b64_tr_b16 a[6:7], v6 offset:6400
  v_mfma_f32_32x32x16_bf16 v[96:111], a[36:39], a[56:59], v[96:111]
  ds_read_b64_tr_b16 a[8:9], v6 offset:10240
  ds_read_b64_tr_b16 a[10:11], v6 offset:10496
  ds_read_b64_tr_b16 a[12:13], v6 offset:14336
  v_mfma_f32_32x32x16_bf16 v[112:127], a[36:39], a[60:63], v[112:127]
  ds_read_b64_tr_b16 a[14:15], v6 offset:14592
  ds_read_b64_tr_b16 a[16:17], v6 offset:18432
  ds_read_b64_tr_b16 a[18:19], v6 offset:18688
  v_mfma_f32_32x32x16_bf16 v[128:143], a[40:43], a[56:59], v[128:143]
  v_mfma_f32_32x32x16_bf16 v[144:159], a[40:43], a[60:63], v[144:159]
  v_mfma_f32_32x32x16_bf16 v[160:175], a[44:47], a[56:59], v[160:175]
  v_mfma_f32_32x32x16_bf16 v[176:191], a[44:47], a[60:63], v[176:191]
  v_mfma_f32_32x32x16_bf16 v[192:207], a[48:51], a[56:59], v[192:207]
  v_mfma_f32_32x32x16_bf16 v[208:223], a[48:51], a[60:63], v[208:223]
  s_waitcnt lgkmcnt(0)
  v_mfma_f32_32x32x16_bf16 v[64:79], a[0:3], a[24:27], v[64:79]
  ds_read_b128 a[56:59], v5 offset:0
  ds_read_b128 a[60:63], v5 offset:4096
  ds_read_b64_tr_b16 a[32:33], v6 offset:3072
  v_mfma_f32_32x32x16_bf16 v[80:95], a[0:3], a[28:31], v[80:95]
  ds_read_b64_tr_b16 a[34:35], v6 offset:3328
  ds_read_b64_tr_b16 a[36:37], v6 offset:7168
  ds_read_b64_tr_b16 a[38:39], v6 offset:7424
  v_mfma_f32_32x32x16_bf16 v[96:111], a[4:7], a[24:27], v[96:111]
  ds_read_b64_tr_b16 a[40:41], v6 offset:11264
  ds_read_b64_tr_b16 a[42:43], v6 offset:11520
  ds_read_b64_tr_b16 a[44:45], v6 offset:15360
  v_mfma_f32_32x32x16_bf16 v[112:127], a[4:7], a[28:31], v[112:127]
  ds_read_b64_tr_b16 a[46:47], v6 offset:15616
  ds_read_b64_tr_b16 a[48:49], v6 offset:19456
  ds_read_b64_tr_b16 a[50:51], v6 offset:19712
  v_mfma_f32_32x32x16_bf16 v[128:143], a[8:11], a[24:27], v[128:143]
  v_mfma_f32_32x32x16_bf16 v[144:159], a[8:11], a[28:31], v[144:159]
  v_mfma_f32_32x32x16_bf16 v[160:175], a[12:15], a[24:27], v[160:175]
  v_mfma_f32_32x32x16_bf16 v[176:191], a[12:15], a[28:31], v[176:191]
  s_add_u32 s83, s81, s52
  s_add_u32 s83, s83, 65536
  v_mfma_f32_32x32x16_bf16 v[192:207], a[16:19], a[24:27], v[192:207]
  s_add_u32 s81, s81, 24576
  s_cmp_eq_u32 s81, 73728
  s_cselect_b32 s81, 0, s81
  v_mfma_f32_32x32x16_bf16 v[208:223], a[16:19], a[28:31], v[208:223]
  v_add_u32 v30, s81, v31
  s_waitcnt lgkmcnt(0)
  v_mfma_f32_32x32x16_bf16 v[64:79], a[32:35], a[56:59], v[64:79]
  v_mfma_f32_32x32x16_bf16 v[80:95], a[32:35], a[60:63], v[80:95]
  s_waitcnt vmcnt(5)
  s_barrier
  v_mov_b32 v7, v30
  s_mov_b32 s82, s83
  ds_read_b128 a[24:27], v2 offset:32768
  ds_read_b128 a[28:31], v2 offset:36864
  ds_read_b64_tr_b16 a[0:1], v7 offset:0
  v_mfma_f32_32x32x16_bf16 v[96:111], a[36:39], a[56:59], v[96:111]
  ds_read_b64_tr_b16 a[2:3], v7 offset:256
  ds_read_b64_tr_b16 a[4:5], v7 offset:4096
  ds_read_b64_tr_b16 a[6:7], v7 offset:4352
  v_mfma_f32_32x32x16_bf16 v[112:127], a[36:39], a[60:63], v[112:127]
  ds_read_b64_tr_b16 a[8:9], v7 offset:8192
  ds_read_b64_tr_b16 a[10:11], v7 offset:8448
  ds_read_b64_tr_b16 a[12:13], v7 offset:12288
  s_add_u32 m0, s50, 0
  s_add_u32 s55, s49, 0
  buffer_load_dwordx4 v10, s[32:35], s55 offen sc1 lds
  v_mfma_f32_32x32x16_bf16 v[128:143], a[40:43], a[56:59], v[128:143]
  ds_read_b64_tr_b16 a[14:15], v7 offset:12544
  ds_read_b64_tr_b16 a[16:17], v7 offset:16384
  ds_read_b64_tr_b16 a[18:19], v7 offset:16640
  s_add_u32 m0, s50, 1024
  s_add_u32 s55, s49, 10240
  buffer_load_dwordx4 v11, s[32:35], s55 offen sc1 lds
  v_mfma_f32_32x32x16_bf16 v[144:159], a[40:43], a[60:63], v[144:159]
  s_add_u32 m0, s50, 2048
  s_add_u32 s55, s49, 20480
  buffer_load_dwordx4 v10, s[32:35], s55 offen sc1 lds
  v_mfma_f32_32x32x16_bf16 v[160:175], a[44:47], a[56:59], v[160:175]
  s_add_u32 m0, s50, 3072
  s_add_u32 s55, s49, 30720
  buffer_load_dwordx4 v11, s[32:35], s55 offen sc1 lds
  v_mfma_f32_32x32x16_bf16 v[176:191], a[44:47], a[60:63], v[176:191]
  s_add_u32 m0, s50, 4096
  s_add_u32 s55, s49, 40960
  buffer_load_dwordx4 v10, s[32:35], s55 offen sc1 lds
  v_mfma_f32_32x32x16_bf16 v[192:207], a[48:51], a[56:59], v[192:207]
  s_add_u32 m0, s50, 5120
  s_add_u32 s55, s49, 51200
  buffer_load_dwordx4 v11, s[32:35], s55 offen sc1 lds
  v_mfma_f32_32x32x16_bf16 v[208:223], a[48:51], a[60:63], v[208:223]
  s_waitcnt lgkmcnt(0)
  v_mfma_f32_32x32x16_bf16 v[64:79], a[0:3], a[24:27], v[64:79]
  ds_read_b128 a[56:59], v3 offset:32768
  ds_read_b128 a[60:63], v3 offset:36864
  ds_read_b64_tr_b16 a[32:33], v7 offset:1024
  v_mfma_f32_32x32x16_bf16 v[80:95], a[0:3], a[28:31], v[80:95]
  ds_read_b64_tr_b16 a[34:35], v7 offset:1280
  ds_read_b64_tr_b16 a[36:37], v7 offset:5120
  ds_read_b64_tr_b16 a[38:39], v7 offset:5376
  v_mfma_f32_32x32x16_bf16 v[96:111], a[4:7], a[24:27], v[96:111]
  ds_read_b64_tr_b16 a[40:41], v7 offset:9216
  ds_read_b64_tr_b16 a[42:43], v7 offset:9472
  ds_read_b64_tr_b16 a[44:45], v7 offset:13312
  v_mfma_f32_32x32x16_bf16 v[112:127], a[4:7], a[28:31], v[112:127]
  ds_read_b64_tr_b16 a[46:47], v7 offset:13568
  ds_read_b64_tr_b16 a[48:49], v7 offset:17408
  ds_read_b64_tr_b16 a[50:51], v7 offset:17664
  v_mfma_f32_32x32x16_bf16 v[128:143], a[8:11], a[24:27], v[128:143]
  s_add_u32 m0, s50, 6144
  s_add_u32 s55, s49, 61440
  buffer_load_dwordx4 v10, s[32:35], s55 offen sc1 lds
  v_mfma_f32_32x32x16_bf16 v[144:159], a[8:11], a[28:31], v[144:159]
  s_add_u32 m0, s50, 7168
  s_add_u32 s55, s49, 71680
  buffer_load_dwordx4 v11, s[32:35], s55 offen sc1 lds
  s_add_u32 s49, s49, 128
  v_mfma_f32_32x32x16_bf16 v[160:175], a[12:15], a[24:27], v[160:175]
  s_add_u32 m0, s82, 0
  s_add_u32 s55, s51, 0
  buffer_load_dwordx4 v12, s[36:39], s55 offen sc1 lds
  v_mfma_f32_32x32x16_bf16 v[176:191], a[12:15], a[28:31], v[176:191]
  s_add_u32 m0, s82, 4096
  s_add_u32 s55, s51, 64
  buffer_load_dwordx4 v12, s[36:39], s55 offen sc1 lds
  v_mfma_f32_32x32x16_bf16 v[192:207], a[16:19], a[24:27], v[192:207]
  s_add_u32 m0, s82, 8192
  s_add_u32 s55, s51, 128
  buffer_load_dwordx4 v12, s[36:39], s55 offen sc1 lds
  v_mfma_f32_32x32x16_bf16 v[208:223], a[16:19], a[28:31], v[208:223]
  s_waitcnt lgkmcnt(0)
  v_mfma_f32_32x32x16_bf16 v[64:79], a[32:35], a[56:59], v[64:79]
  ds_read_b128 a[24:27], v4 offset:32768
  ds_read_b128 a[28:31], v4 offset:36864
  ds_read_b64_tr_b16 a[0:1], v7 offset:2048
  v_mfma_f32_32x32x16_bf16 v[80:95], a[32:35], a[60:63], v[80:95]
  ds_read_b64_tr_b16 a[2:3], v7 offset:2304
  ds_read_b64_tr_b16 a[4:5], v7 offset:6144
  ds_read_b64_tr_b16 a[6:7], v7 offset:6400
  v_mfma_f32_32x32x16_bf16 v[96:111], a[36:39], a[56:59], v[96:111]
  ds_read_b64_tr_b16 a[8:9], v7 offset:10240
  ds_read_b64_tr_b16 a[10:11], v7 offset:10496
  ds_read_b64_tr_b16 a[12:13], v7 offset:14336
  v_mfma_f32_32x32x16_bf16 v[112:127], a[36:39], a[60:63], v[112:127]
  ds_read_b64_tr_b16 a[14:15], v7 offset:14592
  ds_read_b64_tr_b16 a[16:17], v7 offset:18432
  ds_read_b64_tr_b16 a[18:19], v7 offset:18688
  v_mfma_f32_32x32x16_bf16 v[128:143], a[40:43], a[56:59], v[128:143]
  v_mfma_f32_32x32x16_bf16 v[144:159], a[40:43], a[60:63], v[144:159]
  v_mfma_f32_32x32x16_bf16 v[160:175], a[44:47], a[56:59], v[160:175]
  v_mfma_f32_32x32x16_bf16 v[176:191], a[44:47], a[60:63], v[176:191]
  s_add_u32 m0, s82, 12288
  s_add_u32 s55, s51, 192
  buffer_load_dwordx4 v12, s[36:39], s55 offen sc1 lds
  v_mfma_f32_32x32x16_bf16 v[192:207], a[48:51], a[56:59], v[192:207]
  s_add_u32 m0, s82, 16384
  s_add_u32 s55, s51, 256
  buffer_load_dwordx4 v12, s[36:39], s55 offen sc1 lds
  s_add_u32 s51, s51, s54
  v_mfma_f32_32x32x16_bf16 v[208:223], a[48:51], a[60:63], v[208:223]
  s_waitcnt lgkmcnt(0)
  v_mfma_f32_32x32x16_bf16 v[64:79], a[0:3], a[24:27], v[64:79]
  ds_read_b128 a[56:59], v5 offset:32768
  ds_read_b128 a[60:63], v5 offset:36864
  ds_read_b64_tr_b16 a[32:33], v7 offset:3072
  v_mfma_f32_32x32x16_bf16 v[80:95], a[0:3], a[28:31], v[80:95]
  ds_read_b64_tr_b16 a[34:35], v7 offset:3328
  ds_read_b64_tr_b16 a[36:37], v7 offset:7168
  ds_read_b64_tr_b16 a[38:39], v7 offset:7424
  v_mfma_f32_32x32x16_bf16 v[96:111], a[4:7], a[24:27], v[96:111]
  ds_read_b64_tr_b16 a[40:41], v7 offset:11264
  ds_read_b64_tr_b16 a[42:43], v7 offset:11520
  ds_read_b64_tr_b16 a[44:45], v7 offset:15360
  v_mfma_f32_32x32x16_bf16 v[112:127], a[4:7], a[28:31], v[112:127]
  ds_read_b64_tr_b16 a[46:47], v7 offset:15616
  ds_read_b64_tr_b16 a[48:49], v7 offset:19456
  ds_read_b64_tr_b16 a[50:51], v7 offset:19712
  v_mfma_f32_32x32x16_bf16 v[128:143], a[8:11], a[24:27], v[128:143]
  v_mfma_f32_32x32x16_bf16 v[144:159], a[8:11], a[28:31], v[144:159]
  v_mfma_f32_32x32x16_bf16 v[160:175], a[12:15], a[24:27], v[160:175]
  v_mfma_f32_32x32x16_bf16 v[176:191], a[12:15], a[28:31], v[176:191]
  s_add_u32 s83, s81, s52
  s_add_u32 s83, s83, 65536
  v_mfma_f32_32x32x16_bf16 v[192:207], a[16:19], a[24:27], v[192:207]
  s_add_u32 s81, s81, 24576
  s_cmp_eq_u32 s81, 73728
  s_cselect_b32 s81, 0, s81
  v_mfma_f32_32x32x16_bf16 v[208:223], a[16:19], a[28:31], v[208:223]
  v_add_u32 v30, s81, v31
  s_waitcnt lgkmcnt(0)
  v_mfma_f32_32x32x16_bf16 v[64:79], a[32:35], a[56:59], v[64:79]
  v_mfma_f32_32x32x16_bf16 v[80:95], a[32:35], a[60:63], v[80:95]
  s_waitcnt vmcnt(5)
  s_barrier
  v_mov_b32 v6, v30
  s_mov_b32 s82, s83
  ds_read_b128 a[24:27], v2 offset:0
  ds_read_b128 a[28:31], v2 offset:4096
  ds_read_b64_tr_b16 a[0:1], v6 offset:0
  v_mfma_f32_32x32x16_bf16 v[96:111], a[36:39], a[56:59], v[96:111]
  ds_read_b64_tr_b16 a[2:3], v6 offset:256
  ds_read_b64_tr_b16 a[4:5], v6 offset:4096
  ds_read_b64_tr_b16 a[6:7], v6 offset:4352
  v_mfma_f32_32x32x16_bf16 v[112:127], a[36:39], a[60:63], v[112:127]
  ds_read_b64_tr_b16 a[8:9], v6 offset:8192
  ds_read_b64_tr_b16 a[10:11], v6 offset:8448
  ds_read_b64_tr_b16 a[12:13], v6 offset:12288
  s_add_u32 m0, s50, 32768
  s_add_u32 s55, s49, 0
  buffer_load_dwordx4 v10, s[32:35], s55 offen sc1 lds
  v_mfma_f32_32x32x16_bf16 v[128:143], a[40:43], a[56:59], v[128:143]
  ds_read_b64_tr_b16 a[14:15], v6 offset:12544
  ds_read_b64_tr_b16 a[16:17], v6 offset:16384
  ds_read_b64_tr_b16 a[18:19], v6 offset:16640
  s_add_u32 m0, s50, 33792
  s_add_u32 s55, s49, 10240
  buffer_load_dwordx4 v11, s[32:35], s55 offen sc1 lds
  v_mfma_f32_32x32x16_bf16 v[144:159], a[40:43], a[60:63], v[144:159]
  s_add_u32 m0, s50, 34816
  s_add_u32 s55, s49, 20480
  buffer_load_dwordx4 v10, s[32:35], s55 offen sc1 lds
  v_mfma_f32_32x32x16_bf16 v[160:175], a[44:47], a[56:59], v[160:175]
  s_add_u32 m0, s50, 35840
  s_add_u32 s55, s49, 30720
  buffer_load_dwordx4 v11, s[32:35], s55 offen sc1 lds
  v_mfma_f32_32x32x16_bf16 v[176:191], a[44:47], a[60:63], v[176:191]
  s_add_u32 m0, s50, 36864
  s_add_u32 s55, s49, 40960
  buffer_load_dwordx4 v10, s[32:35], s55 offen sc1 lds
  v_mfma_f32_32x32x16_bf16 v[192:207], a[48:51], a[56:59], v[192:207]
  s_add_u32 m0, s50, 37888
  s_add_u32 s55, s49, 51200
  buffer_load_dwordx4 v11, s[32:35], s55 offen sc1 lds
  v_mfma_f32_32x32x16_bf16 v[208:223], a[48:51], a[60:63], v[208:223]
  s_mov_b32 s80, 0
PL_170:
  s_waitcnt lgkmcnt(0)
  v_mfma_f32_32x32x16_bf16 v[64:79], a[0:3], a[24:27], v[64:79]
  ds_read_b128 a[56:59], v3 offset:0
  ds_read_b128 a[60:63], v3 offset:4096
  ds_read_b64_tr_b16 a[32:33], v6 offset:1024
  v_mfma_f32_32x32x16_bf16 v[80:95], a[0:3], a[28:31], v[80:95]
  ds_read_b64_tr_b16 a[34:35], v6 offset:1280
  ds_read_b64_tr_b16 a[36:37], v6 offset:5120
  ds_read_b64_tr_b16 a[38:39], v6 offset:5376
  v_mfma_f32_32x32x16_bf16 v[96:111], a[4:7], a[24:27], v[96:111]
  ds_read_b64_tr_b16 a[40:41], v6 offset:9216
  ds_read_b64_tr_b16 a[42:43], v6 offset:9472
  ds_read_b64_tr_b16 a[44:45], v6 offset:13312
  v_mfma_f32_32x32x16_bf16 v[112:127], a[4:7], a[28:31], v[112:127]
  ds_read_b64_tr_b16 a[46:47], v6 offset:13568
  ds_read_b64_tr_b16 a[48:49], v6 offset:17408
  ds_read_b64_tr_b16 a[50:51], v6 offset:17664
  v_mfma_f32_32x32x16_bf16 v[128:143], a[8:11], a[24:27], v[128:143]
  s_add_u32 m0, s50, 38912
  s_add_u32 s55, s49, 61440
  buffer_load_dwordx4 v10, s[32:35], s55 offen sc1 lds
  v_mfma_f32_32x32x16_bf16 v[144:159], a[8:11], a[28:31], v[144:159]
  s_add_u32 m0, s50, 39936
  s_add_u32 s55, s49, 71680
  buffer_load_dwordx4 v11, s[32:35], s55 offen sc1 lds
  s_add_u32 s49, s49, 128
  v_mfma_f32_32x32x16_bf16 v[160:175], a[12:15], a[24:27], v[160:175]
  s_add_u32 m0, s82, 0
  s_add_u32 s55, s51, 0
  buffer_load_dwordx4 v12, s[36:39], s55 offen sc1 lds
  v_mfma_f32_32x32x16_bf16 v[176:191], a[12:15], a[28:31], v[176:191]
  s_add_u32 m0, s82, 4096
  s_add_u32 s55, s51, 64
  buffer_load_dwordx4 v12, s[36:39], s55 offen sc1 lds
  v_mfma_f32_32x32x16_bf16 v[192:207], a[16:19], a[24:27], v[192:207]
  s_add_u32 m0, s82, 8192
  s_add_u32 s55, s51, 128
  buffer_load_dwordx4 v12, s[36:39], s55 offen sc1 lds
  v_mfma_f32_32x32x16_bf16 v[208:223], a[16:19], a[28:31], v[208:223]
  s_waitcnt lgkmcnt(0)
  v_mfma_f32_32x32x16_bf16 v[64:79], a[32:35], a[56:59], v[64:79]
  ds_read_b128 a[24:27], v4 offset:0
  ds_read_b128 a[28:31], v4 offset:4096
  ds_read_b64_tr_b16 a[0:1], v6 offset:2048
  v_mfma_f32_32x32x16_bf16 v[80:95], a[32:35], a[60:63], v[80:95]
  ds_read_b64_tr_b16 a[2:3], v6 offset:2304
  ds_read_b64_tr_b16 a[4:5], v6 offset:6144
  ds_read_b64_tr_b16 a[6:7], v6 offset:6400
  v_mfma_f32_32x32x16_bf16 v[96:111], a[36:39], a[56:59], v[96:111]
  ds_read_b64_tr_b16 a[8:9], v6 offset:10240
  ds_read_b64_tr_b16 a[10:11], v6 offset:10496
  ds_read_b64_tr_b16 a[12:13], v6 offset:14336
  v_mfma_f32_32x32x16_bf16 v[112:127], a[36:39], a[60:63], v[112:127]
  ds_read_b64_tr_b16 a[14:15], v6 offset:14592
  ds_read_b64_tr_b16 a[16:17], v6 offset:18432
  ds_read_b64_tr_b16 a[18:19], v6 offset:18688
  v_mfma_f32_32x32x16_bf16 v[128:143], a[40:43], a[56:59], v[128:143]
  v_mfma_f32_32x32x16_bf16 v[144:159], a[40:43], a[60:63], v[144:159]
  v_mfma_f32_32x32x16_bf16 v[160:175], a[44:47], a[56:59], v[160:175]
  v_mfma_f32_32x32x16_bf16 v[176:191], a[44:47], a[60:63], v[176:191]
  s_add_u32 m0, s82, 12288
  s_add_u32 s55, s51, 192
  buffer_load_dwordx4 v12, s[36:39], s55 offen sc1 lds
  v_mfma_f32_32x32x16_bf16 v[192:207], a[48:51], a[56:59], v[192:207]
  s_add_u32 m0, s82, 16384
  s_add_u32 s55, s51, 256
  buffer_load_dwordx4 v12, s[36:39], s55 offen sc1 lds
  s_add_u32 s51, s51, s54
  v_mfma_f32_32x32x16_bf16 v[208:223], a[48:51], a[60:63], v[208:223]
  s_waitcnt lgkmcnt(0)
  v_mfma_f32_32x32x16_bf16 v[64:79], a[0:3], a[24:27], v[64:79]
  ds_read_b128 a[56:59], v5 offset:0
  ds_read_b128 a[60:63], v5 offset:4096
  ds_read_b64_tr_b16 a[32:33], v6 offset:3072
  v_mfma_f32_32x32x16_bf16 v[80:95], a[0:3], a[28:31], v[80:95]
  ds_read_b64_tr_b16 a[34:35], v6 offset:3328
  ds_read_b64_tr_b16 a[36:37], v6 offset:7168
  ds_read_b64_tr_b16 a[38:39], v6 offset:7424
  v_mfma_f32_32x32x16_bf16 v[96:111], a[4:7], a[24:27], v[96:111]
  ds_read_b64_tr_b16 a[40:41], v6 offset:11264
  ds_read_b64_tr_b16 a[42:43], v6 offset:11520
  ds_read_b64_tr_b16 a[44:45], v6 offset:15360
  v_mfma_f32_32x32x16_bf16 v[112:127], a[4:7], a[28:31], v[112:127]
  ds_read_b64_tr_b16 a[46:47], v6 offset:15616
  ds_read_b64_tr_b16 a[48:49], v6 offset:19456
  ds_read_b64_tr_b16 a[50:51], v6 offset:19712
  v_mfma_f32_32x32x16_bf16 v[128:143], a[8:11], a[24:27], v[128:143]
  v_mfma_f32_32x32x16_bf16 v[144:159], a[8:11], a[28:31], v[144:159]
  v_mfma_f32_32x32x16_bf16 v[160:175], a[12:15], a[24:27], v[160:175]
  v_mfma_f32_32x32x16_bf16 v[176:191], a[12:15], a[28:31], v[176:191]
  s_add_u32 s83, s81, s52
  s_add_u32 s83, s83, 65536
  v_mfma_f32_32x32x16_bf16 v[192:207], a[16:19], a[24:27], v[192:207]
  s_add_u32 s81, s81, 24576
  s_cmp_eq_u32 s81, 73728
  s_cselect_b32 s81, 0, s81
  v_mfma_f32_32x32x16_bf16 v[208:223], a[16:19], a[28:31], v[208:223]
  v_add_u32 v30, s81, v31
  s_waitcnt lgkmcnt(0)
  v_mfma_f32_32x32x16_bf16 v[64:79], a[32:35], a[56:59], v[64:79]
  v_mfma_f32_32x32x16_bf16 v[80:95], a[32:35], a[60:63], v[80:95]
  s_waitcnt vmcnt(5)
  s_barrier
  v_mov_b32 v7, v30
  s_mov_b32 s82, s83
  ds_read_b128 a[24:27], v2 offset:32768
  ds_read_b128 a[28:31], v2 offset:36864
  ds_read_b64_tr_b16 a[0:1], v7 offset:0
  v_mfma_f32_32x32x16_bf16 v[96:111], a[36:39], a[56:59], v[96:111]
  ds_read_b64_tr_b16 a[2:3], v7 offset:256
  ds_read_b64_tr_b16 a[4:5], v7 offset:4096
  ds_read_b64_tr_b16 a[6:7], v7 offset:4352
  v_mfma_f32_32x32x16_bf16 v[112:127], a[36:39], a[60:63], v[112:127]
  ds_read_b64_tr_b16 a[8:9], v7 offset:8192
  ds_read_b64_tr_b16 a[10:11], v7 offset:8448
  ds_read_b64_tr_b16 a[12:13], v7 offset:12288
  s_add_u32 m0, s50, 0
  s_add_u32 s55, s49, 0
  buffer_load_dwordx4 v10, s[32:35], s55 offen sc1 lds
  v_mfma_f32_32x32x16_bf16 v[128:143], a[40:43], a[56:59], v[128:143]
  ds_read_b64_tr_b16 a[14:15], v7 offset:12544
  ds_read_b64_tr_b16 a[16:17], v7 offset:16384
  ds_read_b64_tr_b16 a[18:19], v7 offset:16640
  s_add_u32 m0, s50, 1024
  s_add_u32 s55, s49, 10240
  buffer_load_dwordx4 v11, s[32:35], s55 offen sc1 lds
  v_mfma_f32_32x32x16_bf16 v[144:159], a[40:43], a[60:63], v[144:159]
  s_add_u32 m0, s50, 2048
  s_add_u32 s55, s49, 20480
  buffer_load_dwordx4 v10, s[32:35], s55 offen sc1 lds
  v_mfma_f32_32x32x16_bf16 v[160:175], a[44:47], a[56:59], v[160:175]
  s_add_u32 m0, s50, 3072
  s_add_u32 s55, s49, 30720
  buffer_load_dwordx4 v11, s[32:35], s55 offen sc1 lds
  v_mfma_f32_32x32x16_bf16 v[176:191], a[44:47], a[60:63], v[176:191]
  s_add_u32 m0, s50, 4096
  s_add_u32 s55, s49, 40960
  buffer_load_dwordx4 v10, s[32:35], s55 offen sc1 lds
  v_mfma_f32_32x32x16_bf16 v[192:207], a[48:51], a[56:59], v[192:207]
  s_add_u32 m0, s50, 5120
  s_add_u32 s55, s49, 51200
  buffer_load_dwordx4 v11, s[32:35], s55 offen sc1 lds
  v_mfma_f32_32x32x16_bf16 v[208:223], a[48:51], a[60:63], v[208:223]
  s_waitcnt lgkmcnt(0)
  v_mfma_f32_32x32x16_bf16 v[64:79], a[0:3], a[24:27], v[64:79]
  ds_read_b128 a[56:59], v3 offset:32768
  ds_read_b128 a[60:63], v3 offset:36864
  ds_read_b64_tr_b16 a[32:33], v7 offset:1024
  v_mfma_f32_32x32x16_bf16 v[80:95], a[0:3], a[28:31], v[80:95]
  ds_read_b64_tr_b16 a[34:35], v7 offset:1280
  ds_read_b64_tr_b16 a[36:37], v7 offset:5120
  ds_read_b64_tr_b16 a[38:39], v7 offset:5376
  v_mfma_f32_32x32x16_bf16 v[96:111], a[4:7], a[24:27], v[96:111]
  ds_read_b64_tr_b16 a[40:41], v7 offset:9216
  ds_read_b64_tr_b16 a[42:43], v7 offset:9472
  ds_read_b64_tr_b16 a[44:45], v7 offset:13312
  v_mfma_f32_32x32x16_bf16 v[112:127], a[4:7], a[28:31], v[112:127]
  ds_read_b64_tr_b16 a[46:47], v7 offset:13568
  ds_read_b64_tr_b16 a[48:49], v7 offset:17408
  ds_read_b64_tr_b16 a[50:51], v7 offset:17664
  v_mfma_f32_32x32x16_bf16 v[128:143], a[8:11], a[24:27], v[128:143]
  s_add_u32 m0, s50, 6144
  s_add_u32 s55, s49, 61440
  buffer_load_dwordx4 v10, s[32:35], s55 offen sc1 lds
  v_mfma_f32_32x32x16_bf16 v[144:159], a[8:11], a[28:31], v[144:159]
  s_add_u32 m0, s50, 7168
  s_add_u32 s55, s49, 71680
  buffer_load_dwordx4 v11, s[32:35], s55 offen sc1 lds
  s_add_u32 s49, s49, 128
  v_mfma_f32_32x32x16_bf16 v[160:175], a[12:15], a[24:27], v[160:175]
  s_add_u32 m0, s82, 0
  s_add_u32 s55, s51, 0
  buffer_load_dwordx4 v12, s[36:39], s55 offen sc1 lds
  v_mfma_f32_32x32x16_bf16 v[176:191], a[12:15], a[28:31], v[176:191]
  s_add_u32 m0, s82, 4096
  s_add_u32 s55, s51, 64
  buffer_load_dwordx4 v12, s[36:39], s55 offen sc1 lds
  v_mfma_f32_32x32x16_bf16 v[192:207], a[16:19], a[24:27], v[192:207]
  s_add_u32 m0, s82, 8192
  s_add_u32 s55, s51, 128
  buffer_load_dwordx4 v12, s[36:39], s55 offen sc1 lds
  v_mfma_f32_32x32x16_bf16 v[208:223], a[16:19], a[28:31], v[208:223]
  s_waitcnt lgkmcnt(0)
  v_mfma_f32_32x32x16_bf16 v[64:79], a[32:35], a[56:59], v[64:79]
  ds_read_b128 a[24:27], v4 offset:32768
  ds_read_b128 a[28:31], v4 offset:36864
  ds_read_b64_tr_b16 a[0:1], v7 offset:2048
  v_mfma_f32_32x32x16_bf16 v[80:95], a[32:35], a[60:63], v[80:95]
  ds_read_b64_tr_b16 a[2:3], v7 offset:2304
  ds_read_b64_tr_b16 a[4:5], v7 offset:6144
  ds_read_b64_tr_b16 a[6:7], v7 offset:6400
  v_mfma_f32_32x32x16_bf16 v[96:111], a[36:39], a[56:59], v[96:111]
  ds_read_b64_tr_b16 a[8:9], v7 offset:10240
  ds_read_b64_tr_b16 a[10:11], v7 offset:10496
  ds_read_b64_tr_b16 a[12:13], v7 offset:14336
  v_mfma_f32_32x32x16_bf16 v[112:127], a[36:39], a[60:63], v[112:127]
  ds_read_b64_tr_b16 a[14:15], v7 offset:14592
  ds_read_b64_tr_b16 a[16:17], v7 offset:18432
  ds_read_b64_tr_b16 a[18:19], v7 offset:18688
  v_mfma_f32_32x32x16_bf16 v[128:143], a[40:43], a[56:59], v[128:143]
  v_mfma_f32_32x32x16_bf16 v[144:159], a[40:43], a[60:63], v[144:159]
  v_mfma_f32_32x32x16_bf16 v[160:175], a[44:47], a[56:59], v[160:175]
  v_mfma_f32_32x32x16_bf16 v[176:191], a[44:47], a[60:63], v[176:191]
  s_add_u32 m0, s82, 12288
  s_add_u32 s55, s51, 192
  buffer_load_dwordx4 v12, s[36:39], s55 offen sc1 lds
  v_mfma_f32_32x32x16_bf16 v[192:207], a[48:51], a[56:59], v[192:207]
  s_add_u32 m0, s82, 16384
  s_add_u32 s55, s51, 256
  buffer_load_dwordx4 v12, s[36:39], s55 offen sc1 lds
  s_add_u32 s51, s51, s54
  v_mfma_f32_32x32x16_bf16 v[208:223], a[48:51], a[60:63], v[208:223]
  s_waitcnt lgkmcnt(0)
  v_mfma_f32_32x32x16_bf16 v[64:79], a[0:3], a[24:27], v[64:79]
  ds_read_b128 a[56:59], v5 offset:32768
  ds_read_b128 a[60:63], v5 offset:36864
  ds_read_b64_tr_b16 a[32:33], v7 offset:3072
  v_mfma_f32_32x32x16_bf16 v[80:95], a[0:3], a[28:31], v[80:95]
  ds_read_b64_tr_b16 a[34:35], v7 offset:3328
  ds_read_b64_tr_b16 a[36:37], v7 offset:7168
  ds_read_b64_tr_b16 a[38:39], v7 offset:7424
  v_mfma_f32_32x32x16_bf16 v[96:111], a[4:7], a[24:27], v[96:111]
  ds_read_b64_tr_b16 a[40:41], v7 offset:11264
  ds_read_b64_tr_b16 a[42:43], v7 offset:11520
  ds_read_b64_tr_b16 a[44:45], v7 offset:15360
  v_mfma_f32_32x32x16_bf16 v[112:127], a[4:7], a[28:31], v[112:127]
  ds_read_b64_tr_b16 a[46:47], v7 offset:15616
  ds_read_b64_tr_b16 a[48:49], v7 offset:19456
  ds_read_b64_tr_b16 a[50:51], v7 offset:19712
  v_mfma_f32_32x32x16_bf16 v[128:143], a[8:11], a[24:27], v[128:143]
  v_mfma_f32_32x32x16_bf16 v[144:159], a[8:11], a[28:31], v[144:159]
  v_mfma_f32_32x32x16_bf16 v[160:175], a[12:15], a[24:27], v[160:175]
  v_mfma_f32_32x32x16_bf16 v[176:191], a[12:15], a[28:31], v[176:191]
  s_add_u32 s83, s81, s52
  s_add_u32 s83, s83, 65536
  v_mfma_f32_32x32x16_bf16 v[192:207], a[16:19], a[24:27], v[192:207]
  s_add_u32 s81, s81, 24576
  s_cmp_eq_u32 s81, 73728
  s_cselect_b32 s81, 0, s81
  v_mfma_f32_32x32x16_bf16 v[208:223], a[16:19], a[28:31], v[208:223]
  v_add_u32 v30, s81, v31
  s_waitcnt lgkmcnt(0)
  v_mfma_f32_32x32x16_bf16 v[64:79], a[32:35], a[56:59], v[64:79]
  v_mfma_f32_32x32x16_bf16 v[80:95], a[32:35], a[60:63], v[80:95]
  s_waitcnt vmcnt(5)
  s_barrier
  v_mov_b32 v6, v30
  s_mov_b32 s82, s83
  ds_read_b128 a[24:27], v2 offset:0
  ds_read_b128 a[28:31], v2 offset:4096
  ds_read_b64_tr_b16 a[0:1], v6 offset:0
  v_mfma_f32_32x32x16_bf16 v[96:111], a[36:39], a[56:59], v[96:111]
  ds_read_b64_tr_b16 a[2:3], v6 offset:256
  ds_read_b64_tr_b16 a[4:5], v6 offset:4096
  ds_read_b64_tr_b16 a[6:7], v6 offset:4352
  v_mfma_f32_32x32x16_bf16 v[112:127], a[36:39], a[60:63], v[112:127]
  ds_read_b64_tr_b16 a[8:9], v6 offset:8192
  ds_read_b64_tr_b16 a[10:11], v6 offset:8448
  ds_read_b64_tr_b16 a[12:13], v6 offset:12288
  s_add_u32 m0, s50, 32768
  s_add_u32 s55, s49, 0
  buffer_load_dwordx4 v10, s[32:35], s55 offen sc1 lds
  v_mfma_f32_32x32x16_bf16 v[128:143], a[40:43], a[56:59], v[128:143]
  ds_read_b64_tr_b16 a[14:15], v6 offset:12544
  ds_read_b64_tr_b16 a[16:17], v6 offset:16384
  ds_read_b64_tr_b16 a[18:19], v6 offset:16640
  s_add_u32 m0, s50, 33792
  s_add_u32 s55, s49, 10240
  buffer_load_dwordx4 v11, s[32:35], s55 offen sc1 lds
  v_mfma_f32_32x32x16_bf16 v[144:159], a[40:43], a[60:63], v[144:159]
  s_add_u32 m0, s50, 34816
  s_add_u32 s55, s49, 20480
  buffer_load_dwordx4 v10, s[32:35], s55 offen sc1 lds
  v_mfma_f32_32x32x16_bf16 v[160:175], a[44:47], a[56:59], v[160:175]
  s_add_u32 m0, s50, 35840
  s_add_u32 s55, s49, 30720
  buffer_load_dwordx4 v11, s[32:35], s55 offen sc1 lds
  v_mfma_f32_32x32x16_bf16 v[176:191], a[44:47], a[60:63], v[176:191]
  s_add_u32 m0, s50, 36864
  s_add_u32 s55, s49, 40960
  buffer_load_dwordx4 v10, s[32:35], s55 offen sc1 lds
  v_mfma_f32_32x32x16_bf16 v[192:207], a[48:51], a[56:59], v[192:207]
  s_add_u32 m0, s50, 37888
  s_add_u32 s55, s49, 51200
  buffer_load_dwordx4 v11, s[32:35], s55 offen sc1 lds
  v_mfma_f32_32x32x16_bf16 v[208:223], a[48:51], a[60:63], v[208:223]
  s_add_u32 s80, s80, 1
  s_cmp_lt_u32 s80, 3
  s_cbranch_scc1 PL_170
  s_waitcnt lgkmcnt(0)
  v_mfma_f32_32x32x16_bf16 v[64:79], a[0:3], a[24:27], v[64:79]
  ds_read_b128 a[56:59], v3 offset:0
  ds_read_b128 a[60:63], v3 offset:4096
  ds_read_b64_tr_b16 a[32:33], v6 offset:1024
  v_mfma_f32_32x32x16_bf16 v[80:95], a[0:3], a[28:31], v[80:95]
  ds_read_b64_tr_b16 a[34:35], v6 offset:1280
  ds_read_b64_tr_b16 a[36:37], v6 offset:5120
  ds_read_b64_tr_b16 a[38:39], v6 offset:5376
  v_mfma_f32_32x32x16_bf16 v[96:111], a[4:7], a[24:27], v[96:111]
  ds_read_b64_tr_b16 a[40:41], v6 offset:9216
  ds_read_b64_tr_b16 a[42:43], v6 offset:9472
  ds_read_b64_tr_b16 a[44:45], v6 offset:13312
  v_mfma_f32_32x32x16_bf16 v[112:127], a[4:7], a[28:31], v[112:127]
  ds_read_b64_tr_b16 a[46:47], v6 offset:13568
  ds_read_b64_tr_b16 a[48:49], v6 offset:17408
  ds_read_b64_tr_b16 a[50:51], v6 offset:17664
  v_mfma_f32_32x32x16_bf16 v[128:143], a[8:11], a[24:27], v[128:143]
  v_mfma_f32_32x32x16_bf16 v[144:159], a[8:11], a[28:31], v[144:159]
  v_mfma_f32_32x32x16_bf16 v[160:175], a[12:15], a[24:27], v[160:175]
  v_mfma_f32_32x32x16_bf16 v[176:191], a[12:15], a[28:31], v[176:191]
  s_add_u32 m0, s50, 38912
  s_add_u32 s55, s49, 61440
  buffer_load_dwordx4 v10, s[32:35], s55 offen sc1 lds
  v_mfma_f32_32x32x16_bf16 v[192:207], a[16:19], a[24:27], v[192:207]
  s_add_u32 m0, s50, 39936
  s_add_u32 s55, s49, 71680
  buffer_load_dwordx4 v11, s[32:35], s55 offen sc1 lds
  s_add_u32 s49, s49, 128
  v_mfma_f32_32x32x16_bf16 v[208:223], a[16:19], a[28:31], v[208:223]
  s_waitcnt lgkmcnt(0)
  v_mfma_f32_32x32x16_bf16 v[64:79], a[32:35], a[56:59], v[64:79]
  ds_read_b128 a[24:27], v4 offset:0
  ds_read_b128 a[28:31], v4 offset:4096
  ds_read_b64_tr_b16 a[0:1], v6 offset:2048
  v_mfma_f32_32x32x16_bf16 v[80:95], a[32:35], a[60:63], v[80:95]
  ds_read_b64_tr_b16 a[2:3], v6 offset:2304
  ds_read_b64_tr_b16 a[4:5], v6 offset:6144
  ds_read_b64_tr_b16 a[6:7], v6 offset:6400
  v_mfma_f32_32x32x16_bf16 v[96:111], a[36:39], a[56:59], v[96:111]
  ds_read_b64_tr_b16 a[8:9], v6 offset:10240
  ds_read_b64_tr_b16 a[10:11], v6 offset:10496
  ds_read_b64_tr_b16 a[12:13], v6 offset:14336
  v_mfma_f32_32x32x16_bf16 v[112:127], a[36:39], a[60:63], v[112:127]
  ds_read_b64_tr_b16 a[14:15], v6 offset:14592
  ds_read_b64_tr_b16 a[16:17], v6 offset:18432
  ds_read_b64_tr_b16 a[18:19], v6 offset:18688
  v_mfma_f32_32x32x16_bf16 v[128:143], a[40:43], a[56:59], v[128:143]
  v_mfma_f32_32x32x16_bf16 v[144:159], a[40:43], a[60:63], v[144:159]
  v_mfma_f32_32x32x16_bf16 v[160:175], a[44:47], a[56:59], v[160:175]
  v_mfma_f32_32x32x16_bf16 v[176:191], a[44:47], a[60:63], v[176:191]
  v_mfma_f32_32x32x16_bf16 v[192:207], a[48:51], a[56:59], v[192:207]
  v_mfma_f32_32x32x16_bf16 v[208:223], a[48:51], a[60:63], v[208:223]
  s_waitcnt lgkmcnt(0)
  v_mfma_f32_32x32x16_bf16 v[64:79], a[0:3], a[24:27], v[64:79]
  ds_read_b128 a[56:59], v5 offset:0
  ds_read_b128 a[60:63], v5 offset:4096
  ds_read_b64_tr_b16 a[32:33], v6 offset:3072
  v_mfma_f32_32x32x16_bf16 v[80:95], a[0:3], a[28:31], v[80:95]
  ds_read_b64_tr_b16 a[34:35], v6 offset:3328
  ds_read_b64_tr_b16 a[36:37], v6 offset:7168
  ds_read_b64_tr_b16 a[38:39], v6 offset:7424
  v_mfma_f32_32x32x16_bf16 v[96:111], a[4:7], a[24:27], v[96:111]
  ds_read_b64_tr_b16 a[40:41], v6 offset:11264
  ds_read_b64_tr_b16 a[42:43], v6 offset:11520
  ds_read_b64_tr_b16 a[44:45], v6 offset:15360
  v_mfma_f32_32x32x16_bf16 v[112:127], a[4:7], a[28:31], v[112:127]
  ds_read_b64_tr_b16 a[46:47], v6 offset:15616
  ds_read_b64_tr_b16 a[48:49], v6 offset:19456
  ds_read_b64_tr_b16 a[50:51], v6 offset:19712
  v_mfma_f32_32x32x16_bf16 v[128:143], a[8:11], a[24:27], v[128:143]
  v_mfma_f32_32x32x16_bf16 v[144:159], a[8:11], a[28:31], v[144:159]
  v_mfma_f32_32x32x16_bf16 v[160:175], a[12:15], a[24:27], v[160:175]
  v_mfma_f32_32x32x16_bf16 v[176:191], a[12:15], a[28:31], v[176:191]
  s_add_u32 s83, s81, s52
  s_add_u32 s83, s83, 65536
  v_mfma_f32_32x32x16_bf16 v[192:207], a[16:19], a[24:27], v[192:207]
  s_add_u32 s81, s81, 24576
  s_cmp_eq_u32 s81, 73728
  s_cselect_b32 s81, 0, s81
  v_mfma_f32_32x32x16_bf16 v[208:223], a[16:19], a[28:31], v[208:223]
  v_add_u32 v30, s81, v31
  s_waitcnt lgkmcnt(0)
  v_mfma_f32_32x32x16_bf16 v[64:79], a[32:35], a[56:59], v[64:79]
  v_mfma_f32_32x32x16_bf16 v[80:95], a[32:35], a[60:63], v[80:95]
  s_waitcnt vmcnt(0)
  s_barrier
  v_mov_b32 v7, v30
  s_mov_b32 s82, s83
  ds_read_b128 a[24:27], v2 offset:32768
  ds_read_b128 a[28:31], v2 offset:36864
  ds_read_b64_tr_b16 a[0:1], v7 offset:0
  v_mfma_f32_32x32x16_bf16 v[96:111], a[36:39], a[56:59], v[96:111]
  ds_read_b64_tr_b16 a[2:3], v7 offset:256
  ds_read_b64_tr_b16 a[4:5], v7 offset:4096
  ds_read_b64_tr_b16 a[6:7], v7 offset:4352
  v_mfma_f32_32x32x16_bf16 v[112:127], a[36:39], a[60:63], v[112:127]
  ds_read_b64_tr_b16 a[8:9], v7 offset:8192
  ds_read_b64_tr_b16 a[10:11], v7 offset:8448
  ds_read_b64_tr_b16 a[12:13], v7 offset:12288
  v_mfma_f32_32x32x16_bf16 v[128:143], a[40:43], a[56:59], v[128:143]
  ds_read_b64_tr_b16 a[14:15], v7 offset:12544
  ds_read_b64_tr_b16 a[16:17], v7 offset:16384
  ds_read_b64_tr_b16 a[18:19], v7 offset:16640
  v_mfma_f32_32x32x16_bf16 v[144:159], a[40:43], a[60:63], v[144:159]
  v_mfma_f32_32x32x16_bf16 v[160:175], a[44:47], a[56:59], v[160:175]
  v_mfma_f32_32x32x16_bf16 v[176:191], a[44:47], a[60:63], v[176:191]
  v_mfma_f32_32x32x16_bf16 v[192:207], a[48:51], a[56:59], v[192:207]
  v_mfma_f32_32x32x16_bf16 v[208:223], a[48:51], a[60:63], v[208:223]
  s_waitcnt lgkmcnt(0)
  v_mfma_f32_32x32x16_bf16 v[64:79], a[0:3], a[24:27], v[64:79]
  ds_read_b128 a[56:59], v3 offset:32768
  ds_read_b128 a[60:63], v3 offset:36864
  ds_read_b64_tr_b16 a[32:33], v7 offset:1024
  v_mfma_f32_32x32x16_bf16 v[80:95], a[0:3], a[28:31], v[80:95]
  ds_read_b64_tr_b16 a[34:35], v7 offset:1280
  ds_read_b64_tr_b16 a[36:37], v7 offset:5120
  ds_read_b64_tr_b16 a[38:39], v7 offset:5376
  v_mfma_f32_32x32x16_bf16 v[96:111], a[4:7], a[24:27], v[96:111]
  ds_read_b64_tr_b16 a[40:41], v7 offset:9216
  ds_read_b64_tr_b16 a[42:43], v7 offset:9472
  ds_read_b64_tr_b16 a[44:45], v7 offset:13312
  v_mfma_f32_32x32x16_bf16 v[112:127], a[4:7], a[28:31], v[112:127]
  ds_read_b64_tr_b16 a[46:47], v7 offset:13568
  ds_read_b64_tr_b16 a[48:49], v7 offset:17408
  ds_read_b64_tr_b16 a[50:51], v7 offset:17664
  v_mfma_f32_32x32x16_bf16 v[128:143], a[8:11], a[24:27], v[128:143]
  v_mfma_f32_32x32x16_bf16 v[144:159], a[8:11], a[28:31], v[144:159]
  v_mfma_f32_32x32x16_bf16 v[160:175], a[12:15], a[24:27], v[160:175]
  v_mfma_f32_32x32x16_bf16 v[176:191], a[12:15], a[28:31], v[176:191]
  v_mfma_f32_32x32x16_bf16 v[192:207], a[16:19], a[24:27], v[192:207]
  v_mfma_f32_32x32x16_bf16 v[208:223], a[16:19], a[28:31], v[208:223]
  s_waitcnt lgkmcnt(0)
  v_mfma_f32_32x32x16_bf16 v[64:79], a[32:35], a[56:59], v[64:79]
  ds_read_b128 a[24:27], v4 offset:32768
  ds_read_b128 a[28:31], v4 offset:36864
  ds_read_b64_tr_b16 a[0:1], v7 offset:2048
  v_mfma_f32_32x32x16_bf16 v[80:95], a[32:35], a[60:63], v[80:95]
  ds_read_b64_tr_b16 a[2:3], v7 offset:2304
  ds_read_b64_tr_b16 a[4:5], v7 offset:6144
  ds_read_b64_tr_b16 a[6:7], v7 offset:6400
  v_mfma_f32_32x32x16_bf16 v[96:111], a[36:39], a[56:59], v[96:111]
  ds_read_b64_tr_b16 a[8:9], v7 offset:10240
  ds_read_b64_tr_b16 a[10:11], v7 offset:10496
  ds_read_b64_tr_b16 a[12:13], v7 offset:14336
  v_mfma_f32_32x32x16_bf16 v[112:127], a[36:39], a[60:63], v[112:127]
  ds_read_b64_tr_b16 a[14:15], v7 offset:14592
  ds_read_b64_tr_b16 a[16:17], v7 offset:18432
  ds_read_b64_tr_b16 a[18:19], v7 offset:18688
  v_mfma_f32_32x32x16_bf16 v[128:143], a[40:43], a[56:59], v[128:143]
  v_mfma_f32_32x32x16_bf16 v[144:159], a[40:43], a[60:63], v[144:159]
  v_mfma_f32_32x32x16_bf16 v[160:175], a[44:47], a[56:59], v[160:175]
  v_mfma_f32_32x32x16_bf16 v[176:191], a[44:47], a[60:63], v[176:191]
  v_mfma_f32_32x32x16_bf16 v[192:207], a[48:51], a[56:59], v[192:207]
  v_mfma_f32_32x32x16_bf16 v[208:223], a[48:51], a[60:63], v[208:223]
  s_waitcnt lgkmcnt(0)
  v_mfma_f32_32x32x16_bf16 v[64:79], a[0:3], a[24:27], v[64:79]
  ds_read_b128 a[56:59], v5 offset:32768
  ds_read_b128 a[60:63], v5 offset:36864
  ds_read_b64_tr_b16 a[32:33], v7 offset:3072
  v_mfma_f32_32x32x16_bf16 v[80:95], a[0:3], a[28:31], v[80:95]
  ds_read_b64_tr_b16 a[34:35], v7 offset:3328
  ds_read_b64_tr_b16 a[36:37], v7 offset:7168
  ds_read_b64_tr_b16 a[38:39], v7 offset:7424
  v_mfma_f32_32x32x16_bf16 v[96:111], a[4:7], a[24:27], v[96:111]
  ds_read_b64_tr_b16 a[40:41], v7 offset:11264
  ds_read_b64_tr_b16 a[42:43], v7 offset:11520
  ds_read_b64_tr_b16 a[44:45], v7 offset:15360
  v_mfma_f32_32x32x16_bf16 v[112:127], a[4:7], a[28:31], v[112:127]
  ds_read_b64_tr_b16 a[46:47], v7 offset:15616
  ds_read_b64_tr_b16 a[48:49], v7 offset:19456
  ds_read_b64_tr_b16 a[50:51], v7 offset:19712
  v_mfma_f32_32x32x16_bf16 v[128:143], a[8:11], a[24:27], v[128:143]
  v_mfma_f32_32x32x16_bf16 v[144:159], a[8:11], a[28:31], v[144:159]
  v_mfma_f32_32x32x16_bf16 v[160:175], a[12:15], a[24:27], v[160:175]
  v_mfma_f32_32x32x16_bf16 v[176:191], a[12:15], a[28:31], v[176:191]
  v_mfma_f32_32x32x16_bf16 v[192:207], a[16:19], a[24:27], v[192:207]
  v_mfma_f32_32x32x16_bf16 v[208:223], a[16:19], a[28:31], v[208:223]
  s_waitcnt lgkmcnt(0)
  v_mfma_f32_32x32x16_bf16 v[64:79], a[32:35], a[56:59], v[64:79]
  v_mfma_f32_32x32x16_bf16 v[80:95], a[32:35], a[60:63], v[80:95]
  v_mfma_f32_32x32x16_bf16 v[96:111], a[36:39], a[56:59], v[96:111]
  v_mfma_f32_32x32x16_bf16 v[112:127], a[36:39], a[60:63], v[112:127]
  v_mfma_f32_32x32x16_bf16 v[128:143], a[40:43], a[56:59], v[128:143]
  v_mfma_f32_32x32x16_bf16 v[144:159], a[40:43], a[60:63], v[144:159]
  v_mfma_f32_32x32x16_bf16 v[160:175], a[44:47], a[56:59], v[160:175]
  v_mfma_f32_32x32x16_bf16 v[176:191], a[44:47], a[60:63], v[176:191]
  v_mfma_f32_32x32x16_bf16 v[192:207], a[48:51], a[56:59], v[192:207]
  v_mfma_f32_32x32x16_bf16 v[208:223], a[48:51], a[60:63], v[208:223]
  s_nop 7
  s_nop 7
  v_cvt_pk_bf16_f32 v16, v64, v65
  v_cvt_pk_bf16_f32 v17, v66, v67
  v_cvt_pk_bf16_f32 v18, v68, v69
  v_cvt_pk_bf16_f32 v19, v70, v71
  v_cvt_pk_bf16_f32 v20, v72, v73
  v_cvt_pk_bf16_f32 v21, v74, v75
  v_cvt_pk_bf16_f32 v22, v76, v77
  v_cvt_pk_bf16_f32 v23, v78, v79
  buffer_store_dwordx4 v[16:19], v15, s[44:47], s56 offen offset:0
  buffer_store_dwordx4 v[20:23], v15, s[44:47], s56 offen offset:32
  v_cvt_pk_bf16_f32 v24, v80, v81
  v_cvt_pk_bf16_f32 v25, v82, v83
  v_cvt_pk_bf16_f32 v26, v84, v85
  v_cvt_pk_bf16_f32 v27, v86, v87
  v_cvt_pk_bf16_f32 v28, v88, v89
  v_cvt_pk_bf16_f32 v29, v90, v91
  v_cvt_pk_bf16_f32 v30, v92, v93
  v_cvt_pk_bf16_f32 v31, v94, v95
  buffer_store_dwordx4 v[24:27], v15, s[44:47], s57 offen offset:0
  buffer_store_dwordx4 v[28:31], v15, s[44:47], s57 offen offset:32
  v_cvt_pk_bf16_f32 v16, v96, v97
  v_cvt_pk_bf16_f32 v17, v98, v99
  v_cvt_pk_bf16_f32 v18, v100, v101
  v_cvt_pk_bf16_f32 v19, v102, v103
  v_cvt_pk_bf16_f32 v20, v104, v105
  v_cvt_pk_bf16_f32 v21, v106, v107
  v_cvt_pk_bf16_f32 v22, v108, v109
  v_cvt_pk_bf16_f32 v23, v110, v111
  buffer_store_dwordx4 v[16:19], v15, s[44:47], s56 offen offset:64
  buffer_store_dwordx4 v[20:23], v15, s[44:47], s56 offen offset:96
  v_cvt_pk_bf16_f32 v24, v112, v113
  v_cvt_pk_bf16_f32 v25, v114, v115
  v_cvt_pk_bf16_f32 v26, v116, v117
  v_cvt_pk_bf16_f32 v27, v118, v119
  v_cvt_pk_bf16_f32 v28, v120, v121
  v_cvt_pk_bf16_f32 v29, v122, v123
  v_cvt_pk_bf16_f32 v30, v124, v125
  v_cvt_pk_bf16_f32 v31, v126, v127
  buffer_store_dwordx4 v[24:27], v15, s[44:47], s57 offen offset:64
  buffer_store_dwordx4 v[28:31], v15, s[44:47], s57 offen offset:96
  v_cvt_pk_bf16_f32 v16, v128, v129
  v_cvt_pk_bf16_f32 v17, v130, v131
  v_cvt_pk_bf16_f32 v18, v132, v133
  v_cvt_pk_bf16_f32 v19, v134, v135
  v_cvt_pk_bf16_f32 v20, v136, v137
  v_cvt_pk_bf16_f32 v21, v138, v139
  v_cvt_pk_bf16_f32 v22, v140, v141
  v_cvt_pk_bf16_f32 v23, v142, v143
  buffer_store_dwordx4 v[16:19], v15, s[44:47], s56 offen offset:128
  buffer_store_dwordx4 v[20:23], v15, s[44:47], s56 offen offset:160
  v_cvt_pk_bf16_f32 v24, v144, v145
  v_cvt_pk_bf16_f32 v25, v146, v147
  v_cvt_pk_bf16_f32 v26, v148, v149
  v_cvt_pk_bf16_f32 v27, v150, v151
  v_cvt_pk_bf16_f32 v28, v152, v153
  v_cvt_pk_bf16_f32 v29, v154, v155
  v_cvt_pk_bf16_f32 v30, v156, v157
  v_cvt_pk_bf16_f32 v31, v158, v159
  buffer_store_dwordx4 v[24:27], v15, s[44:47], s57 offen offset:128
  buffer_store_dwordx4 v[28:31], v15, s[44:47], s57 offen offset:160
  v_cvt_pk_bf16_f32 v16, v160, v161
  v_cvt_pk_bf16_f32 v17, v162, v163
  v_cvt_pk_bf16_f32 v18, v164, v165
  v_cvt_pk_bf16_f32 v19, v166, v167
  v_cvt_pk_bf16_f32 v20, v168, v169
  v_cvt_pk_bf16_f32 v21, v170, v171
  v_cvt_pk_bf16_f32 v22, v172, v173
  v_cvt_pk_bf16_f32 v23, v174, v175
  buffer_store_dwordx4 v[16:19], v15, s[44:47], s56 offen offset:192
  buffer_store_dwordx4 v[20:23], v15, s[44:47], s56 offen offset:224
  v_cvt_pk_bf16_f32 v24, v176, v177
  v_cvt_pk_bf16_f32 v25, v178, v179
  v_cvt_pk_bf16_f32 v26, v180, v181
  v_cvt_pk_bf16_f32 v27, v182, v183
  v_cvt_pk_bf16_f32 v28, v184, v185
  v_cvt_pk_bf16_f32 v29, v186, v187
  v_cvt_pk_bf16_f32 v30, v188, v189
  v_cvt_pk_bf16_f32 v31, v190, v191
  buffer_store_dwordx4 v[24:27], v15, s[44:47], s57 offen offset:192
  buffer_store_dwordx4 v[28:31], v15, s[44:47], s57 offen offset:224
  v_cvt_pk_bf16_f32 v16, v192, v193
  v_cvt_pk_bf16_f32 v17, v194, v195
  v_cvt_pk_bf16_f32 v18, v196, v197
  v_cvt_pk_bf16_f32 v19, v198, v199
  v_cvt_pk_bf16_f32 v20, v200, v201
  v_cvt_pk_bf16_f32 v21, v202, v203
  v_cvt_pk_bf16_f32 v22, v204, v205
  v_cvt_pk_bf16_f32 v23, v206, v207
  buffer_store_dwordx4 v[16:19], v15, s[44:47], s56 offen offset:256
  buffer_store_dwordx4 v[20:23], v15, s[44:47], s56 offen offset:288
  v_cvt_pk_bf16_f32 v24, v208, v209
  v_cvt_pk_bf16_f32 v25, v210, v211
  v_cvt_pk_bf16_f32 v26, v212, v213
  v_cvt_pk_bf16_f32 v27, v214, v215
  v_cvt_pk_bf16_f32 v28, v216, v217
  v_cvt_pk_bf16_f32 v29, v218, v219
  v_cvt_pk_bf16_f32 v30, v220, v221
  v_cvt_pk_bf16_f32 v31, v222, v223
  buffer_store_dwordx4 v[24:27], v15, s[44:47], s57 offen offset:256
  buffer_store_dwordx4 v[28:31], v15, s[44:47], s57 offen offset:288
W_LOOP_T4:
  s_branch W_LOOP_T5
W_FIN_T:
  s_lshr_b32 s49, s93, 3
  s_and_b32 s50, s93, 7
  s_add_u32 s61, s50, 1
  s_cmp_eq_u32 s50, 4
  s_cselect_b32 s50, 0, s50
  s_cselect_b32 s61, 4, s61
  s_lshr_b32 s68, s49, 3
  s_lshl_b32 s68, s68, 2
  s_add_u32 s67, s68, 96
  s_add_u32 s68, s68, 128
  s_mov_b32 s69, 64
  s_cmp_lt_u32 s49, 8
  s_cselect_b32 s69, 128, s69
  s_cmp_eq_u32 s48, 0
  s_cbranch_scc0 WN_172
  v_mov_b32 v2, 64
  v_mov_b32 v4, 0
  v_and_b32 v5, 63, v0
  v_mov_b32 v6, 64
  v_mov_b32 v7, 128
  v_cmp_eq_u32 vcc, 0, v5
  s_nop 1
  v_cndmask_b32 v2, v2, v6, vcc
  v_cndmask_b32 v4, v4, v7, vcc
  v_mov_b32 v6, s68
  v_mov_b32 v7, 32
  v_cmp_eq_u32 vcc, 1, v5
  s_nop 1
  v_cndmask_b32 v2, v2, v6, vcc
  v_cndmask_b32 v4, v4, v7, vcc
  v_mov_b32 v6, s67
  v_mov_b32 v7, s69
  v_cmp_eq_u32 vcc, 2, v5
  s_nop 1
  v_cndmask_b32 v2, v2, v6, vcc
  v_cndmask_b32 v4, v4, v7, vcc
WM_171:
  buffer_load_dword v1, v2, s[96:99], 0 offen sc1
  s_waitcnt vmcnt(0)
  v_cmp_gt_u32 vcc, v4, v1
  s_cbranch_vccz WN_172
  s_sleep 12
  s_sub_u32 s101, s101, 1
  s_cbranch_scc0 WM_171
  s_mov_b32 s101, 0
WN_172:
  s_barrier
  v_and_b32 v1, 63, v0
  v_lshrrev_b32 v9, 6, v0
  s_nop 0
  v_readfirstlane_b32 s48, v9
  v_and_b32 v9, 31, v1
  v_lshrrev_b32 v10, 5, v1
  v_lshlrev_b32 v2, 5, v9
  v_lshl_add_u32 v2, v10, 4, v2
  v_and_b32 v3, 0x13, v9
  v_and_b32 v11, 4, v9
  v_lshl_add_u32 v3, v11, 1, v3
  v_and_b32 v11, 8, v9
  v_lshrrev_b32 v11, 1, v11
  v_add_u32 v3, v3, v11
  v_lshlrev_b32 v3, 5, v3
  v_lshl_add_u32 v3, v10, 4, v3
  v_lshrrev_b32 v4, 3, v9
  v_mul_u32_u24 v4, 196608, v4
  v_and_b32 v11, 7, v9
  v_lshl_add_u32 v4, v11, 5, v4
  v_lshl_add_u32 v4, v10, 4, v4
  v_lshrrev_b32 v5, 4, v9
  v_lshlrev_b32 v6, 14, v5
  v_lshlrev_b32 v5, 16, v5
  v_and_b32 v11, 15, v9
  v_lshl_add_u32 v5, v11, 5, v5
  v_lshl_add_u32 v5, v10, 4, v5
  v_lshl_add_u32 v6, v11, 4, v6
  v_lshl_add_u32 v6, v10, 3, v6
  v_mul_u32_u24 v7, 2560, v9
  v_lshl_add_u32 v7, v10, 4, v7
  v_lshlrev_b32 v8, 4, v1
  v_mov_b32 v14, 0xff800000
  v_mov_b32 v58, 0
  v_mov_b32 v59, 0
  s_mov_b32 s59, 0x3dd53b95
  v_mov_b32 v106, 0
  v_mov_b32 v107, 0
  v_mov_b32 v110, 0
  v_mov_b32 v111, 0
  v_mov_b32 v114, 0
  v_mov_b32 v115, 0
  v_mov_b32 v118, 0
  v_mov_b32 v119, 0
  v_mov_b32 v122, 0
  v_mov_b32 v123, 0
  v_mov_b32 v11, 0
  v_mov_b32 v12, 8
  v_cmp_eq_u32 vcc, 1, v10
  s_nop 1
  v_cndmask_b32 v11, v11, v12, vcc
  v_cmp_le_u32 vcc, v11, v9
  s_mov_b64 s[64:65], vcc
  v_mov_b32 v11, 1
  v_mov_b32 v12, 9
  v_cmp_eq_u32 vcc, 1, v10
  s_nop 1
  v_cndmask_b32 v11, v11, v12, vcc
  v_cmp_le_u32 vcc, v11, v9
  s_mov_b64 s[66:67], vcc
  v_mov_b32 v11, 2
  v_mov_b32 v12, 10
  v_cmp_eq_u32 vcc, 1, v10
  s_nop 1
  v_cndmask_b32 v11, v11, v12, vcc
  v_cmp_le_u32 vcc, v11, v9
  s_mov_b64 s[68:69], vcc
  v_mov_b32 v11, 3
  v_mov_b32 v12, 11
  v_cmp_eq_u32 vcc, 1, v10
  s_nop 1
  v_cndmask_b32 v11, v11, v12, vcc
  v_cmp_le_u32 vcc, v11, v9
  s_mov_b64 s[70:71], vcc
  v_mov_b32 v11, 4
  v_mov_b32 v12, 12
  v_cmp_eq_u32 vcc, 1, v10
  s_nop 1
  v_cndmask_b32 v11, v11, v12, vcc
  v_cmp_le_u32 vcc, v11, v9
  s_mov_b64 s[72:73], vcc
  v_mov_b32 v11, 5
  v_mov_b32 v12, 13
  v_cmp_eq_u32 vcc, 1, v10
  s_nop 1
  v_cndmask_b32 v11, v11, v12, vcc
  v_cmp_le_u32 vcc, v11, v9
  s_mov_b64 s[74:75], vcc
  v_mov_b32 v11, 6
  v_mov_b32 v12, 14
  v_cmp_eq_u32 vcc, 1, v10
  s_nop 1
  v_cndmask_b32 v11, v11, v12, vcc
  v_cmp_le_u32 vcc, v11, v9
  s_mov_b64 s[76:77], vcc
  v_mov_b32 v11, 7
  v_mov_b32 v12, 15
  v_cmp_eq_u32 vcc, 1, v10
  s_nop 1
  v_cndmask_b32 v11, v11, v12, vcc
  v_cmp_le_u32 vcc, v11, v9
  s_mov_b64 s[78:79], vcc
  v_mov_b32 v11, 16
  v_mov_b32 v12, 24
  v_cmp_eq_u32 vcc, 1, v10
  s_nop 1
  v_cndmask_b32 v11, v11, v12, vcc
  v_cmp_le_u32 vcc, v11, v9
  s_mov_b64 s[80:81], vcc
  v_mov_b32 v11, 17
  v_mov_b32 v12, 25
  v_cmp_eq_u32 vcc, 1, v10
  s_nop 1
  v_cndmask_b32 v11, v11, v12, vcc
  v_cmp_le_u32 vcc, v11, v9
  s_mov_b64 s[82:83], vcc
  v_mov_b32 v11, 18
  v_mov_b32 v12, 26
  v_cmp_eq_u32 vcc, 1, v10
  s_nop 1
  v_cndmask_b32 v11, v11, v12, vcc
  v_cmp_le_u32 vcc, v11, v9
  s_mov_b64 s[84:85], vcc
  v_mov_b32 v11, 19
  v_mov_b32 v12, 27
  v_cmp_eq_u32 vcc, 1, v10
  s_nop 1
  v_cndmask_b32 v11, v11, v12, vcc
  v_cmp_le_u32 vcc, v11, v9
  s_mov_b64 s[86:87], vcc
  v_mov_b32 v11, 20
  v_mov_b32 v12, 28
  v_cmp_eq_u32 vcc, 1, v10
  s_nop 1
  v_cndmask_b32 v11, v11, v12, vcc
  v_cmp_le_u32 vcc, v11, v9
  s_mov_b64 s[88:89], vcc
  v_mov_b32 v11, 21
  v_mov_b32 v12, 29
  v_cmp_eq_u32 vcc, 1, v10
  s_nop 1
  v_cndmask_b32 v11, v11, v12, vcc
  v_cmp_le_u32 vcc, v11, v9
  s_mov_b64 s[90:91], vcc
  v_mov_b32 v11, 22
  v_mov_b32 v12, 30
  v_cmp_eq_u32 vcc, 1, v10
  s_nop 1
  v_cndmask_b32 v11, v11, v12, vcc
  v_cmp_le_u32 vcc, v11, v9
  s_mov_b64 s[92:93], vcc
  v_mov_b32 v11, 23
  v_mov_b32 v12, 31
  v_cmp_eq_u32 vcc, 1, v10
  s_nop 1
  v_cndmask_b32 v11, v11, v12, vcc
  v_cmp_le_u32 vcc, v11, v9
  s_mov_b64 s[94:95], vcc
  s_sub_u32 s60, s61, s50
  s_mov_b32 s62, 0
  s_cmp_eq_u32 s60, 4
  s_cbranch_scc1 W_FPC
HQ_173:
  s_lshl_b32 s58, s50, 3
  s_lshl_b32 s51, s48, 1
  s_add_u32 s58, s58, s51
  s_mul_i32 s51, s58, 768
  s_add_u32 s51, s51, s49
  s_lshl_b32 s52, s51, 10
  s_add_u32 s53, s52, 25165824
  s_add_u32 s54, s52, 0
  s_add_u32 s51, s53, 0
  buffer_load_dwordx4 a[0:3], v2, s[40:43], s51 offen sc1
  s_add_u32 s51, s54, 0
  buffer_load_dwordx4 a[48:51], v3, s[40:43], s51 offen sc1
  s_add_u32 s51, s53, 65536
  buffer_load_dwordx4 a[4:7], v2, s[40:43], s51 offen sc1
  s_add_u32 s51, s54, 65536
  buffer_load_dwordx4 a[52:55], v3, s[40:43], s51 offen sc1
  s_add_u32 s51, s53, 131072
  buffer_load_dwordx4 a[8:11], v2, s[40:43], s51 offen sc1
  s_add_u32 s51, s54, 131072
  buffer_load_dwordx4 a[56:59], v3, s[40:43], s51 offen sc1
  s_add_u32 s51, s53, 196608
  buffer_load_dwordx4 a[12:15], v2, s[40:43], s51 offen sc1
  s_add_u32 s51, s54, 196608
  buffer_load_dwordx4 a[60:63], v3, s[40:43], s51 offen sc1
  s_add_u32 s51, s53, 262144
  buffer_load_dwordx4 a[16:19], v2, s[40:43], s51 offen sc1
  s_add_u32 s51, s54, 262144
  buffer_load_dwordx4 a[64:67], v3, s[40:43], s51 offen sc1
  s_add_u32 s51, s53, 327680
  buffer_load_dwordx4 a[20:23], v2, s[40:43], s51 offen sc1
  s_add_u32 s51, s54, 327680
  buffer_load_dwordx4 a[68:71], v3, s[40:43], s51 offen sc1
  s_add_u32 s51, s53, 393216
  buffer_load_dwordx4 a[24:27], v2, s[40:43], s51 offen sc1
  s_add_u32 s51, s54, 393216
  buffer_load_dwordx4 a[72:75], v3, s[40:43], s51 offen sc1
  s_add_u32 s51, s53, 458752
  buffer_load_dwordx4 a[28:31], v2, s[40:43], s51 offen sc1
  s_add_u32 s51, s54, 458752
  buffer_load_dwordx4 a[76:79], v3, s[40:43], s51 offen sc1
  s_add_u32 s51, s53, 524288
  buffer_load_dwordx4 a[32:35], v2, s[40:43], s51 offen sc1
  s_add_u32 s51, s54, 524288
  buffer_load_dwordx4 a[80:83], v3, s[40:43], s51 offen sc1
  s_add_u32 s51, s53, 589824
  buffer_load_dwordx4 a[36:39], v2, s[40:43], s51 offen sc1
  s_add_u32 s51, s54, 589824
  buffer_load_dwordx4 a[84:87], v3, s[40:43], s51 offen sc1
  s_add_u32 s51, s53, 655360
  buffer_load_dwordx4 a[40:43], v2, s[40:43], s51 offen sc1
  s_add_u32 s51, s54, 655360
  buffer_load_dwordx4 a[88:91], v3, s[40:43], s51 offen sc1
  s_add_u32 s51, s53, 720896
  buffer_load_dwordx4 a[44:47], v2, s[40:43], s51 offen sc1
  s_add_u32 s51, s54, 720896
  buffer_load_dwordx4 a[92:95], v3, s[40:43], s51 offen sc1
  s_add_u32 s53, s53, 786432
  s_add_u32 s54, s54, 786432
  s_add_u32 s51, s53, 0
  buffer_load_dwordx4 a[96:99], v2, s[40:43], s51 offen sc1
  s_add_u32 s51, s54, 0
  buffer_load_dwordx4 a[144:147], v3, s[40:43], s51 offen sc1
  s_add_u32 s51, s53, 65536
  buffer_load_dwordx4 a[100:103], v2, s[40:43], s51 offen sc1
  s_add_u32 s51, s54, 65536
  buffer_load_dwordx4 a[148:151], v3, s[40:43], s51 offen sc1
  s_add_u32 s51, s53, 131072
  buffer_load_dwordx4 a[104:107], v2, s[40:43], s51 offen sc1
  s_add_u32 s51, s54, 131072
  buffer_load_dwordx4 a[152:155], v3, s[40:43], s51 offen sc1
  s_add_u32 s51, s53, 196608
  buffer_load_dwordx4 a[108:111], v2, s[40:43], s51 offen sc1
  s_add_u32 s51, s54, 196608
  buffer_load_dwordx4 a[156:159], v3, s[40:43], s51 offen sc1
  s_add_u32 s51, s53, 262144
  buffer_load_dwordx4 a[112:115], v2, s[40:43], s51 offen sc1
  s_add_u32 s51, s54, 262144
  buffer_load_dwordx4 a[160:163], v3, s[40:43], s51 offen sc1
  s_add_u32 s51, s53, 327680
  buffer_load_dwordx4 a[116:119], v2, s[40:43], s51 offen sc1
  s_add_u32 s51, s54, 327680
  buffer_load_dwordx4 a[164:167], v3, s[40:43], s51 offen sc1
  s_add_u32 s51, s53, 393216
  buffer_load_dwordx4 a[120:123], v2, s[40:43], s51 offen sc1
  s_add_u32 s51, s54, 393216
  buffer_load_dwordx4 a[168:171], v3, s[40:43], s51 offen sc1
  s_add_u32 s51, s53, 458752
  buffer_load_dwordx4 a[124:127], v2, s[40:43], s51 offen sc1
  s_add_u32 s51, s54, 458752
  buffer_load_dwordx4 a[172:175], v3, s[40:43], s51 offen sc1
  s_add_u32 s51, s53, 524288
  buffer_load_dwordx4 a[128:131], v2, s[40:43], s51 offen sc1
  s_add_u32 s51, s54, 524288
  buffer_load_dwordx4 a[176:179], v3, s[40:43], s51 offen sc1
  s_add_u32 s51, s53, 589824
  buffer_load_dwordx4 a[132:135], v2, s[40:43], s51 offen sc1
  s_add_u32 s51, s54, 589824
  buffer_load_dwordx4 a[180:183], v3, s[40:43], s51 offen sc1
  s_add_u32 s51, s53, 655360
  buffer_load_dwordx4 a[136:139], v2, s[40:43], s51 offen sc1
  s_add_u32 s51, s54, 655360
  buffer_load_dwordx4 a[184:187], v3, s[40:43], s51 offen sc1
  s_add_u32 s51, s53, 720896
  buffer_load_dwordx4 a[140:143], v2, s[40:43], s51 offen sc1
  s_add_u32 s51, s54, 720896
  buffer_load_dwordx4 a[188:191], v3, s[40:43], s51 offen sc1
  s_waitcnt vmcnt(24)
  v_mfma_f32_32x32x16_bf16 v[16:31], a[48:51], a[0:3], 0
  v_mfma_f32_32x32x16_bf16 v[16:31], a[52:55], a[4:7], v[16:31]
  v_mfma_f32_32x32x16_bf16 v[16:31], a[56:59], a[8:11], v[16:31]
  v_mfma_f32_32x32x16_bf16 v[16:31], a[60:63], a[12:15], v[16:31]
  v_mfma_f32_32x32x16_bf16 v[16:31], a[64:67], a[16:19], v[16:31]
  v_mfma_f32_32x32x16_bf16 v[16:31], a[68:71], a[20:23], v[16:31]
  v_mfma_f32_32x32x16_bf16 v[16:31], a[72:75], a[24:27], v[16:31]
  v_mfma_f32_32x32x16_bf16 v[16:31], a[76:79], a[28:31], v[16:31]
  v_mfma_f32_32x32x16_bf16 v[16:31], a[80:83], a[32:35], v[16:31]
  v_mfma_f32_32x32x16_bf16 v[16:31], a[84:87], a[36:39], v[16:31]
  v_mfma_f32_32x32x16_bf16 v[16:31], a[88:91], a[40:43], v[16:31]
  v_mfma_f32_32x32x16_bf16 v[16:31], a[92:95], a[44:47], v[16:31]
  s_waitcnt vmcnt(0)
  v_mfma_f32_32x32x16_bf16 v[64:79], a[144:147], a[96:99], 0
  v_mfma_f32_32x32x16_bf16 v[64:79], a[148:151], a[100:103], v[64:79]
  v_mfma_f32_32x32x16_bf16 v[64:79], a[152:155], a[104:107], v[64:79]
  v_mfma_f32_32x32x16_bf16 v[64:79], a[156:159], a[108:111], v[64:79]
  v_mfma_f32_32x32x16_bf16 v[64:79], a[160:163], a[112:115], v[64:79]
  v_mfma_f32_32x32x16_bf16 v[64:79], a[164:167], a[116:119], v[64:79]
  v_mfma_f32_32x32x16_bf16 v[64:79], a[168:171], a[120:123], v[64:79]
  v_mfma_f32_32x32x16_bf16 v[64:79], a[172:175], a[124:127], v[64:79]
  v_mfma_f32_32x32x16_bf16 v[64:79], a[176:179], a[128:131], v[64:79]
  v_mfma_f32_32x32x16_bf16 v[64:79], a[180:183], a[132:135], v[64:79]
  v_mfma_f32_32x32x16_bf16 v[64:79], a[184:187], a[136:139], v[64:79]
  v_mfma_f32_32x32x16_bf16 v[64:79], a[188:191], a[140:143], v[64:79]
  s_cmp_eq_u32 s62, 1
  s_cbranch_scc1 NWP_174
  s_add_u32 s63, s49, 1
  s_cmp_eq_u32 s48, 0
  s_cbranch_scc0 FX_176
  v_and_b32 v2, 63, v0
  v_lshlrev_b32 v2, 8, v2
  s_mov_b32 s57, 182452224
  s_add_u32 s56, s57, 16384
FP_175:
  buffer_load_dword v4, v2, s[40:43], s57 offen sc1
  buffer_load_dword v5, v2, s[40:43], s56 offen sc1
  s_waitcnt vmcnt(0)
  v_min_u32 v4, v4, v5
  v_cmp_gt_u32 vcc, s63, v4
  s_cbranch_vccz FX_176
  s_sleep 6
  s_sub_u32 s101, s101, 1
  s_cbranch_scc0 FP_175
  s_mov_b32 s101, 0
FX_176:
  s_barrier
  s_mov_b32 s62, 1
NWP_174:
  v_and_b32 v9, 31, v1
  v_lshrrev_b32 v10, 5, v1
  v_lshlrev_b32 v2, 5, v9
  v_lshl_add_u32 v2, v10, 4, v2
  v_lshrrev_b32 v4, 3, v9
  v_mul_u32_u24 v4, 196608, v4
  v_and_b32 v11, 7, v9
  v_lshl_add_u32 v4, v11, 5, v4
  v_lshl_add_u32 v4, v10, 4, v4
  v_lshlrev_b32 v15, 4, v1
  s_and_b32 s51, s58, 0xfc
  s_mul_i32 s51, s51, 768
  s_add_u32 s51, s51, s49
  s_lshl_b32 s52, s51, 8
  s_add_u32 s55, s52, 155189248
  s_add_u32 s51, s55, 0
  buffer_load_dwordx4 a[192:195], v4, s[40:43], s51 offen sc1
  s_add_u32 s51, s55, 16384
  buffer_load_dwordx4 a[196:199], v4, s[40:43], s51 offen sc1
  s_add_u32 s51, s55, 32768
  buffer_load_dwordx4 a[200:203], v4, s[40:43], s51 offen sc1
  s_add_u32 s51, s55, 49152
  buffer_load_dwordx4 a[204:207], v4, s[40:43], s51 offen sc1
  s_add_u32 s51, s55, 65536
  buffer_load_dwordx4 a[208:211], v4, s[40:43], s51 offen sc1
  s_add_u32 s51, s55, 81920
  buffer_load_dwordx4 a[212:215], v4, s[40:43], s51 offen sc1
  s_add_u32 s51, s55, 98304
  buffer_load_dwordx4 a[216:219], v4, s[40:43], s51 offen sc1
  s_add_u32 s51, s55, 114688
  buffer_load_dwordx4 a[220:223], v4, s[40:43], s51 offen sc1
  s_add_u32 s51, s55, 131072
  buffer_load_dwordx4 a[224:227], v4, s[40:43], s51 offen sc1
  s_add_u32 s51, s55, 147456
  buffer_load_dwordx4 a[228:231], v4, s[40:43], s51 offen sc1
  s_add_u32 s51, s55, 163840
  buffer_load_dwordx4 a[232:235], v4, s[40:43], s51 offen sc1
  s_add_u32 s51, s55, 180224
  buffer_load_dwordx4 a[236:239], v4, s[40:43], s51 offen sc1
  s_lshl_b32 s51, s49, 5
  s_add_u32 s51, s51, s58
  s_mul_i32 s56, s51, 3072
  s_add_u32 s56, s56, 192937984
  s_waitcnt vmcnt(0)
  v_mfma_f32_32x32x16_bf16 v[32:47], a[192:195], a[0:3], 0
  v_mfma_f32_32x32x16_bf16 v[32:47], a[196:199], a[4:7], v[32:47]
  v_mfma_f32_32x32x16_bf16 v[32:47], a[200:203], a[8:11], v[32:47]
  v_mfma_f32_32x32x16_bf16 v[32:47], a[204:207], a[12:15], v[32:47]
  v_mfma_f32_32x32x16_bf16 v[32:47], a[208:211], a[16:19], v[32:47]
  v_mfma_f32_32x32x16_bf16 v[32:47], a[212:215], a[20:23], v[32:47]
  v_mfma_f32_32x32x16_bf16 v[32:47], a[216:219], a[24:27], v[32:47]
  v_mfma_f32_32x32x16_bf16 v[32:47], a[220:223], a[28:31], v[32:47]
  v_mfma_f32_32x32x16_bf16 v[32:47], a[224:227], a[32:35], v[32:47]
  v_mfma_f32_32x32x16_bf16 v[32:47], a[228:231], a[36:39], v[32:47]
  v_mfma_f32_32x32x16_bf16 v[32:47], a[232:235], a[40:43], v[32:47]
  v_mfma_f32_32x32x16_bf16 v[32:47], a[236:239], a[44:47], v[32:47]
  v_mfma_f32_32x32x16_bf16 v[80:95], a[192:195], a[96:99], 0
  v_mfma_f32_32x32x16_bf16 v[80:95], a[196:199], a[100:103], v[80:95]
  v_mfma_f32_32x32x16_bf16 v[80:95], a[200:203], a[104:107], v[80:95]
  v_mfma_f32_32x32x16_bf16 v[80:95], a[204:207], a[108:111], v[80:95]
  v_mfma_f32_32x32x16_bf16 v[80:95], a[208:211], a[112:115], v[80:95]
  v_mfma_f32_32x32x16_bf16 v[80:95], a[212:215], a[116:119], v[80:95]
  v_mfma_f32_32x32x16_bf16 v[80:95], a[216:219], a[120:123], v[80:95]
  v_mfma_f32_32x32x16_bf16 v[80:95], a[220:223], a[124:127], v[80:95]
  v_mfma_f32_32x32x16_bf16 v[80:95], a[224:227], a[128:131], v[80:95]
  v_mfma_f32_32x32x16_bf16 v[80:95], a[228:231], a[132:135], v[80:95]
  v_mfma_f32_32x32x16_bf16 v[80:95], a[232:235], a[136:139], v[80:95]
  v_mfma_f32_32x32x16_bf16 v[80:95], a[236:239], a[140:143], v[80:95]
  s_nop 7
  s_nop 3
  s_bitcmp1_b32 s48, 0
  s_cbranch_scc1 FA_177
  v_mov_b32 v96, v32
  v_mov_b32 v97, v33
  v_mov_b32 v98, v34
  v_mov_b32 v99, v35
  s_branch FB_178
FA_177:
  v_mov_b32 v96, v40
  v_mov_b32 v97, v41
  v_mov_b32 v98, v42
  v_mov_b32 v99, v43
FB_178:
  v_cndmask_b32 v16, v14, v16, s[64:65]
  v_cndmask_b32 v17, v14, v17, s[66:67]
  v_cndmask_b32 v18, v14, v18, s[68:69]
  v_cndmask_b32 v19, v14, v19, s[70:71]
  v_cndmask_b32 v20, v14, v20, s[72:73]
  v_cndmask_b32 v21, v14, v21, s[74:75]
  v_cndmask_b32 v22, v14, v22, s[76:77]
  v_cndmask_b32 v23, v14, v23, s[78:79]
  v_cndmask_b32 v24, v14, v24, s[80:81]
  v_cndmask_b32 v25, v14, v25, s[82:83]
  v_cndmask_b32 v26, v14, v26, s[84:85]
  v_cndmask_b32 v27, v14, v27, s[86:87]
  v_cndmask_b32 v28, v14, v28, s[88:89]
  v_cndmask_b32 v29, v14, v29, s[90:91]
  v_cndmask_b32 v30, v14, v30, s[92:93]
  v_cndmask_b32 v31, v14, v31, s[94:95]
  v_max3_f32 v11, v16, v17, v18
  v_max3_f32 v12, v19, v20, v21
  v_max3_f32 v11, v22, v23, v11
  v_max3_f32 v12, v24, v25, v12
  v_max3_f32 v11, v26, v27, v11
  v_max3_f32 v12, v28, v29, v12
  v_max3_f32 v11, v30, v31, v11
  v_max3_f32 v12, v96, v97, v12
  v_max3_f32 v11, v98, v99, v11
  v_max_f32 v11, v11, v12
  v_mov_b32 v12, v11
  s_nop 1
  v_permlane32_swap_b32 v11, v12
  s_nop 0
  v_max_f32 v11, v11, v12
  v_mul_f32 v11, s59, v11
  v_fma_f32 v16, v16, s59, -v11
  v_fma_f32 v17, v17, s59, -v11
  v_fma_f32 v18, v18, s59, -v11
  v_fma_f32 v19, v19, s59, -v11
  v_fma_f32 v20, v20, s59, -v11
  v_fma_f32 v21, v21, s59, -v11
  v_fma_f32 v22, v22, s59, -v11
  v_fma_f32 v23, v23, s59, -v11
  v_fma_f32 v24, v24, s59, -v11
  v_fma_f32 v25, v25, s59, -v11
  v_fma_f32 v26, v26, s59, -v11
  v_fma_f32 v27, v27, s59, -v11
  v_fma_f32 v28, v28, s59, -v11
  v_fma_f32 v29, v29, s59, -v11
  v_fma_f32 v30, v30, s59, -v11
  v_fma_f32 v31, v31, s59, -v11
  v_fma_f32 v96, v96, s59, -v11
  v_fma_f32 v97, v97, s59, -v11
  v_fma_f32 v98, v98, s59, -v11
  v_fma_f32 v99, v99, s59, -v11
  v_exp_f32 v16, v16
  v_exp_f32 v17, v17
  v_exp_f32 v18, v18
  v_exp_f32 v19, v19
  v_exp_f32 v20, v20
  v_exp_f32 v21, v21
  v_exp_f32 v22, v22
  v_exp_f32 v23, v23
  v_exp_f32 v24, v24
  v_exp_f32 v25, v25
  v_exp_f32 v26, v26
  v_exp_f32 v27, v27
  v_exp_f32 v28, v28
  v_exp_f32 v29, v29
  v_exp_f32 v30, v30
  v_exp_f32 v31, v31
  v_exp_f32 v96, v96
  v_exp_f32 v97, v97
  v_exp_f32 v98, v98
  v_exp_f32 v99, v99
  s_nop 0
  v_add_f32 v13, v16, v17
  v_add_f32 v12, v18, v19
  v_add_f32 v13, v13, v20
  v_add_f32 v12, v12, v21
  v_add_f32 v13, v13, v22
  v_add_f32 v12, v12, v23
  v_add_f32 v13, v13, v24
  v_add_f32 v12, v12, v25
  v_add_f32 v13, v13, v26
  v_add_f32 v12, v12, v27
  v_add_f32 v13, v13, v28
  v_add_f32 v12, v12, v29
  v_add_f32 v13, v13, v30
  v_add_f32 v12, v12, v31
  v_add_f32 v13, v13, v96
  v_add_f32 v12, v12, v97
  v_add_f32 v13, v13, v98
  v_add_f32 v12, v12, v99
  v_add_f32 v13, v13, v12
  v_mov_b32 v12, v13
  s_nop 1
  v_permlane32_swap_b32 v13, v12
  s_nop 0
  v_add_f32 v13, v13, v12
  v_rcp_f32 v13, v13
  s_nop 0
  v_mul_f32 v16, v16, v13
  v_mul_f32 v17, v17, v13
  v_mul_f32 v18, v18, v13
  v_mul_f32 v19, v19, v13
  v_mul_f32 v20, v20, v13
  v_mul_f32 v21, v21, v13
  v_mul_f32 v22, v22, v13
  v_mul_f32 v23, v23, v13
  v_mul_f32 v24, v24, v13
  v_mul_f32 v25, v25, v13
  v_mul_f32 v26, v26, v13
  v_mul_f32 v27, v27, v13
  v_mul_f32 v28, v28, v13
  v_mul_f32 v29, v29, v13
  v_mul_f32 v30, v30, v13
  v_mul_f32 v31, v31, v13
  v_mul_f32 v96, v96, v13
  v_mul_f32 v97, v97, v13
  v_mul_f32 v98, v98, v13
  v_mul_f32 v99, v99, v13
  v_cvt_pk_bf16_f32 v100, v16, v17
  v_cvt_pk_bf16_f32 v101, v18, v19
  v_cvt_pk_bf16_f32 v102, v20, v21
  v_cvt_pk_bf16_f32 v103, v22, v23
  v_cvt_pk_bf16_f32 v104, v24, v25
  v_cvt_pk_bf16_f32 v105, v26, v27
  v_cvt_pk_bf16_f32 v106, v28, v29
  v_cvt_pk_bf16_f32 v107, v30, v31
  v_cvt_pk_bf16_f32 v108, v96, v97
  v_cvt_pk_bf16_f32 v109, v98, v99
  buffer_store_dwordx4 v[100:103], v15, s[40:43], s56 offen sc1
  buffer_store_dwordx4 v[104:107], v15, s[40:43], s56 offen offset:1024 sc1
  v_lshrrev_b32 v9, 1, v15
  buffer_store_dwordx2 v[108:109], v9, s[40:43], s56 offen offset:2048 sc1
  s_add_u32 s56, s56, 3072
  s_bitcmp1_b32 s48, 0
  s_cbranch_scc1 FA_179
  v_mov_b32 v96, v84
  v_mov_b32 v97, v85
  v_mov_b32 v98, v86
  v_mov_b32 v99, v87
  s_branch FB_180
FA_179:
  v_mov_b32 v96, v92
  v_mov_b32 v97, v93
  v_mov_b32 v98, v94
  v_mov_b32 v99, v95
FB_180:
  v_cndmask_b32 v64, v14, v64, s[64:65]
  v_cndmask_b32 v65, v14, v65, s[66:67]
  v_cndmask_b32 v66, v14, v66, s[68:69]
  v_cndmask_b32 v67, v14, v67, s[70:71]
  v_cndmask_b32 v68, v14, v68, s[72:73]
  v_cndmask_b32 v69, v14, v69, s[74:75]
  v_cndmask_b32 v70, v14, v70, s[76:77]
  v_cndmask_b32 v71, v14, v71, s[78:79]
  v_cndmask_b32 v72, v14, v72, s[80:81]
  v_cndmask_b32 v73, v14, v73, s[82:83]
  v_cndmask_b32 v74, v14, v74, s[84:85]
  v_cndmask_b32 v75, v14, v75, s[86:87]
  v_cndmask_b32 v76, v14, v76, s[88:89]
  v_cndmask_b32 v77, v14, v77, s[90:91]
  v_cndmask_b32 v78, v14, v78, s[92:93]
  v_cndmask_b32 v79, v14, v79, s[94:95]
  v_max3_f32 v11, v64, v65, v66
  v_max3_f32 v12, v67, v68, v69
  v_max3_f32 v11, v70, v71, v11
  v_max3_f32 v12, v72, v73, v12
  v_max3_f32 v11, v74, v75, v11
  v_max3_f32 v12, v76, v77, v12
  v_max3_f32 v11, v78, v79, v11
  v_max3_f32 v12, v96, v97, v12
  v_max3_f32 v11, v98, v99, v11
  v_max_f32 v11, v11, v12
  v_mov_b32 v12, v11
  s_nop 1
  v_permlane32_swap_b32 v11, v12
  s_nop 0
  v_max_f32 v11, v11, v12
  v_mul_f32 v11, s59, v11
  v_fma_f32 v64, v64, s59, -v11
  v_fma_f32 v65, v65, s59, -v11
  v_fma_f32 v66, v66, s59, -v11
  v_fma_f32 v67, v67, s59, -v11
  v_fma_f32 v68, v68, s59, -v11
  v_fma_f32 v69, v69, s59, -v11
  v_fma_f32 v70, v70, s59, -v11
  v_fma_f32 v71, v71, s59, -v11
  v_fma_f32 v72, v72, s59, -v11
  v_fma_f32 v73, v73, s59, -v11
  v_fma_f32 v74, v74, s59, -v11
  v_fma_f32 v75, v75, s59, -v11
  v_fma_f32 v76, v76, s59, -v11
  v_fma_f32 v77, v77, s59, -v11
  v_fma_f32 v78, v78, s59, -v11
  v_fma_f32 v79, v79, s59, -v11
  v_fma_f32 v96, v96, s59, -v11
  v_fma_f32 v97, v97, s59, -v11
  v_fma_f32 v98, v98, s59, -v11
  v_fma_f32 v99, v99, s59, -v11
  v_exp_f32 v64, v64
  v_exp_f32 v65, v65
  v_exp_f32 v66, v66
  v_exp_f32 v67, v67
  v_exp_f32 v68, v68
  v_exp_f32 v69, v69
  v_exp_f32 v70, v70
  v_exp_f32 v71, v71
  v_exp_f32 v72, v72
  v_exp_f32 v73, v73
  v_exp_f32 v74, v74
  v_exp_f32 v75, v75
  v_exp_f32 v76, v76
  v_exp_f32 v77, v77
  v_exp_f32 v78, v78
  v_exp_f32 v79, v79
  v_exp_f32 v96, v96
  v_exp_f32 v97, v97
  v_exp_f32 v98, v98
  v_exp_f32 v99, v99
  s_nop 0
  v_add_f32 v13, v64, v65
  v_add_f32 v12, v66, v67
  v_add_f32 v13, v13, v68
  v_add_f32 v12, v12, v69
  v_add_f32 v13, v13, v70
  v_add_f32 v12, v12, v71
  v_add_f32 v13, v13, v72
  v_add_f32 v12, v12, v73
  v_add_f32 v13, v13, v74
  v_add_f32 v12, v12, v75
  v_add_f32 v13, v13, v76
  v_add_f32 v12, v12, v77
  v_add_f32 v13, v13, v78
  v_add_f32 v12, v12, v79
  v_add_f32 v13, v13, v96
  v_add_f32 v12, v12, v97
  v_add_f32 v13, v13, v98
  v_add_f32 v12, v12, v99
  v_add_f32 v13, v13, v12
  v_mov_b32 v12, v13
  s_nop 1
  v_permlane32_swap_b32 v13, v12
  s_nop 0
  v_add_f32 v13, v13, v12
  v_rcp_f32 v13, v13
  s_nop 0
  v_mul_f32 v64, v64, v13
  v_mul_f32 v65, v65, v13
  v_mul_f32 v66, v66, v13
  v_mul_f32 v67, v67, v13
  v_mul_f32 v68, v68, v13
  v_mul_f32 v69, v69, v13
  v_mul_f32 v70, v70, v13
  v_mul_f32 v71, v71, v13
  v_mul_f32 v72, v72, v13
  v_mul_f32 v73, v73, v13
  v_mul_f32 v74, v74, v13
  v_mul_f32 v75, v75, v13
  v_mul_f32 v76, v76, v13
  v_mul_f32 v77, v77, v13
  v_mul_f32 v78, v78, v13
  v_mul_f32 v79, v79, v13
  v_mul_f32 v96, v96, v13
  v_mul_f32 v97, v97, v13
  v_mul_f32 v98, v98, v13
  v_mul_f32 v99, v99, v13
  v_cvt_pk_bf16_f32 v112, v64, v65
  v_cvt_pk_bf16_f32 v113, v66, v67
  v_cvt_pk_bf16_f32 v114, v68, v69
  v_cvt_pk_bf16_f32 v115, v70, v71
  v_cvt_pk_bf16_f32 v116, v72, v73
  v_cvt_pk_bf16_f32 v117, v74, v75
  v_cvt_pk_bf16_f32 v118, v76, v77
  v_cvt_pk_bf16_f32 v119, v78, v79
  v_cvt_pk_bf16_f32 v120, v96, v97
  v_cvt_pk_bf16_f32 v121, v98, v99
  buffer_store_dwordx4 v[112:115], v15, s[40:43], s56 offen sc1
  buffer_store_dwordx4 v[116:119], v15, s[40:43], s56 offen offset:1024 sc1
  v_lshrrev_b32 v9, 1, v15
  buffer_store_dwordx2 v[120:121], v9, s[40:43], s56 offen offset:2048 sc1
  s_add_u32 s56, s56, 3072
  s_add_u32 s50, s50, 1
  s_cmp_lt_u32 s50, s61
  s_cbranch_scc1 HQ_173
  s_branch W_FPD
W_FPC:
  s_add_u32 s63, s49, 1
  s_cmp_eq_u32 s48, 0
  s_cbranch_scc0 FX_182
  v_and_b32 v2, 63, v0
  v_lshlrev_b32 v2, 8, v2
  s_mov_b32 s57, 182452224
  s_add_u32 s56, s57, 16384
FP_181:
  buffer_load_dword v4, v2, s[40:43], s57 offen sc1
  buffer_load_dword v5, v2, s[40:43], s56 offen sc1
  s_waitcnt vmcnt(0)
  v_min_u32 v4, v4, v5
  v_cmp_gt_u32 vcc, s63, v4
  s_cbranch_vccz FX_182
  s_sleep 20
  s_sub_u32 s101, s101, 1
  s_cbranch_scc0 FP_181
  s_mov_b32 s101, 0
FX_182:
  s_barrier
  v_and_b32 v1, 63, v0
  v_lshrrev_b32 v9, 6, v0
  s_nop 0
  v_readfirstlane_b32 s48, v9
  v_and_b32 v9, 31, v1
  v_lshrrev_b32 v10, 5, v1
  v_lshlrev_b32 v2, 5, v9
  v_lshl_add_u32 v2, v10, 4, v2
  v_and_b32 v3, 0x13, v9
  v_and_b32 v11, 4, v9
  v_lshl_add_u32 v3, v11, 1, v3
  v_and_b32 v11, 8, v9
  v_lshrrev_b32 v11, 1, v11
  v_add_u32 v3, v3, v11
  v_lshlrev_b32 v3, 5, v3
  v_lshl_add_u32 v3, v10, 4, v3
  v_lshrrev_b32 v4, 3, v9
  v_mul_u32_u24 v4, 196608, v4
  v_and_b32 v11, 7, v9
  v_lshl_add_u32 v4, v11, 5, v4
  v_lshl_add_u32 v4, v10, 4, v4
  v_lshrrev_b32 v5, 4, v9
  v_lshlrev_b32 v6, 14, v5
  v_lshlrev_b32 v5, 16, v5
  v_and_b32 v11, 15, v9
  v_lshl_add_u32 v5, v11, 5, v5
  v_lshl_add_u32 v5, v10, 4, v5
  v_lshl_add_u32 v6, v11, 4, v6
  v_lshl_add_u32 v6, v10, 3, v6
  v_mul_u32_u24 v7, 2560, v9
  v_lshl_add_u32 v7, v10, 4, v7
  v_lshlrev_b32 v8, 4, v1
  v_mov_b32 v14, 0xff800000
  v_mov_b32 v58, 0
  v_mov_b32 v59, 0
  s_mov_b32 s59, 0x3dd53b95
  v_mov_b32 v106, 0
  v_mov_b32 v107, 0
  v_mov_b32 v110, 0
  v_mov_b32 v111, 0
  v_mov_b32 v114, 0
  v_mov_b32 v115, 0
  v_mov_b32 v118, 0
  v_mov_b32 v119, 0
  v_mov_b32 v122, 0
  v_mov_b32 v123, 0
  v_mov_b32 v11, 0
  v_mov_b32 v12, 8
  v_cmp_eq_u32 vcc, 1, v10
  s_nop 1
  v_cndmask_b32 v11, v11, v12, vcc
  v_cmp_le_u32 vcc, v11, v9
  s_mov_b64 s[64:65], vcc
  v_mov_b32 v11, 1
  v_mov_b32 v12, 9
  v_cmp_eq_u32 vcc, 1, v10
  s_nop 1
  v_cndmask_b32 v11, v11, v12, vcc
  v_cmp_le_u32 vcc, v11, v9
  s_mov_b64 s[66:67], vcc
  v_mov_b32 v11, 2
  v_mov_b32 v12, 10
  v_cmp_eq_u32 vcc, 1, v10
  s_nop 1
  v_cndmask_b32 v11, v11, v12, vcc
  v_cmp_le_u32 vcc, v11, v9
  s_mov_b64 s[68:69], vcc
  v_mov_b32 v11, 3
  v_mov_b32 v12, 11
  v_cmp_eq_u32 vcc, 1, v10
  s_nop 1
  v_cndmask_b32 v11, v11, v12, vcc
  v_cmp_le_u32 vcc, v11, v9
  s_mov_b64 s[70:71], vcc
  v_mov_b32 v11, 4
  v_mov_b32 v12, 12
  v_cmp_eq_u32 vcc, 1, v10
  s_nop 1
  v_cndmask_b32 v11, v11, v12, vcc
  v_cmp_le_u32 vcc, v11, v9
  s_mov_b64 s[72:73], vcc
  v_mov_b32 v11, 5
  v_mov_b32 v12, 13
  v_cmp_eq_u32 vcc, 1, v10
  s_nop 1
  v_cndmask_b32 v11, v11, v12, vcc
  v_cmp_le_u32 vcc, v11, v9
  s_mov_b64 s[74:75], vcc
  v_mov_b32 v11, 6
  v_mov_b32 v12, 14
  v_cmp_eq_u32 vcc, 1, v10
  s_nop 1
  v_cndmask_b32 v11, v11, v12, vcc
  v_cmp_le_u32 vcc, v11, v9
  s_mov_b64 s[76:77], vcc
  v_mov_b32 v11, 7
  v_mov_b32 v12, 15
  v_cmp_eq_u32 vcc, 1, v10
  s_nop 1
  v_cndmask_b32 v11, v11, v12, vcc
  v_cmp_le_u32 vcc, v11, v9
  s_mov_b64 s[78:79], vcc
  v_mov_b32 v11, 16
  v_mov_b32 v12, 24
  v_cmp_eq_u32 vcc, 1, v10
  s_nop 1
  v_cndmask_b32 v11, v11, v12, vcc
  v_cmp_le_u32 vcc, v11, v9
  s_mov_b64 s[80:81], vcc
  v_mov_b32 v11, 17
  v_mov_b32 v12, 25
  v_cmp_eq_u32 vcc, 1, v10
  s_nop 1
  v_cndmask_b32 v11, v11, v12, vcc
  v_cmp_le_u32 vcc, v11, v9
  s_mov_b64 s[82:83], vcc
  v_mov_b32 v11, 18
  v_mov_b32 v12, 26
  v_cmp_eq_u32 vcc, 1, v10
  s_nop 1
  v_cndmask_b32 v11, v11, v12, vcc
  v_cmp_le_u32 vcc, v11, v9
  s_mov_b64 s[84:85], vcc
  v_mov_b32 v11, 19
  v_mov_b32 v12, 27
  v_cmp_eq_u32 vcc, 1, v10
  s_nop 1
  v_cndmask_b32 v11, v11, v12, vcc
  v_cmp_le_u32 vcc, v11, v9
  s_mov_b64 s[86:87], vcc
  v_mov_b32 v11, 20
  v_mov_b32 v12, 28
  v_cmp_eq_u32 vcc, 1, v10
  s_nop 1
  v_cndmask_b32 v11, v11, v12, vcc
  v_cmp_le_u32 vcc, v11, v9
  s_mov_b64 s[88:89], vcc
  v_mov_b32 v11, 21
  v_mov_b32 v12, 29
  v_cmp_eq_u32 vcc, 1, v10
  s_nop 1
  v_cndmask_b32 v11, v11, v12, vcc
  v_cmp_le_u32 vcc, v11, v9
  s_mov_b64 s[90:91], vcc
  v_mov_b32 v11, 22
  v_mov_b32 v12, 30
  v_cmp_eq_u32 vcc, 1, v10
  s_nop 1
  v_cndmask_b32 v11, v11, v12, vcc
  v_cmp_le_u32 vcc, v11, v9
  s_mov_b64 s[92:93], vcc
  v_mov_b32 v11, 23
  v_mov_b32 v12, 31
  v_cmp_eq_u32 vcc, 1, v10
  s_nop 1
  v_cndmask_b32 v11, v11, v12, vcc
  v_cmp_le_u32 vcc, v11, v9
  s_mov_b64 s[94:95], vcc
  s_lshl_b32 s58, s48, 3
  s_mul_i32 s51, s58, 768
  s_add_u32 s51, s51, s49
  s_lshl_b32 s52, s51, 10
  s_add_u32 s53, s52, 25165824
  s_add_u32 s54, s52, 0
  s_lshl_b32 s52, s51, 8
  s_add_u32 s55, s52, 155189248
  s_mul_i32 s51, s58, 40
  s_mul_i32 s52, s50, 10
  s_add_u32 s51, s51, s52
  s_lshl_b32 s51, s51, 6
  s_add_u32 s51, s51, s49
  s_lshl_b32 s52, s51, 10
  s_add_u32 s56, s52, 50331648
  s_lshl_b32 s52, s51, 8
  s_add_u32 s57, s52, 134217728
  v_lshlrev_b32 v15, 4, v1
  s_lshl_b32 s51, s49, 5
  s_lshl_b32 s52, s48, 3
  s_add_u32 s51, s51, s52
  s_mul_i32 s56, s51, 3072
  s_add_u32 s56, s56, 192937984
  v_lshrrev_b32 v7, 1, v15
  s_add_u32 s51, s55, 0
  buffer_load_dwordx4 a[192:195], v4, s[40:43], s51 offen sc1
  s_add_u32 s51, s55, 16384
  buffer_load_dwordx4 a[196:199], v4, s[40:43], s51 offen sc1
  s_add_u32 s51, s55, 32768
  buffer_load_dwordx4 a[200:203], v4, s[40:43], s51 offen sc1
  s_add_u32 s51, s55, 49152
  buffer_load_dwordx4 a[204:207], v4, s[40:43], s51 offen sc1
  s_add_u32 s51, s55, 65536
  buffer_load_dwordx4 a[208:211], v4, s[40:43], s51 offen sc1
  s_add_u32 s51, s55, 81920
  buffer_load_dwordx4 a[212:215], v4, s[40:43], s51 offen sc1
  s_add_u32 s51, s55, 98304
  buffer_load_dwordx4 a[216:219], v4, s[40:43], s51 offen sc1
  s_add_u32 s51, s55, 114688
  buffer_load_dwordx4 a[220:223], v4, s[40:43], s51 offen sc1
  s_add_u32 s51, s55, 131072
  buffer_load_dwordx4 a[224:227], v4, s[40:43], s51 offen sc1
  s_add_u32 s51, s55, 147456
  buffer_load_dwordx4 a[228:231], v4, s[40:43], s51 offen sc1
  s_add_u32 s51, s55, 163840
  buffer_load_dwordx4 a[232:235], v4, s[40:43], s51 offen sc1
  s_add_u32 s51, s55, 180224
  buffer_load_dwordx4 a[236:239], v4, s[40:43], s51 offen sc1
  s_add_u32 s51, s53, 0
  buffer_load_dwordx4 a[0:3], v2, s[40:43], s51 offen sc1
  s_add_u32 s51, s54, 0
  buffer_load_dwordx4 a[48:51], v3, s[40:43], s51 offen sc1
  s_add_u32 s51, s53, 65536
  buffer_load_dwordx4 a[4:7], v2, s[40:43], s51 offen sc1
  s_add_u32 s51, s54, 65536
  buffer_load_dwordx4 a[52:55], v3, s[40:43], s51 offen sc1
  s_add_u32 s51, s53, 131072
  buffer_load_dwordx4 a[8:11], v2, s[40:43], s51 offen sc1
  s_add_u32 s51, s54, 131072
  buffer_load_dwordx4 a[56:59], v3, s[40:43], s51 offen sc1
  s_add_u32 s51, s53, 196608
  buffer_load_dwordx4 a[12:15], v2, s[40:43], s51 offen sc1
  s_add_u32 s51, s54, 196608
  buffer_load_dwordx4 a[60:63], v3, s[40:43], s51 offen sc1
  s_add_u32 s51, s53, 262144
  buffer_load_dwordx4 a[16:19], v2, s[40:43], s51 offen sc1
  s_add_u32 s51, s54, 262144
  buffer_load_dwordx4 a[64:67], v3, s[40:43], s51 offen sc1
  s_add_u32 s51, s53, 327680
  buffer_load_dwordx4 a[20:23], v2, s[40:43], s51 offen sc1
  s_add_u32 s51, s54, 327680
  buffer_load_dwordx4 a[68:71], v3, s[40:43], s51 offen sc1
  s_add_u32 s51, s53, 393216
  buffer_load_dwordx4 a[24:27], v2, s[40:43], s51 offen sc1
  s_add_u32 s51, s54, 393216
  buffer_load_dwordx4 a[72:75], v3, s[40:43], s51 offen sc1
  s_add_u32 s51, s53, 458752
  buffer_load_dwordx4 a[28:31], v2, s[40:43], s51 offen sc1
  s_add_u32 s51, s54, 458752
  buffer_load_dwordx4 a[76:79], v3, s[40:43], s51 offen sc1
  s_add_u32 s51, s53, 524288
  buffer_load_dwordx4 a[32:35], v2, s[40:43], s51 offen sc1
  s_add_u32 s51, s54, 524288
  buffer_load_dwordx4 a[80:83], v3, s[40:43], s51 offen sc1
  s_add_u32 s51, s53, 589824
  buffer_load_dwordx4 a[36:39], v2, s[40:43], s51 offen sc1
  s_add_u32 s51, s54, 589824
  buffer_load_dwordx4 a[84:87], v3, s[40:43], s51 offen sc1
  s_add_u32 s51, s53, 655360
  buffer_load_dwordx4 a[40:43], v2, s[40:43], s51 offen sc1
  s_add_u32 s51, s54, 655360
  buffer_load_dwordx4 a[88:91], v3, s[40:43], s51 offen sc1
  s_add_u32 s51, s53, 720896
  buffer_load_dwordx4 a[44:47], v2, s[40:43], s51 offen sc1
  s_add_u32 s51, s54, 720896
  buffer_load_dwordx4 a[92:95], v3, s[40:43], s51 offen sc1
  s_add_u32 s53, s53, 786432
  s_add_u32 s54, s54, 786432
  s_add_u32 s51, s53, 0
  buffer_load_dwordx4 a[96:99], v2, s[40:43], s51 offen sc1
  s_add_u32 s51, s54, 0
  buffer_load_dwordx4 a[144:147], v3, s[40:43], s51 offen sc1
  s_add_u32 s51, s53, 65536
  buffer_load_dwordx4 a[100:103], v2, s[40:43], s51 offen sc1
  s_add_u32 s51, s54, 65536
  buffer_load_dwordx4 a[148:151], v3, s[40:43], s51 offen sc1
  s_add_u32 s51, s53, 131072
  buffer_load_dwordx4 a[104:107], v2, s[40:43], s51 offen sc1
  s_add_u32 s51, s54, 131072
  buffer_load_dwordx4 a[152:155], v3, s[40:43], s51 offen sc1
  s_add_u32 s51, s53, 196608
  buffer_load_dwordx4 a[108:111], v2, s[40:43], s51 offen sc1
  s_add_u32 s51, s54, 196608
  buffer_load_dwordx4 a[156:159], v3, s[40:43], s51 offen sc1
  s_add_u32 s51, s53, 262144
  buffer_load_dwordx4 a[112:115], v2, s[40:43], s51 offen sc1
  s_add_u32 s51, s54, 262144
  buffer_load_dwordx4 a[160:163], v3, s[40:43], s51 offen sc1
  s_add_u32 s51, s53, 327680
  buffer_load_dwordx4 a[116:119], v2, s[40:43], s51 offen sc1
  s_add_u32 s51, s54, 327680
  buffer_load_dwordx4 a[164:167], v3, s[40:43], s51 offen sc1
  s_add_u32 s51, s53, 393216
  buffer_load_dwordx4 a[120:123], v2, s[40:43], s51 offen sc1
  s_add_u32 s51, s54, 393216
  buffer_load_dwordx4 a[168:171], v3, s[40:43], s51 offen sc1
  s_add_u32 s51, s53, 458752
  buffer_load_dwordx4 a[124:127], v2, s[40:43], s51 offen sc1
  s_add_u32 s51, s54, 458752
  buffer_load_dwordx4 a[172:175], v3, s[40:43], s51 offen sc1
  s_add_u32 s51, s53, 524288
  buffer_load_dwordx4 a[128:131], v2, s[40:43], s51 offen sc1
  s_add_u32 s51, s54, 524288
  buffer_load_dwordx4 a[176:179], v3, s[40:43], s51 offen sc1
  s_add_u32 s51, s53, 589824
  buffer_load_dwordx4 a[132:135], v2, s[40:43], s51 offen sc1
  s_add_u32 s51, s54, 589824
  buffer_load_dwordx4 a[180:183], v3, s[40:43], s51 offen sc1
  s_add_u32 s51, s53, 655360
  buffer_load_dwordx4 a[136:139], v2, s[40:43], s51 offen sc1
  s_add_u32 s51, s54, 655360
  buffer_load_dwordx4 a[184:187], v3, s[40:43], s51 offen sc1
  s_add_u32 s51, s53, 720896
  buffer_load_dwordx4 a[140:143], v2, s[40:43], s51 offen sc1
  s_add_u32 s51, s54, 720896
  buffer_load_dwordx4 a[188:191], v3, s[40:43], s51 offen sc1
  s_add_u32 s53, s53, 786432
  s_add_u32 s54, s54, 786432
  s_waitcnt vmcnt(24)
  v_mfma_f32_32x32x16_bf16 v[16:31], a[48:51], a[0:3], 0
  s_add_u32 s51, s53, 0
  buffer_load_dwordx4 v[128:131], v2, s[40:43], s51 offen sc1
  v_mfma_f32_32x32x16_bf16 v[32:47], a[192:195], a[0:3], 0
  s_add_u32 s51, s54, 0
  buffer_load_dwordx4 v[176:179], v3, s[40:43], s51 offen sc1
  v_mfma_f32_32x32x16_bf16 v[16:31], a[52:55], a[4:7], v[16:31]
  s_add_u32 s51, s53, 65536
  buffer_load_dwordx4 v[132:135], v2, s[40:43], s51 offen sc1
  v_mfma_f32_32x32x16_bf16 v[32:47], a[196:199], a[4:7], v[32:47]
  s_add_u32 s51, s54, 65536
  buffer_load_dwordx4 v[180:183], v3, s[40:43], s51 offen sc1
  v_mfma_f32_32x32x16_bf16 v[16:31], a[56:59], a[8:11], v[16:31]
  s_add_u32 s51, s53, 131072
  buffer_load_dwordx4 v[136:139], v2, s[40:43], s51 offen sc1
  v_mfma_f32_32x32x16_bf16 v[32:47], a[200:203], a[8:11], v[32:47]
  s_add_u32 s51, s54, 131072
  buffer_load_dwordx4 v[184:187], v3, s[40:43], s51 offen sc1
  v_mfma_f32_32x32x16_bf16 v[16:31], a[60:63], a[12:15], v[16:31]
  s_add_u32 s51, s53, 196608
  buffer_load_dwordx4 v[140:143], v2, s[40:43], s51 offen sc1
  v_mfma_f32_32x32x16_bf16 v[32:47], a[204:207], a[12:15], v[32:47]
  s_add_u32 s51, s54, 196608
  buffer_load_dwordx4 v[188:191], v3, s[40:43], s51 offen sc1
  v_mfma_f32_32x32x16_bf16 v[16:31], a[64:67], a[16:19], v[16:31]
  s_add_u32 s51, s53, 262144
  buffer_load_dwordx4 v[144:147], v2, s[40:43], s51 offen sc1
  v_mfma_f32_32x32x16_bf16 v[32:47], a[208:211], a[16:19], v[32:47]
  s_add_u32 s51, s54, 262144
  buffer_load_dwordx4 v[192:195], v3, s[40:43], s51 offen sc1
  v_mfma_f32_32x32x16_bf16 v[16:31], a[68:71], a[20:23], v[16:31]
  s_add_u32 s51, s53, 327680
  buffer_load_dwordx4 v[148:151], v2, s[40:43], s51 offen sc1
  v_mfma_f32_32x32x16_bf16 v[32:47], a[212:215], a[20:23], v[32:47]
  s_add_u32 s51, s54, 327680
  buffer_load_dwordx4 v[196:199], v3, s[40:43], s51 offen sc1
  v_mfma_f32_32x32x16_bf16 v[16:31], a[72:75], a[24:27], v[16:31]
  s_add_u32 s51, s53, 393216
  buffer_load_dwordx4 v[152:155], v2, s[40:43], s51 offen sc1
  v_mfma_f32_32x32x16_bf16 v[32:47], a[216:219], a[24:27], v[32:47]
  s_add_u32 s51, s54, 393216
  buffer_load_dwordx4 v[200:203], v3, s[40:43], s51 offen sc1
  v_mfma_f32_32x32x16_bf16 v[16:31], a[76:79], a[28:31], v[16:31]
  s_add_u32 s51, s53, 458752
  buffer_load_dwordx4 v[156:159], v2, s[40:43], s51 offen sc1
  v_mfma_f32_32x32x16_bf16 v[32:47], a[220:223], a[28:31], v[32:47]
  s_add_u32 s51, s54, 458752
  buffer_load_dwordx4 v[204:207], v3, s[40:43], s51 offen sc1
  v_mfma_f32_32x32x16_bf16 v[16:31], a[80:83], a[32:35], v[16:31]
  s_add_u32 s51, s53, 524288
  buffer_load_dwordx4 v[160:163], v2, s[40:43], s51 offen sc1
  v_mfma_f32_32x32x16_bf16 v[32:47], a[224:227], a[32:35], v[32:47]
  s_add_u32 s51, s54, 524288
  buffer_load_dwordx4 v[208:211], v3, s[40:43], s51 offen sc1
  v_mfma_f32_32x32x16_bf16 v[16:31], a[84:87], a[36:39], v[16:31]
  s_add_u32 s51, s53, 589824
  buffer_load_dwordx4 v[164:167], v2, s[40:43], s51 offen sc1
  v_mfma_f32_32x32x16_bf16 v[32:47], a[228:231], a[36:39], v[32:47]
  s_add_u32 s51, s54, 589824
  buffer_load_dwordx4 v[212:215], v3, s[40:43], s51 offen sc1
  v_mfma_f32_32x32x16_bf16 v[16:31], a[88:91], a[40:43], v[16:31]
  s_add_u32 s51, s53, 655360
  buffer_load_dwordx4 v[168:171], v2, s[40:43], s51 offen sc1
  v_mfma_f32_32x32x16_bf16 v[32:47], a[232:235], a[40:43], v[32:47]
  s_add_u32 s51, s54, 655360
  buffer_load_dwordx4 v[216:219], v3, s[40:43], s51 offen sc1
  v_mfma_f32_32x32x16_bf16 v[16:31], a[92:95], a[44:47], v[16:31]
  s_add_u32 s51, s53, 720896
  buffer_load_dwordx4 v[172:175], v2, s[40:43], s51 offen sc1
  v_mfma_f32_32x32x16_bf16 v[32:47], a[236:239], a[44:47], v[32:47]
  s_add_u32 s51, s54, 720896
  buffer_load_dwordx4 v[220:223], v3, s[40:43], s51 offen sc1
  s_add_u32 s53, s53, 786432
  s_add_u32 s54, s54, 786432
  s_nop 7
  s_nop 3
  v_cndmask_b32 v16, v14, v16, s[64:65]
  v_cndmask_b32 v17, v14, v17, s[66:67]
  v_cndmask_b32 v18, v14, v18, s[68:69]
  v_cndmask_b32 v19, v14, v19, s[70:71]
  v_cndmask_b32 v20, v14, v20, s[72:73]
  v_cndmask_b32 v21, v14, v21, s[74:75]
  v_cndmask_b32 v22, v14, v22, s[76:77]
  v_cndmask_b32 v23, v14, v23, s[78:79]
  v_cndmask_b32 v24, v14, v24, s[80:81]
  v_cndmask_b32 v25, v14, v25, s[82:83]
  v_cndmask_b32 v26, v14, v26, s[84:85]
  v_cndmask_b32 v27, v14, v27, s[86:87]
  v_cndmask_b32 v28, v14, v28, s[88:89]
  v_cndmask_b32 v29, v14, v29, s[90:91]
  v_cndmask_b32 v30, v14, v30, s[92:93]
  v_cndmask_b32 v31, v14, v31, s[94:95]
  v_max3_f32 v11, v16, v17, v18
  v_max3_f32 v12, v19, v20, v21
  v_max3_f32 v11, v22, v23, v11
  v_max3_f32 v12, v24, v25, v12
  v_max3_f32 v11, v26, v27, v11
  v_max3_f32 v12, v28, v29, v12
  v_max3_f32 v11, v30, v31, v11
  v_max3_f32 v12, v32, v33, v12
  v_max3_f32 v11, v34, v35, v11
  v_max_f32 v11, v11, v12
  v_mov_b32 v12, v11
  s_nop 1
  v_permlane32_swap_b32 v11, v12
  s_nop 0
  v_max_f32 v11, v11, v12
  v_mul_f32 v11, s59, v11
  v_fma_f32 v16, v16, s59, -v11
  v_fma_f32 v17, v17, s59, -v11
  v_fma_f32 v18, v18, s59, -v11
  v_fma_f32 v19, v19, s59, -v11
  v_fma_f32 v20, v20, s59, -v11
  v_fma_f32 v21, v21, s59, -v11
  v_fma_f32 v22, v22, s59, -v11
  v_fma_f32 v23, v23, s59, -v11
  v_fma_f32 v24, v24, s59, -v11
  v_fma_f32 v25, v25, s59, -v11
  v_fma_f32 v26, v26, s59, -v11
  v_fma_f32 v27, v27, s59, -v11
  v_fma_f32 v28, v28, s59, -v11
  v_fma_f32 v29, v29, s59, -v11
  v_fma_f32 v30, v30, s59, -v11
  v_fma_f32 v31, v31, s59, -v11
  v_fma_f32 v32, v32, s59, -v11
  v_fma_f32 v33, v33, s59, -v11
  v_fma_f32 v34, v34, s59, -v11
  v_fma_f32 v35, v35, s59, -v11
  v_exp_f32 v16, v16
  v_exp_f32 v17, v17
  v_exp_f32 v18, v18
  v_exp_f32 v19, v19
  v_exp_f32 v20, v20
  v_exp_f32 v21, v21
  v_exp_f32 v22, v22
  v_exp_f32 v23, v23
  v_exp_f32 v24, v24
  v_exp_f32 v25, v25
  v_exp_f32 v26, v26
  v_exp_f32 v27, v27
  v_exp_f32 v28, v28
  v_exp_f32 v29, v29
  v_exp_f32 v30, v30
  v_exp_f32 v31, v31
  v_exp_f32 v32, v32
  v_exp_f32 v33, v33
  v_exp_f32 v34, v34
  v_exp_f32 v35, v35
  s_nop 0
  v_add_f32 v13, v16, v17
  v_add_f32 v12, v18, v19
  v_add_f32 v13, v13, v20
  v_add_f32 v12, v12, v21
  v_add_f32 v13, v13, v22
  v_add_f32 v12, v12, v23
  v_add_f32 v13, v13, v24
  v_add_f32 v12, v12, v25
  v_add_f32 v13, v13, v26
  v_add_f32 v12, v12, v27
  v_add_f32 v13, v13, v28
  v_add_f32 v12, v12, v29
  v_add_f32 v13, v13, v30
  v_add_f32 v12, v12, v31
  v_add_f32 v13, v13, v32
  v_add_f32 v12, v12, v33
  v_add_f32 v13, v13, v34
  v_add_f32 v12, v12, v35
  v_add_f32 v13, v13, v12
  v_mov_b32 v12, v13
  s_nop 1
  v_permlane32_swap_b32 v13, v12
  s_nop 0
  v_add_f32 v13, v13, v12
  v_rcp_f32 v13, v13
  s_nop 0
  v_mul_f32 v16, v16, v13
  v_mul_f32 v17, v17, v13
  v_mul_f32 v18, v18, v13
  v_mul_f32 v19, v19, v13
  v_mul_f32 v20, v20, v13
  v_mul_f32 v21, v21, v13
  v_mul_f32 v22, v22, v13
  v_mul_f32 v23, v23, v13
  v_mul_f32 v24, v24, v13
  v_mul_f32 v25, v25, v13
  v_mul_f32 v26, v26, v13
  v_mul_f32 v27, v27, v13
  v_mul_f32 v28, v28, v13
  v_mul_f32 v29, v29, v13
  v_mul_f32 v30, v30, v13
  v_mul_f32 v31, v31, v13
  v_mul_f32 v32, v32, v13
  v_mul_f32 v33, v33, v13
  v_mul_f32 v34, v34, v13
  v_mul_f32 v35, v35, v13
  v_cvt_pk_bf16_f32 v64, v16, v17
  v_cvt_pk_bf16_f32 v65, v18, v19
  v_cvt_pk_bf16_f32 v66, v20, v21
  v_cvt_pk_bf16_f32 v67, v22, v23
  v_cvt_pk_bf16_f32 v68, v24, v25
  v_cvt_pk_bf16_f32 v69, v26, v27
  v_cvt_pk_bf16_f32 v70, v28, v29
  v_cvt_pk_bf16_f32 v71, v30, v31
  v_cvt_pk_bf16_f32 v72, v32, v33
  v_cvt_pk_bf16_f32 v73, v34, v35
  buffer_store_dwordx4 v[64:67], v15, s[40:43], s56 offen sc1
  buffer_store_dwordx4 v[68:71], v15, s[40:43], s56 offen offset:1024 sc1
  buffer_store_dwordx2 v[72:73], v7, s[40:43], s56 offen offset:2048 sc1
  s_add_u32 s56, s56, 3072
  s_waitcnt vmcnt(27)
  v_mfma_f32_32x32x16_bf16 v[16:31], a[144:147], a[96:99], 0
  s_add_u32 s51, s53, 0
  buffer_load_dwordx4 a[0:3], v2, s[40:43], s51 offen sc1
  v_mfma_f32_32x32x16_bf16 v[32:47], a[192:195], a[96:99], 0
  s_add_u32 s51, s54, 0
  buffer_load_dwordx4 a[48:51], v3, s[40:43], s51 offen sc1
  v_mfma_f32_32x32x16_bf16 v[16:31], a[148:151], a[100:103], v[16:31]
  s_add_u32 s51, s53, 65536
  buffer_load_dwordx4 a[4:7], v2, s[40:43], s51 offen sc1
  v_mfma_f32_32x32x16_bf16 v[32:47], a[196:199], a[100:103], v[32:47]
  s_add_u32 s51, s54, 65536
  buffer_load_dwordx4 a[52:55], v3, s[40:43], s51 offen sc1
  v_mfma_f32_32x32x16_bf16 v[16:31], a[152:155], a[104:107], v[16:31]
  s_add_u32 s51, s53, 131072
  buffer_load_dwordx4 a[8:11], v2, s[40:43], s51 offen sc1
  v_mfma_f32_32x32x16_bf16 v[32:47], a[200:203], a[104:107], v[32:47]
  s_add_u32 s51, s54, 131072
  buffer_load_dwordx4 a[56:59], v3, s[40:43], s51 offen sc1
  v_mfma_f32_32x32x16_bf16 v[16:31], a[156:159], a[108:111], v[16:31]
  s_add_u32 s51, s53, 196608
  buffer_load_dwordx4 a[12:15], v2, s[40:43], s51 offen sc1
  v_mfma_f32_32x32x16_bf16 v[32:47], a[204:207], a[108:111], v[32:47]
  s_add_u32 s51, s54, 196608
  buffer_load_dwordx4 a[60:63], v3, s[40:43], s51 offen sc1
  v_mfma_f32_32x32x16_bf16 v[16:31], a[160:163], a[112:115], v[16:31]
  s_add_u32 s51, s53, 262144
  buffer_load_dwordx4 a[16:19], v2, s[40:43], s51 offen sc1
  v_mfma_f32_32x32x16_bf16 v[32:47], a[208:211], a[112:115], v[32:47]
  s_add_u32 s51, s54, 262144
  buffer_load_dwordx4 a[64:67], v3, s[40:43], s51 offen sc1
  v_mfma_f32_32x32x16_bf16 v[16:31], a[164:167], a[116:119], v[16:31]
  s_add_u32 s51, s53, 327680
  buffer_load_dwordx4 a[20:23], v2, s[40:43], s51 offen sc1
  v_mfma_f32_32x32x16_bf16 v[32:47], a[212:215], a[116:119], v[32:47]
  s_add_u32 s51, s54, 327680
  buffer_load_dwordx4 a[68:71], v3, s[40:43], s51 offen sc1
  v_mfma_f32_32x32x16_bf16 v[16:31], a[168:171], a[120:123], v[16:31]
  s_add_u32 s51, s53, 393216
  buffer_load_dwordx4 a[24:27], v2, s[40:43], s51 offen sc1
  v_mfma_f32_32x32x16_bf16 v[32:47], a[216:219], a[120:123], v[32:47]
  s_add_u32 s51, s54, 393216
  buffer_load_dwordx4 a[72:75], v3, s[40:43], s51 offen sc1
  v_mfma_f32_32x32x16_bf16 v[16:31], a[172:175], a[124:127], v[16:31]
  s_add_u32 s51, s53, 458752
  buffer_load_dwordx4 a[28:31], v2, s[40:43], s51 offen sc1
  v_mfma_f32_32x32x16_bf16 v[32:47], a[220:223], a[124:127], v[32:47]
  s_add_u32 s51, s54, 458752
  buffer_load_dwordx4 a[76:79], v3, s[40:43], s51 offen sc1
  v_mfma_f32_32x32x16_bf16 v[16:31], a[176:179], a[128:131], v[16:31]
  s_add_u32 s51, s53, 524288
  buffer_load_dwordx4 a[32:35], v2, s[40:43], s51 offen sc1
  v_mfma_f32_32x32x16_bf16 v[32:47], a[224:227], a[128:131], v[32:47]
  s_add_u32 s51, s54, 524288
  buffer_load_dwordx4 a[80:83], v3, s[40:43], s51 offen sc1
  v_mfma_f32_32x32x16_bf16 v[16:31], a[180:183], a[132:135], v[16:31]
  s_add_u32 s51, s53, 589824
  buffer_load_dwordx4 a[36:39], v2, s[40:43], s51 offen sc1
  v_mfma_f32_32x32x16_bf16 v[32:47], a[228:231], a[132:135], v[32:47]
  s_add_u32 s51, s54, 589824
  buffer_load_dwordx4 a[84:87], v3, s[40:43], s51 offen sc1
  v_mfma_f32_32x32x16_bf16 v[16:31], a[184:187], a[136:139], v[16:31]
  s_add_u32 s51, s53, 655360
  buffer_load_dwordx4 a[40:43], v2, s[40:43], s51 offen sc1
  v_mfma_f32_32x32x16_bf16 v[32:47], a[232:235], a[136:139], v[32:47]
  s_add_u32 s51, s54, 655360
  buffer_load_dwordx4 a[88:91], v3, s[40:43], s51 offen sc1
  v_mfma_f32_32x32x16_bf16 v[16:31], a[188:191], a[140:143], v[16:31]
  s_add_u32 s51, s53, 720896
  buffer_load_dwordx4 a[44:47], v2, s[40:43], s51 offen sc1
  v_mfma_f32_32x32x16_bf16 v[32:47], a[236:239], a[140:143], v[32:47]
  s_add_u32 s51, s54, 720896
  buffer_load_dwordx4 a[92:95], v3, s[40:43], s51 offen sc1
  s_add_u32 s53, s53, 786432
  s_add_u32 s54, s54, 786432
  s_nop 7
  s_nop 3
  v_cndmask_b32 v16, v14, v16, s[64:65]
  v_cndmask_b32 v17, v14, v17, s[66:67]
  v_cndmask_b32 v18, v14, v18, s[68:69]
  v_cndmask_b32 v19, v14, v19, s[70:71]
  v_cndmask_b32 v20, v14, v20, s[72:73]
  v_cndmask_b32 v21, v14, v21, s[74:75]
  v_cndmask_b32 v22, v14, v22, s[76:77]
  v_cndmask_b32 v23, v14, v23, s[78:79]
  v_cndmask_b32 v24, v14, v24, s[80:81]
  v_cndmask_b32 v25, v14, v25, s[82:83]
  v_cndmask_b32 v26, v14, v26, s[84:85]
  v_cndmask_b32 v27, v14, v27, s[86:87]
  v_cndmask_b32 v28, v14, v28, s[88:89]
  v_cndmask_b32 v29, v14, v29, s[90:91]
  v_cndmask_b32 v30, v14, v30, s[92:93]
  v_cndmask_b32 v31, v14, v31, s[94:95]
  v_max3_f32 v11, v16, v17, v18
  v_max3_f32 v12, v19, v20, v21
  v_max3_f32 v11, v22, v23, v11
  v_max3_f32 v12, v24, v25, v12
  v_max3_f32 v11, v26, v27, v11
  v_max3_f32 v12, v28, v29, v12
  v_max3_f32 v11, v30, v31, v11
  v_max3_f32 v12, v36, v37, v12
  v_max3_f32 v11, v38, v39, v11
  v_max_f32 v11, v11, v12
  v_mov_b32 v12, v11
  s_nop 1
  v_permlane32_swap_b32 v11, v12
  s_nop 0
  v_max_f32 v11, v11, v12
  v_mul_f32 v11, s59, v11
  v_fma_f32 v16, v16, s59, -v11
  v_fma_f32 v17, v17, s59, -v11
  v_fma_f32 v18, v18, s59, -v11
  v_fma_f32 v19, v19, s59, -v11
  v_fma_f32 v20, v20, s59, -v11
  v_fma_f32 v21, v21, s59, -v11
  v_fma_f32 v22, v22, s59, -v11
  v_fma_f32 v23, v23, s59, -v11
  v_fma_f32 v24, v24, s59, -v11
  v_fma_f32 v25, v25, s59, -v11
  v_fma_f32 v26, v26, s59, -v11
  v_fma_f32 v27, v27, s59, -v11
  v_fma_f32 v28, v28, s59, -v11
  v_fma_f32 v29, v29, s59, -v11
  v_fma_f32 v30, v30, s59, -v11
  v_fma_f32 v31, v31, s59, -v11
  v_fma_f32 v36, v36, s59, -v11
  v_fma_f32 v37, v37, s59, -v11
  v_fma_f32 v38, v38, s59, -v11
  v_fma_f32 v39, v39, s59, -v11
  v_exp_f32 v16, v16
  v_exp_f32 v17, v17
  v_exp_f32 v18, v18
  v_exp_f32 v19, v19
  v_exp_f32 v20, v20
  v_exp_f32 v21, v21
  v_exp_f32 v22, v22
  v_exp_f32 v23, v23
  v_exp_f32 v24, v24
  v_exp_f32 v25, v25
  v_exp_f32 v26, v26
  v_exp_f32 v27, v27
  v_exp_f32 v28, v28
  v_exp_f32 v29, v29
  v_exp_f32 v30, v30
  v_exp_f32 v31, v31
  v_exp_f32 v36, v36
  v_exp_f32 v37, v37
  v_exp_f32 v38, v38
  v_exp_f32 v39, v39
  s_nop 0
  v_add_f32 v13, v16, v17
  v_add_f32 v12, v18, v19
  v_add_f32 v13, v13, v20
  v_add_f32 v12, v12, v21
  v_add_f32 v13, v13, v22
  v_add_f32 v12, v12, v23
  v_add_f32 v13, v13, v24
  v_add_f32 v12, v12, v25
  v_add_f32 v13, v13, v26
  v_add_f32 v12, v12, v27
  v_add_f32 v13, v13, v28
  v_add_f32 v12, v12, v29
  v_add_f32 v13, v13, v30
  v_add_f32 v12, v12, v31
  v_add_f32 v13, v13, v36
  v_add_f32 v12, v12, v37
  v_add_f32 v13, v13, v38
  v_add_f32 v12, v12, v39
  v_add_f32 v13, v13, v12
  v_mov_b32 v12, v13
  s_nop 1
  v_permlane32_swap_b32 v13, v12
  s_nop 0
  v_add_f32 v13, v13, v12
  v_rcp_f32 v13, v13
  s_nop 0
  v_mul_f32 v16, v16, v13
  v_mul_f32 v17, v17, v13
  v_mul_f32 v18, v18, v13
  v_mul_f32 v19, v19, v13
  v_mul_f32 v20, v20, v13
  v_mul_f32 v21, v21, v13
  v_mul_f32 v22, v22, v13
  v_mul_f32 v23, v23, v13
  v_mul_f32 v24, v24, v13
  v_mul_f32 v25, v25, v13
  v_mul_f32 v26, v26, v13
  v_mul_f32 v27, v27, v13
  v_mul_f32 v28, v28, v13
  v_mul_f32 v29, v29, v13
  v_mul_f32 v30, v30, v13
  v_mul_f32 v31, v31, v13
  v_mul_f32 v36, v36, v13
  v_mul_f32 v37, v37, v13
  v_mul_f32 v38, v38, v13
  v_mul_f32 v39, v39, v13
  v_cvt_pk_bf16_f32 v76, v16, v17
  v_cvt_pk_bf16_f32 v77, v18, v19
  v_cvt_pk_bf16_f32 v78, v20, v21
  v_cvt_pk_bf16_f32 v79, v22, v23
  v_cvt_pk_bf16_f32 v80, v24, v25
  v_cvt_pk_bf16_f32 v81, v26, v27
  v_cvt_pk_bf16_f32 v82, v28, v29
  v_cvt_pk_bf16_f32 v83, v30, v31
  v_cvt_pk_bf16_f32 v84, v36, v37
  v_cvt_pk_bf16_f32 v85, v38, v39
  buffer_store_dwordx4 v[76:79], v15, s[40:43], s56 offen sc1
  buffer_store_dwordx4 v[80:83], v15, s[40:43], s56 offen offset:1024 sc1
  buffer_store_dwordx2 v[84:85], v7, s[40:43], s56 offen offset:2048 sc1
  s_add_u32 s56, s56, 3072
  s_waitcnt vmcnt(30)
  v_mfma_f32_32x32x16_bf16 v[16:31], v[176:179], v[128:131], 0
  s_add_u32 s51, s53, 0
  buffer_load_dwordx4 a[96:99], v2, s[40:43], s51 offen sc1
  v_mfma_f32_32x32x16_bf16 v[32:47], a[192:195], v[128:131], 0
  s_add_u32 s51, s54, 0
  buffer_load_dwordx4 a[144:147], v3, s[40:43], s51 offen sc1
  v_mfma_f32_32x32x16_bf16 v[16:31], v[180:183], v[132:135], v[16:31]
  s_add_u32 s51, s53, 65536
  buffer_load_dwordx4 a[100:103], v2, s[40:43], s51 offen sc1
  v_mfma_f32_32x32x16_bf16 v[32:47], a[196:199], v[132:135], v[32:47]
  s_add_u32 s51, s54, 65536
  buffer_load_dwordx4 a[148:151], v3, s[40:43], s51 offen sc1
  v_mfma_f32_32x32x16_bf16 v[16:31], v[184:187], v[136:139], v[16:31]
  s_add_u32 s51, s53, 131072
  buffer_load_dwordx4 a[104:107], v2, s[40:43], s51 offen sc1
  v_mfma_f32_32x32x16_bf16 v[32:47], a[200:203], v[136:139], v[32:47]
  s_add_u32 s51, s54, 131072
  buffer_load_dwordx4 a[152:155], v3, s[40:43], s51 offen sc1
  v_mfma_f32_32x32x16_bf16 v[16:31], v[188:191], v[140:143], v[16:31]
  s_add_u32 s51, s53, 196608
  buffer_load_dwordx4 a[108:111], v2, s[40:43], s51 offen sc1
  v_mfma_f32_32x32x16_bf16 v[32:47], a[204:207], v[140:143], v[32:47]
  s_add_u32 s51, s54, 196608
  buffer_load_dwordx4 a[156:159], v3, s[40:43], s51 offen sc1
  v_mfma_f32_32x32x16_bf16 v[16:31], v[192:195], v[144:147], v[16:31]
  s_add_u32 s51, s53, 262144
  buffer_load_dwordx4 a[112:115], v2, s[40:43], s51 offen sc1
  v_mfma_f32_32x32x16_bf16 v[32:47], a[208:211], v[144:147], v[32:47]
  s_add_u32 s51, s54, 262144
  buffer_load_dwordx4 a[160:163], v3, s[40:43], s51 offen sc1
  v_mfma_f32_32x32x16_bf16 v[16:31], v[196:199], v[148:151], v[16:31]
  s_add_u32 s51, s53, 327680
  buffer_load_dwordx4 a[116:119], v2, s[40:43], s51 offen sc1
  v_mfma_f32_32x32x16_bf16 v[32:47], a[212:215], v[148:151], v[32:47]
  s_add_u32 s51, s54, 327680
  buffer_load_dwordx4 a[164:167], v3, s[40:43], s51 offen sc1
  v_mfma_f32_32x32x16_bf16 v[16:31], v[200:203], v[152:155], v[16:31]
  s_add_u32 s51, s53, 393216
  buffer_load_dwordx4 a[120:123], v2, s[40:43], s51 offen sc1
  v_mfma_f32_32x32x16_bf16 v[32:47], a[216:219], v[152:155], v[32:47]
  s_add_u32 s51, s54, 393216
  buffer_load_dwordx4 a[168:171], v3, s[40:43], s51 offen sc1
  v_mfma_f32_32x32x16_bf16 v[16:31], v[204:207], v[156:159], v[16:31]
  s_add_u32 s51, s53, 458752
  buffer_load_dwordx4 a[124:127], v2, s[40:43], s51 offen sc1
  v_mfma_f32_32x32x16_bf16 v[32:47], a[220:223], v[156:159], v[32:47]
  s_add_u32 s51, s54, 458752
  buffer_load_dwordx4 a[172:175], v3, s[40:43], s51 offen sc1
  v_mfma_f32_32x32x16_bf16 v[16:31], v[208:211], v[160:163], v[16:31]
  s_add_u32 s51, s53, 524288
  buffer_load_dwordx4 a[128:131], v2, s[40:43], s51 offen sc1
  v_mfma_f32_32x32x16_bf16 v[32:47], a[224:227], v[160:163], v[32:47]
  s_add_u32 s51, s54, 524288
  buffer_load_dwordx4 a[176:179], v3, s[40:43], s51 offen sc1
  v_mfma_f32_32x32x16_bf16 v[16:31], v[212:215], v[164:167], v[16:31]
  s_add_u32 s51, s53, 589824
  buffer_load_dwordx4 a[132:135], v2, s[40:43], s51 offen sc1
  v_mfma_f32_32x32x16_bf16 v[32:47], a[228:231], v[164:167], v[32:47]
  s_add_u32 s51, s54, 589824
  buffer_load_dwordx4 a[180:183], v3, s[40:43], s51 offen sc1
  v_mfma_f32_32x32x16_bf16 v[16:31], v[216:219], v[168:171], v[16:31]
  s_add_u32 s51, s53, 655360
  buffer_load_dwordx4 a[136:139], v2, s[40:43], s51 offen sc1
  v_mfma_f32_32x32x16_bf16 v[32:47], a[232:235], v[168:171], v[32:47]
  s_add_u32 s51, s54, 655360
  buffer_load_dwordx4 a[184:187], v3, s[40:43], s51 offen sc1
  v_mfma_f32_32x32x16_bf16 v[16:31], v[220:223], v[172:175], v[16:31]
  s_add_u32 s51, s53, 720896
  buffer_load_dwordx4 a[140:143], v2, s[40:43], s51 offen sc1
  v_mfma_f32_32x32x16_bf16 v[32:47], a[236:239], v[172:175], v[32:47]
  s_add_u32 s51, s54, 720896
  buffer_load_dwordx4 a[188:191], v3, s[40:43], s51 offen sc1
  s_add_u32 s53, s53, 786432
  s_add_u32 s54, s54, 786432
  s_nop 7
  s_nop 3
  v_cndmask_b32 v16, v14, v16, s[64:65]
  v_cndmask_b32 v17, v14, v17, s[66:67]
  v_cndmask_b32 v18, v14, v18, s[68:69]
  v_cndmask_b32 v19, v14, v19, s[70:71]
  v_cndmask_b32 v20, v14, v20, s[72:73]
  v_cndmask_b32 v21, v14, v21, s[74:75]
  v_cndmask_b32 v22, v14, v22, s[76:77]
  v_cndmask_b32 v23, v14, v23, s[78:79]
  v_cndmask_b32 v24, v14, v24, s[80:81]
  v_cndmask_b32 v25, v14, v25, s[82:83]
  v_cndmask_b32 v26, v14, v26, s[84:85]
  v_cndmask_b32 v27, v14, v27, s[86:87]
  v_cndmask_b32 v28, v14, v28, s[88:89]
  v_cndmask_b32 v29, v14, v29, s[90:91]
  v_cndmask_b32 v30, v14, v30, s[92:93]
  v_cndmask_b32 v31, v14, v31, s[94:95]
  v_max3_f32 v11, v16, v17, v18
  v_max3_f32 v12, v19, v20, v21
  v_max3_f32 v11, v22, v23, v11
  v_max3_f32 v12, v24, v25, v12
  v_max3_f32 v11, v26, v27, v11
  v_max3_f32 v12, v28, v29, v12
  v_max3_f32 v11, v30, v31, v11
  v_max3_f32 v12, v40, v41, v12
  v_max3_f32 v11, v42, v43, v11
  v_max_f32 v11, v11, v12
  v_mov_b32 v12, v11
  s_nop 1
  v_permlane32_swap_b32 v11, v12
  s_nop 0
  v_max_f32 v11, v11, v12
  v_mul_f32 v11, s59, v11
  v_fma_f32 v16, v16, s59, -v11
  v_fma_f32 v17, v17, s59, -v11
  v_fma_f32 v18, v18, s59, -v11
  v_fma_f32 v19, v19, s59, -v11
  v_fma_f32 v20, v20, s59, -v11
  v_fma_f32 v21, v21, s59, -v11
  v_fma_f32 v22, v22, s59, -v11
  v_fma_f32 v23, v23, s59, -v11
  v_fma_f32 v24, v24, s59, -v11
  v_fma_f32 v25, v25, s59, -v11
  v_fma_f32 v26, v26, s59, -v11
  v_fma_f32 v27, v27, s59, -v11
  v_fma_f32 v28, v28, s59, -v11
  v_fma_f32 v29, v29, s59, -v11
  v_fma_f32 v30, v30, s59, -v11
  v_fma_f32 v31, v31, s59, -v11
  v_fma_f32 v40, v40, s59, -v11
  v_fma_f32 v41, v41, s59, -v11
  v_fma_f32 v42, v42, s59, -v11
  v_fma_f32 v43, v43, s59, -v11
  v_exp_f32 v16, v16
  v_exp_f32 v17, v17
  v_exp_f32 v18, v18
  v_exp_f32 v19, v19
  v_exp_f32 v20, v20
  v_exp_f32 v21, v21
  v_exp_f32 v22, v22
  v_exp_f32 v23, v23
  v_exp_f32 v24, v24
  v_exp_f32 v25, v25
  v_exp_f32 v26, v26
  v_exp_f32 v27, v27
  v_exp_f32 v28, v28
  v_exp_f32 v29, v29
  v_exp_f32 v30, v30
  v_exp_f32 v31, v31
  v_exp_f32 v40, v40
  v_exp_f32 v41, v41
  v_exp_f32 v42, v42
  v_exp_f32 v43, v43
  s_nop 0
  v_add_f32 v13, v16, v17
  v_add_f32 v12, v18, v19
  v_add_f32 v13, v13, v20
  v_add_f32 v12, v12, v21
  v_add_f32 v13, v13, v22
  v_add_f32 v12, v12, v23
  v_add_f32 v13, v13, v24
  v_add_f32 v12, v12, v25
  v_add_f32 v13, v13, v26
  v_add_f32 v12, v12, v27
  v_add_f32 v13, v13, v28
  v_add_f32 v12, v12, v29
  v_add_f32 v13, v13, v30
  v_add_f32 v12, v12, v31
  v_add_f32 v13, v13, v40
  v_add_f32 v12, v12, v41
  v_add_f32 v13, v13, v42
  v_add_f32 v12, v12, v43
  v_add_f32 v13, v13, v12
  v_mov_b32 v12, v13
  s_nop 1
  v_permlane32_swap_b32 v13, v12
  s_nop 0
  v_add_f32 v13, v13, v12
  v_rcp_f32 v13, v13
  s_nop 0
  v_mul_f32 v16, v16, v13
  v_mul_f32 v17, v17, v13
  v_mul_f32 v18, v18, v13
  v_mul_f32 v19, v19, v13
  v_mul_f32 v20, v20, v13
  v_mul_f32 v21, v21, v13
  v_mul_f32 v22, v22, v13
  v_mul_f32 v23, v23, v13
  v_mul_f32 v24, v24, v13
  v_mul_f32 v25, v25, v13
  v_mul_f32 v26, v26, v13
  v_mul_f32 v27, v27, v13
  v_mul_f32 v28, v28, v13
  v_mul_f32 v29, v29, v13
  v_mul_f32 v30, v30, v13
  v_mul_f32 v31, v31, v13
  v_mul_f32 v40, v40, v13
  v_mul_f32 v41, v41, v13
  v_mul_f32 v42, v42, v13
  v_mul_f32 v43, v43, v13
  v_cvt_pk_bf16_f32 v64, v16, v17
  v_cvt_pk_bf16_f32 v65, v18, v19
  v_cvt_pk_bf16_f32 v66, v20, v21
  v_cvt_pk_bf16_f32 v67, v22, v23
  v_cvt_pk_bf16_f32 v68, v24, v25
  v_cvt_pk_bf16_f32 v69, v26, v27
  v_cvt_pk_bf16_f32 v70, v28, v29
  v_cvt_pk_bf16_f32 v71, v30, v31
  v_cvt_pk_bf16_f32 v72, v40, v41
  v_cvt_pk_bf16_f32 v73, v42, v43
  buffer_store_dwordx4 v[64:67], v15, s[40:43], s56 offen sc1
  buffer_store_dwordx4 v[68:71], v15, s[40:43], s56 offen offset:1024 sc1
  buffer_store_dwordx2 v[72:73], v7, s[40:43], s56 offen offset:2048 sc1
  s_add_u32 s56, s56, 3072
  s_waitcnt vmcnt(30)
  v_mfma_f32_32x32x16_bf16 v[16:31], a[48:51], a[0:3], 0
  s_add_u32 s51, s53, 0
  buffer_load_dwordx4 v[128:131], v2, s[40:43], s51 offen sc1
  v_mfma_f32_32x32x16_bf16 v[32:47], a[192:195], a[0:3], 0
  s_add_u32 s51, s54, 0
  buffer_load_dwordx4 v[176:179], v3, s[40:43], s51 offen sc1
  v_mfma_f32_32x32x16_bf16 v[16:31], a[52:55], a[4:7], v[16:31]
  s_add_u32 s51, s53, 65536
  buffer_load_dwordx4 v[132:135], v2, s[40:43], s51 offen sc1
  v_mfma_f32_32x32x16_bf16 v[32:47], a[196:199], a[4:7], v[32:47]
  s_add_u32 s51, s54, 65536
  buffer_load_dwordx4 v[180:183], v3, s[40:43], s51 offen sc1
  v_mfma_f32_32x32x16_bf16 v[16:31], a[56:59], a[8:11], v[16:31]
  s_add_u32 s51, s53, 131072
  buffer_load_dwordx4 v[136:139], v2, s[40:43], s51 offen sc1
  v_mfma_f32_32x32x16_bf16 v[32:47], a[200:203], a[8:11], v[32:47]
  s_add_u32 s51, s54, 131072
  buffer_load_dwordx4 v[184:187], v3, s[40:43], s51 offen sc1
  v_mfma_f32_32x32x16_bf16 v[16:31], a[60:63], a[12:15], v[16:31]
  s_add_u32 s51, s53, 196608
  buffer_load_dwordx4 v[140:143], v2, s[40:43], s51 offen sc1
  v_mfma_f32_32x32x16_bf16 v[32:47], a[204:207], a[12:15], v[32:47]
  s_add_u32 s51, s54, 196608
  buffer_load_dwordx4 v[188:191], v3, s[40:43], s51 offen sc1
  v_mfma_f32_32x32x16_bf16 v[16:31], a[64:67], a[16:19], v[16:31]
  s_add_u32 s51, s53, 262144
  buffer_load_dwordx4 v[144:147], v2, s[40:43], s51 offen sc1
  v_mfma_f32_32x32x16_bf16 v[32:47], a[208:211], a[16:19], v[32:47]
  s_add_u32 s51, s54, 262144
  buffer_load_dwordx4 v[192:195], v3, s[40:43], s51 offen sc1
  v_mfma_f32_32x32x16_bf16 v[16:31], a[68:71], a[20:23], v[16:31]
  s_add_u32 s51, s53, 327680
  buffer_load_dwordx4 v[148:151], v2, s[40:43], s51 offen sc1
  v_mfma_f32_32x32x16_bf16 v[32:47], a[212:215], a[20:23], v[32:47]
  s_add_u32 s51, s54, 327680
  buffer_load_dwordx4 v[196:199], v3, s[40:43], s51 offen sc1
  v_mfma_f32_32x32x16_bf16 v[16:31], a[72:75], a[24:27], v[16:31]
  s_add_u32 s51, s53, 393216
  buffer_load_dwordx4 v[152:155], v2, s[40:43], s51 offen sc1
  v_mfma_f32_32x32x16_bf16 v[32:47], a[216:219], a[24:27], v[32:47]
  s_add_u32 s51, s54, 393216
  buffer_load_dwordx4 v[200:203], v3, s[40:43], s51 offen sc1
  v_mfma_f32_32x32x16_bf16 v[16:31], a[76:79], a[28:31], v[16:31]
  s_add_u32 s51, s53, 458752
  buffer_load_dwordx4 v[156:159], v2, s[40:43], s51 offen sc1
  v_mfma_f32_32x32x16_bf16 v[32:47], a[220:223], a[28:31], v[32:47]
  s_add_u32 s51, s54, 458752
  buffer_load_dwordx4 v[204:207], v3, s[40:43], s51 offen sc1
  v_mfma_f32_32x32x16_bf16 v[16:31], a[80:83], a[32:35], v[16:31]
  s_add_u32 s51, s53, 524288
  buffer_load_dwordx4 v[160:163], v2, s[40:43], s51 offen sc1
  v_mfma_f32_32x32x16_bf16 v[32:47], a[224:227], a[32:35], v[32:47]
  s_add_u32 s51, s54, 524288
  buffer_load_dwordx4 v[208:211], v3, s[40:43], s51 offen sc1
  v_mfma_f32_32x32x16_bf16 v[16:31], a[84:87], a[36:39], v[16:31]
  s_add_u32 s51, s53, 589824
  buffer_load_dwordx4 v[164:167], v2, s[40:43], s51 offen sc1
  v_mfma_f32_32x32x16_bf16 v[32:47], a[228:231], a[36:39], v[32:47]
  s_add_u32 s51, s54, 589824
  buffer_load_dwordx4 v[212:215], v3, s[40:43], s51 offen sc1
  v_mfma_f32_32x32x16_bf16 v[16:31], a[88:91], a[40:43], v[16:31]
  s_add_u32 s51, s53, 655360
  buffer_load_dwordx4 v[168:171], v2, s[40:43], s51 offen sc1
  v_mfma_f32_32x32x16_bf16 v[32:47], a[232:235], a[40:43], v[32:47]
  s_add_u32 s51, s54, 655360
  buffer_load_dwordx4 v[216:219], v3, s[40:43], s51 offen sc1
  v_mfma_f32_32x32x16_bf16 v[16:31], a[92:95], a[44:47], v[16:31]
  s_add_u32 s51, s53, 720896
  buffer_load_dwordx4 v[172:175], v2, s[40:43], s51 offen sc1
  v_mfma_f32_32x32x16_bf16 v[32:47], a[236:239], a[44:47], v[32:47]
  s_add_u32 s51, s54, 720896
  buffer_load_dwordx4 v[220:223], v3, s[40:43], s51 offen sc1
  s_add_u32 s53, s53, 786432
  s_add_u32 s54, s54, 786432
  s_nop 7
  s_nop 3
  s_add_u32 s55, s55, 786432
  s_add_u32 s51, s55, 0
  buffer_load_dwordx4 a[192:195], v4, s[40:43], s51 offen sc1
  s_add_u32 s51, s55, 16384
  buffer_load_dwordx4 a[196:199], v4, s[40:43], s51 offen sc1
  s_add_u32 s51, s55, 32768
  buffer_load_dwordx4 a[200:203], v4, s[40:43], s51 offen sc1
  s_add_u32 s51, s55, 49152
  buffer_load_dwordx4 a[204:207], v4, s[40:43], s51 offen sc1
  s_add_u32 s51, s55, 65536
  buffer_load_dwordx4 a[208:211], v4, s[40:43], s51 offen sc1
  s_add_u32 s51, s55, 81920
  buffer_load_dwordx4 a[212:215], v4, s[40:43], s51 offen sc1
  s_add_u32 s51, s55, 98304
  buffer_load_dwordx4 a[216:219], v4, s[40:43], s51 offen sc1
  s_add_u32 s51, s55, 114688
  buffer_load_dwordx4 a[220:223], v4, s[40:43], s51 offen sc1
  s_add_u32 s51, s55, 131072
  buffer_load_dwordx4 a[224:227], v4, s[40:43], s51 offen sc1
  s_add_u32 s51, s55, 147456
  buffer_load_dwordx4 a[228:231], v4, s[40:43], s51 offen sc1
  s_add_u32 s51, s55, 163840
  buffer_load_dwordx4 a[232:235], v4, s[40:43], s51 offen sc1
  s_add_u32 s51, s55, 180224
  buffer_load_dwordx4 a[236:239], v4, s[40:43], s51 offen sc1
  v_cndmask_b32 v16, v14, v16, s[64:65]
  v_cndmask_b32 v17, v14, v17, s[66:67]
  v_cndmask_b32 v18, v14, v18, s[68:69]
  v_cndmask_b32 v19, v14, v19, s[70:71]
  v_cndmask_b32 v20, v14, v20, s[72:73]
  v_cndmask_b32 v21, v14, v21, s[74:75]
  v_cndmask_b32 v22, v14, v22, s[76:77]
  v_cndmask_b32 v23, v14, v23, s[78:79]
  v_cndmask_b32 v24, v14, v24, s[80:81]
  v_cndmask_b32 v25, v14, v25, s[82:83]
  v_cndmask_b32 v26, v14, v26, s[84:85]
  v_cndmask_b32 v27, v14, v27, s[86:87]
  v_cndmask_b32 v28, v14, v28, s[88:89]
  v_cndmask_b32 v29, v14, v29, s[90:91]
  v_cndmask_b32 v30, v14, v30, s[92:93]
  v_cndmask_b32 v31, v14, v31, s[94:95]
  v_max3_f32 v11, v16, v17, v18
  v_max3_f32 v12, v19, v20, v21
  v_max3_f32 v11, v22, v23, v11
  v_max3_f32 v12, v24, v25, v12
  v_max3_f32 v11, v26, v27, v11
  v_max3_f32 v12, v28, v29, v12
  v_max3_f32 v11, v30, v31, v11
  v_max3_f32 v12, v44, v45, v12
  v_max3_f32 v11, v46, v47, v11
  v_max_f32 v11, v11, v12
  v_mov_b32 v12, v11
  s_nop 1
  v_permlane32_swap_b32 v11, v12
  s_nop 0
  v_max_f32 v11, v11, v12
  v_mul_f32 v11, s59, v11
  v_fma_f32 v16, v16, s59, -v11
  v_fma_f32 v17, v17, s59, -v11
  v_fma_f32 v18, v18, s59, -v11
  v_fma_f32 v19, v19, s59, -v11
  v_fma_f32 v20, v20, s59, -v11
  v_fma_f32 v21, v21, s59, -v11
  v_fma_f32 v22, v22, s59, -v11
  v_fma_f32 v23, v23, s59, -v11
  v_fma_f32 v24, v24, s59, -v11
  v_fma_f32 v25, v25, s59, -v11
  v_fma_f32 v26, v26, s59, -v11
  v_fma_f32 v27, v27, s59, -v11
  v_fma_f32 v28, v28, s59, -v11
  v_fma_f32 v29, v29, s59, -v11
  v_fma_f32 v30, v30, s59, -v11
  v_fma_f32 v31, v31, s59, -v11
  v_fma_f32 v44, v44, s59, -v11
  v_fma_f32 v45, v45, s59, -v11
  v_fma_f32 v46, v46, s59, -v11
  v_fma_f32 v47, v47, s59, -v11
  v_exp_f32 v16, v16
  v_exp_f32 v17, v17
  v_exp_f32 v18, v18
  v_exp_f32 v19, v19
  v_exp_f32 v20, v20
  v_exp_f32 v21, v21
  v_exp_f32 v22, v22
  v_exp_f32 v23, v23
  v_exp_f32 v24, v24
  v_exp_f32 v25, v25
  v_exp_f32 v26, v26
  v_exp_f32 v27, v27
  v_exp_f32 v28, v28
  v_exp_f32 v29, v29
  v_exp_f32 v30, v30
  v_exp_f32 v31, v31
  v_exp_f32 v44, v44
  v_exp_f32 v45, v45
  v_exp_f32 v46, v46
  v_exp_f32 v47, v47
  s_nop 0
  v_add_f32 v13, v16, v17
  v_add_f32 v12, v18, v19
  v_add_f32 v13, v13, v20
  v_add_f32 v12, v12, v21
  v_add_f32 v13, v13, v22
  v_add_f32 v12, v12, v23
  v_add_f32 v13, v13, v24
  v_add_f32 v12, v12, v25
  v_add_f32 v13, v13, v26
  v_add_f32 v12, v12, v27
  v_add_f32 v13, v13, v28
  v_add_f32 v12, v12, v29
  v_add_f32 v13, v13, v30
  v_add_f32 v12, v12, v31
  v_add_f32 v13, v13, v44
  v_add_f32 v12, v12, v45
  v_add_f32 v13, v13, v46
  v_add_f32 v12, v12, v47
  v_add_f32 v13, v13, v12
  v_mov_b32 v12, v13
  s_nop 1
  v_permlane32_swap_b32 v13, v12
  s_nop 0
  v_add_f32 v13, v13, v12
  v_rcp_f32 v13, v13
  s_nop 0
  v_mul_f32 v16, v16, v13
  v_mul_f32 v17, v17, v13
  v_mul_f32 v18, v18, v13
  v_mul_f32 v19, v19, v13
  v_mul_f32 v20, v20, v13
  v_mul_f32 v21, v21, v13
  v_mul_f32 v22, v22, v13
  v_mul_f32 v23, v23, v13
  v_mul_f32 v24, v24, v13
  v_mul_f32 v25, v25, v13
  v_mul_f32 v26, v26, v13
  v_mul_f32 v27, v27, v13
  v_mul_f32 v28, v28, v13
  v_mul_f32 v29, v29, v13
  v_mul_f32 v30, v30, v13
  v_mul_f32 v31, v31, v13
  v_mul_f32 v44, v44, v13
  v_mul_f32 v45, v45, v13
  v_mul_f32 v46, v46, v13
  v_mul_f32 v47, v47, v13
  v_cvt_pk_bf16_f32 v76, v16, v17
  v_cvt_pk_bf16_f32 v77, v18, v19
  v_cvt_pk_bf16_f32 v78, v20, v21
  v_cvt_pk_bf16_f32 v79, v22, v23
  v_cvt_pk_bf16_f32 v80, v24, v25
  v_cvt_pk_bf16_f32 v81, v26, v27
  v_cvt_pk_bf16_f32 v82, v28, v29
  v_cvt_pk_bf16_f32 v83, v30, v31
  v_cvt_pk_bf16_f32 v84, v44, v45
  v_cvt_pk_bf16_f32 v85, v46, v47
  buffer_store_dwordx4 v[76:79], v15, s[40:43], s56 offen sc1
  buffer_store_dwordx4 v[80:83], v15, s[40:43], s56 offen offset:1024 sc1
  buffer_store_dwordx2 v[84:85], v7, s[40:43], s56 offen offset:2048 sc1
  s_add_u32 s56, s56, 3072
  s_waitcnt vmcnt(3)
  v_mfma_f32_32x32x16_bf16 v[16:31], a[144:147], a[96:99], 0
  s_add_u32 s51, s53, 0
  buffer_load_dwordx4 a[0:3], v2, s[40:43], s51 offen sc1
  v_mfma_f32_32x32x16_bf16 v[32:47], a[192:195], a[96:99], 0
  s_add_u32 s51, s54, 0
  buffer_load_dwordx4 a[48:51], v3, s[40:43], s51 offen sc1
  v_mfma_f32_32x32x16_bf16 v[16:31], a[148:151], a[100:103], v[16:31]
  s_add_u32 s51, s53, 65536
  buffer_load_dwordx4 a[4:7], v2, s[40:43], s51 offen sc1
  v_mfma_f32_32x32x16_bf16 v[32:47], a[196:199], a[100:103], v[32:47]
  s_add_u32 s51, s54, 65536
  buffer_load_dwordx4 a[52:55], v3, s[40:43], s51 offen sc1
  v_mfma_f32_32x32x16_bf16 v[16:31], a[152:155], a[104:107], v[16:31]
  s_add_u32 s51, s53, 131072
  buffer_load_dwordx4 a[8:11], v2, s[40:43], s51 offen sc1
  v_mfma_f32_32x32x16_bf16 v[32:47], a[200:203], a[104:107], v[32:47]
  s_add_u32 s51, s54, 131072
  buffer_load_dwordx4 a[56:59], v3, s[40:43], s51 offen sc1
  v_mfma_f32_32x32x16_bf16 v[16:31], a[156:159], a[108:111], v[16:31]
  s_add_u32 s51, s53, 196608
  buffer_load_dwordx4 a[12:15], v2, s[40:43], s51 offen sc1
  v_mfma_f32_32x32x16_bf16 v[32:47], a[204:207], a[108:111], v[32:47]
  s_add_u32 s51, s54, 196608
  buffer_load_dwordx4 a[60:63], v3, s[40:43], s51 offen sc1
  v_mfma_f32_32x32x16_bf16 v[16:31], a[160:163], a[112:115], v[16:31]
  s_add_u32 s51, s53, 262144
  buffer_load_dwordx4 a[16:19], v2, s[40:43], s51 offen sc1
  v_mfma_f32_32x32x16_bf16 v[32:47], a[208:211], a[112:115], v[32:47]
  s_add_u32 s51, s54, 262144
  buffer_load_dwordx4 a[64:67], v3, s[40:43], s51 offen sc1
  v_mfma_f32_32x32x16_bf16 v[16:31], a[164:167], a[116:119], v[16:31]
  s_add_u32 s51, s53, 327680
  buffer_load_dwordx4 a[20:23], v2, s[40:43], s51 offen sc1
  v_mfma_f32_32x32x16_bf16 v[32:47], a[212:215], a[116:119], v[32:47]
  s_add_u32 s51, s54, 327680
  buffer_load_dwordx4 a[68:71], v3, s[40:43], s51 offen sc1
  v_mfma_f32_32x32x16_bf16 v[16:31], a[168:171], a[120:123], v[16:31]
  s_add_u32 s51, s53, 393216
  buffer_load_dwordx4 a[24:27], v2, s[40:43], s51 offen sc1
  v_mfma_f32_32x32x16_bf16 v[32:47], a[216:219], a[120:123], v[32:47]
  s_add_u32 s51, s54, 393216
  buffer_load_dwordx4 a[72:75], v3, s[40:43], s51 offen sc1
  v_mfma_f32_32x32x16_bf16 v[16:31], a[172:175], a[124:127], v[16:31]
  s_add_u32 s51, s53, 458752
  buffer_load_dwordx4 a[28:31], v2, s[40:43], s51 offen sc1
  v_mfma_f32_32x32x16_bf16 v[32:47], a[220:223], a[124:127], v[32:47]
  s_add_u32 s51, s54, 458752
  buffer_load_dwordx4 a[76:79], v3, s[40:43], s51 offen sc1
  v_mfma_f32_32x32x16_bf16 v[16:31], a[176:179], a[128:131], v[16:31]
  s_add_u32 s51, s53, 524288
  buffer_load_dwordx4 a[32:35], v2, s[40:43], s51 offen sc1
  v_mfma_f32_32x32x16_bf16 v[32:47], a[224:227], a[128:131], v[32:47]
  s_add_u32 s51, s54, 524288
  buffer_load_dwordx4 a[80:83], v3, s[40:43], s51 offen sc1
  v_mfma_f32_32x32x16_bf16 v[16:31], a[180:183], a[132:135], v[16:31]
  s_add_u32 s51, s53, 589824
  buffer_load_dwordx4 a[36:39], v2, s[40:43], s51 offen sc1
  v_mfma_f32_32x32x16_bf16 v[32:47], a[228:231], a[132:135], v[32:47]
  s_add_u32 s51, s54, 589824
  buffer_load_dwordx4 a[84:87], v3, s[40:43], s51 offen sc1
  v_mfma_f32_32x32x16_bf16 v[16:31], a[184:187], a[136:139], v[16:31]
  s_add_u32 s51, s53, 655360
  buffer_load_dwordx4 a[40:43], v2, s[40:43], s51 offen sc1
  v_mfma_f32_32x32x16_bf16 v[32:47], a[232:235], a[136:139], v[32:47]
  s_add_u32 s51, s54, 655360
  buffer_load_dwordx4 a[88:91], v3, s[40:43], s51 offen sc1
  v_mfma_f32_32x32x16_bf16 v[16:31], a[188:191], a[140:143], v[16:31]
  s_add_u32 s51, s53, 720896
  buffer_load_dwordx4 a[44:47], v2, s[40:43], s51 offen sc1
  v_mfma_f32_32x32x16_bf16 v[32:47], a[236:239], a[140:143], v[32:47]
  s_add_u32 s51, s54, 720896
  buffer_load_dwordx4 a[92:95], v3, s[40:43], s51 offen sc1
  s_add_u32 s53, s53, 786432
  s_add_u32 s54, s54, 786432
  s_nop 7
  s_nop 3
  v_cndmask_b32 v16, v14, v16, s[64:65]
  v_cndmask_b32 v17, v14, v17, s[66:67]
  v_cndmask_b32 v18, v14, v18, s[68:69]
  v_cndmask_b32 v19, v14, v19, s[70:71]
  v_cndmask_b32 v20, v14, v20, s[72:73]
  v_cndmask_b32 v21, v14, v21, s[74:75]
  v_cndmask_b32 v22, v14, v22, s[76:77]
  v_cndmask_b32 v23, v14, v23, s[78:79]
  v_cndmask_b32 v24, v14, v24, s[80:81]
  v_cndmask_b32 v25, v14, v25, s[82:83]
  v_cndmask_b32 v26, v14, v26, s[84:85]
  v_cndmask_b32 v27, v14, v27, s[86:87]
  v_cndmask_b32 v28, v14, v28, s[88:89]
  v_cndmask_b32 v29, v14, v29, s[90:91]
  v_cndmask_b32 v30, v14, v30, s[92:93]
  v_cndmask_b32 v31, v14, v31, s[94:95]
  v_max3_f32 v11, v16, v17, v18
  v_max3_f32 v12, v19, v20, v21
  v_max3_f32 v11, v22, v23, v11
  v_max3_f32 v12, v24, v25, v12
  v_max3_f32 v11, v26, v27, v11
  v_max3_f32 v12, v28, v29, v12
  v_max3_f32 v11, v30, v31, v11
  v_max3_f32 v12, v32, v33, v12
  v_max3_f32 v11, v34, v35, v11
  v_max_f32 v11, v11, v12
  v_mov_b32 v12, v11
  s_nop 1
  v_permlane32_swap_b32 v11, v12
  s_nop 0
  v_max_f32 v11, v11, v12
  v_mul_f32 v11, s59, v11
  v_fma_f32 v16, v16, s59, -v11
  v_fma_f32 v17, v17, s59, -v11
  v_fma_f32 v18, v18, s59, -v11
  v_fma_f32 v19, v19, s59, -v11
  v_fma_f32 v20, v20, s59, -v11
  v_fma_f32 v21, v21, s59, -v11
  v_fma_f32 v22, v22, s59, -v11
  v_fma_f32 v23, v23, s59, -v11
  v_fma_f32 v24, v24, s59, -v11
  v_fma_f32 v25, v25, s59, -v11
  v_fma_f32 v26, v26, s59, -v11
  v_fma_f32 v27, v27, s59, -v11
  v_fma_f32 v28, v28, s59, -v11
  v_fma_f32 v29, v29, s59, -v11
  v_fma_f32 v30, v30, s59, -v11
  v_fma_f32 v31, v31, s59, -v11
  v_fma_f32 v32, v32, s59, -v11
  v_fma_f32 v33, v33, s59, -v11
  v_fma_f32 v34, v34, s59, -v11
  v_fma_f32 v35, v35, s59, -v11
  v_exp_f32 v16, v16
  v_exp_f32 v17, v17
  v_exp_f32 v18, v18
  v_exp_f32 v19, v19
  v_exp_f32 v20, v20
  v_exp_f32 v21, v21
  v_exp_f32 v22, v22
  v_exp_f32 v23, v23
  v_exp_f32 v24, v24
  v_exp_f32 v25, v25
  v_exp_f32 v26, v26
  v_exp_f32 v27, v27
  v_exp_f32 v28, v28
  v_exp_f32 v29, v29
  v_exp_f32 v30, v30
  v_exp_f32 v31, v31
  v_exp_f32 v32, v32
  v_exp_f32 v33, v33
  v_exp_f32 v34, v34
  v_exp_f32 v35, v35
  s_nop 0
  v_add_f32 v13, v16, v17
  v_add_f32 v12, v18, v19
  v_add_f32 v13, v13, v20
  v_add_f32 v12, v12, v21
  v_add_f32 v13, v13, v22
  v_add_f32 v12, v12, v23
  v_add_f32 v13, v13, v24
  v_add_f32 v12, v12, v25
  v_add_f32 v13, v13, v26
  v_add_f32 v12, v12, v27
  v_add_f32 v13, v13, v28
  v_add_f32 v12, v12, v29
  v_add_f32 v13, v13, v30
  v_add_f32 v12, v12, v31
  v_add_f32 v13, v13, v32
  v_add_f32 v12, v12, v33
  v_add_f32 v13, v13, v34
  v_add_f32 v12, v12, v35
  v_add_f32 v13, v13, v12
  v_mov_b32 v12, v13
  s_nop 1
  v_permlane32_swap_b32 v13, v12
  s_nop 0
  v_add_f32 v13, v13, v12
  v_rcp_f32 v13, v13
  s_nop 0
  v_mul_f32 v16, v16, v13
  v_mul_f32 v17, v17, v13
  v_mul_f32 v18, v18, v13
  v_mul_f32 v19, v19, v13
  v_mul_f32 v20, v20, v13
  v_mul_f32 v21, v21, v13
  v_mul_f32 v22, v22, v13
  v_mul_f32 v23, v23, v13
  v_mul_f32 v24, v24, v13
  v_mul_f32 v25, v25, v13
  v_mul_f32 v26, v26, v13
  v_mul_f32 v27, v27, v13
  v_mul_f32 v28, v28, v13
  v_mul_f32 v29, v29, v13
  v_mul_f32 v30, v30, v13
  v_mul_f32 v31, v31, v13
  v_mul_f32 v32, v32, v13
  v_mul_f32 v33, v33, v13
  v_mul_f32 v34, v34, v13
  v_mul_f32 v35, v35, v13
  v_cvt_pk_bf16_f32 v64, v16, v17
  v_cvt_pk_bf16_f32 v65, v18, v19
  v_cvt_pk_bf16_f32 v66, v20, v21
  v_cvt_pk_bf16_f32 v67, v22, v23
  v_cvt_pk_bf16_f32 v68, v24, v25
  v_cvt_pk_bf16_f32 v69, v26, v27
  v_cvt_pk_bf16_f32 v70, v28, v29
  v_cvt_pk_bf16_f32 v71, v30, v31
  v_cvt_pk_bf16_f32 v72, v32, v33
  v_cvt_pk_bf16_f32 v73, v34, v35
  buffer_store_dwordx4 v[64:67], v15, s[40:43], s56 offen sc1
  buffer_store_dwordx4 v[68:71], v15, s[40:43], s56 offen offset:1024 sc1
  buffer_store_dwordx2 v[72:73], v7, s[40:43], s56 offen offset:2048 sc1
  s_add_u32 s56, s56, 3072
  s_waitcnt vmcnt(42)
  v_mfma_f32_32x32x16_bf16 v[16:31], v[176:179], v[128:131], 0
  s_add_u32 s51, s53, 0
  buffer_load_dwordx4 a[96:99], v2, s[40:43], s51 offen sc1
  v_mfma_f32_32x32x16_bf16 v[32:47], a[192:195], v[128:131], 0
  s_add_u32 s51, s54, 0
  buffer_load_dwordx4 a[144:147], v3, s[40:43], s51 offen sc1
  v_mfma_f32_32x32x16_bf16 v[16:31], v[180:183], v[132:135], v[16:31]
  s_add_u32 s51, s53, 65536
  buffer_load_dwordx4 a[100:103], v2, s[40:43], s51 offen sc1
  v_mfma_f32_32x32x16_bf16 v[32:47], a[196:199], v[132:135], v[32:47]
  s_add_u32 s51, s54, 65536
  buffer_load_dwordx4 a[148:151], v3, s[40:43], s51 offen sc1
  v_mfma_f32_32x32x16_bf16 v[16:31], v[184:187], v[136:139], v[16:31]
  s_add_u32 s51, s53, 131072
  buffer_load_dwordx4 a[104:107], v2, s[40:43], s51 offen sc1
  v_mfma_f32_32x32x16_bf16 v[32:47], a[200:203], v[136:139], v[32:47]
  s_add_u32 s51, s54, 131072
  buffer_load_dwordx4 a[152:155], v3, s[40:43], s51 offen sc1
  v_mfma_f32_32x32x16_bf16 v[16:31], v[188:191], v[140:143], v[16:31]
  s_add_u32 s51, s53, 196608
  buffer_load_dwordx4 a[108:111], v2, s[40:43], s51 offen sc1
  v_mfma_f32_32x32x16_bf16 v[32:47], a[204:207], v[140:143], v[32:47]
  s_add_u32 s51, s54, 196608
  buffer_load_dwordx4 a[156:159], v3, s[40:43], s51 offen sc1
  v_mfma_f32_32x32x16_bf16 v[16:31], v[192:195], v[144:147], v[16:31]
  s_add_u32 s51, s53, 262144
  buffer_load_dwordx4 a[112:115], v2, s[40:43], s51 offen sc1
  v_mfma_f32_32x32x16_bf16 v[32:47], a[208:211], v[144:147], v[32:47]
  s_add_u32 s51, s54, 262144
  buffer_load_dwordx4 a[160:163], v3, s[40:43], s51 offen sc1
  v_mfma_f32_32x32x16_bf16 v[16:31], v[196:199], v[148:151], v[16:31]
  s_add_u32 s51, s53, 327680
  buffer_load_dwordx4 a[116:119], v2, s[40:43], s51 offen sc1
  v_mfma_f32_32x32x16_bf16 v[32:47], a[212:215], v[148:151], v[32:47]
  s_add_u32 s51, s54, 327680
  buffer_load_dwordx4 a[164:167], v3, s[40:43], s51 offen sc1
  v_mfma_f32_32x32x16_bf16 v[16:31], v[200:203], v[152:155], v[16:31]
  s_add_u32 s51, s53, 393216
  buffer_load_dwordx4 a[120:123], v2, s[40:43], s51 offen sc1
  v_mfma_f32_32x32x16_bf16 v[32:47], a[216:219], v[152:155], v[32:47]
  s_add_u32 s51, s54, 393216
  buffer_load_dwordx4 a[168:171], v3, s[40:43], s51 offen sc1
  v_mfma_f32_32x32x16_bf16 v[16:31], v[204:207], v[156:159], v[16:31]
  s_add_u32 s51, s53, 458752
  buffer_load_dwordx4 a[124:127], v2, s[40:43], s51 offen sc1
  v_mfma_f32_32x32x16_bf16 v[32:47], a[220:223], v[156:159], v[32:47]
  s_add_u32 s51, s54, 458752
  buffer_load_dwordx4 a[172:175], v3, s[40:43], s51 offen sc1
  v_mfma_f32_32x32x16_bf16 v[16:31], v[208:211], v[160:163], v[16:31]
  s_add_u32 s51, s53, 524288
  buffer_load_dwordx4 a[128:131], v2, s[40:43], s51 offen sc1
  v_mfma_f32_32x32x16_bf16 v[32:47], a[224:227], v[160:163], v[32:47]
  s_add_u32 s51, s54, 524288
  buffer_load_dwordx4 a[176:179], v3, s[40:43], s51 offen sc1
  v_mfma_f32_32x32x16_bf16 v[16:31], v[212:215], v[164:167], v[16:31]
  s_add_u32 s51, s53, 589824
  buffer_load_dwordx4 a[132:135], v2, s[40:43], s51 offen sc1
  v_mfma_f32_32x32x16_bf16 v[32:47], a[228:231], v[164:167], v[32:47]
  s_add_u32 s51, s54, 589824
  buffer_load_dwordx4 a[180:183], v3, s[40:43], s51 offen sc1
  v_mfma_f32_32x32x16_bf16 v[16:31], v[216:219], v[168:171], v[16:31]
  s_add_u32 s51, s53, 655360
  buffer_load_dwordx4 a[136:139], v2, s[40:43], s51 offen sc1
  v_mfma_f32_32x32x16_bf16 v[32:47], a[232:235], v[168:171], v[32:47]
  s_add_u32 s51, s54, 655360
  buffer_load_dwordx4 a[184:187], v3, s[40:43], s51 offen sc1
  v_mfma_f32_32x32x16_bf16 v[16:31], v[220:223], v[172:175], v[16:31]
  s_add_u32 s51, s53, 720896
  buffer_load_dwordx4 a[140:143], v2, s[40:43], s51 offen sc1
  v_mfma_f32_32x32x16_bf16 v[32:47], a[236:239], v[172:175], v[32:47]
  s_add_u32 s51, s54, 720896
  buffer_load_dwordx4 a[188:191], v3, s[40:43], s51 offen sc1
  s_add_u32 s53, s53, 786432
  s_add_u32 s54, s54, 786432
  s_nop 7
  s_nop 3
  v_cndmask_b32 v16, v14, v16, s[64:65]
  v_cndmask_b32 v17, v14, v17, s[66:67]
  v_cndmask_b32 v18, v14, v18, s[68:69]
  v_cndmask_b32 v19, v14, v19, s[70:71]
  v_cndmask_b32 v20, v14, v20, s[72:73]
  v_cndmask_b32 v21, v14, v21, s[74:75]
  v_cndmask_b32 v22, v14, v22, s[76:77]
  v_cndmask_b32 v23, v14, v23, s[78:79]
  v_cndmask_b32 v24, v14, v24, s[80:81]
  v_cndmask_b32 v25, v14, v25, s[82:83]
  v_cndmask_b32 v26, v14, v26, s[84:85]
  v_cndmask_b32 v27, v14, v27, s[86:87]
  v_cndmask_b32 v28, v14, v28, s[88:89]
  v_cndmask_b32 v29, v14, v29, s[90:91]
  v_cndmask_b32 v30, v14, v30, s[92:93]
  v_cndmask_b32 v31, v14, v31, s[94:95]
  v_max3_f32 v11, v16, v17, v18
  v_max3_f32 v12, v19, v20, v21
  v_max3_f32 v11, v22, v23, v11
  v_max3_f32 v12, v24, v25, v12
  v_max3_f32 v11, v26, v27, v11
  v_max3_f32 v12, v28, v29, v12
  v_max3_f32 v11, v30, v31, v11
  v_max3_f32 v12, v36, v37, v12
  v_max3_f32 v11, v38, v39, v11
  v_max_f32 v11, v11, v12
  v_mov_b32 v12, v11
  s_nop 1
  v_permlane32_swap_b32 v11, v12
  s_nop 0
  v_max_f32 v11, v11, v12
  v_mul_f32 v11, s59, v11
  v_fma_f32 v16, v16, s59, -v11
  v_fma_f32 v17, v17, s59, -v11
  v_fma_f32 v18, v18, s59, -v11
  v_fma_f32 v19, v19, s59, -v11
  v_fma_f32 v20, v20, s59, -v11
  v_fma_f32 v21, v21, s59, -v11
  v_fma_f32 v22, v22, s59, -v11
  v_fma_f32 v23, v23, s59, -v11
  v_fma_f32 v24, v24, s59, -v11
  v_fma_f32 v25, v25, s59, -v11
  v_fma_f32 v26, v26, s59, -v11
  v_fma_f32 v27, v27, s59, -v11
  v_fma_f32 v28, v28, s59, -v11
  v_fma_f32 v29, v29, s59, -v11
  v_fma_f32 v30, v30, s59, -v11
  v_fma_f32 v31, v31, s59, -v11
  v_fma_f32 v36, v36, s59, -v11
  v_fma_f32 v37, v37, s59, -v11
  v_fma_f32 v38, v38, s59, -v11
  v_fma_f32 v39, v39, s59, -v11
  v_exp_f32 v16, v16
  v_exp_f32 v17, v17
  v_exp_f32 v18, v18
  v_exp_f32 v19, v19
  v_exp_f32 v20, v20
  v_exp_f32 v21, v21
  v_exp_f32 v22, v22
  v_exp_f32 v23, v23
  v_exp_f32 v24, v24
  v_exp_f32 v25, v25
  v_exp_f32 v26, v26
  v_exp_f32 v27, v27
  v_exp_f32 v28, v28
  v_exp_f32 v29, v29
  v_exp_f32 v30, v30
  v_exp_f32 v31, v31
  v_exp_f32 v36, v36
  v_exp_f32 v37, v37
  v_exp_f32 v38, v38
  v_exp_f32 v39, v39
  s_nop 0
  v_add_f32 v13, v16, v17
  v_add_f32 v12, v18, v19
  v_add_f32 v13, v13, v20
  v_add_f32 v12, v12, v21
  v_add_f32 v13, v13, v22
  v_add_f32 v12, v12, v23
  v_add_f32 v13, v13, v24
  v_add_f32 v12, v12, v25
  v_add_f32 v13, v13, v26
  v_add_f32 v12, v12, v27
  v_add_f32 v13, v13, v28
  v_add_f32 v12, v12, v29
  v_add_f32 v13, v13, v30
  v_add_f32 v12, v12, v31
  v_add_f32 v13, v13, v36
  v_add_f32 v12, v12, v37
  v_add_f32 v13, v13, v38
  v_add_f32 v12, v12, v39
  v_add_f32 v13, v13, v12
  v_mov_b32 v12, v13
  s_nop 1
  v_permlane32_swap_b32 v13, v12
  s_nop 0
  v_add_f32 v13, v13, v12
  v_rcp_f32 v13, v13
  s_nop 0
  v_mul_f32 v16, v16, v13
  v_mul_f32 v17, v17, v13
  v_mul_f32 v18, v18, v13
  v_mul_f32 v19, v19, v13
  v_mul_f32 v20, v20, v13
  v_mul_f32 v21, v21, v13
  v_mul_f32 v22, v22, v13
  v_mul_f32 v23, v23, v13
  v_mul_f32 v24, v24, v13
  v_mul_f32 v25, v25, v13
  v_mul_f32 v26, v26, v13
  v_mul_f32 v27, v27, v13
  v_mul_f32 v28, v28, v13
  v_mul_f32 v29, v29, v13
  v_mul_f32 v30, v30, v13
  v_mul_f32 v31, v31, v13
  v_mul_f32 v36, v36, v13
  v_mul_f32 v37, v37, v13
  v_mul_f32 v38, v38, v13
  v_mul_f32 v39, v39, v13
  v_cvt_pk_bf16_f32 v76, v16, v17
  v_cvt_pk_bf16_f32 v77, v18, v19
  v_cvt_pk_bf16_f32 v78, v20, v21
  v_cvt_pk_bf16_f32 v79, v22, v23
  v_cvt_pk_bf16_f32 v80, v24, v25
  v_cvt_pk_bf16_f32 v81, v26, v27
  v_cvt_pk_bf16_f32 v82, v28, v29
  v_cvt_pk_bf16_f32 v83, v30, v31
  v_cvt_pk_bf16_f32 v84, v36, v37
  v_cvt_pk_bf16_f32 v85, v38, v39
  buffer_store_dwordx4 v[76:79], v15, s[40:43], s56 offen sc1
  buffer_store_dwordx4 v[80:83], v15, s[40:43], s56 offen offset:1024 sc1
  buffer_store_dwordx2 v[84:85], v7, s[40:43], s56 offen offset:2048 sc1
  s_add_u32 s56, s56, 3072
  s_waitcnt vmcnt(30)
  v_mfma_f32_32x32x16_bf16 v[16:31], a[48:51], a[0:3], 0
  v_mfma_f32_32x32x16_bf16 v[32:47], a[192:195], a[0:3], 0
  v_mfma_f32_32x32x16_bf16 v[16:31], a[52:55], a[4:7], v[16:31]
  v_mfma_f32_32x32x16_bf16 v[32:47], a[196:199], a[4:7], v[32:47]
  v_mfma_f32_32x32x16_bf16 v[16:31], a[56:59], a[8:11], v[16:31]
  v_mfma_f32_32x32x16_bf16 v[32:47], a[200:203], a[8:11], v[32:47]
  v_mfma_f32_32x32x16_bf16 v[16:31], a[60:63], a[12:15], v[16:31]
  v_mfma_f32_32x32x16_bf16 v[32:47], a[204:207], a[12:15], v[32:47]
  v_mfma_f32_32x32x16_bf16 v[16:31], a[64:67], a[16:19], v[16:31]
  v_mfma_f32_32x32x16_bf16 v[32:47], a[208:211], a[16:19], v[32:47]
  v_mfma_f32_32x32x16_bf16 v[16:31], a[68:71], a[20:23], v[16:31]
  v_mfma_f32_32x32x16_bf16 v[32:47], a[212:215], a[20:23], v[32:47]
  v_mfma_f32_32x32x16_bf16 v[16:31], a[72:75], a[24:27], v[16:31]
  v_mfma_f32_32x32x16_bf16 v[32:47], a[216:219], a[24:27], v[32:47]
  v_mfma_f32_32x32x16_bf16 v[16:31], a[76:79], a[28:31], v[16:31]
  v_mfma_f32_32x32x16_bf16 v[32:47], a[220:223], a[28:31], v[32:47]
  v_mfma_f32_32x32x16_bf16 v[16:31], a[80:83], a[32:35], v[16:31]
  v_mfma_f32_32x32x16_bf16 v[32:47], a[224:227], a[32:35], v[32:47]
  v_mfma_f32_32x32x16_bf16 v[16:31], a[84:87], a[36:39], v[16:31]
  v_mfma_f32_32x32x16_bf16 v[32:47], a[228:231], a[36:39], v[32:47]
  v_mfma_f32_32x32x16_bf16 v[16:31], a[88:91], a[40:43], v[16:31]
  v_mfma_f32_32x32x16_bf16 v[32:47], a[232:235], a[40:43], v[32:47]
  v_mfma_f32_32x32x16_bf16 v[16:31], a[92:95], a[44:47], v[16:31]
  v_mfma_f32_32x32x16_bf16 v[32:47], a[236:239], a[44:47], v[32:47]
  s_nop 7
  s_nop 3
  v_cndmask_b32 v16, v14, v16, s[64:65]
  v_cndmask_b32 v17, v14, v17, s[66:67]
  v_cndmask_b32 v18, v14, v18, s[68:69]
  v_cndmask_b32 v19, v14, v19, s[70:71]
  v_cndmask_b32 v20, v14, v20, s[72:73]
  v_cndmask_b32 v21, v14, v21, s[74:75]
  v_cndmask_b32 v22, v14, v22, s[76:77]
  v_cndmask_b32 v23, v14, v23, s[78:79]
  v_cndmask_b32 v24, v14, v24, s[80:81]
  v_cndmask_b32 v25, v14, v25, s[82:83]
  v_cndmask_b32 v26, v14, v26, s[84:85]
  v_cndmask_b32 v27, v14, v27, s[86:87]
  v_cndmask_b32 v28, v14, v28, s[88:89]
  v_cndmask_b32 v29, v14, v29, s[90:91]
  v_cndmask_b32 v30, v14, v30, s[92:93]
  v_cndmask_b32 v31, v14, v31, s[94:95]
  v_max3_f32 v11, v16, v17, v18
  v_max3_f32 v12, v19, v20, v21
  v_max3_f32 v11, v22, v23, v11
  v_max3_f32 v12, v24, v25, v12
  v_max3_f32 v11, v26, v27, v11
  v_max3_f32 v12, v28, v29, v12
  v_max3_f32 v11, v30, v31, v11
  v_max3_f32 v12, v40, v41, v12
  v_max3_f32 v11, v42, v43, v11
  v_max_f32 v11, v11, v12
  v_mov_b32 v12, v11
  s_nop 1
  v_permlane32_swap_b32 v11, v12
  s_nop 0
  v_max_f32 v11, v11, v12
  v_mul_f32 v11, s59, v11
  v_fma_f32 v16, v16, s59, -v11
  v_fma_f32 v17, v17, s59, -v11
  v_fma_f32 v18, v18, s59, -v11
  v_fma_f32 v19, v19, s59, -v11
  v_fma_f32 v20, v20, s59, -v11
  v_fma_f32 v21, v21, s59, -v11
  v_fma_f32 v22, v22, s59, -v11
  v_fma_f32 v23, v23, s59, -v11
  v_fma_f32 v24, v24, s59, -v11
  v_fma_f32 v25, v25, s59, -v11
  v_fma_f32 v26, v26, s59, -v11
  v_fma_f32 v27, v27, s59, -v11
  v_fma_f32 v28, v28, s59, -v11
  v_fma_f32 v29, v29, s59, -v11
  v_fma_f32 v30, v30, s59, -v11
  v_fma_f32 v31, v31, s59, -v11
  v_fma_f32 v40, v40, s59, -v11
  v_fma_f32 v41, v41, s59, -v11
  v_fma_f32 v42, v42, s59, -v11
  v_fma_f32 v43, v43, s59, -v11
  v_exp_f32 v16, v16
  v_exp_f32 v17, v17
  v_exp_f32 v18, v18
  v_exp_f32 v19, v19
  v_exp_f32 v20, v20
  v_exp_f32 v21, v21
  v_exp_f32 v22, v22
  v_exp_f32 v23, v23
  v_exp_f32 v24, v24
  v_exp_f32 v25, v25
  v_exp_f32 v26, v26
  v_exp_f32 v27, v27
  v_exp_f32 v28, v28
  v_exp_f32 v29, v29
  v_exp_f32 v30, v30
  v_exp_f32 v31, v31
  v_exp_f32 v40, v40
  v_exp_f32 v41, v41
  v_exp_f32 v42, v42
  v_exp_f32 v43, v43
  s_nop 0
  v_add_f32 v13, v16, v17
  v_add_f32 v12, v18, v19
  v_add_f32 v13, v13, v20
  v_add_f32 v12, v12, v21
  v_add_f32 v13, v13, v22
  v_add_f32 v12, v12, v23
  v_add_f32 v13, v13, v24
  v_add_f32 v12, v12, v25
  v_add_f32 v13, v13, v26
  v_add_f32 v12, v12, v27
  v_add_f32 v13, v13, v28
  v_add_f32 v12, v12, v29
  v_add_f32 v13, v13, v30
  v_add_f32 v12, v12, v31
  v_add_f32 v13, v13, v40
  v_add_f32 v12, v12, v41
  v_add_f32 v13, v13, v42
  v_add_f32 v12, v12, v43
  v_add_f32 v13, v13, v12
  v_mov_b32 v12, v13
  s_nop 1
  v_permlane32_swap_b32 v13, v12
  s_nop 0
  v_add_f32 v13, v13, v12
  v_rcp_f32 v13, v13
  s_nop 0
  v_mul_f32 v16, v16, v13
  v_mul_f32 v17, v17, v13
  v_mul_f32 v18, v18, v13
  v_mul_f32 v19, v19, v13
  v_mul_f32 v20, v20, v13
  v_mul_f32 v21, v21, v13
  v_mul_f32 v22, v22, v13
  v_mul_f32 v23, v23, v13
  v_mul_f32 v24, v24, v13
  v_mul_f32 v25, v25, v13
  v_mul_f32 v26, v26, v13
  v_mul_f32 v27, v27, v13
  v_mul_f32 v28, v28, v13
  v_mul_f32 v29, v29, v13
  v_mul_f32 v30, v30, v13
  v_mul_f32 v31, v31, v13
  v_mul_f32 v40, v40, v13
  v_mul_f32 v41, v41, v13
  v_mul_f32 v42, v42, v13
  v_mul_f32 v43, v43, v13
  v_cvt_pk_bf16_f32 v64, v16, v17
  v_cvt_pk_bf16_f32 v65, v18, v19
  v_cvt_pk_bf16_f32 v66, v20, v21
  v_cvt_pk_bf16_f32 v67, v22, v23
  v_cvt_pk_bf16_f32 v68, v24, v25
  v_cvt_pk_bf16_f32 v69, v26, v27
  v_cvt_pk_bf16_f32 v70, v28, v29
  v_cvt_pk_bf16_f32 v71, v30, v31
  v_cvt_pk_bf16_f32 v72, v40, v41
  v_cvt_pk_bf16_f32 v73, v42, v43
  buffer_store_dwordx4 v[64:67], v15, s[40:43], s56 offen sc1
  buffer_store_dwordx4 v[68:71], v15, s[40:43], s56 offen offset:1024 sc1
  buffer_store_dwordx2 v[72:73], v7, s[40:43], s56 offen offset:2048 sc1
  s_add_u32 s56, s56, 3072
  s_waitcnt vmcnt(6)
  v_mfma_f32_32x32x16_bf16 v[16:31], a[144:147], a[96:99], 0
  v_mfma_f32_32x32x16_bf16 v[32:47], a[192:195], a[96:99], 0
  v_mfma_f32_32x32x16_bf16 v[16:31], a[148:151], a[100:103], v[16:31]
  v_mfma_f32_32x32x16_bf16 v[32:47], a[196:199], a[100:103], v[32:47]
  v_mfma_f32_32x32x16_bf16 v[16:31], a[152:155], a[104:107], v[16:31]
  v_mfma_f32_32x32x16_bf16 v[32:47], a[200:203], a[104:107], v[32:47]
  v_mfma_f32_32x32x16_bf16 v[16:31], a[156:159], a[108:111], v[16:31]
  v_mfma_f32_32x32x16_bf16 v[32:47], a[204:207], a[108:111], v[32:47]
  v_mfma_f32_32x32x16_bf16 v[16:31], a[160:163], a[112:115], v[16:31]
  v_mfma_f32_32x32x16_bf16 v[32:47], a[208:211], a[112:115], v[32:47]
  v_mfma_f32_32x32x16_bf16 v[16:31], a[164:167], a[116:119], v[16:31]
  v_mfma_f32_32x32x16_bf16 v[32:47], a[212:215], a[116:119], v[32:47]
  v_mfma_f32_32x32x16_bf16 v[16:31], a[168:171], a[120:123], v[16:31]
  v_mfma_f32_32x32x16_bf16 v[32:47], a[216:219], a[120:123], v[32:47]
  v_mfma_f32_32x32x16_bf16 v[16:31], a[172:175], a[124:127], v[16:31]
  v_mfma_f32_32x32x16_bf16 v[32:47], a[220:223], a[124:127], v[32:47]
  v_mfma_f32_32x32x16_bf16 v[16:31], a[176:179], a[128:131], v[16:31]
  v_mfma_f32_32x32x16_bf16 v[32:47], a[224:227], a[128:131], v[32:47]
  v_mfma_f32_32x32x16_bf16 v[16:31], a[180:183], a[132:135], v[16:31]
  v_mfma_f32_32x32x16_bf16 v[32:47], a[228:231], a[132:135], v[32:47]
  v_mfma_f32_32x32x16_bf16 v[16:31], a[184:187], a[136:139], v[16:31]
  v_mfma_f32_32x32x16_bf16 v[32:47], a[232:235], a[136:139], v[32:47]
  v_mfma_f32_32x32x16_bf16 v[16:31], a[188:191], a[140:143], v[16:31]
  v_mfma_f32_32x32x16_bf16 v[32:47], a[236:239], a[140:143], v[32:47]
  s_nop 7
  s_nop 3
  v_cndmask_b32 v16, v14, v16, s[64:65]
  v_cndmask_b32 v17, v14, v17, s[66:67]
  v_cndmask_b32 v18, v14, v18, s[68:69]
  v_cndmask_b32 v19, v14, v19, s[70:71]
  v_cndmask_b32 v20, v14, v20, s[72:73]
  v_cndmask_b32 v21, v14, v21, s[74:75]
  v_cndmask_b32 v22, v14, v22, s[76:77]
  v_cndmask_b32 v23, v14, v23, s[78:79]
  v_cndmask_b32 v24, v14, v24, s[80:81]
  v_cndmask_b32 v25, v14, v25, s[82:83]
  v_cndmask_b32 v26, v14, v26, s[84:85]
  v_cndmask_b32 v27, v14, v27, s[86:87]
  v_cndmask_b32 v28, v14, v28, s[88:89]
  v_cndmask_b32 v29, v14, v29, s[90:91]
  v_cndmask_b32 v30, v14, v30, s[92:93]
  v_cndmask_b32 v31, v14, v31, s[94:95]
  v_max3_f32 v11, v16, v17, v18
  v_max3_f32 v12, v19, v20, v21
  v_max3_f32 v11, v22, v23, v11
  v_max3_f32 v12, v24, v25, v12
  v_max3_f32 v11, v26, v27, v11
  v_max3_f32 v12, v28, v29, v12
  v_max3_f32 v11, v30, v31, v11
  v_max3_f32 v12, v44, v45, v12
  v_max3_f32 v11, v46, v47, v11
  v_max_f32 v11, v11, v12
  v_mov_b32 v12, v11
  s_nop 1
  v_permlane32_swap_b32 v11, v12
  s_nop 0
  v_max_f32 v11, v11, v12
  v_mul_f32 v11, s59, v11
  v_fma_f32 v16, v16, s59, -v11
  v_fma_f32 v17, v17, s59, -v11
  v_fma_f32 v18, v18, s59, -v11
  v_fma_f32 v19, v19, s59, -v11
  v_fma_f32 v20, v20, s59, -v11
  v_fma_f32 v21, v21, s59, -v11
  v_fma_f32 v22, v22, s59, -v11
  v_fma_f32 v23, v23, s59, -v11
  v_fma_f32 v24, v24, s59, -v11
  v_fma_f32 v25, v25, s59, -v11
  v_fma_f32 v26, v26, s59, -v11
  v_fma_f32 v27, v27, s59, -v11
  v_fma_f32 v28, v28, s59, -v11
  v_fma_f32 v29, v29, s59, -v11
  v_fma_f32 v30, v30, s59, -v11
  v_fma_f32 v31, v31, s59, -v11
  v_fma_f32 v44, v44, s59, -v11
  v_fma_f32 v45, v45, s59, -v11
  v_fma_f32 v46, v46, s59, -v11
  v_fma_f32 v47, v47, s59, -v11
  v_exp_f32 v16, v16
  v_exp_f32 v17, v17
  v_exp_f32 v18, v18
  v_exp_f32 v19, v19
  v_exp_f32 v20, v20
  v_exp_f32 v21, v21
  v_exp_f32 v22, v22
  v_exp_f32 v23, v23
  v_exp_f32 v24, v24
  v_exp_f32 v25, v25
  v_exp_f32 v26, v26
  v_exp_f32 v27, v27
  v_exp_f32 v28, v28
  v_exp_f32 v29, v29
  v_exp_f32 v30, v30
  v_exp_f32 v31, v31
  v_exp_f32 v44, v44
  v_exp_f32 v45, v45
  v_exp_f32 v46, v46
  v_exp_f32 v47, v47
  s_nop 0
  v_add_f32 v13, v16, v17
  v_add_f32 v12, v18, v19
  v_add_f32 v13, v13, v20
  v_add_f32 v12, v12, v21
  v_add_f32 v13, v13, v22
  v_add_f32 v12, v12, v23
  v_add_f32 v13, v13, v24
  v_add_f32 v12, v12, v25
  v_add_f32 v13, v13, v26
  v_add_f32 v12, v12, v27
  v_add_f32 v13, v13, v28
  v_add_f32 v12, v12, v29
  v_add_f32 v13, v13, v30
  v_add_f32 v12, v12, v31
  v_add_f32 v13, v13, v44
  v_add_f32 v12, v12, v45
  v_add_f32 v13, v13, v46
  v_add_f32 v12, v12, v47
  v_add_f32 v13, v13, v12
  v_mov_b32 v12, v13
  s_nop 1
  v_permlane32_swap_b32 v13, v12
  s_nop 0
  v_add_f32 v13, v13, v12
  v_rcp_f32 v13, v13
  s_nop 0
  v_mul_f32 v16, v16, v13
  v_mul_f32 v17, v17, v13
  v_mul_f32 v18, v18, v13
  v_mul_f32 v19, v19, v13
  v_mul_f32 v20, v20, v13
  v_mul_f32 v21, v21, v13
  v_mul_f32 v22, v22, v13
  v_mul_f32 v23, v23, v13
  v_mul_f32 v24, v24, v13
  v_mul_f32 v25, v25, v13
  v_mul_f32 v26, v26, v13
  v_mul_f32 v27, v27, v13
  v_mul_f32 v28, v28, v13
  v_mul_f32 v29, v29, v13
  v_mul_f32 v30, v30, v13
  v_mul_f32 v31, v31, v13
  v_mul_f32 v44, v44, v13
  v_mul_f32 v45, v45, v13
  v_mul_f32 v46, v46, v13
  v_mul_f32 v47, v47, v13
  v_cvt_pk_bf16_f32 v76, v16, v17
  v_cvt_pk_bf16_f32 v77, v18, v19
  v_cvt_pk_bf16_f32 v78, v20, v21
  v_cvt_pk_bf16_f32 v79, v22, v23
  v_cvt_pk_bf16_f32 v80, v24, v25
  v_cvt_pk_bf16_f32 v81, v26, v27
  v_cvt_pk_bf16_f32 v82, v28, v29
  v_cvt_pk_bf16_f32 v83, v30, v31
  v_cvt_pk_bf16_f32 v84, v44, v45
  v_cvt_pk_bf16_f32 v85, v46, v47
  buffer_store_dwordx4 v[76:79], v15, s[40:43], s56 offen sc1
  buffer_store_dwordx4 v[80:83], v15, s[40:43], s56 offen offset:1024 sc1
  buffer_store_dwordx2 v[84:85], v7, s[40:43], s56 offen offset:2048 sc1
  s_add_u32 s56, s56, 3072
W_FPD:
  s_waitcnt vmcnt(0)
  s_barrier
  s_cmp_eq_u32 s48, 0
  s_cbranch_scc0 W_FPX
  s_lshl_b32 s61, s49, 8
  s_add_u32 s61, s61, 182517760
  v_mov_b32 v9, s60
  s_mov_b64 exec, 1
  buffer_atomic_add v9, off, s[40:43], s61
  s_mov_b64 exec, -1
W_FPX:
  s_branch W_LOOP_T5
W_FO_T:
  s_lshr_b32 s49, s93, 2
  s_and_b32 s50, s93, 3
  s_lshr_b32 s68, s49, 3
  s_lshl_b32 s68, s68, 2
  s_add_u32 s68, s68, 96
  s_mov_b32 s69, 64
  s_cmp_lt_u32 s49, 8
  s_cselect_b32 s69, 128, s69
  s_cmp_eq_u32 s48, 0
  s_cbranch_scc0 WN_184
  v_mov_b32 v2, 64
  v_mov_b32 v4, 0
  v_and_b32 v5, 63, v0
  v_mov_b32 v6, 64
  v_mov_b32 v7, 128
  v_cmp_eq_u32 vcc, 0, v5
  s_nop 1
  v_cndmask_b32 v2, v2, v6, vcc
  v_cndmask_b32 v4, v4, v7, vcc
  v_mov_b32 v6, s68
  v_mov_b32 v7, s69
  v_cmp_eq_u32 vcc, 1, v5
  s_nop 1
  v_cndmask_b32 v2, v2, v6, vcc
  v_cndmask_b32 v4, v4, v7, vcc
WM_183:
  buffer_load_dword v1, v2, s[96:99], 0 offen sc1
  s_waitcnt vmcnt(0)
  v_cmp_gt_u32 vcc, v4, v1
  s_cbranch_vccz WN_184
  s_sleep 12
  s_sub_u32 s101, s101, 1
  s_cbranch_scc0 WM_183
  s_mov_b32 s101, 0
WN_184:
  s_barrier
  s_mov_b32 s44, s24
  s_mov_b32 s45, s25
  s_mov_b32 s46, 5242880
  s_mov_b32 s47, 0x20000
  v_and_b32 v1, 63, v0
  v_lshrrev_b32 v9, 6, v0
  s_nop 0
  v_readfirstlane_b32 s48, v9
  v_and_b32 v9, 31, v1
  v_lshrrev_b32 v10, 5, v1
  v_lshlrev_b32 v2, 5, v9
  v_lshl_add_u32 v2, v10, 4, v2
  v_and_b32 v3, 0x13, v9
  v_and_b32 v11, 4, v9
  v_lshl_add_u32 v3, v11, 1, v3
  v_and_b32 v11, 8, v9
  v_lshrrev_b32 v11, 1, v11
  v_add_u32 v3, v3, v11
  v_lshlrev_b32 v3, 5, v3
  v_lshl_add_u32 v3, v10, 4, v3
  v_lshrrev_b32 v4, 3, v9
  v_mul_u32_u24 v4, 196608, v4
  v_and_b32 v11, 7, v9
  v_lshl_add_u32 v4, v11, 5, v4
  v_lshl_add_u32 v4, v10, 4, v4
  v_lshrrev_b32 v5, 4, v9
  v_lshlrev_b32 v6, 14, v5
  v_lshlrev_b32 v5, 16, v5
  v_and_b32 v11, 15, v9
  v_lshl_add_u32 v5, v11, 5, v5
  v_lshl_add_u32 v5, v10, 4, v5
  v_lshl_add_u32 v6, v11, 4, v6
  v_lshl_add_u32 v6, v10, 3, v6
  v_mul_u32_u24 v7, 2560, v9
  v_lshl_add_u32 v7, v10, 4, v7
  v_lshlrev_b32 v8, 4, v1
  v_mov_b32 v14, 0xff800000
  v_mov_b32 v58, 0
  v_mov_b32 v59, 0
  s_mov_b32 s59, 0x3dd53b95
  v_mov_b32 v106, 0
  v_mov_b32 v107, 0
  v_mov_b32 v110, 0
  v_mov_b32 v111, 0
  v_mov_b32 v114, 0
  v_mov_b32 v115, 0
  v_mov_b32 v118, 0
  v_mov_b32 v119, 0
  v_mov_b32 v122, 0
  v_mov_b32 v123, 0
  s_lshl_b32 s58, s48, 3
  s_mul_i32 s51, s58, 768
  s_add_u32 s51, s51, s49
  s_lshl_b32 s52, s51, 10
  s_add_u32 s53, s52, 25165824
  s_add_u32 s54, s52, 0
  s_lshl_b32 s52, s51, 8
  s_add_u32 s55, s52, 155189248
  s_mul_i32 s51, s58, 40
  s_mul_i32 s52, s50, 10
  s_add_u32 s51, s51, s52
  s_lshl_b32 s51, s51, 6
  s_add_u32 s51, s51, s49
  s_lshl_b32 s52, s51, 10
  s_add_u32 s56, s52, 50331648
  s_lshl_b32 s52, s51, 8
  s_add_u32 s57, s52, 134217728
  s_add_u32 s51, s56, 0
  buffer_load_dwordx4 a[0:3], v5, s[40:43], s51 offen sc1
  buffer_load_dwordx4 a[4:7], v5, s[40:43], s51 offen offset:512 sc1
  s_add_u32 s51, s56, 131072
  buffer_load_dwordx4 a[8:11], v5, s[40:43], s51 offen sc1
  buffer_load_dwordx4 a[12:15], v5, s[40:43], s51 offen offset:512 sc1
  s_add_u32 s51, s56, 262144
  buffer_load_dwordx4 a[16:19], v5, s[40:43], s51 offen sc1
  buffer_load_dwordx4 a[20:23], v5, s[40:43], s51 offen offset:512 sc1
  s_add_u32 s51, s56, 393216
  buffer_load_dwordx4 a[24:27], v5, s[40:43], s51 offen sc1
  buffer_load_dwordx4 a[28:31], v5, s[40:43], s51 offen offset:512 sc1
  s_add_u32 s51, s56, 524288
  buffer_load_dwordx4 a[32:35], v5, s[40:43], s51 offen sc1
  buffer_load_dwordx4 a[36:39], v5, s[40:43], s51 offen offset:512 sc1
  s_add_u32 s56, s56, 2621440
  s_add_u32 s51, s56, 0
  buffer_load_dwordx4 a[40:43], v5, s[40:43], s51 offen sc1
  buffer_load_dwordx4 a[44:47], v5, s[40:43], s51 offen offset:512 sc1
  s_add_u32 s51, s56, 131072
  buffer_load_dwordx4 a[48:51], v5, s[40:43], s51 offen sc1
  buffer_load_dwordx4 a[52:55], v5, s[40:43], s51 offen offset:512 sc1
  s_add_u32 s51, s56, 262144
  buffer_load_dwordx4 a[56:59], v5, s[40:43], s51 offen sc1
  buffer_load_dwordx4 a[60:63], v5, s[40:43], s51 offen offset:512 sc1
  s_add_u32 s51, s56, 393216
  buffer_load_dwordx4 a[64:67], v5, s[40:43], s51 offen sc1
  buffer_load_dwordx4 a[68:71], v5, s[40:43], s51 offen offset:512 sc1
  s_add_u32 s51, s56, 524288
  buffer_load_dwordx4 a[72:75], v5, s[40:43], s51 offen sc1
  buffer_load_dwordx4 a[76:79], v5, s[40:43], s51 offen offset:512 sc1
  s_add_u32 s56, s56, 2621440
  s_add_u32 s51, s56, 0
  buffer_load_dwordx4 a[80:83], v5, s[40:43], s51 offen sc1
  buffer_load_dwordx4 a[84:87], v5, s[40:43], s51 offen offset:512 sc1
  s_add_u32 s51, s56, 131072
  buffer_load_dwordx4 a[88:91], v5, s[40:43], s51 offen sc1
  buffer_load_dwordx4 a[92:95], v5, s[40:43], s51 offen offset:512 sc1
  s_add_u32 s51, s56, 262144
  buffer_load_dwordx4 a[96:99], v5, s[40:43], s51 offen sc1
  buffer_load_dwordx4 a[100:103], v5, s[40:43], s51 offen offset:512 sc1
  s_add_u32 s51, s56, 393216
  buffer_load_dwordx4 a[104:107], v5, s[40:43], s51 offen sc1
  buffer_load_dwordx4 a[108:111], v5, s[40:43], s51 offen offset:512 sc1
  s_add_u32 s51, s56, 524288
  buffer_load_dwordx4 a[112:115], v5, s[40:43], s51 offen sc1
  buffer_load_dwordx4 a[116:119], v5, s[40:43], s51 offen offset:512 sc1
  s_add_u32 s56, s56, 2621440
  s_add_u32 s51, s56, 0
  buffer_load_dwordx4 a[120:123], v5, s[40:43], s51 offen sc1
  buffer_load_dwordx4 a[124:127], v5, s[40:43], s51 offen offset:512 sc1
  s_add_u32 s51, s56, 131072
  buffer_load_dwordx4 a[128:131], v5, s[40:43], s51 offen sc1
  buffer_load_dwordx4 a[132:135], v5, s[40:43], s51 offen offset:512 sc1
  s_add_u32 s51, s56, 262144
  buffer_load_dwordx4 a[136:139], v5, s[40:43], s51 offen sc1
  buffer_load_dwordx4 a[140:143], v5, s[40:43], s51 offen offset:512 sc1
  s_add_u32 s51, s56, 393216
  buffer_load_dwordx4 a[144:147], v5, s[40:43], s51 offen sc1
  buffer_load_dwordx4 a[148:151], v5, s[40:43], s51 offen offset:512 sc1
  s_add_u32 s51, s56, 524288
  buffer_load_dwordx4 a[152:155], v5, s[40:43], s51 offen sc1
  buffer_load_dwordx4 a[156:159], v5, s[40:43], s51 offen offset:512 sc1
  s_add_u32 s56, s56, 2621440
  s_waitcnt vmcnt(20)
  s_add_u32 s51, s56, 0
  buffer_load_dwordx4 a[160:163], v5, s[40:43], s51 offen sc1
  buffer_load_dwordx4 a[164:167], v5, s[40:43], s51 offen offset:512 sc1
  s_add_u32 s51, s56, 131072
  buffer_load_dwordx4 a[168:171], v5, s[40:43], s51 offen sc1
  buffer_load_dwordx4 a[172:175], v5, s[40:43], s51 offen offset:512 sc1
  s_add_u32 s51, s56, 262144
  buffer_load_dwordx4 a[176:179], v5, s[40:43], s51 offen sc1
  buffer_load_dwordx4 a[180:183], v5, s[40:43], s51 offen offset:512 sc1
  s_add_u32 s51, s56, 393216
  buffer_load_dwordx4 a[184:187], v5, s[40:43], s51 offen sc1
  buffer_load_dwordx4 a[188:191], v5, s[40:43], s51 offen offset:512 sc1
  s_add_u32 s51, s56, 524288
  buffer_load_dwordx4 a[192:195], v5, s[40:43], s51 offen sc1
  buffer_load_dwordx4 a[196:199], v5, s[40:43], s51 offen offset:512 sc1
  s_add_u32 s56, s56, 2621440
  s_add_u32 s51, s56, 0
  buffer_load_dwordx4 a[200:203], v5, s[40:43], s51 offen sc1
  buffer_load_dwordx4 a[204:207], v5, s[40:43], s51 offen offset:512 sc1
  s_add_u32 s51, s56, 131072
  buffer_load_dwordx4 a[208:211], v5, s[40:43], s51 offen sc1
  buffer_load_dwordx4 a[212:215], v5, s[40:43], s51 offen offset:512 sc1
  s_add_u32 s51, s56, 262144
  buffer_load_dwordx4 a[216:219], v5, s[40:43], s51 offen sc1
  buffer_load_dwordx4 a[220:223], v5, s[40:43], s51 offen offset:512 sc1
  s_add_u32 s51, s56, 393216
  buffer_load_dwordx4 a[224:227], v5, s[40:43], s51 offen sc1
  buffer_load_dwordx4 a[228:231], v5, s[40:43], s51 offen offset:512 sc1
  s_add_u32 s51, s56, 524288
  buffer_load_dwordx4 a[232:235], v5, s[40:43], s51 offen sc1
  buffer_load_dwordx4 a[236:239], v5, s[40:43], s51 offen offset:512 sc1
  s_add_u32 s56, s56, 2621440
  s_add_u32 s51, s56, 0
  buffer_load_dwordx4 v[16:19], v5, s[40:43], s51 offen sc1
  buffer_load_dwordx4 v[20:23], v5, s[40:43], s51 offen offset:512 sc1
  s_add_u32 s51, s56, 131072
  buffer_load_dwordx4 v[24:27], v5, s[40:43], s51 offen sc1
  buffer_load_dwordx4 v[28:31], v5, s[40:43], s51 offen offset:512 sc1
  s_add_u32 s51, s56, 262144
  buffer_load_dwordx4 v[32:35], v5, s[40:43], s51 offen sc1
  buffer_load_dwordx4 v[36:39], v5, s[40:43], s51 offen offset:512 sc1
  s_add_u32 s51, s56, 393216
  buffer_load_dwordx4 v[40:43], v5, s[40:43], s51 offen sc1
  buffer_load_dwordx4 v[44:47], v5, s[40:43], s51 offen offset:512 sc1
  s_add_u32 s51, s56, 524288
  buffer_load_dwordx4 v[48:51], v5, s[40:43], s51 offen sc1
  buffer_load_dwordx4 v[52:55], v5, s[40:43], s51 offen offset:512 sc1
  s_add_u32 s56, s56, 2621440
  s_add_u32 s51, s56, 0
  buffer_load_dwordx4 v[64:67], v5, s[40:43], s51 offen sc1
  buffer_load_dwordx4 v[68:71], v5, s[40:43], s51 offen offset:512 sc1
  s_add_u32 s51, s56, 131072
  buffer_load_dwordx4 v[72:75], v5, s[40:43], s51 offen sc1
  buffer_load_dwordx4 v[76:79], v5, s[40:43], s51 offen offset:512 sc1
  s_add_u32 s51, s56, 262144
  buffer_load_dwordx4 v[80:83], v5, s[40:43], s51 offen sc1
  buffer_load_dwordx4 v[84:87], v5, s[40:43], s51 offen offset:512 sc1
  s_add_u32 s51, s56, 393216
  buffer_load_dwordx4 v[88:91], v5, s[40:43], s51 offen sc1
  buffer_load_dwordx4 v[92:95], v5, s[40:43], s51 offen offset:512 sc1
  s_add_u32 s51, s56, 524288
  buffer_load_dwordx4 v[96:99], v5, s[40:43], s51 offen sc1
  buffer_load_dwordx4 v[100:103], v5, s[40:43], s51 offen offset:512 sc1
  s_add_u32 s56, s56, 2621440
  s_waitcnt vmcnt(20)
  s_cmp_eq_u32 s48, 0
  s_cbranch_scc0 FY_186
  s_lshl_b32 s61, s49, 8
  s_add_u32 s61, s61, 182517760
FW_185:
  buffer_load_dword v9, off, s[40:43], s61 sc1
  s_waitcnt vmcnt(0)
  v_cmp_gt_u32 vcc, 4, v9
  s_cbranch_vccz FY_186
  s_sleep 6
  s_sub_u32 s101, s101, 1
  s_cbranch_scc0 FW_185
  s_mov_b32 s101, 0
FY_186:
  s_barrier
  v_and_b32 v1, 63, v0
  v_lshlrev_b32 v15, 4, v1
  v_lshrrev_b32 v10, 1, v15
  s_lshl_b32 s51, s49, 5
  s_lshl_b32 s52, s48, 3
  s_add_u32 s51, s51, s52
  s_mul_i32 s53, s51, 3072
  s_add_u32 s53, s53, 192937984
  v_mov_b32 v114, 0
  v_mov_b32 v115, 0
  v_mov_b32 v210, 0
  v_mov_b32 v211, 0
  v_mov_b32 v214, 0
  v_mov_b32 v215, 0
  v_mov_b32 v218, 0
  v_mov_b32 v219, 0
  v_mov_b32 v222, 0
  v_mov_b32 v223, 0
  v_mov_b32 v226, 0
  v_mov_b32 v227, 0
  v_mov_b32 v126, 0
  v_mov_b32 v127, 0
  v_mov_b32 v230, 0
  v_mov_b32 v231, 0
  v_mov_b32 v234, 0
  v_mov_b32 v235, 0
  v_mov_b32 v238, 0
  v_mov_b32 v239, 0
  v_mov_b32 v242, 0
  v_mov_b32 v243, 0
  v_mov_b32 v246, 0
  v_mov_b32 v247, 0
  buffer_load_dwordx4 v[104:107], v15, s[40:43], s53 offen sc1
  buffer_load_dwordx4 v[108:111], v15, s[40:43], s53 offen offset:1024 sc1
  buffer_load_dwordx2 v[112:113], v10, s[40:43], s53 offen offset:2048 sc1
  s_add_u32 s51, s57, 0
  buffer_load_dwordx2 v[208:209], v6, s[40:43], s51 offen sc1
  s_add_u32 s51, s57, 32768
  buffer_load_dwordx2 v[212:213], v6, s[40:43], s51 offen sc1
  s_add_u32 s51, s57, 65536
  buffer_load_dwordx2 v[216:217], v6, s[40:43], s51 offen sc1
  s_add_u32 s51, s57, 98304
  buffer_load_dwordx2 v[220:221], v6, s[40:43], s51 offen sc1
  s_add_u32 s51, s57, 131072
  buffer_load_dwordx2 v[224:225], v6, s[40:43], s51 offen sc1
  s_add_u32 s53, s53, 3072
  s_add_u32 s57, s57, 655360
  buffer_load_dwordx4 v[116:119], v15, s[40:43], s53 offen sc1
  buffer_load_dwordx4 v[120:123], v15, s[40:43], s53 offen offset:1024 sc1
  buffer_load_dwordx2 v[124:125], v10, s[40:43], s53 offen offset:2048 sc1
  s_add_u32 s51, s57, 0
  buffer_load_dwordx2 v[228:229], v6, s[40:43], s51 offen sc1
  s_add_u32 s51, s57, 32768
  buffer_load_dwordx2 v[232:233], v6, s[40:43], s51 offen sc1
  s_add_u32 s51, s57, 65536
  buffer_load_dwordx2 v[236:237], v6, s[40:43], s51 offen sc1
  s_add_u32 s51, s57, 98304
  buffer_load_dwordx2 v[240:241], v6, s[40:43], s51 offen sc1
  s_add_u32 s51, s57, 131072
  buffer_load_dwordx2 v[244:245], v6, s[40:43], s51 offen sc1
  s_add_u32 s53, s53, 3072
  s_add_u32 s57, s57, 655360
  s_waitcnt vmcnt(8)
  v_mfma_f32_32x32x16_bf16 v[128:143], a[0:3], v[104:107], 0
  v_mfma_f32_32x32x16_bf16 v[144:159], a[8:11], v[104:107], 0
  v_mfma_f32_32x32x16_bf16 v[160:175], a[16:19], v[104:107], 0
  v_mfma_f32_32x32x16_bf16 v[176:191], a[24:27], v[104:107], 0
  v_mfma_f32_32x32x16_bf16 v[192:207], a[32:35], v[104:107], 0
  v_mfma_f32_32x32x16_bf16 v[128:143], a[4:7], v[108:111], v[128:143]
  v_mfma_f32_32x32x16_bf16 v[144:159], a[12:15], v[108:111], v[144:159]
  v_mfma_f32_32x32x16_bf16 v[160:175], a[20:23], v[108:111], v[160:175]
  v_mfma_f32_32x32x16_bf16 v[176:191], a[28:31], v[108:111], v[176:191]
  v_mfma_f32_32x32x16_bf16 v[192:207], a[36:39], v[108:111], v[192:207]
  v_mfma_f32_32x32x16_bf16 v[128:143], v[208:211], v[112:115], v[128:143]
  v_mfma_f32_32x32x16_bf16 v[144:159], v[212:215], v[112:115], v[144:159]
  v_mfma_f32_32x32x16_bf16 v[160:175], v[216:219], v[112:115], v[160:175]
  v_mfma_f32_32x32x16_bf16 v[176:191], v[220:223], v[112:115], v[176:191]
  v_mfma_f32_32x32x16_bf16 v[192:207], v[224:227], v[112:115], v[192:207]
  buffer_load_dwordx4 v[104:107], v15, s[40:43], s53 offen sc1
  buffer_load_dwordx4 v[108:111], v15, s[40:43], s53 offen offset:1024 sc1
  buffer_load_dwordx2 v[112:113], v10, s[40:43], s53 offen offset:2048 sc1
  s_add_u32 s51, s57, 0
  buffer_load_dwordx2 v[208:209], v6, s[40:43], s51 offen sc1
  s_add_u32 s51, s57, 32768
  buffer_load_dwordx2 v[212:213], v6, s[40:43], s51 offen sc1
  s_add_u32 s51, s57, 65536
  buffer_load_dwordx2 v[216:217], v6, s[40:43], s51 offen sc1
  s_add_u32 s51, s57, 98304
  buffer_load_dwordx2 v[220:221], v6, s[40:43], s51 offen sc1
  s_add_u32 s51, s57, 131072
  buffer_load_dwordx2 v[224:225], v6, s[40:43], s51 offen sc1
  s_add_u32 s53, s53, 3072
  s_add_u32 s57, s57, 655360
  s_waitcnt vmcnt(8)
  v_mfma_f32_32x32x16_bf16 v[128:143], a[40:43], v[116:119], v[128:143]
  v_mfma_f32_32x32x16_bf16 v[144:159], a[48:51], v[116:119], v[144:159]
  v_mfma_f32_32x32x16_bf16 v[160:175], a[56:59], v[116:119], v[160:175]
  v_mfma_f32_32x32x16_bf16 v[176:191], a[64:67], v[116:119], v[176:191]
  v_mfma_f32_32x32x16_bf16 v[192:207], a[72:75], v[116:119], v[192:207]
  v_mfma_f32_32x32x16_bf16 v[128:143], a[44:47], v[120:123], v[128:143]
  v_mfma_f32_32x32x16_bf16 v[144:159], a[52:55], v[120:123], v[144:159]
  v_mfma_f32_32x32x16_bf16 v[160:175], a[60:63], v[120:123], v[160:175]
  v_mfma_f32_32x32x16_bf16 v[176:191], a[68:71], v[120:123], v[176:191]
  v_mfma_f32_32x32x16_bf16 v[192:207], a[76:79], v[120:123], v[192:207]
  v_mfma_f32_32x32x16_bf16 v[128:143], v[228:231], v[124:127], v[128:143]
  v_mfma_f32_32x32x16_bf16 v[144:159], v[232:235], v[124:127], v[144:159]
  v_mfma_f32_32x32x16_bf16 v[160:175], v[236:239], v[124:127], v[160:175]
  v_mfma_f32_32x32x16_bf16 v[176:191], v[240:243], v[124:127], v[176:191]
  v_mfma_f32_32x32x16_bf16 v[192:207], v[244:247], v[124:127], v[192:207]
  buffer_load_dwordx4 v[116:119], v15, s[40:43], s53 offen sc1
  buffer_load_dwordx4 v[120:123], v15, s[40:43], s53 offen offset:1024 sc1
  buffer_load_dwordx2 v[124:125], v10, s[40:43], s53 offen offset:2048 sc1
  s_add_u32 s51, s57, 0
  buffer_load_dwordx2 v[228:229], v6, s[40:43], s51 offen sc1
  s_add_u32 s51, s57, 32768
  buffer_load_dwordx2 v[232:233], v6, s[40:43], s51 offen sc1
  s_add_u32 s51, s57, 65536
  buffer_load_dwordx2 v[236:237], v6, s[40:43], s51 offen sc1
  s_add_u32 s51, s57, 98304
  buffer_load_dwordx2 v[240:241], v6, s[40:43], s51 offen sc1
  s_add_u32 s51, s57, 131072
  buffer_load_dwordx2 v[244:245], v6, s[40:43], s51 offen sc1
  s_add_u32 s53, s53, 3072
  s_add_u32 s57, s57, 655360
  s_waitcnt vmcnt(8)
  v_mfma_f32_32x32x16_bf16 v[128:143], a[80:83], v[104:107], v[128:143]
  v_mfma_f32_32x32x16_bf16 v[144:159], a[88:91], v[104:107], v[144:159]
  v_mfma_f32_32x32x16_bf16 v[160:175], a[96:99], v[104:107], v[160:175]
  v_mfma_f32_32x32x16_bf16 v[176:191], a[104:107], v[104:107], v[176:191]
  v_mfma_f32_32x32x16_bf16 v[192:207], a[112:115], v[104:107], v[192:207]
  v_mfma_f32_32x32x16_bf16 v[128:143], a[84:87], v[108:111], v[128:143]
  v_mfma_f32_32x32x16_bf16 v[144:159], a[92:95], v[108:111], v[144:159]
  v_mfma_f32_32x32x16_bf16 v[160:175], a[100:103], v[108:111], v[160:175]
  v_mfma_f32_32x32x16_bf16 v[176:191], a[108:111], v[108:111], v[176:191]
  v_mfma_f32_32x32x16_bf16 v[192:207], a[116:119], v[108:111], v[192:207]
  v_mfma_f32_32x32x16_bf16 v[128:143], v[208:211], v[112:115], v[128:143]
  v_mfma_f32_32x32x16_bf16 v[144:159], v[212:215], v[112:115], v[144:159]
  v_mfma_f32_32x32x16_bf16 v[160:175], v[216:219], v[112:115], v[160:175]
  v_mfma_f32_32x32x16_bf16 v[176:191], v[220:223], v[112:115], v[176:191]
  v_mfma_f32_32x32x16_bf16 v[192:207], v[224:227], v[112:115], v[192:207]
  buffer_load_dwordx4 v[104:107], v15, s[40:43], s53 offen sc1
  buffer_load_dwordx4 v[108:111], v15, s[40:43], s53 offen offset:1024 sc1
  buffer_load_dwordx2 v[112:113], v10, s[40:43], s53 offen offset:2048 sc1
  s_add_u32 s51, s57, 0
  buffer_load_dwordx2 v[208:209], v6, s[40:43], s51 offen sc1
  s_add_u32 s51, s57, 32768
  buffer_load_dwordx2 v[212:213], v6, s[40:43], s51 offen sc1
  s_add_u32 s51, s57, 65536
  buffer_load_dwordx2 v[216:217], v6, s[40:43], s51 offen sc1
  s_add_u32 s51, s57, 98304
  buffer_load_dwordx2 v[220:221], v6, s[40:43], s51 offen sc1
  s_add_u32 s51, s57, 131072
  buffer_load_dwordx2 v[224:225], v6, s[40:43], s51 offen sc1
  s_add_u32 s53, s53, 3072
  s_add_u32 s57, s57, 655360
  s_waitcnt vmcnt(8)
  v_mfma_f32_32x32x16_bf16 v[128:143], a[120:123], v[116:119], v[128:143]
  v_mfma_f32_32x32x16_bf16 v[144:159], a[128:131], v[116:119], v[144:159]
  v_mfma_f32_32x32x16_bf16 v[160:175], a[136:139], v[116:119], v[160:175]
  v_mfma_f32_32x32x16_bf16 v[176:191], a[144:147], v[116:119], v[176:191]
  v_mfma_f32_32x32x16_bf16 v[192:207], a[152:155], v[116:119], v[192:207]
  v_mfma_f32_32x32x16_bf16 v[128:143], a[124:127], v[120:123], v[128:143]
  v_mfma_f32_32x32x16_bf16 v[144:159], a[132:135], v[120:123], v[144:159]
  v_mfma_f32_32x32x16_bf16 v[160:175], a[140:143], v[120:123], v[160:175]
  v_mfma_f32_32x32x16_bf16 v[176:191], a[148:151], v[120:123], v[176:191]
  v_mfma_f32_32x32x16_bf16 v[192:207], a[156:159], v[120:123], v[192:207]
  v_mfma_f32_32x32x16_bf16 v[128:143], v[228:231], v[124:127], v[128:143]
  v_mfma_f32_32x32x16_bf16 v[144:159], v[232:235], v[124:127], v[144:159]
  v_mfma_f32_32x32x16_bf16 v[160:175], v[236:239], v[124:127], v[160:175]
  v_mfma_f32_32x32x16_bf16 v[176:191], v[240:243], v[124:127], v[176:191]
  v_mfma_f32_32x32x16_bf16 v[192:207], v[244:247], v[124:127], v[192:207]
  buffer_load_dwordx4 v[116:119], v15, s[40:43], s53 offen sc1
  buffer_load_dwordx4 v[120:123], v15, s[40:43], s53 offen offset:1024 sc1
  buffer_load_dwordx2 v[124:125], v10, s[40:43], s53 offen offset:2048 sc1
  s_add_u32 s51, s57, 0
  buffer_load_dwordx2 v[228:229], v6, s[40:43], s51 offen sc1
  s_add_u32 s51, s57, 32768
  buffer_load_dwordx2 v[232:233], v6, s[40:43], s51 offen sc1
  s_add_u32 s51, s57, 65536
  buffer_load_dwordx2 v[236:237], v6, s[40:43], s51 offen sc1
  s_add_u32 s51, s57, 98304
  buffer_load_dwordx2 v[240:241], v6, s[40:43], s51 offen sc1
  s_add_u32 s51, s57, 131072
  buffer_load_dwordx2 v[244:245], v6, s[40:43], s51 offen sc1
  s_add_u32 s53, s53, 3072
  s_add_u32 s57, s57, 655360
  s_waitcnt vmcnt(8)
  v_mfma_f32_32x32x16_bf16 v[128:143], a[160:163], v[104:107], v[128:143]
  v_mfma_f32_32x32x16_bf16 v[144:159], a[168:171], v[104:107], v[144:159]
  v_mfma_f32_32x32x16_bf16 v[160:175], a[176:179], v[104:107], v[160:175]
  v_mfma_f32_32x32x16_bf16 v[176:191], a[184:187], v[104:107], v[176:191]
  v_mfma_f32_32x32x16_bf16 v[192:207], a[192:195], v[104:107], v[192:207]
  v_mfma_f32_32x32x16_bf16 v[128:143], a[164:167], v[108:111], v[128:143]
  v_mfma_f32_32x32x16_bf16 v[144:159], a[172:175], v[108:111], v[144:159]
  v_mfma_f32_32x32x16_bf16 v[160:175], a[180:183], v[108:111], v[160:175]
  v_mfma_f32_32x32x16_bf16 v[176:191], a[188:191], v[108:111], v[176:191]
  v_mfma_f32_32x32x16_bf16 v[192:207], a[196:199], v[108:111], v[192:207]
  v_mfma_f32_32x32x16_bf16 v[128:143], v[208:211], v[112:115], v[128:143]
  v_mfma_f32_32x32x16_bf16 v[144:159], v[212:215], v[112:115], v[144:159]
  v_mfma_f32_32x32x16_bf16 v[160:175], v[216:219], v[112:115], v[160:175]
  v_mfma_f32_32x32x16_bf16 v[176:191], v[220:223], v[112:115], v[176:191]
  v_mfma_f32_32x32x16_bf16 v[192:207], v[224:227], v[112:115], v[192:207]
  buffer_load_dwordx4 v[104:107], v15, s[40:43], s53 offen sc1
  buffer_load_dwordx4 v[108:111], v15, s[40:43], s53 offen offset:1024 sc1
  buffer_load_dwordx2 v[112:113], v10, s[40:43], s53 offen offset:2048 sc1
  s_add_u32 s51, s57, 0
  buffer_load_dwordx2 v[208:209], v6, s[40:43], s51 offen sc1
  s_add_u32 s51, s57, 32768
  buffer_load_dwordx2 v[212:213], v6, s[40:43], s51 offen sc1
  s_add_u32 s51, s57, 65536
  buffer_load_dwordx2 v[216:217], v6, s[40:43], s51 offen sc1
  s_add_u32 s51, s57, 98304
  buffer_load_dwordx2 v[220:221], v6, s[40:43], s51 offen sc1
  s_add_u32 s51, s57, 131072
  buffer_load_dwordx2 v[224:225], v6, s[40:43], s51 offen sc1
  s_add_u32 s53, s53, 3072
  s_add_u32 s57, s57, 655360
  s_waitcnt vmcnt(8)
  v_mfma_f32_32x32x16_bf16 v[128:143], a[200:203], v[116:119], v[128:143]
  v_mfma_f32_32x32x16_bf16 v[144:159], a[208:211], v[116:119], v[144:159]
  v_mfma_f32_32x32x16_bf16 v[160:175], a[216:219], v[116:119], v[160:175]
  v_mfma_f32_32x32x16_bf16 v[176:191], a[224:227], v[116:119], v[176:191]
  v_mfma_f32_32x32x16_bf16 v[192:207], a[232:235], v[116:119], v[192:207]
  v_mfma_f32_32x32x16_bf16 v[128:143], a[204:207], v[120:123], v[128:143]
  v_mfma_f32_32x32x16_bf16 v[144:159], a[212:215], v[120:123], v[144:159]
  v_mfma_f32_32x32x16_bf16 v[160:175], a[220:223], v[120:123], v[160:175]
  v_mfma_f32_32x32x16_bf16 v[176:191], a[228:231], v[120:123], v[176:191]
  v_mfma_f32_32x32x16_bf16 v[192:207], a[236:239], v[120:123], v[192:207]
  v_mfma_f32_32x32x16_bf16 v[128:143], v[228:231], v[124:127], v[128:143]
  v_mfma_f32_32x32x16_bf16 v[144:159], v[232:235], v[124:127], v[144:159]
  v_mfma_f32_32x32x16_bf16 v[160:175], v[236:239], v[124:127], v[160:175]
  v_mfma_f32_32x32x16_bf16 v[176:191], v[240:243], v[124:127], v[176:191]
  v_mfma_f32_32x32x16_bf16 v[192:207], v[244:247], v[124:127], v[192:207]
  buffer_load_dwordx4 v[116:119], v15, s[40:43], s53 offen sc1
  buffer_load_dwordx4 v[120:123], v15, s[40:43], s53 offen offset:1024 sc1
  buffer_load_dwordx2 v[124:125], v10, s[40:43], s53 offen offset:2048 sc1
  s_add_u32 s51, s57, 0
  buffer_load_dwordx2 v[228:229], v6, s[40:43], s51 offen sc1
  s_add_u32 s51, s57, 32768
  buffer_load_dwordx2 v[232:233], v6, s[40:43], s51 offen sc1
  s_add_u32 s51, s57, 65536
  buffer_load_dwordx2 v[236:237], v6, s[40:43], s51 offen sc1
  s_add_u32 s51, s57, 98304
  buffer_load_dwordx2 v[240:241], v6, s[40:43], s51 offen sc1
  s_add_u32 s51, s57, 131072
  buffer_load_dwordx2 v[244:245], v6, s[40:43], s51 offen sc1
  s_add_u32 s53, s53, 3072
  s_add_u32 s57, s57, 655360
  s_waitcnt vmcnt(8)
  v_mfma_f32_32x32x16_bf16 v[128:143], v[16:19], v[104:107], v[128:143]
  v_mfma_f32_32x32x16_bf16 v[144:159], v[24:27], v[104:107], v[144:159]
  v_mfma_f32_32x32x16_bf16 v[160:175], v[32:35], v[104:107], v[160:175]
  v_mfma_f32_32x32x16_bf16 v[176:191], v[40:43], v[104:107], v[176:191]
  v_mfma_f32_32x32x16_bf16 v[192:207], v[48:51], v[104:107], v[192:207]
  v_mfma_f32_32x32x16_bf16 v[128:143], v[20:23], v[108:111], v[128:143]
  v_mfma_f32_32x32x16_bf16 v[144:159], v[28:31], v[108:111], v[144:159]
  v_mfma_f32_32x32x16_bf16 v[160:175], v[36:39], v[108:111], v[160:175]
  v_mfma_f32_32x32x16_bf16 v[176:191], v[44:47], v[108:111], v[176:191]
  v_mfma_f32_32x32x16_bf16 v[192:207], v[52:55], v[108:111], v[192:207]
  v_mfma_f32_32x32x16_bf16 v[128:143], v[208:211], v[112:115], v[128:143]
  v_mfma_f32_32x32x16_bf16 v[144:159], v[212:215], v[112:115], v[144:159]
  v_mfma_f32_32x32x16_bf16 v[160:175], v[216:219], v[112:115], v[160:175]
  v_mfma_f32_32x32x16_bf16 v[176:191], v[220:223], v[112:115], v[176:191]
  v_mfma_f32_32x32x16_bf16 v[192:207], v[224:227], v[112:115], v[192:207]
  s_waitcnt vmcnt(0)
  v_mfma_f32_32x32x16_bf16 v[128:143], v[64:67], v[116:119], v[128:143]
  v_mfma_f32_32x32x16_bf16 v[144:159], v[72:75], v[116:119], v[144:159]
  v_mfma_f32_32x32x16_bf16 v[160:175], v[80:83], v[116:119], v[160:175]
  v_mfma_f32_32x32x16_bf16 v[176:191], v[88:91], v[116:119], v[176:191]
  v_mfma_f32_32x32x16_bf16 v[192:207], v[96:99], v[116:119], v[192:207]
  v_mfma_f32_32x32x16_bf16 v[128:143], v[68:71], v[120:123], v[128:143]
  v_mfma_f32_32x32x16_bf16 v[144:159], v[76:79], v[120:123], v[144:159]
  v_mfma_f32_32x32x16_bf16 v[160:175], v[84:87], v[120:123], v[160:175]
  v_mfma_f32_32x32x16_bf16 v[176:191], v[92:95], v[120:123], v[176:191]
  v_mfma_f32_32x32x16_bf16 v[192:207], v[100:103], v[120:123], v[192:207]
  v_mfma_f32_32x32x16_bf16 v[128:143], v[228:231], v[124:127], v[128:143]
  v_mfma_f32_32x32x16_bf16 v[144:159], v[232:235], v[124:127], v[144:159]
  v_mfma_f32_32x32x16_bf16 v[160:175], v[236:239], v[124:127], v[160:175]
  v_mfma_f32_32x32x16_bf16 v[176:191], v[240:243], v[124:127], v[176:191]
  v_mfma_f32_32x32x16_bf16 v[192:207], v[244:247], v[124:127], v[192:207]
  s_nop 7
  s_nop 7
  s_mul_i32 s51, s48, 20480
  v_add_u32 v9, s51, v8
  ds_write_b128 v9, v[128:131] offset:0
  ds_write_b128 v9, v[132:135] offset:1024
  ds_write_b128 v9, v[136:139] offset:2048
  ds_write_b128 v9, v[140:143] offset:3072
  ds_write_b128 v9, v[144:147] offset:4096
  ds_write_b128 v9, v[148:151] offset:5120
  ds_write_b128 v9, v[152:155] offset:6144
  ds_write_b128 v9, v[156:159] offset:7168
  ds_write_b128 v9, v[160:163] offset:8192
  ds_write_b128 v9, v[164:167] offset:9216
  ds_write_b128 v9, v[168:171] offset:10240
  ds_write_b128 v9, v[172:175] offset:11264
  ds_write_b128 v9, v[176:179] offset:12288
  ds_write_b128 v9, v[180:183] offset:13312
  ds_write_b128 v9, v[184:187] offset:14336
  ds_write_b128 v9, v[188:191] offset:15360
  ds_write_b128 v9, v[192:195] offset:16384
  ds_write_b128 v9, v[196:199] offset:17408
  ds_write_b128 v9, v[200:203] offset:18432
  ds_write_b128 v9, v[204:207] offset:19456
  s_waitcnt lgkmcnt(0)
  s_barrier
  s_mul_i32 s60, s49, 81920
  s_mul_i32 s51, s50, 320
  s_add_u32 s60, s60, s51
  s_add_u32 s60, s60, 1280
  s_lshl_b32 s51, s48, 12
  v_add_u32 v9, s51, v8
  s_lshl_b32 s52, s48, 6
  s_add_u32 s52, s52, s60
  ds_read_b128 v[208:211], v9 offset:0
  ds_read_b128 v[212:215], v9 offset:1024
  ds_read_b128 v[216:219], v9 offset:2048
  ds_read_b128 v[220:223], v9 offset:3072
  ds_read_b128 v[224:227], v9 offset:20480
  ds_read_b128 v[228:231], v9 offset:21504
  ds_read_b128 v[232:235], v9 offset:22528
  ds_read_b128 v[236:239], v9 offset:23552
  ds_read_b128 v[240:243], v9 offset:40960
  ds_read_b128 v[244:247], v9 offset:41984
  ds_read_b128 v[248:251], v9 offset:43008
  ds_read_b128 v[252:255], v9 offset:44032
  ds_read_b128 v[16:19], v9 offset:61440
  ds_read_b128 v[20:23], v9 offset:62464
  ds_read_b128 v[24:27], v9 offset:63488
  ds_read_b128 v[28:31], v9 offset:64512
  s_waitcnt lgkmcnt(0)
  v_pk_add_f32 v[208:209], v[208:209], v[224:225]
  v_pk_add_f32 v[16:17], v[16:17], v[240:241]
  v_pk_add_f32 v[210:211], v[210:211], v[226:227]
  v_pk_add_f32 v[18:19], v[18:19], v[242:243]
  v_pk_add_f32 v[212:213], v[212:213], v[228:229]
  v_pk_add_f32 v[20:21], v[20:21], v[244:245]
  v_pk_add_f32 v[214:215], v[214:215], v[230:231]
  v_pk_add_f32 v[22:23], v[22:23], v[246:247]
  v_pk_add_f32 v[216:217], v[216:217], v[232:233]
  v_pk_add_f32 v[24:25], v[24:25], v[248:249]
  v_pk_add_f32 v[218:219], v[218:219], v[234:235]
  v_pk_add_f32 v[26:27], v[26:27], v[250:251]
  v_pk_add_f32 v[220:221], v[220:221], v[236:237]
  v_pk_add_f32 v[28:29], v[28:29], v[252:253]
  v_pk_add_f32 v[222:223], v[222:223], v[238:239]
  v_pk_add_f32 v[30:31], v[30:31], v[254:255]
  v_pk_add_f32 v[208:209], v[208:209], v[16:17]
  v_pk_add_f32 v[210:211], v[210:211], v[18:19]
  v_pk_add_f32 v[212:213], v[212:213], v[20:21]
  v_pk_add_f32 v[214:215], v[214:215], v[22:23]
  v_pk_add_f32 v[216:217], v[216:217], v[24:25]
  v_pk_add_f32 v[218:219], v[218:219], v[26:27]
  v_pk_add_f32 v[220:221], v[220:221], v[28:29]
  v_pk_add_f32 v[222:223], v[222:223], v[30:31]
  v_cvt_pk_bf16_f32 v48, v208, v209
  v_cvt_pk_bf16_f32 v49, v210, v211
  v_cvt_pk_bf16_f32 v50, v212, v213
  v_cvt_pk_bf16_f32 v51, v214, v215
  v_cvt_pk_bf16_f32 v52, v216, v217
  v_cvt_pk_bf16_f32 v53, v218, v219
  v_cvt_pk_bf16_f32 v54, v220, v221
  v_cvt_pk_bf16_f32 v55, v222, v223
  s_nop 1
  v_permlane32_swap_b32 v48, v50
  v_permlane32_swap_b32 v49, v51
  v_permlane32_swap_b32 v52, v54
  v_permlane32_swap_b32 v53, v55
  buffer_store_dwordx4 v[48:51], v7, s[44:47], s52 offen
  buffer_store_dwordx4 v[52:55], v7, s[44:47], s52 offen offset:32
  s_cmp_eq_u32 s48, 0
  s_cbranch_scc0 FB_187
  v_add_u32 v9, 16384, v9
  s_add_u32 s52, s60, 256
  s_nop 1
  ds_read_b128 v[208:211], v9 offset:0
  ds_read_b128 v[212:215], v9 offset:1024
  ds_read_b128 v[216:219], v9 offset:2048
  ds_read_b128 v[220:223], v9 offset:3072
  ds_read_b128 v[224:227], v9 offset:20480
  ds_read_b128 v[228:231], v9 offset:21504
  ds_read_b128 v[232:235], v9 offset:22528
  ds_read_b128 v[236:239], v9 offset:23552
  ds_read_b128 v[240:243], v9 offset:40960
  ds_read_b128 v[244:247], v9 offset:41984
  ds_read_b128 v[248:251], v9 offset:43008
  ds_read_b128 v[252:255], v9 offset:44032
  ds_read_b128 v[16:19], v9 offset:61440
  ds_read_b128 v[20:23], v9 offset:62464
  ds_read_b128 v[24:27], v9 offset:63488
  ds_read_b128 v[28:31], v9 offset:64512
  s_waitcnt lgkmcnt(0)
  v_pk_add_f32 v[208:209], v[208:209], v[224:225]
  v_pk_add_f32 v[16:17], v[16:17], v[240:241]
  v_pk_add_f32 v[210:211], v[210:211], v[226:227]
  v_pk_add_f32 v[18:19], v[18:19], v[242:243]
  v_pk_add_f32 v[212:213], v[212:213], v[228:229]
  v_pk_add_f32 v[20:21], v[20:21], v[244:245]
  v_pk_add_f32 v[214:215], v[214:215], v[230:231]
  v_pk_add_f32 v[22:23], v[22:23], v[246:247]
  v_pk_add_f32 v[216:217], v[216:217], v[232:233]
  v_pk_add_f32 v[24:25], v[24:25], v[248:249]
  v_pk_add_f32 v[218:219], v[218:219], v[234:235]
  v_pk_add_f32 v[26:27], v[26:27], v[250:251]
  v_pk_add_f32 v[220:221], v[220:221], v[236:237]
  v_pk_add_f32 v[28:29], v[28:29], v[252:253]
  v_pk_add_f32 v[222:223], v[222:223], v[238:239]
  v_pk_add_f32 v[30:31], v[30:31], v[254:255]
  v_pk_add_f32 v[208:209], v[208:209], v[16:17]
  v_pk_add_f32 v[210:211], v[210:211], v[18:19]
  v_pk_add_f32 v[212:213], v[212:213], v[20:21]
  v_pk_add_f32 v[214:215], v[214:215], v[22:23]
  v_pk_add_f32 v[216:217], v[216:217], v[24:25]
  v_pk_add_f32 v[218:219], v[218:219], v[26:27]
  v_pk_add_f32 v[220:221], v[220:221], v[28:29]
  v_pk_add_f32 v[222:223], v[222:223], v[30:31]
  v_cvt_pk_bf16_f32 v48, v208, v209
  v_cvt_pk_bf16_f32 v49, v210, v211
  v_cvt_pk_bf16_f32 v50, v212, v213
  v_cvt_pk_bf16_f32 v51, v214, v215
  v_cvt_pk_bf16_f32 v52, v216, v217
  v_cvt_pk_bf16_f32 v53, v218, v219
  v_cvt_pk_bf16_f32 v54, v220, v221
  v_cvt_pk_bf16_f32 v55, v222, v223
  s_nop 1
  v_permlane32_swap_b32 v48, v50
  v_permlane32_swap_b32 v49, v51
  v_permlane32_swap_b32 v52, v54
  v_permlane32_swap_b32 v53, v55
  buffer_store_dwordx4 v[48:51], v7, s[44:47], s52 offen
  buffer_store_dwordx4 v[52:55], v7, s[44:47], s52 offen offset:32
FB_187:
W_LOOP_T5:
  s_branch W_LOOP
K_END_T:
  s_waitcnt vmcnt(0)
  v_lshrrev_b32 v1, 6, v0
  s_nop 0
  v_readfirstlane_b32 s48, v1
  s_nop 3
K_END:
  s_endpgm
.p2align 2
QTAB:
.long 0x70000, 0x70001, 0x70002, 0x70003, 0x70004, 0x70005, 0x70006, 0x70007
.long 0x70020, 0x70021, 0x70022, 0x70023, 0x70024, 0x70025, 0x70026, 0x70027
.long 0x70040, 0x70041, 0x70042, 0x70043, 0x70044, 0x70045, 0x70046, 0x70047
.long 0x70060, 0x70061, 0x70062, 0x70063, 0x70064, 0x70065, 0x70066, 0x70067
.long 0x40, 0x41, 0x42, 0x43, 0x44, 0x45, 0x46, 0x47
.long 0x60, 0x61, 0x62, 0x63, 0x64, 0x65, 0x66, 0x67
.long 0x80, 0x81, 0x82, 0x83, 0x84, 0x85, 0x86, 0x87
.long 0xa0, 0xa1, 0xa2, 0xa3, 0xa4, 0xa5, 0xa6, 0xa7
.long 0xc0, 0xc1, 0xc2, 0xc3, 0xc4, 0xc5, 0xc6, 0xc7
.long 0xe0, 0xe1, 0xe2, 0xe3, 0xe4, 0xe5, 0xe6, 0xe7
.long 0x100, 0x140, 0x180, 0x1c0, 0x120, 0x160, 0x1a0, 0x1e0
.long 0x101, 0x141, 0x181, 0x1c1, 0x121, 0x161, 0x1a1, 0x1e1
.long 0x102, 0x142, 0x182, 0x1c2, 0x122, 0x162, 0x1a2, 0x1e2
.long 0x103, 0x143, 0x183, 0x1c3, 0x123, 0x163, 0x1a3, 0x1e3
.long 0x104, 0x144, 0x184, 0x1c4, 0x124, 0x164, 0x1a4, 0x1e4
.long 0x105, 0x145, 0x185, 0x1c5, 0x125, 0x165, 0x1a5, 0x1e5
.long 0x106, 0x146, 0x186, 0x1c6, 0x126, 0x166, 0x1a6, 0x1e6
.long 0x107, 0x147, 0x187, 0x1c7, 0x127, 0x167, 0x1a7, 0x1e7
.long 0x20000, 0x2000a, 0x20014, 0x2001e, 0x20028, 0x20032, 0x2003c, 0x20046
.long 0x20004, 0x2000e, 0x20018, 0x20022, 0x2002c, 0x20036, 0x20040, 0x2004a
.long 0x20008, 0x20012, 0x2001c, 0x20026, 0x20030, 0x2003a, 0x20044, 0x2004e
.long 0x10000, 0x10020, 0x10040, 0x10060, 0x10001, 0x10021, 0x10041, 0x10061
.long 0x10002, 0x10022, 0x10042, 0x10062, 0x10003, 0x10023, 0x10043, 0x10063
.long 0x10004, 0x10024, 0x10044, 0x10064, 0x10005, 0x10025, 0x10045, 0x10065
.long 0x10006, 0x10026, 0x10046, 0x10066, 0x10007, 0x10027, 0x10047, 0x10067
.long 0x60004, 0x60024, 0x60044, 0x60064, 0x60084, 0x600a4, 0x30000, 0x30004
.long 0x30008, 0x3000c, 0x30010, 0x10080, 0x100a0, 0x100c0, 0x100e0, 0x10081
.long 0x100a1, 0x100c1, 0x100e1, 0x10082, 0x100a2, 0x100c2, 0x100e2, 0x10083
.long 0x100a3, 0x100c3, 0x100e3, 0x10084, 0x100a4, 0x100c4, 0x100e4, 0x10085
.long 0x100a5, 0x100c5, 0x100e5, 0x10086, 0x100a6, 0x100c6, 0x100e6, 0x10087
.long 0x100a7, 0x100c7, 0x100e7, 0x80000, 0x80001, 0x80002, 0x80003, 0x80010
.long 0x80011, 0x80012, 0x80013, 0x80020, 0x80021, 0x80022, 0x80023, 0x80030
.long 0x80031, 0x80032, 0x80033, 0x80040, 0x80041, 0x80042, 0x80043, 0x80050
.long 0x80051, 0x80052, 0x80053, 0x600c4, 0x600e4, 0x60104, 0x40000, 0x40004
.long 0x40008, 0x4000c, 0x40010, 0x40014, 0x40018, 0x4001c, 0x40020, 0x40024
.long 0x40028, 0x4002c, 0x40030, 0x40034, 0x40038, 0x4003c, 0x80060, 0x80061
.long 0x80062, 0x80063, 0x80070, 0x80071, 0x80072, 0x80073, 0x80080, 0x80081
.long 0x80082, 0x80083, 0x60124, 0x60144, 0x60164, 0x50000, 0x50004, 0x50008
.long 0x5000c, 0x50010, 0x50014, 0x50018, 0x5001c, 0x80090, 0x80091, 0x80092
.long 0x80093, 0x800a0, 0x800a1, 0x800a2, 0x800a3, 0x800b0, 0x800b1, 0x800b2
.long 0x800b3, 0x60184, 0x800c0, 0x800c1, 0x800c2, 0x800c3, 0x601a0, 0x601a1
.long 0x601a2, 0x601a3, 0x800d0, 0x800d1, 0x800d2, 0x800d3, 0x601c0, 0x601c1
.long 0x601c2, 0x601c3, 0x800e0, 0x800e1, 0x800e2, 0x800e3, 0x601e0, 0x601e1
.long 0x601e2, 0x601e3, 0x800f0, 0x800f1, 0x800f2, 0x800f3, 0xffffffff
.long 0x70008, 0x70009, 0x7000a, 0x7000b, 0x7000c, 0x7000d, 0x7000e, 0x7000f
.long 0x70028, 0x70029, 0x7002a, 0x7002b, 0x7002c, 0x7002d, 0x7002e, 0x7002f
.long 0x70048, 0x70049, 0x7004a, 0x7004b, 0x7004c, 0x7004d, 0x7004e, 0x7004f
.long 0x70068, 0x70069, 0x7006a, 0x7006b, 0x7006c, 0x7006d, 0x7006e, 0x7006f
.long 0x48, 0x49, 0x4a, 0x4b, 0x4c, 0x4d, 0x4e, 0x4f
.long 0x68, 0x69, 0x6a, 0x6b, 0x6c, 0x6d, 0x6e, 0x6f
.long 0x88, 0x89, 0x8a, 0x8b, 0x8c, 0x8d, 0x8e, 0x8f
.long 0xa8, 0xa9, 0xaa, 0xab, 0xac, 0xad, 0xae, 0xaf
.long 0xc8, 0xc9, 0xca, 0xcb, 0xcc, 0xcd, 0xce, 0xcf
.long 0xe8, 0xe9, 0xea, 0xeb, 0xec, 0xed, 0xee, 0xef
.long 0x108, 0x148, 0x188, 0x1c8, 0x128, 0x168, 0x1a8, 0x1e8
.long 0x109, 0x149, 0x189, 0x1c9, 0x129, 0x169, 0x1a9, 0x1e9
.long 0x10a, 0x14a, 0x18a, 0x1ca, 0x12a, 0x16a, 0x1aa, 0x1ea
.long 0x10b, 0x14b, 0x18b, 0x1cb, 0x12b, 0x16b, 0x1ab, 0x1eb
.long 0x10c, 0x14c, 0x18c, 0x1cc, 0x12c, 0x16c, 0x1ac, 0x1ec
.long 0x10d, 0x14d, 0x18d, 0x1cd, 0x12d, 0x16d, 0x1ad, 0x1ed
.long 0x10e, 0x14e, 0x18e, 0x1ce, 0x12e, 0x16e, 0x1ae, 0x1ee
.long 0x10f, 0x14f, 0x18f, 0x1cf, 0x12f, 0x16f, 0x1af, 0x1ef
.long 0x20001, 0x2000b, 0x20015, 0x2001f, 0x20029, 0x20033, 0x2003d, 0x20047
.long 0x20005, 0x2000f, 0x20019, 0x20023, 0x2002d, 0x20037, 0x20041, 0x2004b
.long 0x20009, 0x20013, 0x2001d, 0x20027, 0x20031, 0x2003b, 0x20045, 0x2004f
.long 0x10008, 0x10028, 0x10048, 0x10068, 0x10009, 0x10029, 0x10049, 0x10069
.long 0x1000a, 0x1002a, 0x1004a, 0x1006a, 0x1000b, 0x1002b, 0x1004b, 0x1006b
.long 0x1000c, 0x1002c, 0x1004c, 0x1006c, 0x1000d, 0x1002d, 0x1004d, 0x1006d
.long 0x1000e, 0x1002e, 0x1004e, 0x1006e, 0x1000f, 0x1002f, 0x1004f, 0x1006f
.long 0x6000c, 0x6002c, 0x6004c, 0x6006c, 0x6008c, 0x600ac, 0x30001, 0x30005
.long 0x30009, 0x3000d, 0x30011, 0x10088, 0x100a8, 0x100c8, 0x100e8, 0x10089
.long 0x100a9, 0x100c9, 0x100e9, 0x1008a, 0x100aa, 0x100ca, 0x100ea, 0x1008b
.long 0x100ab, 0x100cb, 0x100eb, 0x1008c, 0x100ac, 0x100cc, 0x100ec, 0x1008d
.long 0x100ad, 0x100cd, 0x100ed, 0x1008e, 0x100ae, 0x100ce, 0x100ee, 0x1008f
.long 0x100af, 0x100cf, 0x100ef, 0x80004, 0x80005, 0x80006, 0x80007, 0x80014
.long 0x80015, 0x80016, 0x80017, 0x80024, 0x80025, 0x80026, 0x80027, 0x80034
.long 0x80035, 0x80036, 0x80037, 0x80044, 0x80045, 0x80046, 0x80047, 0x80054
.long 0x80055, 0x80056, 0x80057, 0x600cc, 0x600ec, 0x6010c, 0x40001, 0x40005
.long 0x40009, 0x4000d, 0x40011, 0x40015, 0x40019, 0x4001d, 0x40021, 0x40025
.long 0x40029, 0x4002d, 0x40031, 0x40035, 0x40039, 0x4003d, 0x80064, 0x80065
.long 0x80066, 0x80067, 0x80074, 0x80075, 0x80076, 0x80077, 0x80084, 0x80085
.long 0x80086, 0x80087, 0x6012c, 0x6014c, 0x6016c, 0x50001, 0x50005, 0x50009
.long 0x5000d, 0x50011, 0x50015, 0x50019, 0x5001d, 0x80094, 0x80095, 0x80096
.long 0x80097, 0x800a4, 0x800a5, 0x800a6, 0x800a7, 0x800b4, 0x800b5, 0x800b6
.long 0x800b7, 0x6018c, 0x800c4, 0x800c5, 0x800c6, 0x800c7, 0x601a8, 0x601a9
.long 0x601aa, 0x601ab, 0x800d4, 0x800d5, 0x800d6, 0x800d7, 0x601c8, 0x601c9
.long 0x601ca, 0x601cb, 0x800e4, 0x800e5, 0x800e6, 0x800e7, 0x601e8, 0x601e9
.long 0x601ea, 0x601eb, 0x800f4, 0x800f5, 0x800f6, 0x800f7, 0xffffffff
.long 0x70010, 0x70011, 0x70012, 0x70013, 0x70014, 0x70015, 0x70016, 0x70017
.long 0x70030, 0x70031, 0x70032, 0x70033, 0x70034, 0x70035, 0x70036, 0x70037
.long 0x70050, 0x70051, 0x70052, 0x70053, 0x70054, 0x70055, 0x70056, 0x70057
.long 0x70070, 0x70071, 0x70072, 0x70073, 0x70074, 0x70075, 0x70076, 0x70077
.long 0x50, 0x51, 0x52, 0x53, 0x54, 0x55, 0x56, 0x57
.long 0x70, 0x71, 0x72, 0x73, 0x74, 0x75, 0x76, 0x77
.long 0x90, 0x91, 0x92, 0x93, 0x94, 0x95, 0x96, 0x97
.long 0xb0, 0xb1, 0xb2, 0xb3, 0xb4, 0xb5, 0xb6, 0xb7
.long 0xd0, 0xd1, 0xd2, 0xd3, 0xd4, 0xd5, 0xd6, 0xd7
.long 0xf0, 0xf1, 0xf2, 0xf3, 0xf4, 0xf5, 0xf6, 0xf7
.long 0x110, 0x150, 0x190, 0x1d0, 0x130, 0x170, 0x1b0, 0x1f0
.long 0x111, 0x151, 0x191, 0x1d1, 0x131, 0x171, 0x1b1, 0x1f1
.long 0x112, 0x152, 0x192, 0x1d2, 0x132, 0x172, 0x1b2, 0x1f2
.long 0x113, 0x153, 0x193, 0x1d3, 0x133, 0x173, 0x1b3, 0x1f3
.long 0x114, 0x154, 0x194, 0x1d4, 0x134, 0x174, 0x1b4, 0x1f4
.long 0x115, 0x155, 0x195, 0x1d5, 0x135, 0x175, 0x1b5, 0x1f5
.long 0x116, 0x156, 0x196, 0x1d6, 0x136, 0x176, 0x1b6, 0x1f6
.long 0x117, 0x157, 0x197, 0x1d7, 0x137, 0x177, 0x1b7, 0x1f7
.long 0x20002, 0x2000c, 0x20016, 0x20020, 0x2002a, 0x20034, 0x2003e, 0x20048
.long 0x20006, 0x20010, 0x2001a, 0x20024, 0x2002e, 0x20038, 0x20042, 0x2004c
.long 0x10010, 0x10030, 0x10050, 0x10070, 0x10011, 0x10031, 0x10051, 0x10071
.long 0x10012, 0x10032, 0x10052, 0x10072, 0x10013, 0x10033, 0x10053, 0x10073
.long 0x10014, 0x10034, 0x10054, 0x10074, 0x10015, 0x10035, 0x10055, 0x10075
.long 0x10016, 0x10036, 0x10056, 0x10076, 0x10017, 0x10037, 0x10057, 0x10077
.long 0x60014, 0x60034, 0x60054, 0x60074, 0x60094, 0x600b4, 0x30002, 0x30006
.long 0x3000a, 0x3000e, 0x30012, 0x10090, 0x100b0, 0x100d0, 0x100f0, 0x10091
.long 0x100b1, 0x100d1, 0x100f1, 0x10092, 0x100b2, 0x100d2, 0x100f2, 0x10093
.long 0x100b3, 0x100d3, 0x100f3, 0x10094, 0x100b4, 0x100d4, 0x100f4, 0x10095
.long 0x100b5, 0x100d5, 0x100f5, 0x10096, 0x100b6, 0x100d6, 0x100f6, 0x10097
.long 0x100b7, 0x100d7, 0x100f7, 0x80008, 0x80009, 0x8000a, 0x8000b, 0x80018
.long 0x80019, 0x8001a, 0x8001b, 0x80028, 0x80029, 0x8002a, 0x8002b, 0x80038
.long 0x80039, 0x8003a, 0x8003b, 0x80048, 0x80049, 0x8004a, 0x8004b, 0x80058
.long 0x80059, 0x8005a, 0x8005b, 0x600d4, 0x600f4, 0x60114, 0x40002, 0x40006
.long 0x4000a, 0x4000e, 0x40012, 0x40016, 0x4001a, 0x4001e, 0x40022, 0x40026
.long 0x4002a, 0x4002e, 0x40032, 0x40036, 0x4003a, 0x4003e, 0x80068, 0x80069
.long 0x8006a, 0x8006b, 0x80078, 0x80079, 0x8007a, 0x8007b, 0x80088, 0x80089
.long 0x8008a, 0x8008b, 0x60134, 0x60154, 0x60174, 0x50002, 0x50006, 0x5000a
.long 0x5000e, 0x50012, 0x50016, 0x5001a, 0x5001e, 0x80098, 0x80099, 0x8009a
.long 0x8009b, 0x800a8, 0x800a9, 0x800aa, 0x800ab, 0x800b8, 0x800b9, 0x800ba
.long 0x800bb, 0x60194, 0x800c8, 0x800c9, 0x800ca, 0x800cb, 0x601b0, 0x601b1
.long 0x601b2, 0x601b3, 0x800d8, 0x800d9, 0x800da, 0x800db, 0x601d0, 0x601d1
.long 0x601d2, 0x601d3, 0x800e8, 0x800e9, 0x800ea, 0x800eb, 0x601f0, 0x601f1
.long 0x601f2, 0x601f3, 0x800f8, 0x800f9, 0x800fa, 0x800fb, 0xffffffff, 0xffffffff
.long 0xffffffff, 0xffffffff, 0xffffffff, 0xffffffff, 0xffffffff, 0xffffffff, 0xffffffff
.long 0x70018, 0x70019, 0x7001a, 0x7001b, 0x7001c, 0x7001d, 0x7001e, 0x7001f
.long 0x70038, 0x70039, 0x7003a, 0x7003b, 0x7003c, 0x7003d, 0x7003e, 0x7003f
.long 0x70058, 0x70059, 0x7005a, 0x7005b, 0x7005c, 0x7005d, 0x7005e, 0x7005f
.long 0x70078, 0x70079, 0x7007a, 0x7007b, 0x7007c, 0x7007d, 0x7007e, 0x7007f
.long 0x58, 0x59, 0x5a, 0x5b, 0x5c, 0x5d, 0x5e, 0x5f
.long 0x78, 0x79, 0x7a, 0x7b, 0x7c, 0x7d, 0x7e, 0x7f
.long 0x98, 0x99, 0x9a, 0x9b, 0x9c, 0x9d, 0x9e, 0x9f
.long 0xb8, 0xb9, 0xba, 0xbb, 0xbc, 0xbd, 0xbe, 0xbf
.long 0xd8, 0xd9, 0xda, 0xdb, 0xdc, 0xdd, 0xde, 0xdf
.long 0xf8, 0xf9, 0xfa, 0xfb, 0xfc, 0xfd, 0xfe, 0xff
.long 0x118, 0x158, 0x198, 0x1d8, 0x138, 0x178, 0x1b8, 0x1f8
.long 0x119, 0x159, 0x199, 0x1d9, 0x139, 0x179, 0x1b9, 0x1f9
.long 0x11a, 0x15a, 0x19a, 0x1da, 0x13a, 0x17a, 0x1ba, 0x1fa
.long 0x11b, 0x15b, 0x19b, 0x1db, 0x13b, 0x17b, 0x1bb, 0x1fb
.long 0x11c, 0x15c, 0x19c, 0x1dc, 0x13c, 0x17c, 0x1bc, 0x1fc
.long 0x11d, 0x15d, 0x19d, 0x1dd, 0x13d, 0x17d, 0x1bd, 0x1fd
.long 0x11e, 0x15e, 0x19e, 0x1de, 0x13e, 0x17e, 0x1be, 0x1fe
.long 0x11f, 0x15f, 0x19f, 0x1df, 0x13f, 0x17f, 0x1bf, 0x1ff
.long 0x20003, 0x2000d, 0x20017, 0x20021, 0x2002b, 0x20035, 0x2003f, 0x20049
.long 0x20007, 0x20011, 0x2001b, 0x20025, 0x2002f, 0x20039, 0x20043, 0x2004d
.long 0x10018, 0x10038, 0x10058, 0x10078, 0x10019, 0x10039, 0x10059, 0x10079
.long 0x1001a, 0x1003a, 0x1005a, 0x1007a, 0x1001b, 0x1003b, 0x1005b, 0x1007b
.long 0x1001c, 0x1003c, 0x1005c, 0x1007c, 0x1001d, 0x1003d, 0x1005d, 0x1007d
.long 0x1001e, 0x1003e, 0x1005e, 0x1007e, 0x1001f, 0x1003f, 0x1005f, 0x1007f
.long 0x6001c, 0x6003c, 0x6005c, 0x6007c, 0x6009c, 0x600bc, 0x30003, 0x30007
.long 0x3000b, 0x3000f, 0x30013, 0x10098, 0x100b8, 0x100d8, 0x100f8, 0x10099
.long 0x100b9, 0x100d9, 0x100f9, 0x1009a, 0x100ba, 0x100da, 0x100fa, 0x1009b
.long 0x100bb, 0x100db, 0x100fb, 0x1009c, 0x100bc, 0x100dc, 0x100fc, 0x1009d
.long 0x100bd, 0x100dd, 0x100fd, 0x1009e, 0x100be, 0x100de, 0x100fe, 0x1009f
.long 0x100bf, 0x100df, 0x100ff, 0x8000c, 0x8000d, 0x8000e, 0x8000f, 0x8001c
.long 0x8001d, 0x8001e, 0x8001f, 0x8002c, 0x8002d, 0x8002e, 0x8002f, 0x8003c
.long 0x8003d, 0x8003e, 0x8003f, 0x8004c, 0x8004d, 0x8004e, 0x8004f, 0x8005c
.long 0x8005d, 0x8005e, 0x8005f, 0x600dc, 0x600fc, 0x6011c, 0x40003, 0x40007
.long 0x4000b, 0x4000f, 0x40013, 0x40017, 0x4001b, 0x4001f, 0x40023, 0x40027
.long 0x4002b, 0x4002f, 0x40033, 0x40037, 0x4003b, 0x4003f, 0x8006c, 0x8006d
.long 0x8006e, 0x8006f, 0x8007c, 0x8007d, 0x8007e, 0x8007f, 0x8008c, 0x8008d
.long 0x8008e, 0x8008f, 0x6013c, 0x6015c, 0x6017c, 0x50003, 0x50007, 0x5000b
.long 0x5000f, 0x50013, 0x50017, 0x5001b, 0x5001f, 0x8009c, 0x8009d, 0x8009e
.long 0x8009f, 0x800ac, 0x800ad, 0x800ae, 0x800af, 0x800bc, 0x800bd, 0x800be
.long 0x800bf, 0x6019c, 0x800cc, 0x800cd, 0x800ce, 0x800cf, 0x601b8, 0x601b9
.long 0x601ba, 0x601bb, 0x800dc, 0x800dd, 0x800de, 0x800df, 0x601d8, 0x601d9
.long 0x601da, 0x601db, 0x800ec, 0x800ed, 0x800ee, 0x800ef, 0x601f8, 0x601f9
.long 0x601fa, 0x601fb, 0x800fc, 0x800fd, 0x800fe, 0x800ff, 0xffffffff, 0xffffffff
.long 0xffffffff, 0xffffffff, 0xffffffff, 0xffffffff, 0xffffffff, 0xffffffff, 0xffffffff
.section .rodata,"a"
.p2align 6
.amdhsa_kernel concat_heads__linear_attn_block__memory_aug_recurrent_mem_tr__prompt_kernel
  .amdhsa_next_free_vgpr 512
  .amdhsa_next_free_sgpr 102
  .amdhsa_accum_offset 256
  .amdhsa_group_segment_fixed_size 0
  .amdhsa_kernarg_size 104
  .amdhsa_user_sgpr_count 2
  .amdhsa_user_sgpr_kernarg_segment_ptr 1
  .amdhsa_system_sgpr_workgroup_id_x 1
  .amdhsa_float_denorm_mode_32 3
.end_amdhsa_kernel
```
